```python
import torch

def _softmax(x, axis=-1):
    return torch.softmax(x, dim=axis)
def _gelu(x):
    return torch.nn.functional.gelu(x, approximate="tanh")
def _silu(x):
    return torch.nn.functional.silu(x)
def _sigmoid(x):
    return torch.sigmoid(x)
def _layernorm(x, axis=-1, eps=1e-5):
    m = x.mean(dim=axis, keepdim=True)
    v = x.var(dim=axis, keepdim=True, unbiased=False)
    return (x - m) / torch.sqrt(v + eps)
def _scatter_add(tgt, idx, src, axis=0):
    return tgt.clone().index_add_(axis, idx, src)
def _segment_sum(src, seg, n):
    out = torch.zeros((n,) + src.shape[1:], dtype=src.dtype)
    return out.index_add_(0, seg, src)
def _pad(x, pw):
    flat = tuple(v for pair in reversed(pw) for v in pair)
    return torch.nn.functional.pad(x, flat)

kernel_name = 'recurrent_scan__softmax_full_mha__glu_gated_bilinear__prompt'

def setup_inputs():

    _w = (lambda a: (lambda t: t.to(torch.bfloat16) if t.is_floating_point() else t)(torch.as_tensor(a)))
    def _A_setup():
        B, S, D = 1, 2048, 576
        return {
            "x": _w((lambda *s: torch.randn(*s, dtype=torch.bfloat16) * 0.05)(B, S, D)),
            "wqkv": _w((lambda *s: torch.randn(*s, dtype=torch.bfloat16) * 0.2)(D, 3 * D)),
            "wo": _w((lambda *s: torch.randn(*s, dtype=torch.bfloat16) * 0.2)(D, D)),
        }
    _A_in = _A_setup()

    def _B_setup():
        B, S, D, F = 1, 2048, 576, 4608
        return {
            "x": _w((lambda *s: torch.randn(*s, dtype=torch.bfloat16) * 0.05)(B, S, D)),
            "w_gate": _w((lambda *s: torch.randn(*s, dtype=torch.bfloat16) * 0.1)(D, F) * (D ** -0.5)),
            "w_up": _w((lambda *s: torch.randn(*s, dtype=torch.bfloat16) * 0.1)(D, F) * (D ** -0.5)),
            "w_down": _w((lambda *s: torch.randn(*s, dtype=torch.bfloat16) * 0.1)(F, D) * (F ** -0.5)),
        }
    _B_in = _B_setup()

    return {
        "A_x": _A_in["x"],
        "A_wqkv": _A_in["wqkv"],
        "A_wo": _A_in["wo"],
        "B_x": _B_in["x"],
        "B_w_gate": _B_in["w_gate"],
        "B_w_up": _B_in["w_up"],
        "B_w_down": _B_in["w_down"],
    }

def reference(A_x, A_wqkv, A_wo, B_x, B_w_gate, B_w_up, B_w_down):
    def _A_ref(x, wqkv, wo):
        B, S, D = x.shape
        H = 32; Dh = D // H
        qkv = (lambda x, *d: x.permute(*d))((x @ wqkv).reshape(B, S, 3, H, Dh), 2, 0, 3, 1, 4)
        q, k, v = qkv[0], qkv[1], qkv[2]
        scale = Dh ** -0.5
        scores = torch.einsum("bhqd,bhkd->bhqk", q, k) * scale
        p = _softmax(scores, axis=-1)
        o = torch.einsum("bhqk,bhkd->bhqd", p, v)
        return (lambda x, *d: x.permute(*d))(o, 0, 2, 1, 3).reshape(B, S, D) @ wo

    def _B_ref(x, w_gate, w_up, w_down):
        g = torch.einsum("bsd,df->bsf", x, w_gate)
        u = torch.einsum("bsd,df->bsf", x, w_up)
        h = g * u
        return torch.einsum("bsf,fd->bsd", h, w_down)

    x = A_x
    xn = _layernorm(x, axis=-1)
    s = _A_ref(xn, A_wqkv, A_wo)
    g = _silu(_B_ref(xn, B_w_gate, B_w_up, B_w_down))
    return x + s * g
```

```asm
; @launch grid=(256,1,1) block=(256,1,1) lds=163840
.amdgcn_target "amdgcn-amd-amdhsa--gfx950"
.text
.globl recurrent_scan__softmax_full_mha__glu_gated_bilinear__prompt_kernel
.p2align 8
.type recurrent_scan__softmax_full_mha__glu_gated_bilinear__prompt_kernel,@function
recurrent_scan__softmax_full_mha__glu_gated_bilinear__prompt_kernel:
    s_cmp_ge_u32 s2, 256
    s_cbranch_scc1 L_end
    s_load_dwordx4 s[4:7], s[0:1], 0
    s_load_dwordx2 s[8:9], s[0:1], 16
    s_load_dwordx4 s[12:15], s[0:1], 32
    s_load_dwordx4 s[16:19], s[0:1], 48
    s_load_dwordx4 s[20:23], s[0:1], 64
    v_lshrrev_b32 v1, 6, v0
    v_and_b32 v208, 63, v0
    v_cmp_eq_u32 vcc, 0, v0
    v_mov_b32 v2, 0x80000000
    s_nop 0
    v_cndmask_b32 v209, v2, 0, vcc
    v_readfirstlane_b32 s28, v1
    v_lshlrev_b32 v210, 4, v208
    v_mov_b32 v128, 0
    v_mov_b32 v129, 147456
    ds_write_b32 v129, v128
    ds_write_b32 v129, v128 offset:4
    ds_write_b32 v129, v128 offset:8
    s_lshr_b32 s29, s2, 5
    s_and_b32 s30, s2, 7
    s_bfe_u32 s31, s2, 0x20003
    s_waitcnt lgkmcnt(0)
    s_mov_b32 s24, s22
    s_mov_b32 s25, s23
    s_mov_b32 s26, 50733056
    s_mov_b32 s27, 0x00020000
    s_mov_b32 s88, s4
    s_mov_b32 s89, s5
    s_mov_b32 s90, 2359296
    s_mov_b32 s91, 0x00020000
    s_mov_b32 s84, s20
    s_mov_b32 s85, s21
    s_mov_b32 s86, 256
    s_mov_b32 s87, 0x00020000
    s_cmp_lg_u32 s2, 0
    s_cbranch_scc1 L_noep
    s_memrealtime s[32:33]
    s_waitcnt lgkmcnt(0)
    s_or_b32 s32, s32, 1
    v_mov_b32 v2, s32
    v_mov_b32 v3, s33
    buffer_store_dwordx2 v[2:3], v209, s[84:87], 0 offen sc1
L_noep:
    s_cmp_eq_u32 s28, 3
    s_cbranch_scc1 L_skipx
    v_and_b32 v1, 7, v208
    v_lshrrev_b32 v2, 3, v208
    s_lshl_b32 s34, s2, 3
    v_add_u32 v3, s34, v1
    v_mul_u32_u24 v4, 1152, v3
    v_lshlrev_b32 v5, 4, v2
    v_add_u32 v4, v4, v5
    s_add_u32 s34, s28, 0
    s_cmp_ge_u32 s34, 3
    s_cselect_b32 s35, 3, 0
    s_sub_u32 s34, s34, s35
    s_mul_i32 s34, s34, 384
    buffer_load_dwordx4 v[8:11], v4, s[88:91], s34 offen offset:0
    buffer_load_dwordx4 v[12:15], v4, s[88:91], s34 offen offset:128
    buffer_load_dwordx4 v[16:19], v4, s[88:91], s34 offen offset:256
    s_add_u32 s34, s28, 1
    s_cmp_ge_u32 s34, 3
    s_cselect_b32 s35, 3, 0
    s_sub_u32 s34, s34, s35
    s_mul_i32 s34, s34, 384
    buffer_load_dwordx4 v[20:23], v4, s[88:91], s34 offen offset:0
    buffer_load_dwordx4 v[24:27], v4, s[88:91], s34 offen offset:128
    buffer_load_dwordx4 v[28:31], v4, s[88:91], s34 offen offset:256
    s_add_u32 s34, s28, 2
    s_cmp_ge_u32 s34, 3
    s_cselect_b32 s35, 3, 0
    s_sub_u32 s34, s34, s35
    s_mul_i32 s34, s34, 384
    buffer_load_dwordx4 v[32:35], v4, s[88:91], s34 offen offset:0
    buffer_load_dwordx4 v[36:39], v4, s[88:91], s34 offen offset:128
    buffer_load_dwordx4 v[40:43], v4, s[88:91], s34 offen offset:256
    s_getpc_b64 s[92:93]
L_pcref:
    s_mov_b32 s94, L_codeend-L_pcref
    s_mov_b32 s95, 0x00020000
    s_lshr_b32 s34, s2, 3
    s_mul_i32 s34, s34, 3
    s_add_u32 s34, s34, s28
    s_lshl_b32 s34, s34, 10
    buffer_load_dwordx4 v[124:127], v210, s[92:95], s34 offen
    s_add_u32 s34, s34, 98304
    buffer_load_dwordx4 v[132:135], v210, s[92:95], s34 offen
L_skipx:
    s_waitcnt lgkmcnt(0)
    s_barrier
    s_mul_i32 s34, s30, 18
    s_lshl_b32 s35, s31, 2
    s_add_u32 s68, s34, s35
    s_add_u32 s69, s34, s31
    s_add_u32 s69, s69, 16
    s_cmp_lt_u32 s30, 4
    s_cselect_b32 s34, 0, 1
    s_cmp_eq_u32 s31, 2
    s_cselect_b32 s34, 0, s34
    s_mov_b32 s73, 215
    s_cmp_eq_u32 s31, 1
    s_cselect_b32 s73, 0, s73
    s_cselect_b32 s74, 44, 48
    s_lshr_b32 s35, s73, s30
    s_and_b32 s35, s35, 1
    s_sub_u32 s35, 3, s35
    s_cmp_ge_u32 s31, 2
    s_cselect_b32 s37, s34, s35
    s_cmp_eq_u32 s31, 3
    s_cselect_b32 s34, 8, 0
    s_add_u32 s34, s34, s30
    s_lshl_b32 s66, s34, 1
    s_cmp_eq_u32 s37, 1
    s_cselect_b32 s35, 12, 0
    s_cselect_b32 s36, 32, 24
    s_add_u32 s66, s66, s35
    s_add_u32 s67, s34, s36
    s_bfm_b32 s34, s30, 0
    s_and_b32 s34, s34, s73
    s_bcnt1_i32_b32 s34, s34
    s_add_u32 s34, s34, s74
    s_cmp_eq_u32 s37, 2
    s_cselect_b32 s67, s34, s67
    s_cmp_lt_u32 s28, 2
    s_cselect_b32 s52, s12, s14
    s_cselect_b32 s53, s13, s15
    s_mov_b32 s54, 5308416
    s_mov_b32 s55, 0x00020000
    s_lshl_b32 s56, s28, 10
    s_mov_b32 s40, s6
    s_mov_b32 s41, s7
    s_mov_b32 s42, 1990656
    s_mov_b32 s43, 0x00020000
    s_mov_b32 s44, s12
    s_mov_b32 s45, s13
    s_mov_b32 s46, 5308416
    s_mov_b32 s47, 0x00020000
    s_mov_b32 s48, s14
    s_mov_b32 s49, s15
    s_mov_b32 s50, 5308416
    s_mov_b32 s51, 0x00020000
    v_lshrrev_b32 v1, 2, v208
    v_and_b32 v2, 3, v208
    v_lshlrev_b32 v2, 4, v2
    v_mul_u32_u24 v211, 9216, v1
    v_add_u32 v211, v211, v2
    v_mul_u32_u24 v212, 3456, v1
    v_add_u32 v212, v212, v2
    v_and_b32 v1, 7, v1
    v_lshrrev_b32 v3, 5, v208
    v_lshlrev_b32 v3, 6, v3
    v_add_u32 v2, v2, v3
    v_mul_u32_u24 v213, 9216, v1
    v_add_u32 v213, v213, v2
    v_mul_u32_u24 v214, 3456, v1
    v_add_u32 v214, v214, v2
    s_lshl_b32 s57, s68, 6
    s_and_b32 s34, s28, 1
    s_mul_i32 s34, s34, 73728
    s_add_u32 s57, s57, s34
    s_add_u32 s57, s57, 1327104
    s_cmp_eq_u32 s28, 3
    s_cbranch_scc1 L_dma
    s_waitcnt vmcnt(10)
    v_lshlrev_b32 v48, 16, v8
    v_and_b32 v49, 0xffff0000, v8
    v_lshlrev_b32 v50, 16, v9
    v_and_b32 v51, 0xffff0000, v9
    v_lshlrev_b32 v52, 16, v10
    v_and_b32 v53, 0xffff0000, v10
    v_lshlrev_b32 v54, 16, v11
    v_and_b32 v55, 0xffff0000, v11
    s_waitcnt vmcnt(9)
    v_lshlrev_b32 v56, 16, v12
    v_and_b32 v57, 0xffff0000, v12
    v_lshlrev_b32 v58, 16, v13
    v_and_b32 v59, 0xffff0000, v13
    v_lshlrev_b32 v60, 16, v14
    v_and_b32 v61, 0xffff0000, v14
    v_lshlrev_b32 v62, 16, v15
    v_and_b32 v63, 0xffff0000, v15
    s_waitcnt vmcnt(8)
    v_lshlrev_b32 v64, 16, v16
    v_and_b32 v65, 0xffff0000, v16
    v_lshlrev_b32 v66, 16, v17
    v_and_b32 v67, 0xffff0000, v17
    v_lshlrev_b32 v68, 16, v18
    v_and_b32 v69, 0xffff0000, v18
    v_lshlrev_b32 v70, 16, v19
    v_and_b32 v71, 0xffff0000, v19
    s_waitcnt vmcnt(7)
    v_lshlrev_b32 v72, 16, v20
    v_and_b32 v73, 0xffff0000, v20
    v_lshlrev_b32 v74, 16, v21
    v_and_b32 v75, 0xffff0000, v21
    v_lshlrev_b32 v76, 16, v22
    v_and_b32 v77, 0xffff0000, v22
    v_lshlrev_b32 v78, 16, v23
    v_and_b32 v79, 0xffff0000, v23
    s_waitcnt vmcnt(6)
    v_lshlrev_b32 v80, 16, v24
    v_and_b32 v81, 0xffff0000, v24
    v_lshlrev_b32 v82, 16, v25
    v_and_b32 v83, 0xffff0000, v25
    v_lshlrev_b32 v84, 16, v26
    v_and_b32 v85, 0xffff0000, v26
    v_lshlrev_b32 v86, 16, v27
    v_and_b32 v87, 0xffff0000, v27
    s_waitcnt vmcnt(5)
    v_lshlrev_b32 v88, 16, v28
    v_and_b32 v89, 0xffff0000, v28
    v_lshlrev_b32 v90, 16, v29
    v_and_b32 v91, 0xffff0000, v29
    v_lshlrev_b32 v92, 16, v30
    v_and_b32 v93, 0xffff0000, v30
    v_lshlrev_b32 v94, 16, v31
    v_and_b32 v95, 0xffff0000, v31
    s_waitcnt vmcnt(4)
    v_lshlrev_b32 v96, 16, v32
    v_and_b32 v97, 0xffff0000, v32
    v_lshlrev_b32 v98, 16, v33
    v_and_b32 v99, 0xffff0000, v33
    v_lshlrev_b32 v100, 16, v34
    v_and_b32 v101, 0xffff0000, v34
    v_lshlrev_b32 v102, 16, v35
    v_and_b32 v103, 0xffff0000, v35
    s_waitcnt vmcnt(3)
    v_lshlrev_b32 v104, 16, v36
    v_and_b32 v105, 0xffff0000, v36
    v_lshlrev_b32 v106, 16, v37
    v_and_b32 v107, 0xffff0000, v37
    v_lshlrev_b32 v108, 16, v38
    v_and_b32 v109, 0xffff0000, v38
    v_lshlrev_b32 v110, 16, v39
    v_and_b32 v111, 0xffff0000, v39
    s_waitcnt vmcnt(2)
    v_lshlrev_b32 v112, 16, v40
    v_and_b32 v113, 0xffff0000, v40
    v_lshlrev_b32 v114, 16, v41
    v_and_b32 v115, 0xffff0000, v41
    v_lshlrev_b32 v116, 16, v42
    v_and_b32 v117, 0xffff0000, v42
    v_lshlrev_b32 v118, 16, v43
    v_and_b32 v119, 0xffff0000, v43
    buffer_load_dwordx2 v[120:121], v128, s[84:87], 0 offen sc1
    v_pk_add_f32 v[4:5], v[48:49], v[50:51]
    v_pk_add_f32 v[6:7], v[52:53], v[54:55]
    v_pk_add_f32 v[4:5], v[4:5], v[56:57]
    v_pk_add_f32 v[6:7], v[6:7], v[58:59]
    v_pk_add_f32 v[4:5], v[4:5], v[60:61]
    v_pk_add_f32 v[6:7], v[6:7], v[62:63]
    v_pk_add_f32 v[4:5], v[4:5], v[64:65]
    v_pk_add_f32 v[6:7], v[6:7], v[66:67]
    v_pk_add_f32 v[4:5], v[4:5], v[68:69]
    v_pk_add_f32 v[6:7], v[6:7], v[70:71]
    v_pk_add_f32 v[4:5], v[4:5], v[72:73]
    v_pk_add_f32 v[6:7], v[6:7], v[74:75]
    v_pk_add_f32 v[4:5], v[4:5], v[76:77]
    v_pk_add_f32 v[6:7], v[6:7], v[78:79]
    v_pk_add_f32 v[4:5], v[4:5], v[80:81]
    v_pk_add_f32 v[6:7], v[6:7], v[82:83]
    v_pk_add_f32 v[4:5], v[4:5], v[84:85]
    v_pk_add_f32 v[6:7], v[6:7], v[86:87]
    v_pk_add_f32 v[4:5], v[4:5], v[88:89]
    v_pk_add_f32 v[6:7], v[6:7], v[90:91]
    v_pk_add_f32 v[4:5], v[4:5], v[92:93]
    v_pk_add_f32 v[6:7], v[6:7], v[94:95]
    v_pk_add_f32 v[4:5], v[4:5], v[96:97]
    v_pk_add_f32 v[6:7], v[6:7], v[98:99]
    v_pk_add_f32 v[4:5], v[4:5], v[100:101]
    v_pk_add_f32 v[6:7], v[6:7], v[102:103]
    v_pk_add_f32 v[4:5], v[4:5], v[104:105]
    v_pk_add_f32 v[6:7], v[6:7], v[106:107]
    v_pk_add_f32 v[4:5], v[4:5], v[108:109]
    v_pk_add_f32 v[6:7], v[6:7], v[110:111]
    v_pk_add_f32 v[4:5], v[4:5], v[112:113]
    v_pk_add_f32 v[6:7], v[6:7], v[114:115]
    v_pk_add_f32 v[4:5], v[4:5], v[116:117]
    v_pk_add_f32 v[6:7], v[6:7], v[118:119]
    v_pk_add_f32 v[4:5], v[4:5], v[6:7]
    v_add_f32 v4, v4, v5
    s_nop 1
    v_add_f32_dpp v4, v4, v4 row_ror:8 row_mask:0xf bank_mask:0xf
    v_mov_b32 v5, v4
    s_nop 1
    v_permlane16_swap_b32 v4, v5
    v_add_f32 v4, v4, v5
    v_mov_b32 v5, v4
    s_nop 1
    v_permlane32_swap_b32 v4, v5
    v_add_f32 v4, v4, v5
    v_mul_f32 v4, 0x3ae38e39, v4
    v_pk_add_f32 v[44:45], v[48:49], v[4:5] op_sel_hi:[1,0] neg_lo:[0,1] neg_hi:[0,1]
    v_pk_mul_f32 v[6:7], v[44:45], v[44:45]
    v_pk_add_f32 v[46:47], v[50:51], v[4:5] op_sel_hi:[1,0] neg_lo:[0,1] neg_hi:[0,1]
    v_pk_mul_f32 v[122:123], v[46:47], v[46:47]
    v_pk_add_f32 v[44:45], v[52:53], v[4:5] op_sel_hi:[1,0] neg_lo:[0,1] neg_hi:[0,1]
    v_pk_fma_f32 v[6:7], v[44:45], v[44:45], v[6:7]
    v_pk_add_f32 v[46:47], v[54:55], v[4:5] op_sel_hi:[1,0] neg_lo:[0,1] neg_hi:[0,1]
    v_pk_fma_f32 v[122:123], v[46:47], v[46:47], v[122:123]
    v_pk_add_f32 v[44:45], v[56:57], v[4:5] op_sel_hi:[1,0] neg_lo:[0,1] neg_hi:[0,1]
    v_pk_fma_f32 v[6:7], v[44:45], v[44:45], v[6:7]
    v_pk_add_f32 v[46:47], v[58:59], v[4:5] op_sel_hi:[1,0] neg_lo:[0,1] neg_hi:[0,1]
    v_pk_fma_f32 v[122:123], v[46:47], v[46:47], v[122:123]
    v_pk_add_f32 v[44:45], v[60:61], v[4:5] op_sel_hi:[1,0] neg_lo:[0,1] neg_hi:[0,1]
    v_pk_fma_f32 v[6:7], v[44:45], v[44:45], v[6:7]
    v_pk_add_f32 v[46:47], v[62:63], v[4:5] op_sel_hi:[1,0] neg_lo:[0,1] neg_hi:[0,1]
    v_pk_fma_f32 v[122:123], v[46:47], v[46:47], v[122:123]
    v_pk_add_f32 v[44:45], v[64:65], v[4:5] op_sel_hi:[1,0] neg_lo:[0,1] neg_hi:[0,1]
    v_pk_fma_f32 v[6:7], v[44:45], v[44:45], v[6:7]
    v_pk_add_f32 v[46:47], v[66:67], v[4:5] op_sel_hi:[1,0] neg_lo:[0,1] neg_hi:[0,1]
    v_pk_fma_f32 v[122:123], v[46:47], v[46:47], v[122:123]
    v_pk_add_f32 v[44:45], v[68:69], v[4:5] op_sel_hi:[1,0] neg_lo:[0,1] neg_hi:[0,1]
    v_pk_fma_f32 v[6:7], v[44:45], v[44:45], v[6:7]
    v_pk_add_f32 v[46:47], v[70:71], v[4:5] op_sel_hi:[1,0] neg_lo:[0,1] neg_hi:[0,1]
    v_pk_fma_f32 v[122:123], v[46:47], v[46:47], v[122:123]
    v_pk_add_f32 v[44:45], v[72:73], v[4:5] op_sel_hi:[1,0] neg_lo:[0,1] neg_hi:[0,1]
    v_pk_fma_f32 v[6:7], v[44:45], v[44:45], v[6:7]
    v_pk_add_f32 v[46:47], v[74:75], v[4:5] op_sel_hi:[1,0] neg_lo:[0,1] neg_hi:[0,1]
    v_pk_fma_f32 v[122:123], v[46:47], v[46:47], v[122:123]
    v_pk_add_f32 v[44:45], v[76:77], v[4:5] op_sel_hi:[1,0] neg_lo:[0,1] neg_hi:[0,1]
    v_pk_fma_f32 v[6:7], v[44:45], v[44:45], v[6:7]
    v_pk_add_f32 v[46:47], v[78:79], v[4:5] op_sel_hi:[1,0] neg_lo:[0,1] neg_hi:[0,1]
    v_pk_fma_f32 v[122:123], v[46:47], v[46:47], v[122:123]
    v_pk_add_f32 v[44:45], v[80:81], v[4:5] op_sel_hi:[1,0] neg_lo:[0,1] neg_hi:[0,1]
    v_pk_fma_f32 v[6:7], v[44:45], v[44:45], v[6:7]
    v_pk_add_f32 v[46:47], v[82:83], v[4:5] op_sel_hi:[1,0] neg_lo:[0,1] neg_hi:[0,1]
    v_pk_fma_f32 v[122:123], v[46:47], v[46:47], v[122:123]
    v_pk_add_f32 v[44:45], v[84:85], v[4:5] op_sel_hi:[1,0] neg_lo:[0,1] neg_hi:[0,1]
    v_pk_fma_f32 v[6:7], v[44:45], v[44:45], v[6:7]
    v_pk_add_f32 v[46:47], v[86:87], v[4:5] op_sel_hi:[1,0] neg_lo:[0,1] neg_hi:[0,1]
    v_pk_fma_f32 v[122:123], v[46:47], v[46:47], v[122:123]
    v_pk_add_f32 v[44:45], v[88:89], v[4:5] op_sel_hi:[1,0] neg_lo:[0,1] neg_hi:[0,1]
    v_pk_fma_f32 v[6:7], v[44:45], v[44:45], v[6:7]
    v_pk_add_f32 v[46:47], v[90:91], v[4:5] op_sel_hi:[1,0] neg_lo:[0,1] neg_hi:[0,1]
    v_pk_fma_f32 v[122:123], v[46:47], v[46:47], v[122:123]
    v_pk_add_f32 v[44:45], v[92:93], v[4:5] op_sel_hi:[1,0] neg_lo:[0,1] neg_hi:[0,1]
    v_pk_fma_f32 v[6:7], v[44:45], v[44:45], v[6:7]
    v_pk_add_f32 v[46:47], v[94:95], v[4:5] op_sel_hi:[1,0] neg_lo:[0,1] neg_hi:[0,1]
    v_pk_fma_f32 v[122:123], v[46:47], v[46:47], v[122:123]
    v_pk_add_f32 v[44:45], v[96:97], v[4:5] op_sel_hi:[1,0] neg_lo:[0,1] neg_hi:[0,1]
    v_pk_fma_f32 v[6:7], v[44:45], v[44:45], v[6:7]
    v_pk_add_f32 v[46:47], v[98:99], v[4:5] op_sel_hi:[1,0] neg_lo:[0,1] neg_hi:[0,1]
    v_pk_fma_f32 v[122:123], v[46:47], v[46:47], v[122:123]
    v_pk_add_f32 v[44:45], v[100:101], v[4:5] op_sel_hi:[1,0] neg_lo:[0,1] neg_hi:[0,1]
    v_pk_fma_f32 v[6:7], v[44:45], v[44:45], v[6:7]
    v_pk_add_f32 v[46:47], v[102:103], v[4:5] op_sel_hi:[1,0] neg_lo:[0,1] neg_hi:[0,1]
    v_pk_fma_f32 v[122:123], v[46:47], v[46:47], v[122:123]
    v_pk_add_f32 v[44:45], v[104:105], v[4:5] op_sel_hi:[1,0] neg_lo:[0,1] neg_hi:[0,1]
    v_pk_fma_f32 v[6:7], v[44:45], v[44:45], v[6:7]
    v_pk_add_f32 v[46:47], v[106:107], v[4:5] op_sel_hi:[1,0] neg_lo:[0,1] neg_hi:[0,1]
    v_pk_fma_f32 v[122:123], v[46:47], v[46:47], v[122:123]
    v_pk_add_f32 v[44:45], v[108:109], v[4:5] op_sel_hi:[1,0] neg_lo:[0,1] neg_hi:[0,1]
    v_pk_fma_f32 v[6:7], v[44:45], v[44:45], v[6:7]
    v_pk_add_f32 v[46:47], v[110:111], v[4:5] op_sel_hi:[1,0] neg_lo:[0,1] neg_hi:[0,1]
    v_pk_fma_f32 v[122:123], v[46:47], v[46:47], v[122:123]
    v_pk_add_f32 v[44:45], v[112:113], v[4:5] op_sel_hi:[1,0] neg_lo:[0,1] neg_hi:[0,1]
    v_pk_fma_f32 v[6:7], v[44:45], v[44:45], v[6:7]
    v_pk_add_f32 v[46:47], v[114:115], v[4:5] op_sel_hi:[1,0] neg_lo:[0,1] neg_hi:[0,1]
    v_pk_fma_f32 v[122:123], v[46:47], v[46:47], v[122:123]
    v_pk_add_f32 v[44:45], v[116:117], v[4:5] op_sel_hi:[1,0] neg_lo:[0,1] neg_hi:[0,1]
    v_pk_fma_f32 v[6:7], v[44:45], v[44:45], v[6:7]
    v_pk_add_f32 v[46:47], v[118:119], v[4:5] op_sel_hi:[1,0] neg_lo:[0,1] neg_hi:[0,1]
    v_pk_fma_f32 v[122:123], v[46:47], v[46:47], v[122:123]
    v_pk_add_f32 v[6:7], v[6:7], v[122:123]
    v_add_f32 v6, v6, v7
    s_nop 1
    v_add_f32_dpp v6, v6, v6 row_ror:8 row_mask:0xf bank_mask:0xf
    v_mov_b32 v7, v6
    s_nop 1
    v_permlane16_swap_b32 v6, v7
    v_add_f32 v6, v6, v7
    v_mov_b32 v7, v6
    s_nop 1
    v_permlane32_swap_b32 v6, v7
    v_add_f32 v6, v6, v7
    v_mul_f32 v6, 0x3ae38e39, v6
    v_cvt_pk_bf16_f32 v7, v4, v6
    v_lshlrev_b32 v4, 16, v7
    v_and_b32 v6, 0xffff0000, v7
    v_add_f32 v6, 0x3727c5ac, v6
    v_cvt_pk_bf16_f32 v7, v6, v6
    v_lshlrev_b32 v6, 16, v7
    v_sqrt_f32 v6, v6
    s_nop 0
    v_cvt_pk_bf16_f32 v7, v6, v6
    v_lshlrev_b32 v6, 16, v7
    v_rcp_f32 v6, v6
    v_pk_add_f32 v[48:49], v[48:49], v[4:5] op_sel_hi:[1,0] neg_lo:[0,1] neg_hi:[0,1]
    v_cvt_pk_bf16_f32 v7, v48, v49
    v_lshlrev_b32 v48, 16, v7
    v_and_b32 v49, 0xffff0000, v7
    v_pk_mul_f32 v[48:49], v[48:49], v[6:7] op_sel_hi:[1,0]
    v_cvt_pk_bf16_f32 v8, v48, v49
    v_pk_add_f32 v[50:51], v[50:51], v[4:5] op_sel_hi:[1,0] neg_lo:[0,1] neg_hi:[0,1]
    v_cvt_pk_bf16_f32 v7, v50, v51
    v_lshlrev_b32 v50, 16, v7
    v_and_b32 v51, 0xffff0000, v7
    v_pk_mul_f32 v[50:51], v[50:51], v[6:7] op_sel_hi:[1,0]
    v_cvt_pk_bf16_f32 v9, v50, v51
    v_pk_add_f32 v[52:53], v[52:53], v[4:5] op_sel_hi:[1,0] neg_lo:[0,1] neg_hi:[0,1]
    v_cvt_pk_bf16_f32 v7, v52, v53
    v_lshlrev_b32 v52, 16, v7
    v_and_b32 v53, 0xffff0000, v7
    v_pk_mul_f32 v[52:53], v[52:53], v[6:7] op_sel_hi:[1,0]
    v_cvt_pk_bf16_f32 v10, v52, v53
    v_pk_add_f32 v[54:55], v[54:55], v[4:5] op_sel_hi:[1,0] neg_lo:[0,1] neg_hi:[0,1]
    v_cvt_pk_bf16_f32 v7, v54, v55
    v_lshlrev_b32 v54, 16, v7
    v_and_b32 v55, 0xffff0000, v7
    v_pk_mul_f32 v[54:55], v[54:55], v[6:7] op_sel_hi:[1,0]
    v_cvt_pk_bf16_f32 v11, v54, v55
    v_pk_add_f32 v[56:57], v[56:57], v[4:5] op_sel_hi:[1,0] neg_lo:[0,1] neg_hi:[0,1]
    v_cvt_pk_bf16_f32 v7, v56, v57
    v_lshlrev_b32 v56, 16, v7
    v_and_b32 v57, 0xffff0000, v7
    v_pk_mul_f32 v[56:57], v[56:57], v[6:7] op_sel_hi:[1,0]
    v_cvt_pk_bf16_f32 v12, v56, v57
    v_pk_add_f32 v[58:59], v[58:59], v[4:5] op_sel_hi:[1,0] neg_lo:[0,1] neg_hi:[0,1]
    v_cvt_pk_bf16_f32 v7, v58, v59
    v_lshlrev_b32 v58, 16, v7
    v_and_b32 v59, 0xffff0000, v7
    v_pk_mul_f32 v[58:59], v[58:59], v[6:7] op_sel_hi:[1,0]
    v_cvt_pk_bf16_f32 v13, v58, v59
    v_pk_add_f32 v[60:61], v[60:61], v[4:5] op_sel_hi:[1,0] neg_lo:[0,1] neg_hi:[0,1]
    v_cvt_pk_bf16_f32 v7, v60, v61
    v_lshlrev_b32 v60, 16, v7
    v_and_b32 v61, 0xffff0000, v7
    v_pk_mul_f32 v[60:61], v[60:61], v[6:7] op_sel_hi:[1,0]
    v_cvt_pk_bf16_f32 v14, v60, v61
    v_pk_add_f32 v[62:63], v[62:63], v[4:5] op_sel_hi:[1,0] neg_lo:[0,1] neg_hi:[0,1]
    v_cvt_pk_bf16_f32 v7, v62, v63
    v_lshlrev_b32 v62, 16, v7
    v_and_b32 v63, 0xffff0000, v7
    v_pk_mul_f32 v[62:63], v[62:63], v[6:7] op_sel_hi:[1,0]
    v_cvt_pk_bf16_f32 v15, v62, v63
    v_pk_add_f32 v[64:65], v[64:65], v[4:5] op_sel_hi:[1,0] neg_lo:[0,1] neg_hi:[0,1]
    v_cvt_pk_bf16_f32 v7, v64, v65
    v_lshlrev_b32 v64, 16, v7
    v_and_b32 v65, 0xffff0000, v7
    v_pk_mul_f32 v[64:65], v[64:65], v[6:7] op_sel_hi:[1,0]
    v_cvt_pk_bf16_f32 v16, v64, v65
    v_pk_add_f32 v[66:67], v[66:67], v[4:5] op_sel_hi:[1,0] neg_lo:[0,1] neg_hi:[0,1]
    v_cvt_pk_bf16_f32 v7, v66, v67
    v_lshlrev_b32 v66, 16, v7
    v_and_b32 v67, 0xffff0000, v7
    v_pk_mul_f32 v[66:67], v[66:67], v[6:7] op_sel_hi:[1,0]
    v_cvt_pk_bf16_f32 v17, v66, v67
    v_pk_add_f32 v[68:69], v[68:69], v[4:5] op_sel_hi:[1,0] neg_lo:[0,1] neg_hi:[0,1]
    v_cvt_pk_bf16_f32 v7, v68, v69
    v_lshlrev_b32 v68, 16, v7
    v_and_b32 v69, 0xffff0000, v7
    v_pk_mul_f32 v[68:69], v[68:69], v[6:7] op_sel_hi:[1,0]
    v_cvt_pk_bf16_f32 v18, v68, v69
    v_pk_add_f32 v[70:71], v[70:71], v[4:5] op_sel_hi:[1,0] neg_lo:[0,1] neg_hi:[0,1]
    v_cvt_pk_bf16_f32 v7, v70, v71
    v_lshlrev_b32 v70, 16, v7
    v_and_b32 v71, 0xffff0000, v7
    v_pk_mul_f32 v[70:71], v[70:71], v[6:7] op_sel_hi:[1,0]
    v_cvt_pk_bf16_f32 v19, v70, v71
    s_lshr_b32 s34, s2, 2
    s_mul_i32 s34, s34, 36864
    s_and_b32 s35, s2, 3
    s_lshl_b32 s35, s35, 7
    s_add_u32 s34, s34, s35
    s_mul_i32 s35, s28, 12288
    s_add_u32 s34, s34, s35
    s_add_u32 s34, s34, 0
    v_lshrrev_b32 v2, 3, v208
    v_and_b32 v1, 7, v208
    v_lshrrev_b32 v4, 1, v2
    v_lshlrev_b32 v4, 10, v4
    v_and_b32 v5, 1, v2
    v_lshlrev_b32 v5, 9, v5
    v_add_u32 v4, v4, v5
    v_lshlrev_b32 v5, 4, v1
    v_add_u32 v4, v4, v5
    buffer_store_dwordx4 v[8:11], v4, s[24:27], s34 offen sc1
    s_add_u32 s34, s34, 4096
    buffer_store_dwordx4 v[12:15], v4, s[24:27], s34 offen sc1
    s_add_u32 s34, s34, 4096
    buffer_store_dwordx4 v[16:19], v4, s[24:27], s34 offen sc1
    s_waitcnt vmcnt(3)
    v_readfirstlane_b32 s32, v120
    v_readfirstlane_b32 s33, v121
    s_cmp_lg_u32 s32, 0
    s_cbranch_scc1 L_gotepa
    s_mov_b32 s36, 0
L_eppolla:
    buffer_load_dwordx2 v[120:121], v128, s[84:87], 0 offen sc1
    s_waitcnt vmcnt(0)
    v_readfirstlane_b32 s32, v120
    v_readfirstlane_b32 s33, v121
    s_add_u32 s36, s36, 1
    s_cmp_lg_u32 s32, 0
    s_cbranch_scc1 L_gotepa
    s_cmp_lt_u32 s36, 0x20000
    s_cbranch_scc1 L_eppolla
L_gotepa:
    v_mov_b32 v4, s32
    v_mov_b32 v5, s33
    v_cmp_eq_u32 vcc, 0, v208
    s_nop 1
    v_cndmask_b32 v7, 0, 1, vcc
    s_waitcnt vmcnt(0)
    ds_add_rtn_u32 v6, v129, v7 offset:4
    s_lshl_b32 s34, s2, 7
    s_add_u32 s34, s34, 49684480
    s_waitcnt lgkmcnt(0)
    v_readfirstlane_b32 s35, v6
    v_mov_b32 v6, 0x80000000
    s_cmp_eq_u32 s35, 2
    s_cbranch_scc0 L_noflag
    v_cndmask_b32 v6, v6, 0, vcc
    buffer_store_dwordx2 v[4:5], v6, s[24:27], s34 offen sc1
L_noflag:
    s_cmp_ge_u32 s37, 2
    s_cbranch_scc1 L_dma_s
    s_lshl_b32 s70, s66, 6
    s_mul_i32 s73, s28, 331776
    s_add_u32 s70, s70, s73
    s_mul_i32 s74, s28, 12288
    s_add_u32 m0, s74, 55296
    s_add_u32 s35, s70, 995328
    buffer_load_dwordx4 v214, s[40:43], s35 offen lds
    s_add_u32 m0, s74, 56320
    s_add_u32 s35, s70, 1022976
    buffer_load_dwordx4 v214, s[40:43], s35 offen lds
    s_add_u32 m0, s74, 57344
    s_add_u32 s35, s70, 1050624
    buffer_load_dwordx4 v214, s[40:43], s35 offen lds
    s_add_u32 m0, s74, 58368
    s_add_u32 s35, s70, 1078272
    buffer_load_dwordx4 v214, s[40:43], s35 offen lds
    s_add_u32 m0, s74, 59392
    s_add_u32 s35, s70, 1105920
    buffer_load_dwordx4 v214, s[40:43], s35 offen lds
    s_add_u32 m0, s74, 60416
    s_add_u32 s35, s70, 1133568
    buffer_load_dwordx4 v214, s[40:43], s35 offen lds
    s_add_u32 m0, s74, 61440
    s_add_u32 s35, s70, 1161216
    buffer_load_dwordx4 v214, s[40:43], s35 offen lds
    s_add_u32 m0, s74, 62464
    s_add_u32 s35, s70, 1188864
    buffer_load_dwordx4 v214, s[40:43], s35 offen lds
    s_add_u32 m0, s74, 63488
    s_add_u32 s35, s70, 1216512
    buffer_load_dwordx4 v214, s[40:43], s35 offen lds
    s_add_u32 m0, s74, 64512
    s_add_u32 s35, s70, 1244160
    buffer_load_dwordx4 v214, s[40:43], s35 offen lds
    s_add_u32 m0, s74, 65536
    s_add_u32 s35, s70, 1271808
    buffer_load_dwordx4 v214, s[40:43], s35 offen lds
    s_add_u32 m0, s74, 66560
    s_add_u32 s35, s70, 1299456
    buffer_load_dwordx4 v214, s[40:43], s35 offen lds
    s_lshl_b32 s70, s67, 6
    s_mul_i32 s73, s28, 331776
    s_add_u32 s70, s70, s73
    s_mul_i32 s74, s28, 6144
    s_add_u32 m0, s74, 92160
    s_add_u32 s35, s70, 995328
    buffer_load_dwordx4 v212, s[40:43], s35 offen lds
    s_add_u32 m0, s74, 93184
    s_add_u32 s35, s70, 1050624
    buffer_load_dwordx4 v212, s[40:43], s35 offen lds
    s_add_u32 m0, s74, 94208
    s_add_u32 s35, s70, 1105920
    buffer_load_dwordx4 v212, s[40:43], s35 offen lds
    s_add_u32 m0, s74, 95232
    s_add_u32 s35, s70, 1161216
    buffer_load_dwordx4 v212, s[40:43], s35 offen lds
    s_add_u32 m0, s74, 96256
    s_add_u32 s35, s70, 1216512
    buffer_load_dwordx4 v212, s[40:43], s35 offen lds
    s_add_u32 m0, s74, 97280
    s_add_u32 s35, s70, 1271808
    buffer_load_dwordx4 v212, s[40:43], s35 offen lds
    s_branch L_dma_j0
L_dma_s:
    s_lshl_b32 s70, s69, 6
    s_mul_i32 s73, s28, 884736
    s_add_u32 s70, s70, s73
    s_mul_i32 s74, s28, 6144
    s_add_u32 m0, s74, 55296
    s_add_u32 s35, s70, 2654208
    buffer_load_dwordx4 v211, s[44:47], s35 offen lds
    s_add_u32 m0, s74, 56320
    s_add_u32 s35, s70, 2801664
    buffer_load_dwordx4 v211, s[44:47], s35 offen lds
    s_add_u32 m0, s74, 57344
    s_add_u32 s35, s70, 2949120
    buffer_load_dwordx4 v211, s[44:47], s35 offen lds
    s_add_u32 m0, s74, 58368
    s_add_u32 s35, s70, 3096576
    buffer_load_dwordx4 v211, s[44:47], s35 offen lds
    s_add_u32 m0, s74, 59392
    s_add_u32 s35, s70, 3244032
    buffer_load_dwordx4 v211, s[44:47], s35 offen lds
    s_add_u32 m0, s74, 60416
    s_add_u32 s35, s70, 3391488
    buffer_load_dwordx4 v211, s[44:47], s35 offen lds
    s_add_u32 m0, s74, 73728
    s_add_u32 s35, s70, 2654208
    buffer_load_dwordx4 v211, s[48:51], s35 offen lds
    s_add_u32 m0, s74, 74752
    s_add_u32 s35, s70, 2801664
    buffer_load_dwordx4 v211, s[48:51], s35 offen lds
    s_add_u32 m0, s74, 75776
    s_add_u32 s35, s70, 2949120
    buffer_load_dwordx4 v211, s[48:51], s35 offen lds
    s_add_u32 m0, s74, 76800
    s_add_u32 s35, s70, 3096576
    buffer_load_dwordx4 v211, s[48:51], s35 offen lds
    s_add_u32 m0, s74, 77824
    s_add_u32 s35, s70, 3244032
    buffer_load_dwordx4 v211, s[48:51], s35 offen lds
    s_add_u32 m0, s74, 78848
    s_add_u32 s35, s70, 3391488
    buffer_load_dwordx4 v211, s[48:51], s35 offen lds
    s_cmp_eq_u32 s37, 3
    s_cbranch_scc1 L_dma_j0
    s_lshl_b32 s70, s67, 6
    s_mul_i32 s73, s28, 331776
    s_add_u32 s70, s70, s73
    s_add_u32 m0, s74, 92160
    s_add_u32 s35, s70, 995328
    buffer_load_dwordx4 v212, s[40:43], s35 offen lds
    s_add_u32 m0, s74, 93184
    s_add_u32 s35, s70, 1050624
    buffer_load_dwordx4 v212, s[40:43], s35 offen lds
    s_add_u32 m0, s74, 94208
    s_add_u32 s35, s70, 1105920
    buffer_load_dwordx4 v212, s[40:43], s35 offen lds
    s_add_u32 m0, s74, 95232
    s_add_u32 s35, s70, 1161216
    buffer_load_dwordx4 v212, s[40:43], s35 offen lds
    s_add_u32 m0, s74, 96256
    s_add_u32 s35, s70, 1216512
    buffer_load_dwordx4 v212, s[40:43], s35 offen lds
    s_add_u32 m0, s74, 97280
    s_add_u32 s35, s70, 1271808
    buffer_load_dwordx4 v212, s[40:43], s35 offen lds
L_dma_j0:
    s_lshl_b32 s70, s68, 6
    s_mul_i32 s73, s28, 442368
    s_add_u32 s70, s70, s73
    s_mul_i32 s74, s28, 12288
    s_add_u32 m0, s74, 110592
    s_add_u32 s35, s70, 0
    buffer_load_dwordx4 v213, s[44:47], s35 offen lds
    s_add_u32 m0, s74, 111616
    s_add_u32 s35, s70, 73728
    buffer_load_dwordx4 v213, s[44:47], s35 offen lds
    s_add_u32 m0, s74, 112640
    s_add_u32 s35, s70, 0
    buffer_load_dwordx4 v213, s[48:51], s35 offen lds
    s_add_u32 m0, s74, 113664
    s_add_u32 s35, s70, 73728
    buffer_load_dwordx4 v213, s[48:51], s35 offen lds
    s_add_u32 m0, s74, 114688
    s_add_u32 s35, s70, 147456
    buffer_load_dwordx4 v213, s[44:47], s35 offen lds
    s_add_u32 m0, s74, 115712
    s_add_u32 s35, s70, 221184
    buffer_load_dwordx4 v213, s[44:47], s35 offen lds
    s_add_u32 m0, s74, 116736
    s_add_u32 s35, s70, 147456
    buffer_load_dwordx4 v213, s[48:51], s35 offen lds
    s_add_u32 m0, s74, 117760
    s_add_u32 s35, s70, 221184
    buffer_load_dwordx4 v213, s[48:51], s35 offen lds
    s_add_u32 m0, s74, 118784
    s_add_u32 s35, s70, 294912
    buffer_load_dwordx4 v213, s[44:47], s35 offen lds
    s_add_u32 m0, s74, 119808
    s_add_u32 s35, s70, 368640
    buffer_load_dwordx4 v213, s[44:47], s35 offen lds
    s_add_u32 m0, s74, 120832
    s_add_u32 s35, s70, 294912
    buffer_load_dwordx4 v213, s[48:51], s35 offen lds
    s_add_u32 m0, s74, 121856
    s_add_u32 s35, s70, 368640
    buffer_load_dwordx4 v213, s[48:51], s35 offen lds
    s_cmp_eq_u32 s28, 2
    s_cselect_b32 s36, 1, 0
    v_lshrrev_b32 v4, 1, v208
    v_mul_u32_u24 v4, 9216, v4
    v_and_b32 v5, 1, v208
    v_lshl_add_u32 v4, v5, 7, v4
    s_mul_i32 s34, s29, 72
    s_and_b32 s35, s28, 1
    s_mul_i32 s35, s35, 36
    s_add_u32 s34, s34, s35
    s_mul_i32 s34, s34, 9216
    s_lshl_b32 s35, s68, 6
    s_add_u32 s34, s34, s35
    buffer_load_dword v8, v4, s[52:55], s34 offen
    s_add_u32 s34, s34, 294912
    buffer_load_dword v9, v4, s[52:55], s34 offen
    s_cmp_lg_u32 s28, 2
    s_cbranch_scc1 L_notch2
    s_add_u32 s34, s34, 36864
    buffer_load_dword v10, v4, s[52:55], s34 offen
    s_add_u32 s34, s34, 294912
    buffer_load_dword v11, v4, s[52:55], s34 offen
L_notch2:
    s_branch L_ldsw0
L_dma:
    s_cmp_ge_u32 s37, 2
    s_cbranch_scc1 L_dfs
    s_lshl_b32 s70, s66, 6
    s_mov_b32 m0, 0
    s_add_u32 s35, s70, 0
    buffer_load_dwordx4 v214, s[40:43], s35 offen lds
    s_mov_b32 m0, 1024
    s_add_u32 s35, s70, 27648
    buffer_load_dwordx4 v214, s[40:43], s35 offen lds
    s_mov_b32 m0, 2048
    s_add_u32 s35, s70, 55296
    buffer_load_dwordx4 v214, s[40:43], s35 offen lds
    s_mov_b32 m0, 3072
    s_add_u32 s35, s70, 82944
    buffer_load_dwordx4 v214, s[40:43], s35 offen lds
    s_mov_b32 m0, 4096
    s_add_u32 s35, s70, 110592
    buffer_load_dwordx4 v214, s[40:43], s35 offen lds
    s_mov_b32 m0, 5120
    s_add_u32 s35, s70, 138240
    buffer_load_dwordx4 v214, s[40:43], s35 offen lds
    s_mov_b32 m0, 6144
    s_add_u32 s35, s70, 165888
    buffer_load_dwordx4 v214, s[40:43], s35 offen lds
    s_mov_b32 m0, 7168
    s_add_u32 s35, s70, 193536
    buffer_load_dwordx4 v214, s[40:43], s35 offen lds
    s_mov_b32 m0, 8192
    s_add_u32 s35, s70, 221184
    buffer_load_dwordx4 v214, s[40:43], s35 offen lds
    s_mov_b32 m0, 9216
    s_add_u32 s35, s70, 248832
    buffer_load_dwordx4 v214, s[40:43], s35 offen lds
    s_mov_b32 m0, 10240
    s_add_u32 s35, s70, 276480
    buffer_load_dwordx4 v214, s[40:43], s35 offen lds
    s_mov_b32 m0, 11264
    s_add_u32 s35, s70, 304128
    buffer_load_dwordx4 v214, s[40:43], s35 offen lds
    s_mov_b32 m0, 12288
    s_add_u32 s35, s70, 331776
    buffer_load_dwordx4 v214, s[40:43], s35 offen lds
    s_mov_b32 m0, 13312
    s_add_u32 s35, s70, 359424
    buffer_load_dwordx4 v214, s[40:43], s35 offen lds
    s_mov_b32 m0, 14336
    s_add_u32 s35, s70, 387072
    buffer_load_dwordx4 v214, s[40:43], s35 offen lds
    s_mov_b32 m0, 15360
    s_add_u32 s35, s70, 414720
    buffer_load_dwordx4 v214, s[40:43], s35 offen lds
    s_mov_b32 m0, 16384
    s_add_u32 s35, s70, 442368
    buffer_load_dwordx4 v214, s[40:43], s35 offen lds
    s_mov_b32 m0, 17408
    s_add_u32 s35, s70, 470016
    buffer_load_dwordx4 v214, s[40:43], s35 offen lds
    s_mov_b32 m0, 18432
    s_add_u32 s35, s70, 497664
    buffer_load_dwordx4 v214, s[40:43], s35 offen lds
    s_mov_b32 m0, 19456
    s_add_u32 s35, s70, 525312
    buffer_load_dwordx4 v214, s[40:43], s35 offen lds
    s_mov_b32 m0, 20480
    s_add_u32 s35, s70, 552960
    buffer_load_dwordx4 v214, s[40:43], s35 offen lds
    s_mov_b32 m0, 21504
    s_add_u32 s35, s70, 580608
    buffer_load_dwordx4 v214, s[40:43], s35 offen lds
    s_mov_b32 m0, 22528
    s_add_u32 s35, s70, 608256
    buffer_load_dwordx4 v214, s[40:43], s35 offen lds
    s_mov_b32 m0, 23552
    s_add_u32 s35, s70, 635904
    buffer_load_dwordx4 v214, s[40:43], s35 offen lds
    s_mov_b32 m0, 24576
    s_add_u32 s35, s70, 663552
    buffer_load_dwordx4 v214, s[40:43], s35 offen lds
    s_mov_b32 m0, 25600
    s_add_u32 s35, s70, 691200
    buffer_load_dwordx4 v214, s[40:43], s35 offen lds
    s_mov_b32 m0, 26624
    s_add_u32 s35, s70, 718848
    buffer_load_dwordx4 v214, s[40:43], s35 offen lds
    s_mov_b32 m0, 27648
    s_add_u32 s35, s70, 746496
    buffer_load_dwordx4 v214, s[40:43], s35 offen lds
    s_mov_b32 m0, 28672
    s_add_u32 s35, s70, 774144
    buffer_load_dwordx4 v214, s[40:43], s35 offen lds
    s_mov_b32 m0, 29696
    s_add_u32 s35, s70, 801792
    buffer_load_dwordx4 v214, s[40:43], s35 offen lds
    s_mov_b32 m0, 30720
    s_add_u32 s35, s70, 829440
    buffer_load_dwordx4 v214, s[40:43], s35 offen lds
    s_mov_b32 m0, 31744
    s_add_u32 s35, s70, 857088
    buffer_load_dwordx4 v214, s[40:43], s35 offen lds
    s_mov_b32 m0, 32768
    s_add_u32 s35, s70, 884736
    buffer_load_dwordx4 v214, s[40:43], s35 offen lds
    s_mov_b32 m0, 33792
    s_add_u32 s35, s70, 912384
    buffer_load_dwordx4 v214, s[40:43], s35 offen lds
    s_mov_b32 m0, 34816
    s_add_u32 s35, s70, 940032
    buffer_load_dwordx4 v214, s[40:43], s35 offen lds
    s_mov_b32 m0, 35840
    s_add_u32 s35, s70, 967680
    buffer_load_dwordx4 v214, s[40:43], s35 offen lds
    s_lshl_b32 s70, s67, 6
    s_mov_b32 m0, 36864
    s_add_u32 s35, s70, 0
    buffer_load_dwordx4 v212, s[40:43], s35 offen lds
    s_mov_b32 m0, 37888
    s_add_u32 s35, s70, 55296
    buffer_load_dwordx4 v212, s[40:43], s35 offen lds
    s_mov_b32 m0, 38912
    s_add_u32 s35, s70, 110592
    buffer_load_dwordx4 v212, s[40:43], s35 offen lds
    s_mov_b32 m0, 39936
    s_add_u32 s35, s70, 165888
    buffer_load_dwordx4 v212, s[40:43], s35 offen lds
    s_mov_b32 m0, 40960
    s_add_u32 s35, s70, 221184
    buffer_load_dwordx4 v212, s[40:43], s35 offen lds
    s_mov_b32 m0, 41984
    s_add_u32 s35, s70, 276480
    buffer_load_dwordx4 v212, s[40:43], s35 offen lds
    s_mov_b32 m0, 43008
    s_add_u32 s35, s70, 331776
    buffer_load_dwordx4 v212, s[40:43], s35 offen lds
    s_mov_b32 m0, 44032
    s_add_u32 s35, s70, 387072
    buffer_load_dwordx4 v212, s[40:43], s35 offen lds
    s_mov_b32 m0, 45056
    s_add_u32 s35, s70, 442368
    buffer_load_dwordx4 v212, s[40:43], s35 offen lds
    s_mov_b32 m0, 46080
    s_add_u32 s35, s70, 497664
    buffer_load_dwordx4 v212, s[40:43], s35 offen lds
    s_mov_b32 m0, 47104
    s_add_u32 s35, s70, 552960
    buffer_load_dwordx4 v212, s[40:43], s35 offen lds
    s_mov_b32 m0, 48128
    s_add_u32 s35, s70, 608256
    buffer_load_dwordx4 v212, s[40:43], s35 offen lds
    s_mov_b32 m0, 49152
    s_add_u32 s35, s70, 663552
    buffer_load_dwordx4 v212, s[40:43], s35 offen lds
    s_mov_b32 m0, 50176
    s_add_u32 s35, s70, 718848
    buffer_load_dwordx4 v212, s[40:43], s35 offen lds
    s_mov_b32 m0, 51200
    s_add_u32 s35, s70, 774144
    buffer_load_dwordx4 v212, s[40:43], s35 offen lds
    s_mov_b32 m0, 52224
    s_add_u32 s35, s70, 829440
    buffer_load_dwordx4 v212, s[40:43], s35 offen lds
    s_mov_b32 m0, 53248
    s_add_u32 s35, s70, 884736
    buffer_load_dwordx4 v212, s[40:43], s35 offen lds
    s_mov_b32 m0, 54272
    s_add_u32 s35, s70, 940032
    buffer_load_dwordx4 v212, s[40:43], s35 offen lds
    s_branch L_dfx
L_dfs:
    s_lshl_b32 s70, s69, 6
    s_mov_b32 m0, 0
    s_add_u32 s35, s70, 0
    buffer_load_dwordx4 v211, s[44:47], s35 offen lds
    s_mov_b32 m0, 1024
    s_add_u32 s35, s70, 147456
    buffer_load_dwordx4 v211, s[44:47], s35 offen lds
    s_mov_b32 m0, 2048
    s_add_u32 s35, s70, 294912
    buffer_load_dwordx4 v211, s[44:47], s35 offen lds
    s_mov_b32 m0, 3072
    s_add_u32 s35, s70, 442368
    buffer_load_dwordx4 v211, s[44:47], s35 offen lds
    s_mov_b32 m0, 4096
    s_add_u32 s35, s70, 589824
    buffer_load_dwordx4 v211, s[44:47], s35 offen lds
    s_mov_b32 m0, 5120
    s_add_u32 s35, s70, 737280
    buffer_load_dwordx4 v211, s[44:47], s35 offen lds
    s_mov_b32 m0, 6144
    s_add_u32 s35, s70, 884736
    buffer_load_dwordx4 v211, s[44:47], s35 offen lds
    s_mov_b32 m0, 7168
    s_add_u32 s35, s70, 1032192
    buffer_load_dwordx4 v211, s[44:47], s35 offen lds
    s_mov_b32 m0, 8192
    s_add_u32 s35, s70, 1179648
    buffer_load_dwordx4 v211, s[44:47], s35 offen lds
    s_mov_b32 m0, 9216
    s_add_u32 s35, s70, 1327104
    buffer_load_dwordx4 v211, s[44:47], s35 offen lds
    s_mov_b32 m0, 10240
    s_add_u32 s35, s70, 1474560
    buffer_load_dwordx4 v211, s[44:47], s35 offen lds
    s_mov_b32 m0, 11264
    s_add_u32 s35, s70, 1622016
    buffer_load_dwordx4 v211, s[44:47], s35 offen lds
    s_mov_b32 m0, 12288
    s_add_u32 s35, s70, 1769472
    buffer_load_dwordx4 v211, s[44:47], s35 offen lds
    s_mov_b32 m0, 13312
    s_add_u32 s35, s70, 1916928
    buffer_load_dwordx4 v211, s[44:47], s35 offen lds
    s_mov_b32 m0, 14336
    s_add_u32 s35, s70, 2064384
    buffer_load_dwordx4 v211, s[44:47], s35 offen lds
    s_mov_b32 m0, 15360
    s_add_u32 s35, s70, 2211840
    buffer_load_dwordx4 v211, s[44:47], s35 offen lds
    s_mov_b32 m0, 16384
    s_add_u32 s35, s70, 2359296
    buffer_load_dwordx4 v211, s[44:47], s35 offen lds
    s_mov_b32 m0, 17408
    s_add_u32 s35, s70, 2506752
    buffer_load_dwordx4 v211, s[44:47], s35 offen lds
    s_mov_b32 m0, 18432
    s_add_u32 s35, s70, 0
    buffer_load_dwordx4 v211, s[48:51], s35 offen lds
    s_mov_b32 m0, 19456
    s_add_u32 s35, s70, 147456
    buffer_load_dwordx4 v211, s[48:51], s35 offen lds
    s_mov_b32 m0, 20480
    s_add_u32 s35, s70, 294912
    buffer_load_dwordx4 v211, s[48:51], s35 offen lds
    s_mov_b32 m0, 21504
    s_add_u32 s35, s70, 442368
    buffer_load_dwordx4 v211, s[48:51], s35 offen lds
    s_mov_b32 m0, 22528
    s_add_u32 s35, s70, 589824
    buffer_load_dwordx4 v211, s[48:51], s35 offen lds
    s_mov_b32 m0, 23552
    s_add_u32 s35, s70, 737280
    buffer_load_dwordx4 v211, s[48:51], s35 offen lds
    s_mov_b32 m0, 24576
    s_add_u32 s35, s70, 884736
    buffer_load_dwordx4 v211, s[48:51], s35 offen lds
    s_mov_b32 m0, 25600
    s_add_u32 s35, s70, 1032192
    buffer_load_dwordx4 v211, s[48:51], s35 offen lds
    s_mov_b32 m0, 26624
    s_add_u32 s35, s70, 1179648
    buffer_load_dwordx4 v211, s[48:51], s35 offen lds
    s_mov_b32 m0, 27648
    s_add_u32 s35, s70, 1327104
    buffer_load_dwordx4 v211, s[48:51], s35 offen lds
    s_mov_b32 m0, 28672
    s_add_u32 s35, s70, 1474560
    buffer_load_dwordx4 v211, s[48:51], s35 offen lds
    s_mov_b32 m0, 29696
    s_add_u32 s35, s70, 1622016
    buffer_load_dwordx4 v211, s[48:51], s35 offen lds
    s_mov_b32 m0, 30720
    s_add_u32 s35, s70, 1769472
    buffer_load_dwordx4 v211, s[48:51], s35 offen lds
    s_mov_b32 m0, 31744
    s_add_u32 s35, s70, 1916928
    buffer_load_dwordx4 v211, s[48:51], s35 offen lds
    s_mov_b32 m0, 32768
    s_add_u32 s35, s70, 2064384
    buffer_load_dwordx4 v211, s[48:51], s35 offen lds
    s_mov_b32 m0, 33792
    s_add_u32 s35, s70, 2211840
    buffer_load_dwordx4 v211, s[48:51], s35 offen lds
    s_mov_b32 m0, 34816
    s_add_u32 s35, s70, 2359296
    buffer_load_dwordx4 v211, s[48:51], s35 offen lds
    s_mov_b32 m0, 35840
    s_add_u32 s35, s70, 2506752
    buffer_load_dwordx4 v211, s[48:51], s35 offen lds
    s_cmp_eq_u32 s37, 3
    s_cbranch_scc1 L_dfx
    s_lshl_b32 s70, s67, 6
    s_mov_b32 m0, 36864
    s_add_u32 s35, s70, 0
    buffer_load_dwordx4 v212, s[40:43], s35 offen lds
    s_mov_b32 m0, 37888
    s_add_u32 s35, s70, 55296
    buffer_load_dwordx4 v212, s[40:43], s35 offen lds
    s_mov_b32 m0, 38912
    s_add_u32 s35, s70, 110592
    buffer_load_dwordx4 v212, s[40:43], s35 offen lds
    s_mov_b32 m0, 39936
    s_add_u32 s35, s70, 165888
    buffer_load_dwordx4 v212, s[40:43], s35 offen lds
    s_mov_b32 m0, 40960
    s_add_u32 s35, s70, 221184
    buffer_load_dwordx4 v212, s[40:43], s35 offen lds
    s_mov_b32 m0, 41984
    s_add_u32 s35, s70, 276480
    buffer_load_dwordx4 v212, s[40:43], s35 offen lds
    s_mov_b32 m0, 43008
    s_add_u32 s35, s70, 331776
    buffer_load_dwordx4 v212, s[40:43], s35 offen lds
    s_mov_b32 m0, 44032
    s_add_u32 s35, s70, 387072
    buffer_load_dwordx4 v212, s[40:43], s35 offen lds
    s_mov_b32 m0, 45056
    s_add_u32 s35, s70, 442368
    buffer_load_dwordx4 v212, s[40:43], s35 offen lds
    s_mov_b32 m0, 46080
    s_add_u32 s35, s70, 497664
    buffer_load_dwordx4 v212, s[40:43], s35 offen lds
    s_mov_b32 m0, 47104
    s_add_u32 s35, s70, 552960
    buffer_load_dwordx4 v212, s[40:43], s35 offen lds
    s_mov_b32 m0, 48128
    s_add_u32 s35, s70, 608256
    buffer_load_dwordx4 v212, s[40:43], s35 offen lds
    s_mov_b32 m0, 49152
    s_add_u32 s35, s70, 663552
    buffer_load_dwordx4 v212, s[40:43], s35 offen lds
    s_mov_b32 m0, 50176
    s_add_u32 s35, s70, 718848
    buffer_load_dwordx4 v212, s[40:43], s35 offen lds
    s_mov_b32 m0, 51200
    s_add_u32 s35, s70, 774144
    buffer_load_dwordx4 v212, s[40:43], s35 offen lds
    s_mov_b32 m0, 52224
    s_add_u32 s35, s70, 829440
    buffer_load_dwordx4 v212, s[40:43], s35 offen lds
    s_mov_b32 m0, 53248
    s_add_u32 s35, s70, 884736
    buffer_load_dwordx4 v212, s[40:43], s35 offen lds
    s_mov_b32 m0, 54272
    s_add_u32 s35, s70, 940032
    buffer_load_dwordx4 v212, s[40:43], s35 offen lds
L_dfx:
    buffer_load_dwordx2 v[120:121], v128, s[84:87], 0 offen sc1
    s_lshl_b32 s34, s2, 5
    v_add_u32 v4, s34, v208
    v_mul_u32_u24 v4, 304, v4
    v_add_u32 v4, 288, v4
    v_mov_b32 v5, 0x80000000
    v_cmp_gt_u32 vcc, 32, v208
    s_nop 1
    v_cndmask_b32 v4, v5, v4, vcc
    v_mov_b32 v24, 0x3f803f80
    v_mov_b32 v25, 0x3f803f80
    v_mov_b32 v26, 0x3f803f80
    v_mov_b32 v27, 0x3f803f80
    s_mov_b32 s34, 7081984
    buffer_store_dwordx4 v[24:27], v4, s[24:27], s34 offen sc1
    s_waitcnt vmcnt(1)
    v_readfirstlane_b32 s32, v120
    v_readfirstlane_b32 s33, v121
    s_cmp_lg_u32 s32, 0
    s_cbranch_scc1 L_gotepb
    s_mov_b32 s36, 0
L_eppollb:
    buffer_load_dwordx2 v[120:121], v128, s[84:87], 0 offen sc1
    v_readfirstlane_b32 s32, v120
    v_readfirstlane_b32 s33, v121
    s_add_u32 s36, s36, 1
    s_cmp_lg_u32 s32, 0
    s_cbranch_scc1 L_gotepb
    s_cmp_lt_u32 s36, 0x20000
    s_cbranch_scc1 L_eppollb
L_gotepb:
    s_mov_b32 s36, 0
L_ldsc:
    ds_read_b32 v130, v129 offset:4
    s_waitcnt lgkmcnt(0)
    v_readfirstlane_b32 s34, v130
    s_add_u32 s36, s36, 1
    s_cmp_ge_u32 s34, 3
    s_cbranch_scc1 L_ldscx
    s_sleep 1
    s_cmp_lt_u32 s36, 0x400000
    s_cbranch_scc1 L_ldsc
L_ldscx:
    v_and_b32 v30, 31, v208
    v_lshlrev_b32 v30, 7, v30
    s_lshl_b32 s35, s29, 12
    s_add_u32 s35, s35, 49684480
    s_mov_b32 s36, 0
L_poll_1:
    buffer_load_dwordx2 v[32:33], v30, s[24:27], s35 offen sc1
    s_waitcnt vmcnt(0)
    v_cmp_ne_u64 vcc, s[32:33], v[32:33]
    s_add_u32 s36, s36, 1
    s_cbranch_vccz L_polld_2
    s_cmp_lt_u32 s36, 0x20000
    s_cbranch_scc1 L_poll_1
L_polld_2:
    v_mov_b32 v128, 1
    ds_write_b32 v129, v128
    s_branch L_join
L_ldsw0:
    s_mov_b32 s36, 0
L_ldsw:
    ds_read_b32 v130, v129
    s_waitcnt lgkmcnt(0)
    v_readfirstlane_b32 s34, v130
    s_add_u32 s36, s36, 1
    s_cmp_lg_u32 s34, 0
    s_cbranch_scc1 L_join
    s_sleep 1
    s_cmp_lt_u32 s36, 0x400000
    s_cbranch_scc1 L_ldsw
L_join:
    v_lshrrev_b32 v176, 5, v208
    v_bfe_u32 v177, v208, 2, 2
    v_lshlrev_b32 v177, 6, v177
    v_bfe_u32 v179, v208, 4, 1
    v_lshlrev_b32 v179, 5, v179
    v_and_b32 v180, 3, v208
    v_lshlrev_b32 v181, 3, v180
    v_add_u32 v177, v177, v179
    v_add_u32 v177, v177, v181
    v_lshlrev_b32 v178, 9, v176
    v_add_u32 v204, v177, v178
    v_add_u32 v205, 55296, v204
    v_lshlrev_b32 v178, 10, v176
    v_add_u32 v216, v177, v178
    v_add_u32 v217, 36864, v216
    v_add_u32 v218, 73728, v216
    v_add_u32 v219, 110592, v216
    v_add_u32 v203, 55296, v216
    v_and_b32 v184, 31, v208
    v_lshlrev_b32 v184, 4, v184
    v_lshlrev_b32 v185, 15, v176
    v_add_u32 v215, v184, v185
    v_mul_u32_u24 v206, 304, v176
    s_lshl_b32 s34, s29, 3
    s_lshl_b32 s35, s28, 1
    s_add_u32 s34, s34, s35
    s_mul_i32 s64, s34, 36864
    s_add_u32 s64, s64, 0
    s_add_u32 s65, s64, 36864
    s_mul_i32 s36, s34, 294912
    s_add_u32 s36, s36, 9576448
    s_lshl_b32 s35, s68, 11
    s_add_u32 s58, s36, s35
    s_add_u32 s59, s58, 294912
    s_lshl_b32 s35, s69, 11
    s_add_u32 s71, s36, s35
    s_add_u32 s72, s71, 294912
    s_lshl_b32 s60, s34, 9
    s_add_u32 s60, s60, 2359296
    s_mul_i32 s61, s34, 1216
    s_add_u32 s61, s61, 7081984
    v_lshrrev_b32 v2, 1, v208
    v_mul_u32_u24 v2, 9216, v2
    v_and_b32 v3, 1, v208
    v_lshl_add_u32 v2, v3, 7, v2
    v_add_u32 v3, 294912, v2
    v_mov_b32 v4, 0x80000000
    v_cmp_gt_u32 vcc, 8, v208
    s_nop 1
    v_cndmask_b32 v3, v4, v3, vcc
    s_mul_i32 s34, s29, 72
    s_and_b32 s35, s28, 1
    s_mul_i32 s35, s35, 36
    s_add_u32 s34, s34, s35
    s_mul_i32 s34, s34, 9216
    s_lshl_b32 s35, s68, 6
    s_add_u32 s70, s34, s35
    s_cmp_eq_u32 s37, 1
    s_cbranch_scc1 L_cls1
    s_cmp_eq_u32 s37, 2
    s_cbranch_scc1 L_cls2
    s_cmp_eq_u32 s37, 3
    s_cbranch_scc1 L_cls3
    buffer_load_dwordx4 a[0:3], v210, s[24:27], s64 offen offset:0 sc1
    buffer_load_dwordx4 a[4:7], v210, s[24:27], s65 offen offset:0 sc1
    buffer_load_dwordx4 a[8:11], v210, s[24:27], s64 offen offset:1024 sc1
    buffer_load_dwordx4 a[12:15], v210, s[24:27], s65 offen offset:1024 sc1
    buffer_load_dwordx4 a[16:19], v210, s[24:27], s64 offen offset:2048 sc1
    buffer_load_dwordx4 a[20:23], v210, s[24:27], s65 offen offset:2048 sc1
    buffer_load_dwordx4 a[24:27], v210, s[24:27], s64 offen offset:3072 sc1
    buffer_load_dwordx4 a[28:31], v210, s[24:27], s65 offen offset:3072 sc1
    s_add_u32 s64, s64, 4096
    s_add_u32 s65, s65, 4096
    buffer_load_dwordx4 a[32:35], v210, s[24:27], s64 offen offset:0 sc1
    buffer_load_dwordx4 a[36:39], v210, s[24:27], s65 offen offset:0 sc1
    buffer_load_dwordx4 a[40:43], v210, s[24:27], s64 offen offset:1024 sc1
    buffer_load_dwordx4 a[44:47], v210, s[24:27], s65 offen offset:1024 sc1
    buffer_load_dwordx4 a[48:51], v210, s[24:27], s64 offen offset:2048 sc1
    buffer_load_dwordx4 a[52:55], v210, s[24:27], s65 offen offset:2048 sc1
    buffer_load_dwordx4 a[56:59], v210, s[24:27], s64 offen offset:3072 sc1
    buffer_load_dwordx4 a[60:63], v210, s[24:27], s65 offen offset:3072 sc1
    s_add_u32 s64, s64, 4096
    s_add_u32 s65, s65, 4096
    s_barrier
    ds_read_b64_tr_b16 v[160:161], v216 offset:0
    ds_read_b64_tr_b16 v[162:163], v216 offset:256
    ds_read_b64_tr_b16 v[164:165], v216 offset:512
    ds_read_b64_tr_b16 v[166:167], v216 offset:768
    ds_read_b64_tr_b16 v[168:169], v204 offset:36864
    ds_read_b64_tr_b16 v[170:171], v204 offset:37120
    s_waitcnt vmcnt(15) lgkmcnt(4)
    v_mfma_f32_32x32x16_bf16 v[64:79], v[160:163], a[0:3], 0
    ds_read_b64_tr_b16 v[172:173], v216 offset:2048
    ds_read_b64_tr_b16 v[174:175], v216 offset:2304
    s_waitcnt vmcnt(14)
    v_mfma_f32_32x32x16_bf16 v[80:95], v[160:163], a[4:7], 0
    buffer_load_dwordx4 a[64:67], v210, s[24:27], s64 offen offset:0 sc1
    s_waitcnt lgkmcnt(4)
    v_mfma_f32_32x32x16_bf16 v[96:111], v[164:167], a[0:3], 0
    ds_read_b64_tr_b16 v[160:161], v216 offset:2560
    ds_read_b64_tr_b16 v[162:163], v216 offset:2816
    v_mfma_f32_32x32x16_bf16 v[112:127], v[164:167], a[4:7], 0
    buffer_load_dwordx4 a[68:71], v210, s[24:27], s65 offen offset:0 sc1
    s_waitcnt lgkmcnt(4)
    v_mfma_f32_32x32x16_bf16 v[128:143], v[168:171], a[0:3], 0
    ds_read_b64_tr_b16 v[164:165], v204 offset:37888
    ds_read_b64_tr_b16 v[166:167], v204 offset:38144
    v_mfma_f32_32x32x16_bf16 v[144:159], v[168:171], a[4:7], 0
    s_waitcnt vmcnt(15) lgkmcnt(4)
    v_mfma_f32_32x32x16_bf16 v[64:79], v[172:175], a[8:11], v[64:79]
    ds_read_b64_tr_b16 v[168:169], v216 offset:4096
    ds_read_b64_tr_b16 v[170:171], v216 offset:4352
    s_waitcnt vmcnt(14)
    v_mfma_f32_32x32x16_bf16 v[80:95], v[172:175], a[12:15], v[80:95]
    buffer_load_dwordx4 a[72:75], v210, s[24:27], s64 offen offset:1024 sc1
    s_waitcnt lgkmcnt(4)
    v_mfma_f32_32x32x16_bf16 v[96:111], v[160:163], a[8:11], v[96:111]
    ds_read_b64_tr_b16 v[172:173], v216 offset:4608
    ds_read_b64_tr_b16 v[174:175], v216 offset:4864
    v_mfma_f32_32x32x16_bf16 v[112:127], v[160:163], a[12:15], v[112:127]
    buffer_load_dwordx4 a[76:79], v210, s[24:27], s65 offen offset:1024 sc1
    s_waitcnt lgkmcnt(4)
    v_mfma_f32_32x32x16_bf16 v[128:143], v[164:167], a[8:11], v[128:143]
    ds_read_b64_tr_b16 v[160:161], v204 offset:38912
    ds_read_b64_tr_b16 v[162:163], v204 offset:39168
    v_mfma_f32_32x32x16_bf16 v[144:159], v[164:167], a[12:15], v[144:159]
    s_waitcnt vmcnt(15) lgkmcnt(4)
    v_mfma_f32_32x32x16_bf16 v[64:79], v[168:171], a[16:19], v[64:79]
    ds_read_b64_tr_b16 v[164:165], v216 offset:6144
    ds_read_b64_tr_b16 v[166:167], v216 offset:6400
    s_waitcnt vmcnt(14)
    v_mfma_f32_32x32x16_bf16 v[80:95], v[168:171], a[20:23], v[80:95]
    buffer_load_dwordx4 a[80:83], v210, s[24:27], s64 offen offset:2048 sc1
    s_waitcnt lgkmcnt(4)
    v_mfma_f32_32x32x16_bf16 v[96:111], v[172:175], a[16:19], v[96:111]
    ds_read_b64_tr_b16 v[168:169], v216 offset:6656
    ds_read_b64_tr_b16 v[170:171], v216 offset:6912
    v_mfma_f32_32x32x16_bf16 v[112:127], v[172:175], a[20:23], v[112:127]
    buffer_load_dwordx4 a[84:87], v210, s[24:27], s65 offen offset:2048 sc1
    s_waitcnt lgkmcnt(4)
    v_mfma_f32_32x32x16_bf16 v[128:143], v[160:163], a[16:19], v[128:143]
    ds_read_b64_tr_b16 v[172:173], v204 offset:39936
    ds_read_b64_tr_b16 v[174:175], v204 offset:40192
    v_mfma_f32_32x32x16_bf16 v[144:159], v[160:163], a[20:23], v[144:159]
    s_waitcnt vmcnt(15) lgkmcnt(4)
    v_mfma_f32_32x32x16_bf16 v[64:79], v[164:167], a[24:27], v[64:79]
    ds_read_b64_tr_b16 v[160:161], v216 offset:8192
    ds_read_b64_tr_b16 v[162:163], v216 offset:8448
    s_waitcnt vmcnt(14)
    v_mfma_f32_32x32x16_bf16 v[80:95], v[164:167], a[28:31], v[80:95]
    buffer_load_dwordx4 a[88:91], v210, s[24:27], s64 offen offset:3072 sc1
    s_waitcnt lgkmcnt(4)
    v_mfma_f32_32x32x16_bf16 v[96:111], v[168:171], a[24:27], v[96:111]
    ds_read_b64_tr_b16 v[164:165], v216 offset:8704
    ds_read_b64_tr_b16 v[166:167], v216 offset:8960
    v_mfma_f32_32x32x16_bf16 v[112:127], v[168:171], a[28:31], v[112:127]
    buffer_load_dwordx4 a[92:95], v210, s[24:27], s65 offen offset:3072 sc1
    s_add_u32 s64, s64, 4096
    s_add_u32 s65, s65, 4096
    s_waitcnt lgkmcnt(4)
    v_mfma_f32_32x32x16_bf16 v[128:143], v[172:175], a[24:27], v[128:143]
    ds_read_b64_tr_b16 v[168:169], v204 offset:40960
    ds_read_b64_tr_b16 v[170:171], v204 offset:41216
    v_mfma_f32_32x32x16_bf16 v[144:159], v[172:175], a[28:31], v[144:159]
    s_waitcnt vmcnt(15) lgkmcnt(4)
    v_mfma_f32_32x32x16_bf16 v[64:79], v[160:163], a[32:35], v[64:79]
    ds_read_b64_tr_b16 v[172:173], v216 offset:10240
    ds_read_b64_tr_b16 v[174:175], v216 offset:10496
    s_waitcnt vmcnt(14)
    v_mfma_f32_32x32x16_bf16 v[80:95], v[160:163], a[36:39], v[80:95]
    buffer_load_dwordx4 a[96:99], v210, s[24:27], s64 offen offset:0 sc1
    s_waitcnt lgkmcnt(4)
    v_mfma_f32_32x32x16_bf16 v[96:111], v[164:167], a[32:35], v[96:111]
    ds_read_b64_tr_b16 v[160:161], v216 offset:10752
    ds_read_b64_tr_b16 v[162:163], v216 offset:11008
    v_mfma_f32_32x32x16_bf16 v[112:127], v[164:167], a[36:39], v[112:127]
    buffer_load_dwordx4 a[100:103], v210, s[24:27], s65 offen offset:0 sc1
    s_waitcnt lgkmcnt(4)
    v_mfma_f32_32x32x16_bf16 v[128:143], v[168:171], a[32:35], v[128:143]
    ds_read_b64_tr_b16 v[164:165], v204 offset:41984
    ds_read_b64_tr_b16 v[166:167], v204 offset:42240
    v_mfma_f32_32x32x16_bf16 v[144:159], v[168:171], a[36:39], v[144:159]
    s_waitcnt vmcnt(15) lgkmcnt(4)
    v_mfma_f32_32x32x16_bf16 v[64:79], v[172:175], a[40:43], v[64:79]
    ds_read_b64_tr_b16 v[168:169], v216 offset:12288
    ds_read_b64_tr_b16 v[170:171], v216 offset:12544
    s_waitcnt vmcnt(14)
    v_mfma_f32_32x32x16_bf16 v[80:95], v[172:175], a[44:47], v[80:95]
    buffer_load_dwordx4 a[104:107], v210, s[24:27], s64 offen offset:1024 sc1
    s_waitcnt lgkmcnt(4)
    v_mfma_f32_32x32x16_bf16 v[96:111], v[160:163], a[40:43], v[96:111]
    ds_read_b64_tr_b16 v[172:173], v216 offset:12800
    ds_read_b64_tr_b16 v[174:175], v216 offset:13056
    v_mfma_f32_32x32x16_bf16 v[112:127], v[160:163], a[44:47], v[112:127]
    buffer_load_dwordx4 a[108:111], v210, s[24:27], s65 offen offset:1024 sc1
    s_waitcnt lgkmcnt(4)
    v_mfma_f32_32x32x16_bf16 v[128:143], v[164:167], a[40:43], v[128:143]
    ds_read_b64_tr_b16 v[160:161], v204 offset:43008
    ds_read_b64_tr_b16 v[162:163], v204 offset:43264
    v_mfma_f32_32x32x16_bf16 v[144:159], v[164:167], a[44:47], v[144:159]
    s_waitcnt vmcnt(15) lgkmcnt(4)
    v_mfma_f32_32x32x16_bf16 v[64:79], v[168:171], a[48:51], v[64:79]
    ds_read_b64_tr_b16 v[164:165], v216 offset:14336
    ds_read_b64_tr_b16 v[166:167], v216 offset:14592
    s_waitcnt vmcnt(14)
    v_mfma_f32_32x32x16_bf16 v[80:95], v[168:171], a[52:55], v[80:95]
    buffer_load_dwordx4 a[112:115], v210, s[24:27], s64 offen offset:2048 sc1
    s_waitcnt lgkmcnt(4)
    v_mfma_f32_32x32x16_bf16 v[96:111], v[172:175], a[48:51], v[96:111]
    ds_read_b64_tr_b16 v[168:169], v216 offset:14848
    ds_read_b64_tr_b16 v[170:171], v216 offset:15104
    v_mfma_f32_32x32x16_bf16 v[112:127], v[172:175], a[52:55], v[112:127]
    buffer_load_dwordx4 a[116:119], v210, s[24:27], s65 offen offset:2048 sc1
    s_waitcnt lgkmcnt(4)
    v_mfma_f32_32x32x16_bf16 v[128:143], v[160:163], a[48:51], v[128:143]
    ds_read_b64_tr_b16 v[172:173], v204 offset:44032
    ds_read_b64_tr_b16 v[174:175], v204 offset:44288
    v_mfma_f32_32x32x16_bf16 v[144:159], v[160:163], a[52:55], v[144:159]
    s_waitcnt vmcnt(15) lgkmcnt(4)
    v_mfma_f32_32x32x16_bf16 v[64:79], v[164:167], a[56:59], v[64:79]
    ds_read_b64_tr_b16 v[160:161], v216 offset:16384
    ds_read_b64_tr_b16 v[162:163], v216 offset:16640
    s_waitcnt vmcnt(14)
    v_mfma_f32_32x32x16_bf16 v[80:95], v[164:167], a[60:63], v[80:95]
    buffer_load_dwordx4 a[120:123], v210, s[24:27], s64 offen offset:3072 sc1
    s_waitcnt lgkmcnt(4)
    v_mfma_f32_32x32x16_bf16 v[96:111], v[168:171], a[56:59], v[96:111]
    ds_read_b64_tr_b16 v[164:165], v216 offset:16896
    ds_read_b64_tr_b16 v[166:167], v216 offset:17152
    v_mfma_f32_32x32x16_bf16 v[112:127], v[168:171], a[60:63], v[112:127]
    buffer_load_dwordx4 a[124:127], v210, s[24:27], s65 offen offset:3072 sc1
    s_add_u32 s64, s64, 4096
    s_add_u32 s65, s65, 4096
    s_waitcnt lgkmcnt(4)
    v_mfma_f32_32x32x16_bf16 v[128:143], v[172:175], a[56:59], v[128:143]
    ds_read_b64_tr_b16 v[168:169], v204 offset:45056
    ds_read_b64_tr_b16 v[170:171], v204 offset:45312
    v_mfma_f32_32x32x16_bf16 v[144:159], v[172:175], a[60:63], v[144:159]
    s_waitcnt vmcnt(15) lgkmcnt(4)
    v_mfma_f32_32x32x16_bf16 v[64:79], v[160:163], a[64:67], v[64:79]
    ds_read_b64_tr_b16 v[172:173], v216 offset:18432
    ds_read_b64_tr_b16 v[174:175], v216 offset:18688
    s_waitcnt vmcnt(14)
    v_mfma_f32_32x32x16_bf16 v[80:95], v[160:163], a[68:71], v[80:95]
    buffer_load_dwordx4 a[128:131], v210, s[24:27], s64 offen offset:0 sc1
    s_waitcnt lgkmcnt(4)
    v_mfma_f32_32x32x16_bf16 v[96:111], v[164:167], a[64:67], v[96:111]
    ds_read_b64_tr_b16 v[160:161], v216 offset:18944
    ds_read_b64_tr_b16 v[162:163], v216 offset:19200
    v_mfma_f32_32x32x16_bf16 v[112:127], v[164:167], a[68:71], v[112:127]
    buffer_load_dwordx4 a[132:135], v210, s[24:27], s65 offen offset:0 sc1
    s_waitcnt lgkmcnt(4)
    v_mfma_f32_32x32x16_bf16 v[128:143], v[168:171], a[64:67], v[128:143]
    ds_read_b64_tr_b16 v[164:165], v204 offset:46080
    ds_read_b64_tr_b16 v[166:167], v204 offset:46336
    v_mfma_f32_32x32x16_bf16 v[144:159], v[168:171], a[68:71], v[144:159]
    s_waitcnt vmcnt(15) lgkmcnt(4)
    v_mfma_f32_32x32x16_bf16 v[64:79], v[172:175], a[72:75], v[64:79]
    ds_read_b64_tr_b16 v[168:169], v216 offset:20480
    ds_read_b64_tr_b16 v[170:171], v216 offset:20736
    s_waitcnt vmcnt(14)
    v_mfma_f32_32x32x16_bf16 v[80:95], v[172:175], a[76:79], v[80:95]
    buffer_load_dwordx4 a[136:139], v210, s[24:27], s64 offen offset:1024 sc1
    s_waitcnt lgkmcnt(4)
    v_mfma_f32_32x32x16_bf16 v[96:111], v[160:163], a[72:75], v[96:111]
    ds_read_b64_tr_b16 v[172:173], v216 offset:20992
    ds_read_b64_tr_b16 v[174:175], v216 offset:21248
    v_mfma_f32_32x32x16_bf16 v[112:127], v[160:163], a[76:79], v[112:127]
    buffer_load_dwordx4 a[140:143], v210, s[24:27], s65 offen offset:1024 sc1
    s_waitcnt lgkmcnt(4)
    v_mfma_f32_32x32x16_bf16 v[128:143], v[164:167], a[72:75], v[128:143]
    ds_read_b64_tr_b16 v[160:161], v204 offset:47104
    ds_read_b64_tr_b16 v[162:163], v204 offset:47360
    v_mfma_f32_32x32x16_bf16 v[144:159], v[164:167], a[76:79], v[144:159]
    s_waitcnt vmcnt(15) lgkmcnt(4)
    v_mfma_f32_32x32x16_bf16 v[64:79], v[168:171], a[80:83], v[64:79]
    ds_read_b64_tr_b16 v[164:165], v216 offset:22528
    ds_read_b64_tr_b16 v[166:167], v216 offset:22784
    s_waitcnt vmcnt(14)
    v_mfma_f32_32x32x16_bf16 v[80:95], v[168:171], a[84:87], v[80:95]
    buffer_load_dwordx4 a[144:147], v210, s[24:27], s64 offen offset:2048 sc1
    s_waitcnt lgkmcnt(4)
    v_mfma_f32_32x32x16_bf16 v[96:111], v[172:175], a[80:83], v[96:111]
    ds_read_b64_tr_b16 v[168:169], v216 offset:23040
    ds_read_b64_tr_b16 v[170:171], v216 offset:23296
    v_mfma_f32_32x32x16_bf16 v[112:127], v[172:175], a[84:87], v[112:127]
    buffer_load_dwordx4 a[148:151], v210, s[24:27], s65 offen offset:2048 sc1
    s_waitcnt lgkmcnt(4)
    v_mfma_f32_32x32x16_bf16 v[128:143], v[160:163], a[80:83], v[128:143]
    ds_read_b64_tr_b16 v[172:173], v204 offset:48128
    ds_read_b64_tr_b16 v[174:175], v204 offset:48384
    v_mfma_f32_32x32x16_bf16 v[144:159], v[160:163], a[84:87], v[144:159]
    s_waitcnt vmcnt(15) lgkmcnt(4)
    v_mfma_f32_32x32x16_bf16 v[64:79], v[164:167], a[88:91], v[64:79]
    ds_read_b64_tr_b16 v[160:161], v216 offset:24576
    ds_read_b64_tr_b16 v[162:163], v216 offset:24832
    s_waitcnt vmcnt(14)
    v_mfma_f32_32x32x16_bf16 v[80:95], v[164:167], a[92:95], v[80:95]
    buffer_load_dwordx4 a[152:155], v210, s[24:27], s64 offen offset:3072 sc1
    s_waitcnt lgkmcnt(4)
    v_mfma_f32_32x32x16_bf16 v[96:111], v[168:171], a[88:91], v[96:111]
    ds_read_b64_tr_b16 v[164:165], v216 offset:25088
    ds_read_b64_tr_b16 v[166:167], v216 offset:25344
    v_mfma_f32_32x32x16_bf16 v[112:127], v[168:171], a[92:95], v[112:127]
    buffer_load_dwordx4 a[156:159], v210, s[24:27], s65 offen offset:3072 sc1
    s_add_u32 s64, s64, 4096
    s_add_u32 s65, s65, 4096
    s_waitcnt lgkmcnt(4)
    v_mfma_f32_32x32x16_bf16 v[128:143], v[172:175], a[88:91], v[128:143]
    ds_read_b64_tr_b16 v[168:169], v204 offset:49152
    ds_read_b64_tr_b16 v[170:171], v204 offset:49408
    v_mfma_f32_32x32x16_bf16 v[144:159], v[172:175], a[92:95], v[144:159]
    s_waitcnt vmcnt(15) lgkmcnt(4)
    v_mfma_f32_32x32x16_bf16 v[64:79], v[160:163], a[96:99], v[64:79]
    ds_read_b64_tr_b16 v[172:173], v216 offset:26624
    ds_read_b64_tr_b16 v[174:175], v216 offset:26880
    s_waitcnt vmcnt(14)
    v_mfma_f32_32x32x16_bf16 v[80:95], v[160:163], a[100:103], v[80:95]
    buffer_load_dwordx4 a[160:163], v210, s[24:27], s64 offen offset:0 sc1
    s_waitcnt lgkmcnt(4)
    v_mfma_f32_32x32x16_bf16 v[96:111], v[164:167], a[96:99], v[96:111]
    ds_read_b64_tr_b16 v[160:161], v216 offset:27136
    ds_read_b64_tr_b16 v[162:163], v216 offset:27392
    v_mfma_f32_32x32x16_bf16 v[112:127], v[164:167], a[100:103], v[112:127]
    buffer_load_dwordx4 a[164:167], v210, s[24:27], s65 offen offset:0 sc1
    s_waitcnt lgkmcnt(4)
    v_mfma_f32_32x32x16_bf16 v[128:143], v[168:171], a[96:99], v[128:143]
    ds_read_b64_tr_b16 v[164:165], v204 offset:50176
    ds_read_b64_tr_b16 v[166:167], v204 offset:50432
    v_mfma_f32_32x32x16_bf16 v[144:159], v[168:171], a[100:103], v[144:159]
    s_waitcnt vmcnt(15) lgkmcnt(4)
    v_mfma_f32_32x32x16_bf16 v[64:79], v[172:175], a[104:107], v[64:79]
    ds_read_b64_tr_b16 v[168:169], v216 offset:28672
    ds_read_b64_tr_b16 v[170:171], v216 offset:28928
    s_waitcnt vmcnt(14)
    v_mfma_f32_32x32x16_bf16 v[80:95], v[172:175], a[108:111], v[80:95]
    buffer_load_dwordx4 a[168:171], v210, s[24:27], s64 offen offset:1024 sc1
    s_waitcnt lgkmcnt(4)
    v_mfma_f32_32x32x16_bf16 v[96:111], v[160:163], a[104:107], v[96:111]
    ds_read_b64_tr_b16 v[172:173], v216 offset:29184
    ds_read_b64_tr_b16 v[174:175], v216 offset:29440
    v_mfma_f32_32x32x16_bf16 v[112:127], v[160:163], a[108:111], v[112:127]
    buffer_load_dwordx4 a[172:175], v210, s[24:27], s65 offen offset:1024 sc1
    s_waitcnt lgkmcnt(4)
    v_mfma_f32_32x32x16_bf16 v[128:143], v[164:167], a[104:107], v[128:143]
    ds_read_b64_tr_b16 v[160:161], v204 offset:51200
    ds_read_b64_tr_b16 v[162:163], v204 offset:51456
    v_mfma_f32_32x32x16_bf16 v[144:159], v[164:167], a[108:111], v[144:159]
    s_waitcnt vmcnt(15) lgkmcnt(4)
    v_mfma_f32_32x32x16_bf16 v[64:79], v[168:171], a[112:115], v[64:79]
    ds_read_b64_tr_b16 v[164:165], v216 offset:30720
    ds_read_b64_tr_b16 v[166:167], v216 offset:30976
    s_waitcnt vmcnt(14)
    v_mfma_f32_32x32x16_bf16 v[80:95], v[168:171], a[116:119], v[80:95]
    buffer_load_dwordx4 a[176:179], v210, s[24:27], s64 offen offset:2048 sc1
    s_waitcnt lgkmcnt(4)
    v_mfma_f32_32x32x16_bf16 v[96:111], v[172:175], a[112:115], v[96:111]
    ds_read_b64_tr_b16 v[168:169], v216 offset:31232
    ds_read_b64_tr_b16 v[170:171], v216 offset:31488
    v_mfma_f32_32x32x16_bf16 v[112:127], v[172:175], a[116:119], v[112:127]
    buffer_load_dwordx4 a[180:183], v210, s[24:27], s65 offen offset:2048 sc1
    s_waitcnt lgkmcnt(4)
    v_mfma_f32_32x32x16_bf16 v[128:143], v[160:163], a[112:115], v[128:143]
    ds_read_b64_tr_b16 v[172:173], v204 offset:52224
    ds_read_b64_tr_b16 v[174:175], v204 offset:52480
    v_mfma_f32_32x32x16_bf16 v[144:159], v[160:163], a[116:119], v[144:159]
    s_waitcnt vmcnt(15) lgkmcnt(4)
    v_mfma_f32_32x32x16_bf16 v[64:79], v[164:167], a[120:123], v[64:79]
    ds_read_b64_tr_b16 v[160:161], v216 offset:32768
    ds_read_b64_tr_b16 v[162:163], v216 offset:33024
    s_waitcnt vmcnt(14)
    v_mfma_f32_32x32x16_bf16 v[80:95], v[164:167], a[124:127], v[80:95]
    buffer_load_dwordx4 a[184:187], v210, s[24:27], s64 offen offset:3072 sc1
    s_waitcnt lgkmcnt(4)
    v_mfma_f32_32x32x16_bf16 v[96:111], v[168:171], a[120:123], v[96:111]
    ds_read_b64_tr_b16 v[164:165], v216 offset:33280
    ds_read_b64_tr_b16 v[166:167], v216 offset:33536
    v_mfma_f32_32x32x16_bf16 v[112:127], v[168:171], a[124:127], v[112:127]
    buffer_load_dwordx4 a[188:191], v210, s[24:27], s65 offen offset:3072 sc1
    s_add_u32 s64, s64, 4096
    s_add_u32 s65, s65, 4096
    s_waitcnt lgkmcnt(4)
    v_mfma_f32_32x32x16_bf16 v[128:143], v[172:175], a[120:123], v[128:143]
    ds_read_b64_tr_b16 v[168:169], v204 offset:53248
    ds_read_b64_tr_b16 v[170:171], v204 offset:53504
    v_mfma_f32_32x32x16_bf16 v[144:159], v[172:175], a[124:127], v[144:159]
    s_waitcnt vmcnt(15) lgkmcnt(4)
    v_mfma_f32_32x32x16_bf16 v[64:79], v[160:163], a[128:131], v[64:79]
    ds_read_b64_tr_b16 v[172:173], v216 offset:34816
    ds_read_b64_tr_b16 v[174:175], v216 offset:35072
    s_waitcnt vmcnt(14)
    v_mfma_f32_32x32x16_bf16 v[80:95], v[160:163], a[132:135], v[80:95]
    buffer_load_dwordx4 a[192:195], v210, s[24:27], s64 offen offset:0 sc1
    s_waitcnt lgkmcnt(4)
    v_mfma_f32_32x32x16_bf16 v[96:111], v[164:167], a[128:131], v[96:111]
    ds_read_b64_tr_b16 v[160:161], v216 offset:35328
    ds_read_b64_tr_b16 v[162:163], v216 offset:35584
    v_mfma_f32_32x32x16_bf16 v[112:127], v[164:167], a[132:135], v[112:127]
    buffer_load_dwordx4 a[196:199], v210, s[24:27], s65 offen offset:0 sc1
    s_waitcnt lgkmcnt(4)
    v_mfma_f32_32x32x16_bf16 v[128:143], v[168:171], a[128:131], v[128:143]
    ds_read_b64_tr_b16 v[164:165], v204 offset:54272
    ds_read_b64_tr_b16 v[166:167], v204 offset:54528
    v_mfma_f32_32x32x16_bf16 v[144:159], v[168:171], a[132:135], v[144:159]
    s_barrier
    s_waitcnt vmcnt(15) lgkmcnt(4)
    v_mfma_f32_32x32x16_bf16 v[64:79], v[172:175], a[136:139], v[64:79]
    ds_read_b64_tr_b16 v[168:169], v203 offset:0
    ds_read_b64_tr_b16 v[170:171], v203 offset:256
    s_waitcnt vmcnt(14)
    v_mfma_f32_32x32x16_bf16 v[80:95], v[172:175], a[140:143], v[80:95]
    buffer_load_dwordx4 a[200:203], v210, s[24:27], s64 offen offset:1024 sc1
    s_waitcnt lgkmcnt(4)
    v_mfma_f32_32x32x16_bf16 v[96:111], v[160:163], a[136:139], v[96:111]
    ds_read_b64_tr_b16 v[172:173], v203 offset:512
    ds_read_b64_tr_b16 v[174:175], v203 offset:768
    v_mfma_f32_32x32x16_bf16 v[112:127], v[160:163], a[140:143], v[112:127]
    buffer_load_dwordx4 a[204:207], v210, s[24:27], s65 offen offset:1024 sc1
    s_waitcnt lgkmcnt(4)
    v_mfma_f32_32x32x16_bf16 v[128:143], v[164:167], a[136:139], v[128:143]
    ds_read_b64_tr_b16 v[160:161], v205 offset:36864
    ds_read_b64_tr_b16 v[162:163], v205 offset:37120
    v_mfma_f32_32x32x16_bf16 v[144:159], v[164:167], a[140:143], v[144:159]
    s_barrier
    s_waitcnt vmcnt(15) lgkmcnt(4)
    v_mfma_f32_32x32x16_bf16 v[64:79], v[168:171], a[144:147], v[64:79]
    ds_read_b64_tr_b16 v[164:165], v203 offset:2048
    ds_read_b64_tr_b16 v[166:167], v203 offset:2304
    s_add_u32 m0, s56, 0
    s_waitcnt vmcnt(14)
    v_mfma_f32_32x32x16_bf16 v[80:95], v[168:171], a[148:151], v[80:95]
    buffer_load_dwordx4 a[208:211], v210, s[24:27], s64 offen offset:2048 sc1
    buffer_load_dwordx4 v213, s[52:55], s57 offen lds
    s_add_u32 s57, s57, 147456
    s_waitcnt lgkmcnt(4)
    v_mfma_f32_32x32x16_bf16 v[96:111], v[172:175], a[144:147], v[96:111]
    ds_read_b64_tr_b16 v[168:169], v203 offset:2560
    ds_read_b64_tr_b16 v[170:171], v203 offset:2816
    v_mfma_f32_32x32x16_bf16 v[112:127], v[172:175], a[148:151], v[112:127]
    buffer_load_dwordx4 a[212:215], v210, s[24:27], s65 offen offset:2048 sc1
    s_waitcnt lgkmcnt(4)
    v_mfma_f32_32x32x16_bf16 v[128:143], v[160:163], a[144:147], v[128:143]
    ds_read_b64_tr_b16 v[172:173], v205 offset:37888
    ds_read_b64_tr_b16 v[174:175], v205 offset:38144
    v_mfma_f32_32x32x16_bf16 v[144:159], v[160:163], a[148:151], v[144:159]
    s_waitcnt vmcnt(16) lgkmcnt(4)
    v_mfma_f32_32x32x16_bf16 v[64:79], v[164:167], a[152:155], v[64:79]
    ds_read_b64_tr_b16 v[160:161], v203 offset:4096
    ds_read_b64_tr_b16 v[162:163], v203 offset:4352
    s_waitcnt vmcnt(15)
    v_mfma_f32_32x32x16_bf16 v[80:95], v[164:167], a[156:159], v[80:95]
    buffer_load_dwordx4 a[216:219], v210, s[24:27], s64 offen offset:3072 sc1
    s_waitcnt lgkmcnt(4)
    v_mfma_f32_32x32x16_bf16 v[96:111], v[168:171], a[152:155], v[96:111]
    ds_read_b64_tr_b16 v[164:165], v203 offset:4608
    ds_read_b64_tr_b16 v[166:167], v203 offset:4864
    v_mfma_f32_32x32x16_bf16 v[112:127], v[168:171], a[156:159], v[112:127]
    buffer_load_dwordx4 a[220:223], v210, s[24:27], s65 offen offset:3072 sc1
    s_add_u32 s64, s64, 4096
    s_add_u32 s65, s65, 4096
    s_waitcnt lgkmcnt(4)
    v_mfma_f32_32x32x16_bf16 v[128:143], v[172:175], a[152:155], v[128:143]
    ds_read_b64_tr_b16 v[168:169], v205 offset:38912
    ds_read_b64_tr_b16 v[170:171], v205 offset:39168
    v_mfma_f32_32x32x16_bf16 v[144:159], v[172:175], a[156:159], v[144:159]
    s_add_u32 m0, s56, 4096
    s_waitcnt vmcnt(16) lgkmcnt(4)
    v_mfma_f32_32x32x16_bf16 v[64:79], v[160:163], a[160:163], v[64:79]
    ds_read_b64_tr_b16 v[172:173], v203 offset:6144
    ds_read_b64_tr_b16 v[174:175], v203 offset:6400
    buffer_load_dwordx4 v213, s[52:55], s57 offen lds
    s_add_u32 s57, s57, 147456
    s_waitcnt vmcnt(16)
    v_mfma_f32_32x32x16_bf16 v[80:95], v[160:163], a[164:167], v[80:95]
    buffer_load_dwordx4 a[224:227], v210, s[24:27], s64 offen offset:0 sc1
    s_waitcnt lgkmcnt(4)
    v_mfma_f32_32x32x16_bf16 v[96:111], v[164:167], a[160:163], v[96:111]
    ds_read_b64_tr_b16 v[160:161], v203 offset:6656
    ds_read_b64_tr_b16 v[162:163], v203 offset:6912
    v_mfma_f32_32x32x16_bf16 v[112:127], v[164:167], a[164:167], v[112:127]
    buffer_load_dwordx4 a[228:231], v210, s[24:27], s65 offen offset:0 sc1
    s_waitcnt lgkmcnt(4)
    v_mfma_f32_32x32x16_bf16 v[128:143], v[168:171], a[160:163], v[128:143]
    ds_read_b64_tr_b16 v[164:165], v205 offset:39936
    ds_read_b64_tr_b16 v[166:167], v205 offset:40192
    v_mfma_f32_32x32x16_bf16 v[144:159], v[168:171], a[164:167], v[144:159]
    s_waitcnt vmcnt(17) lgkmcnt(4)
    v_mfma_f32_32x32x16_bf16 v[64:79], v[172:175], a[168:171], v[64:79]
    ds_read_b64_tr_b16 v[168:169], v203 offset:8192
    ds_read_b64_tr_b16 v[170:171], v203 offset:8448
    s_waitcnt vmcnt(16)
    v_mfma_f32_32x32x16_bf16 v[80:95], v[172:175], a[172:175], v[80:95]
    buffer_load_dwordx4 a[232:235], v210, s[24:27], s64 offen offset:1024 sc1
    s_waitcnt lgkmcnt(4)
    v_mfma_f32_32x32x16_bf16 v[96:111], v[160:163], a[168:171], v[96:111]
    ds_read_b64_tr_b16 v[172:173], v203 offset:8704
    ds_read_b64_tr_b16 v[174:175], v203 offset:8960
    v_mfma_f32_32x32x16_bf16 v[112:127], v[160:163], a[172:175], v[112:127]
    buffer_load_dwordx4 a[236:239], v210, s[24:27], s65 offen offset:1024 sc1
    s_waitcnt lgkmcnt(4)
    v_mfma_f32_32x32x16_bf16 v[128:143], v[164:167], a[168:171], v[128:143]
    ds_read_b64_tr_b16 v[160:161], v205 offset:40960
    ds_read_b64_tr_b16 v[162:163], v205 offset:41216
    s_add_u32 m0, s56, 8192
    v_mfma_f32_32x32x16_bf16 v[144:159], v[164:167], a[172:175], v[144:159]
    buffer_load_dwordx4 v213, s[52:55], s57 offen lds
    s_add_u32 s57, s57, 147456
    s_waitcnt vmcnt(18) lgkmcnt(4)
    v_mfma_f32_32x32x16_bf16 v[64:79], v[168:171], a[176:179], v[64:79]
    ds_read_b64_tr_b16 v[164:165], v203 offset:10240
    ds_read_b64_tr_b16 v[166:167], v203 offset:10496
    s_waitcnt vmcnt(17)
    v_mfma_f32_32x32x16_bf16 v[80:95], v[168:171], a[180:183], v[80:95]
    buffer_load_dwordx4 a[240:243], v210, s[24:27], s64 offen offset:2048 sc1
    s_waitcnt lgkmcnt(4)
    v_mfma_f32_32x32x16_bf16 v[96:111], v[172:175], a[176:179], v[96:111]
    ds_read_b64_tr_b16 v[168:169], v203 offset:10752
    ds_read_b64_tr_b16 v[170:171], v203 offset:11008
    v_mfma_f32_32x32x16_bf16 v[112:127], v[172:175], a[180:183], v[112:127]
    buffer_load_dwordx4 a[244:247], v210, s[24:27], s65 offen offset:2048 sc1
    s_waitcnt lgkmcnt(4)
    v_mfma_f32_32x32x16_bf16 v[128:143], v[160:163], a[176:179], v[128:143]
    ds_read_b64_tr_b16 v[172:173], v205 offset:41984
    ds_read_b64_tr_b16 v[174:175], v205 offset:42240
    v_mfma_f32_32x32x16_bf16 v[144:159], v[160:163], a[180:183], v[144:159]
    s_waitcnt vmcnt(18) lgkmcnt(4)
    v_mfma_f32_32x32x16_bf16 v[64:79], v[164:167], a[184:187], v[64:79]
    ds_read_b64_tr_b16 v[160:161], v203 offset:12288
    ds_read_b64_tr_b16 v[162:163], v203 offset:12544
    s_waitcnt vmcnt(17)
    v_mfma_f32_32x32x16_bf16 v[80:95], v[164:167], a[188:191], v[80:95]
    buffer_load_dwordx4 a[248:251], v210, s[24:27], s64 offen offset:3072 sc1
    s_waitcnt lgkmcnt(4)
    v_mfma_f32_32x32x16_bf16 v[96:111], v[168:171], a[184:187], v[96:111]
    ds_read_b64_tr_b16 v[164:165], v203 offset:12800
    ds_read_b64_tr_b16 v[166:167], v203 offset:13056
    v_mfma_f32_32x32x16_bf16 v[112:127], v[168:171], a[188:191], v[112:127]
    buffer_load_dwordx4 a[252:255], v210, s[24:27], s65 offen offset:3072 sc1
    s_add_u32 s64, s64, 4096
    s_add_u32 s65, s65, 4096
    s_add_u32 m0, s56, 12288
    s_waitcnt lgkmcnt(4)
    v_mfma_f32_32x32x16_bf16 v[128:143], v[172:175], a[184:187], v[128:143]
    ds_read_b64_tr_b16 v[168:169], v205 offset:43008
    ds_read_b64_tr_b16 v[170:171], v205 offset:43264
    buffer_load_dwordx4 v213, s[52:55], s57 offen lds
    s_add_u32 s57, s57, 147456
    v_mfma_f32_32x32x16_bf16 v[144:159], v[172:175], a[188:191], v[144:159]
    s_waitcnt vmcnt(19) lgkmcnt(4)
    v_mfma_f32_32x32x16_bf16 v[64:79], v[160:163], a[192:195], v[64:79]
    ds_read_b64_tr_b16 v[172:173], v203 offset:14336
    ds_read_b64_tr_b16 v[174:175], v203 offset:14592
    s_waitcnt vmcnt(18)
    v_mfma_f32_32x32x16_bf16 v[80:95], v[160:163], a[196:199], v[80:95]
    buffer_load_dwordx4 v[224:227], v210, s[24:27], s64 offen offset:0 sc1
    s_waitcnt lgkmcnt(4)
    v_mfma_f32_32x32x16_bf16 v[96:111], v[164:167], a[192:195], v[96:111]
    ds_read_b64_tr_b16 v[160:161], v203 offset:14848
    ds_read_b64_tr_b16 v[162:163], v203 offset:15104
    v_mfma_f32_32x32x16_bf16 v[112:127], v[164:167], a[196:199], v[112:127]
    buffer_load_dwordx4 v[228:231], v210, s[24:27], s65 offen offset:0 sc1
    s_waitcnt lgkmcnt(4)
    v_mfma_f32_32x32x16_bf16 v[128:143], v[168:171], a[192:195], v[128:143]
    ds_read_b64_tr_b16 v[164:165], v205 offset:44032
    ds_read_b64_tr_b16 v[166:167], v205 offset:44288
    v_mfma_f32_32x32x16_bf16 v[144:159], v[168:171], a[196:199], v[144:159]
    s_waitcnt vmcnt(19) lgkmcnt(4)
    v_mfma_f32_32x32x16_bf16 v[64:79], v[172:175], a[200:203], v[64:79]
    ds_read_b64_tr_b16 v[168:169], v203 offset:16384
    ds_read_b64_tr_b16 v[170:171], v203 offset:16640
    s_waitcnt vmcnt(18)
    v_mfma_f32_32x32x16_bf16 v[80:95], v[172:175], a[204:207], v[80:95]
    buffer_load_dwordx4 v[232:235], v210, s[24:27], s64 offen offset:1024 sc1
    s_waitcnt lgkmcnt(4)
    v_mfma_f32_32x32x16_bf16 v[96:111], v[160:163], a[200:203], v[96:111]
    ds_read_b64_tr_b16 v[172:173], v203 offset:16896
    ds_read_b64_tr_b16 v[174:175], v203 offset:17152
    s_add_u32 m0, s56, 16384
    v_mfma_f32_32x32x16_bf16 v[112:127], v[160:163], a[204:207], v[112:127]
    buffer_load_dwordx4 v[236:239], v210, s[24:27], s65 offen offset:1024 sc1
    buffer_load_dwordx4 v213, s[52:55], s57 offen lds
    s_add_u32 s57, s57, 147456
    s_waitcnt lgkmcnt(4)
    v_mfma_f32_32x32x16_bf16 v[128:143], v[164:167], a[200:203], v[128:143]
    ds_read_b64_tr_b16 v[160:161], v205 offset:45056
    ds_read_b64_tr_b16 v[162:163], v205 offset:45312
    v_mfma_f32_32x32x16_bf16 v[144:159], v[164:167], a[204:207], v[144:159]
    s_waitcnt vmcnt(20) lgkmcnt(4)
    v_mfma_f32_32x32x16_bf16 v[64:79], v[168:171], a[208:211], v[64:79]
    ds_read_b64_tr_b16 v[164:165], v203 offset:18432
    ds_read_b64_tr_b16 v[166:167], v203 offset:18688
    s_waitcnt vmcnt(18)
    v_mfma_f32_32x32x16_bf16 v[80:95], v[168:171], a[212:215], v[80:95]
    buffer_load_dwordx4 v[240:243], v210, s[24:27], s64 offen offset:2048 sc1
    s_waitcnt lgkmcnt(4)
    v_mfma_f32_32x32x16_bf16 v[96:111], v[172:175], a[208:211], v[96:111]
    ds_read_b64_tr_b16 v[168:169], v203 offset:18944
    ds_read_b64_tr_b16 v[170:171], v203 offset:19200
    v_mfma_f32_32x32x16_bf16 v[112:127], v[172:175], a[212:215], v[112:127]
    buffer_load_dwordx4 v[244:247], v210, s[24:27], s65 offen offset:2048 sc1
    s_waitcnt lgkmcnt(4)
    v_mfma_f32_32x32x16_bf16 v[128:143], v[160:163], a[208:211], v[128:143]
    ds_read_b64_tr_b16 v[172:173], v205 offset:46080
    ds_read_b64_tr_b16 v[174:175], v205 offset:46336
    v_mfma_f32_32x32x16_bf16 v[144:159], v[160:163], a[212:215], v[144:159]
    s_waitcnt vmcnt(19) lgkmcnt(4)
    v_mfma_f32_32x32x16_bf16 v[64:79], v[164:167], a[216:219], v[64:79]
    ds_read_b64_tr_b16 v[160:161], v203 offset:20480
    ds_read_b64_tr_b16 v[162:163], v203 offset:20736
    s_waitcnt vmcnt(18)
    v_mfma_f32_32x32x16_bf16 v[80:95], v[164:167], a[220:223], v[80:95]
    buffer_load_dwordx4 v[248:251], v210, s[24:27], s64 offen offset:3072 sc1
    s_add_u32 m0, s56, 20480
    s_waitcnt lgkmcnt(4)
    v_mfma_f32_32x32x16_bf16 v[96:111], v[168:171], a[216:219], v[96:111]
    ds_read_b64_tr_b16 v[164:165], v203 offset:20992
    ds_read_b64_tr_b16 v[166:167], v203 offset:21248
    buffer_load_dwordx4 v213, s[52:55], s57 offen lds
    s_add_u32 s57, s57, 147456
    v_mfma_f32_32x32x16_bf16 v[112:127], v[168:171], a[220:223], v[112:127]
    buffer_load_dwordx4 v[252:255], v210, s[24:27], s65 offen offset:3072 sc1
    s_add_u32 s64, s64, 4096
    s_add_u32 s65, s65, 4096
    s_waitcnt lgkmcnt(4)
    v_mfma_f32_32x32x16_bf16 v[128:143], v[172:175], a[216:219], v[128:143]
    ds_read_b64_tr_b16 v[168:169], v205 offset:47104
    ds_read_b64_tr_b16 v[170:171], v205 offset:47360
    v_mfma_f32_32x32x16_bf16 v[144:159], v[172:175], a[220:223], v[144:159]
    s_waitcnt vmcnt(19) lgkmcnt(4)
    v_mfma_f32_32x32x16_bf16 v[64:79], v[160:163], a[224:227], v[64:79]
    ds_read_b64_tr_b16 v[172:173], v203 offset:22528
    ds_read_b64_tr_b16 v[174:175], v203 offset:22784
    s_waitcnt vmcnt(18)
    v_mfma_f32_32x32x16_bf16 v[80:95], v[160:163], a[228:231], v[80:95]
    s_waitcnt lgkmcnt(4)
    v_mfma_f32_32x32x16_bf16 v[96:111], v[164:167], a[224:227], v[96:111]
    ds_read_b64_tr_b16 v[160:161], v203 offset:23040
    ds_read_b64_tr_b16 v[162:163], v203 offset:23296
    v_mfma_f32_32x32x16_bf16 v[112:127], v[164:167], a[228:231], v[112:127]
    s_waitcnt lgkmcnt(4)
    v_mfma_f32_32x32x16_bf16 v[128:143], v[168:171], a[224:227], v[128:143]
    ds_read_b64_tr_b16 v[164:165], v205 offset:48128
    ds_read_b64_tr_b16 v[166:167], v205 offset:48384
    v_mfma_f32_32x32x16_bf16 v[144:159], v[168:171], a[228:231], v[144:159]
    s_waitcnt vmcnt(17) lgkmcnt(4)
    v_mfma_f32_32x32x16_bf16 v[64:79], v[172:175], a[232:235], v[64:79]
    ds_read_b64_tr_b16 v[168:169], v203 offset:24576
    ds_read_b64_tr_b16 v[170:171], v203 offset:24832
    s_add_u32 m0, s56, 24576
    s_waitcnt vmcnt(16)
    v_mfma_f32_32x32x16_bf16 v[80:95], v[172:175], a[236:239], v[80:95]
    buffer_load_dwordx4 v213, s[52:55], s57 offen lds
    s_add_u32 s57, s57, 147456
    s_waitcnt lgkmcnt(4)
    v_mfma_f32_32x32x16_bf16 v[96:111], v[160:163], a[232:235], v[96:111]
    ds_read_b64_tr_b16 v[172:173], v203 offset:25088
    ds_read_b64_tr_b16 v[174:175], v203 offset:25344
    v_mfma_f32_32x32x16_bf16 v[112:127], v[160:163], a[236:239], v[112:127]
    s_waitcnt lgkmcnt(4)
    v_mfma_f32_32x32x16_bf16 v[128:143], v[164:167], a[232:235], v[128:143]
    ds_read_b64_tr_b16 v[160:161], v205 offset:49152
    ds_read_b64_tr_b16 v[162:163], v205 offset:49408
    v_mfma_f32_32x32x16_bf16 v[144:159], v[164:167], a[236:239], v[144:159]
    s_waitcnt vmcnt(15) lgkmcnt(4)
    v_mfma_f32_32x32x16_bf16 v[64:79], v[168:171], a[240:243], v[64:79]
    ds_read_b64_tr_b16 v[164:165], v203 offset:26624
    ds_read_b64_tr_b16 v[166:167], v203 offset:26880
    s_waitcnt vmcnt(14)
    v_mfma_f32_32x32x16_bf16 v[80:95], v[168:171], a[244:247], v[80:95]
    s_waitcnt lgkmcnt(4)
    v_mfma_f32_32x32x16_bf16 v[96:111], v[172:175], a[240:243], v[96:111]
    ds_read_b64_tr_b16 v[168:169], v203 offset:27136
    ds_read_b64_tr_b16 v[170:171], v203 offset:27392
    v_mfma_f32_32x32x16_bf16 v[112:127], v[172:175], a[244:247], v[112:127]
    s_waitcnt lgkmcnt(4)
    v_mfma_f32_32x32x16_bf16 v[128:143], v[160:163], a[240:243], v[128:143]
    ds_read_b64_tr_b16 v[172:173], v205 offset:50176
    ds_read_b64_tr_b16 v[174:175], v205 offset:50432
    v_mfma_f32_32x32x16_bf16 v[144:159], v[160:163], a[244:247], v[144:159]
    s_add_u32 m0, s56, 28672
    s_waitcnt vmcnt(13) lgkmcnt(4)
    v_mfma_f32_32x32x16_bf16 v[64:79], v[164:167], a[248:251], v[64:79]
    ds_read_b64_tr_b16 v[160:161], v203 offset:28672
    ds_read_b64_tr_b16 v[162:163], v203 offset:28928
    buffer_load_dwordx4 v213, s[52:55], s57 offen lds
    s_add_u32 s57, s57, 147456
    s_waitcnt vmcnt(13)
    v_mfma_f32_32x32x16_bf16 v[80:95], v[164:167], a[252:255], v[80:95]
    s_waitcnt lgkmcnt(4)
    v_mfma_f32_32x32x16_bf16 v[96:111], v[168:171], a[248:251], v[96:111]
    ds_read_b64_tr_b16 v[164:165], v203 offset:29184
    ds_read_b64_tr_b16 v[166:167], v203 offset:29440
    v_mfma_f32_32x32x16_bf16 v[112:127], v[168:171], a[252:255], v[112:127]
    s_waitcnt lgkmcnt(4)
    v_mfma_f32_32x32x16_bf16 v[128:143], v[172:175], a[248:251], v[128:143]
    ds_read_b64_tr_b16 v[168:169], v205 offset:51200
    ds_read_b64_tr_b16 v[170:171], v205 offset:51456
    v_mfma_f32_32x32x16_bf16 v[144:159], v[172:175], a[252:255], v[144:159]
    s_waitcnt vmcnt(11) lgkmcnt(4)
    v_mfma_f32_32x32x16_bf16 v[64:79], v[160:163], v[224:227], v[64:79]
    ds_read_b64_tr_b16 v[172:173], v203 offset:30720
    ds_read_b64_tr_b16 v[174:175], v203 offset:30976
    s_waitcnt vmcnt(10)
    v_mfma_f32_32x32x16_bf16 v[80:95], v[160:163], v[228:231], v[80:95]
    s_waitcnt lgkmcnt(4)
    v_mfma_f32_32x32x16_bf16 v[96:111], v[164:167], v[224:227], v[96:111]
    ds_read_b64_tr_b16 v[160:161], v203 offset:31232
    ds_read_b64_tr_b16 v[162:163], v203 offset:31488
    v_mfma_f32_32x32x16_bf16 v[112:127], v[164:167], v[228:231], v[112:127]
    s_waitcnt lgkmcnt(4)
    v_mfma_f32_32x32x16_bf16 v[128:143], v[168:171], v[224:227], v[128:143]
    ds_read_b64_tr_b16 v[164:165], v205 offset:52224
    ds_read_b64_tr_b16 v[166:167], v205 offset:52480
    s_add_u32 m0, s56, 32768
    v_mfma_f32_32x32x16_bf16 v[144:159], v[168:171], v[228:231], v[144:159]
    buffer_load_dwordx4 v213, s[52:55], s57 offen lds
    s_add_u32 s57, s57, 147456
    s_waitcnt vmcnt(10) lgkmcnt(4)
    v_mfma_f32_32x32x16_bf16 v[64:79], v[172:175], v[232:235], v[64:79]
    ds_read_b64_tr_b16 v[168:169], v203 offset:32768
    ds_read_b64_tr_b16 v[170:171], v203 offset:33024
    s_waitcnt vmcnt(9)
    v_mfma_f32_32x32x16_bf16 v[80:95], v[172:175], v[236:239], v[80:95]
    s_waitcnt lgkmcnt(4)
    v_mfma_f32_32x32x16_bf16 v[96:111], v[160:163], v[232:235], v[96:111]
    ds_read_b64_tr_b16 v[172:173], v203 offset:33280
    ds_read_b64_tr_b16 v[174:175], v203 offset:33536
    v_mfma_f32_32x32x16_bf16 v[112:127], v[160:163], v[236:239], v[112:127]
    s_waitcnt lgkmcnt(4)
    v_mfma_f32_32x32x16_bf16 v[128:143], v[164:167], v[232:235], v[128:143]
    ds_read_b64_tr_b16 v[160:161], v205 offset:53248
    ds_read_b64_tr_b16 v[162:163], v205 offset:53504
    v_mfma_f32_32x32x16_bf16 v[144:159], v[164:167], v[236:239], v[144:159]
    s_waitcnt vmcnt(7) lgkmcnt(4)
    v_mfma_f32_32x32x16_bf16 v[64:79], v[168:171], v[240:243], v[64:79]
    ds_read_b64_tr_b16 v[164:165], v203 offset:34816
    ds_read_b64_tr_b16 v[166:167], v203 offset:35072
    s_waitcnt vmcnt(6)
    v_mfma_f32_32x32x16_bf16 v[80:95], v[168:171], v[244:247], v[80:95]
    s_waitcnt lgkmcnt(4)
    v_mfma_f32_32x32x16_bf16 v[96:111], v[172:175], v[240:243], v[96:111]
    ds_read_b64_tr_b16 v[168:169], v203 offset:35328
    ds_read_b64_tr_b16 v[170:171], v203 offset:35584
    v_mfma_f32_32x32x16_bf16 v[112:127], v[172:175], v[244:247], v[112:127]
    s_waitcnt lgkmcnt(4)
    v_mfma_f32_32x32x16_bf16 v[128:143], v[160:163], v[240:243], v[128:143]
    ds_read_b64_tr_b16 v[172:173], v205 offset:54272
    ds_read_b64_tr_b16 v[174:175], v205 offset:54528
    v_mfma_f32_32x32x16_bf16 v[144:159], v[160:163], v[244:247], v[144:159]
    s_waitcnt vmcnt(5) lgkmcnt(4)
    v_mfma_f32_32x32x16_bf16 v[64:79], v[164:167], v[248:251], v[64:79]
    ds_read_b64_tr_b16 v[160:161], v219 offset:0
    ds_read_b64_tr_b16 v[162:163], v219 offset:256
    s_waitcnt vmcnt(3)
    v_mfma_f32_32x32x16_bf16 v[80:95], v[164:167], v[252:255], v[80:95]
    s_waitcnt lgkmcnt(4)
    v_mfma_f32_32x32x16_bf16 v[96:111], v[168:171], v[248:251], v[96:111]
    ds_read_b64_tr_b16 v[164:165], v219 offset:2048
    ds_read_b64_tr_b16 v[166:167], v219 offset:2304
    v_mfma_f32_32x32x16_bf16 v[112:127], v[168:171], v[252:255], v[112:127]
    s_waitcnt lgkmcnt(4)
    v_mfma_f32_32x32x16_bf16 v[128:143], v[172:175], v[248:251], v[128:143]
    ds_read_b64_tr_b16 v[168:169], v219 offset:4096
    ds_read_b64_tr_b16 v[170:171], v219 offset:4352
    v_mfma_f32_32x32x16_bf16 v[144:159], v[172:175], v[252:255], v[144:159]
    s_waitcnt lgkmcnt(4)
    v_mfma_f32_32x32x16_bf16 v[0:15], v[160:163], a[0:3], 0
    s_waitcnt vmcnt(0)
    s_barrier
    ds_read_b64_tr_b16 v[172:173], v219 offset:6144
    ds_read_b64_tr_b16 v[174:175], v219 offset:6400
    v_mfma_f32_32x32x16_bf16 v[32:47], v[160:163], a[4:7], 0
    s_waitcnt lgkmcnt(4)
    v_mfma_f32_32x32x16_bf16 v[16:31], v[164:167], a[0:3], 0
    ds_read_b64_tr_b16 v[160:161], v219 offset:8192
    ds_read_b64_tr_b16 v[162:163], v219 offset:8448
    s_add_u32 m0, s56, 36864
    v_mfma_f32_32x32x16_bf16 v[48:63], v[164:167], a[4:7], 0
    buffer_load_dwordx4 v213, s[52:55], s57 offen lds
    s_add_u32 s57, s57, 147456
    s_add_u32 s34, s66, 0
    s_cmp_lt_u32 s34, 18
    s_cselect_b32 s62, 0x3eae1a93, 1.0
    s_mov_b32 s63, s62
    s_lshl_b32 s34, s34, 17
    s_add_u32 s35, s34, s60
    v_mul_f32 v64, s62, v64
    v_mul_f32 v65, s62, v65
    s_waitcnt lgkmcnt(4)
    v_mfma_f32_32x32x16_bf16 v[0:15], v[168:171], a[8:11], v[0:15]
    ds_read_b64_tr_b16 v[164:165], v219 offset:10240
    ds_read_b64_tr_b16 v[166:167], v219 offset:10496
    v_mul_f32 v66, s62, v66
    v_mul_f32 v67, s62, v67
    v_mul_f32 v68, s62, v68
    v_mul_f32 v69, s62, v69
    v_mfma_f32_32x32x16_bf16 v[32:47], v[168:171], a[12:15], v[32:47]
    s_add_u32 m0, s56, 40960
    v_mul_f32 v70, s62, v70
    v_mul_f32 v71, s62, v71
    v_mul_f32 v72, s62, v72
    v_mul_f32 v73, s62, v73
    s_waitcnt lgkmcnt(4)
    v_mfma_f32_32x32x16_bf16 v[16:31], v[172:175], a[8:11], v[16:31]
    ds_read_b64_tr_b16 v[168:169], v219 offset:12288
    ds_read_b64_tr_b16 v[170:171], v219 offset:12544
    buffer_load_dwordx4 v213, s[52:55], s57 offen lds
    s_add_u32 s57, s57, 147456
    v_mul_f32 v74, s62, v74
    v_mul_f32 v75, s62, v75
    v_mul_f32 v76, s62, v76
    v_mul_f32 v77, s62, v77
    v_mfma_f32_32x32x16_bf16 v[48:63], v[172:175], a[12:15], v[48:63]
    v_mul_f32 v78, s62, v78
    v_mul_f32 v79, s62, v79
    v_cvt_pk_bf16_f32 v176, v64, v65
    v_cvt_pk_bf16_f32 v177, v66, v67
    s_waitcnt lgkmcnt(4)
    v_mfma_f32_32x32x16_bf16 v[0:15], v[160:163], a[16:19], v[0:15]
    ds_read_b64_tr_b16 v[172:173], v219 offset:14336
    ds_read_b64_tr_b16 v[174:175], v219 offset:14592
    s_add_u32 m0, s56, 45056
    v_cvt_pk_bf16_f32 v178, v68, v69
    v_cvt_pk_bf16_f32 v179, v70, v71
    v_cvt_pk_bf16_f32 v180, v72, v73
    v_cvt_pk_bf16_f32 v181, v74, v75
    v_mfma_f32_32x32x16_bf16 v[32:47], v[160:163], a[20:23], v[32:47]
    buffer_load_dwordx4 v213, s[52:55], s57 offen lds
    s_add_u32 s57, s57, 147456
    v_cvt_pk_bf16_f32 v182, v76, v77
    v_cvt_pk_bf16_f32 v183, v78, v79
    v_permlane32_swap_b32 v176, v178
    v_permlane32_swap_b32 v177, v179
    s_waitcnt lgkmcnt(4)
    v_mfma_f32_32x32x16_bf16 v[16:31], v[164:167], a[16:19], v[16:31]
    ds_read_b64_tr_b16 v[160:161], v219 offset:16384
    ds_read_b64_tr_b16 v[162:163], v219 offset:16640
    s_add_u32 s34, s35, 0
    buffer_store_dwordx4 v[176:179], v215, s[24:27], s34 offen sc1
    v_permlane32_swap_b32 v180, v182
    v_permlane32_swap_b32 v181, v183
    v_mfma_f32_32x32x16_bf16 v[48:63], v[164:167], a[20:23], v[48:63]
    s_add_u32 s34, s35, 65536
    buffer_store_dwordx4 v[180:183], v215, s[24:27], s34 offen sc1
    v_mul_f32 v80, s62, v80
    v_mul_f32 v81, s62, v81
    v_mul_f32 v82, s62, v82
    s_waitcnt lgkmcnt(4)
    v_mfma_f32_32x32x16_bf16 v[0:15], v[168:171], a[24:27], v[0:15]
    ds_read_b64_tr_b16 v[164:165], v219 offset:18432
    ds_read_b64_tr_b16 v[166:167], v219 offset:18688
    s_add_u32 m0, s56, 49152
    v_mul_f32 v83, s62, v83
    v_mul_f32 v84, s62, v84
    v_mul_f32 v85, s62, v85
    v_mul_f32 v86, s62, v86
    v_mfma_f32_32x32x16_bf16 v[32:47], v[168:171], a[28:31], v[32:47]
    buffer_load_dwordx4 v213, s[52:55], s57 offen lds
    s_add_u32 s57, s57, 147456
    v_mul_f32 v87, s62, v87
    v_mul_f32 v88, s62, v88
    v_mul_f32 v89, s62, v89
    v_mul_f32 v90, s62, v90
    s_waitcnt lgkmcnt(4)
    v_mfma_f32_32x32x16_bf16 v[16:31], v[172:175], a[24:27], v[16:31]
    ds_read_b64_tr_b16 v[168:169], v219 offset:20480
    ds_read_b64_tr_b16 v[170:171], v219 offset:20736
    v_mul_f32 v91, s62, v91
    v_mul_f32 v92, s62, v92
    v_mul_f32 v93, s62, v93
    v_mul_f32 v94, s62, v94
    v_mfma_f32_32x32x16_bf16 v[48:63], v[172:175], a[28:31], v[48:63]
    s_add_u32 m0, s56, 53248
    v_mul_f32 v95, s62, v95
    v_cvt_pk_bf16_f32 v184, v80, v81
    v_cvt_pk_bf16_f32 v185, v82, v83
    v_cvt_pk_bf16_f32 v186, v84, v85
    s_waitcnt lgkmcnt(4)
    v_mfma_f32_32x32x16_bf16 v[0:15], v[160:163], a[32:35], v[0:15]
    ds_read_b64_tr_b16 v[172:173], v219 offset:22528
    ds_read_b64_tr_b16 v[174:175], v219 offset:22784
    buffer_load_dwordx4 v213, s[52:55], s57 offen lds
    s_add_u32 s57, s57, 147456
    v_cvt_pk_bf16_f32 v187, v86, v87
    v_cvt_pk_bf16_f32 v188, v88, v89
    v_cvt_pk_bf16_f32 v189, v90, v91
    v_cvt_pk_bf16_f32 v190, v92, v93
    v_mfma_f32_32x32x16_bf16 v[32:47], v[160:163], a[36:39], v[32:47]
    v_cvt_pk_bf16_f32 v191, v94, v95
    v_permlane32_swap_b32 v184, v186
    v_permlane32_swap_b32 v185, v187
    s_add_u32 s34, s35, 512
    buffer_store_dwordx4 v[184:187], v215, s[24:27], s34 offen sc1
    s_waitcnt lgkmcnt(4)
    v_mfma_f32_32x32x16_bf16 v[16:31], v[164:167], a[32:35], v[16:31]
    ds_read_b64_tr_b16 v[160:161], v219 offset:24576
    ds_read_b64_tr_b16 v[162:163], v219 offset:24832
    v_permlane32_swap_b32 v188, v190
    v_permlane32_swap_b32 v189, v191
    s_add_u32 s34, s35, 66048
    buffer_store_dwordx4 v[188:191], v215, s[24:27], s34 offen sc1
    v_mfma_f32_32x32x16_bf16 v[48:63], v[164:167], a[36:39], v[48:63]
    s_add_u32 m0, s56, 57344
    s_add_u32 s34, s66, 1
    s_cmp_lt_u32 s34, 18
    s_cselect_b32 s62, 0x3eae1a93, 1.0
    s_mov_b32 s63, s62
    s_lshl_b32 s34, s34, 17
    s_add_u32 s35, s34, s60
    v_mul_f32 v96, s62, v96
    v_mul_f32 v97, s62, v97
    s_waitcnt lgkmcnt(4)
    v_mfma_f32_32x32x16_bf16 v[0:15], v[168:171], a[40:43], v[0:15]
    ds_read_b64_tr_b16 v[164:165], v219 offset:26624
    ds_read_b64_tr_b16 v[166:167], v219 offset:26880
    buffer_load_dwordx4 v213, s[52:55], s57 offen lds
    s_add_u32 s57, s57, 147456
    v_mul_f32 v98, s62, v98
    v_mul_f32 v99, s62, v99
    v_mul_f32 v100, s62, v100
    v_mul_f32 v101, s62, v101
    v_mfma_f32_32x32x16_bf16 v[32:47], v[168:171], a[44:47], v[32:47]
    v_mul_f32 v102, s62, v102
    v_mul_f32 v103, s62, v103
    v_mul_f32 v104, s62, v104
    v_mul_f32 v105, s62, v105
    s_waitcnt lgkmcnt(4)
    v_mfma_f32_32x32x16_bf16 v[16:31], v[172:175], a[40:43], v[16:31]
    ds_read_b64_tr_b16 v[168:169], v219 offset:28672
    ds_read_b64_tr_b16 v[170:171], v219 offset:28928
    s_add_u32 m0, s56, 61440
    v_mul_f32 v106, s62, v106
    v_mul_f32 v107, s62, v107
    v_mul_f32 v108, s62, v108
    v_mul_f32 v109, s62, v109
    v_mfma_f32_32x32x16_bf16 v[48:63], v[172:175], a[44:47], v[48:63]
    buffer_load_dwordx4 v213, s[52:55], s57 offen lds
    s_add_u32 s57, s57, 147456
    v_mul_f32 v110, s62, v110
    v_mul_f32 v111, s62, v111
    v_cvt_pk_bf16_f32 v176, v96, v97
    v_cvt_pk_bf16_f32 v177, v98, v99
    s_waitcnt lgkmcnt(4)
    v_mfma_f32_32x32x16_bf16 v[0:15], v[160:163], a[48:51], v[0:15]
    ds_read_b64_tr_b16 v[172:173], v219 offset:30720
    ds_read_b64_tr_b16 v[174:175], v219 offset:30976
    v_cvt_pk_bf16_f32 v178, v100, v101
    v_cvt_pk_bf16_f32 v179, v102, v103
    v_cvt_pk_bf16_f32 v180, v104, v105
    v_cvt_pk_bf16_f32 v181, v106, v107
    v_mfma_f32_32x32x16_bf16 v[32:47], v[160:163], a[52:55], v[32:47]
    v_cvt_pk_bf16_f32 v182, v108, v109
    v_cvt_pk_bf16_f32 v183, v110, v111
    v_permlane32_swap_b32 v176, v178
    v_permlane32_swap_b32 v177, v179
    s_waitcnt lgkmcnt(4)
    v_mfma_f32_32x32x16_bf16 v[16:31], v[164:167], a[48:51], v[16:31]
    ds_read_b64_tr_b16 v[160:161], v219 offset:32768
    ds_read_b64_tr_b16 v[162:163], v219 offset:33024
    s_add_u32 m0, s56, 65536
    s_add_u32 s34, s35, 0
    buffer_store_dwordx4 v[176:179], v215, s[24:27], s34 offen sc1
    v_permlane32_swap_b32 v180, v182
    v_permlane32_swap_b32 v181, v183
    v_mfma_f32_32x32x16_bf16 v[48:63], v[164:167], a[52:55], v[48:63]
    buffer_load_dwordx4 v213, s[52:55], s57 offen lds
    s_add_u32 s57, s57, 147456
    s_add_u32 s34, s35, 65536
    buffer_store_dwordx4 v[180:183], v215, s[24:27], s34 offen sc1
    v_mul_f32 v112, s62, v112
    v_mul_f32 v113, s62, v113
    v_mul_f32 v114, s62, v114
    s_waitcnt lgkmcnt(4)
    v_mfma_f32_32x32x16_bf16 v[0:15], v[168:171], a[56:59], v[0:15]
    ds_read_b64_tr_b16 v[164:165], v219 offset:34816
    ds_read_b64_tr_b16 v[166:167], v219 offset:35072
    v_mul_f32 v115, s62, v115
    v_mul_f32 v116, s62, v116
    v_mul_f32 v117, s62, v117
    v_mul_f32 v118, s62, v118
    v_mfma_f32_32x32x16_bf16 v[32:47], v[168:171], a[60:63], v[32:47]
    s_add_u32 m0, s56, 69632
    v_mul_f32 v119, s62, v119
    v_mul_f32 v120, s62, v120
    v_mul_f32 v121, s62, v121
    v_mul_f32 v122, s62, v122
    s_waitcnt lgkmcnt(4)
    v_mfma_f32_32x32x16_bf16 v[16:31], v[172:175], a[56:59], v[16:31]
    ds_read_b64_tr_b16 v[168:169], v219 offset:512
    ds_read_b64_tr_b16 v[170:171], v219 offset:768
    buffer_load_dwordx4 v213, s[52:55], s57 offen lds
    s_add_u32 s57, s57, 147456
    v_mul_f32 v123, s62, v123
    v_mul_f32 v124, s62, v124
    v_mul_f32 v125, s62, v125
    v_mul_f32 v126, s62, v126
    v_mfma_f32_32x32x16_bf16 v[48:63], v[172:175], a[60:63], v[48:63]
    v_mul_f32 v127, s62, v127
    v_cvt_pk_bf16_f32 v184, v112, v113
    v_cvt_pk_bf16_f32 v185, v114, v115
    v_cvt_pk_bf16_f32 v186, v116, v117
    s_waitcnt lgkmcnt(4)
    v_mfma_f32_32x32x16_bf16 v[0:15], v[160:163], a[64:67], v[0:15]
    ds_read_b64_tr_b16 v[172:173], v219 offset:2560
    ds_read_b64_tr_b16 v[174:175], v219 offset:2816
    v_cvt_pk_bf16_f32 v187, v118, v119
    v_cvt_pk_bf16_f32 v188, v120, v121
    v_cvt_pk_bf16_f32 v189, v122, v123
    v_cvt_pk_bf16_f32 v190, v124, v125
    v_mfma_f32_32x32x16_bf16 v[32:47], v[160:163], a[68:71], v[32:47]
    s_add_u32 m0, s56, 73728
    v_cvt_pk_bf16_f32 v191, v126, v127
    v_permlane32_swap_b32 v184, v186
    v_permlane32_swap_b32 v185, v187
    s_add_u32 s34, s35, 512
    buffer_store_dwordx4 v[184:187], v215, s[24:27], s34 offen sc1
    s_waitcnt lgkmcnt(4)
    v_mfma_f32_32x32x16_bf16 v[16:31], v[164:167], a[64:67], v[16:31]
    ds_read_b64_tr_b16 v[160:161], v219 offset:4608
    ds_read_b64_tr_b16 v[162:163], v219 offset:4864
    buffer_load_dwordx4 v213, s[52:55], s57 offen lds
    s_add_u32 s57, s57, 147456
    v_permlane32_swap_b32 v188, v190
    v_permlane32_swap_b32 v189, v191
    s_add_u32 s34, s35, 66048
    buffer_store_dwordx4 v[188:191], v215, s[24:27], s34 offen sc1
    v_mfma_f32_32x32x16_bf16 v[48:63], v[164:167], a[68:71], v[48:63]
    s_waitcnt lgkmcnt(4)
    v_mfma_f32_32x32x16_bf16 v[64:79], v[168:171], a[0:3], 0
    ds_read_b64_tr_b16 v[164:165], v219 offset:6656
    ds_read_b64_tr_b16 v[166:167], v219 offset:6912
    s_add_u32 m0, s56, 77824
    v_mfma_f32_32x32x16_bf16 v[96:111], v[168:171], a[4:7], 0
    buffer_load_dwordx4 v213, s[52:55], s57 offen lds
    s_add_u32 s57, s57, 147456
    s_waitcnt lgkmcnt(4)
    v_mfma_f32_32x32x16_bf16 v[80:95], v[172:175], a[0:3], 0
    ds_read_b64_tr_b16 v[168:169], v219 offset:8704
    ds_read_b64_tr_b16 v[170:171], v219 offset:8960
    v_mfma_f32_32x32x16_bf16 v[112:127], v[172:175], a[4:7], 0
    s_add_u32 m0, s56, 81920
    s_add_u32 s34, s67, 0
    s_cmp_lt_u32 s34, 18
    s_cselect_b32 s62, 0x3eae1a93, 1.0
    s_mov_b32 s63, s62
    s_lshl_b32 s34, s34, 17
    s_add_u32 s35, s34, s60
    s_waitcnt lgkmcnt(4)
    v_mfma_f32_32x32x16_bf16 v[64:79], v[160:163], a[8:11], v[64:79]
    ds_read_b64_tr_b16 v[172:173], v219 offset:10752
    ds_read_b64_tr_b16 v[174:175], v219 offset:11008
    buffer_load_dwordx4 v213, s[52:55], s57 offen lds
    s_add_u32 s57, s57, 147456
    v_mul_f32 v128, s62, v128
    v_mul_f32 v129, s62, v129
    v_mfma_f32_32x32x16_bf16 v[96:111], v[160:163], a[12:15], v[96:111]
    v_mul_f32 v130, s62, v130
    v_mul_f32 v131, s62, v131
    s_waitcnt lgkmcnt(4)
    v_mfma_f32_32x32x16_bf16 v[80:95], v[164:167], a[8:11], v[80:95]
    ds_read_b64_tr_b16 v[160:161], v219 offset:12800
    ds_read_b64_tr_b16 v[162:163], v219 offset:13056
    v_mul_f32 v132, s62, v132
    v_mul_f32 v133, s62, v133
    v_mfma_f32_32x32x16_bf16 v[112:127], v[164:167], a[12:15], v[112:127]
    s_add_u32 m0, s56, 86016
    v_mul_f32 v134, s62, v134
    v_mul_f32 v135, s62, v135
    s_waitcnt lgkmcnt(4)
    v_mfma_f32_32x32x16_bf16 v[64:79], v[168:171], a[16:19], v[64:79]
    ds_read_b64_tr_b16 v[164:165], v219 offset:14848
    ds_read_b64_tr_b16 v[166:167], v219 offset:15104
    buffer_load_dwordx4 v213, s[52:55], s57 offen lds
    s_add_u32 s57, s57, 147456
    v_mul_f32 v136, s62, v136
    v_mul_f32 v137, s62, v137
    v_mfma_f32_32x32x16_bf16 v[96:111], v[168:171], a[20:23], v[96:111]
    v_mul_f32 v138, s62, v138
    v_mul_f32 v139, s62, v139
    s_waitcnt lgkmcnt(4)
    v_mfma_f32_32x32x16_bf16 v[80:95], v[172:175], a[16:19], v[80:95]
    ds_read_b64_tr_b16 v[168:169], v219 offset:16896
    ds_read_b64_tr_b16 v[170:171], v219 offset:17152
    s_add_u32 m0, s56, 90112
    v_mul_f32 v140, s62, v140
    v_mul_f32 v141, s62, v141
    v_mfma_f32_32x32x16_bf16 v[112:127], v[172:175], a[20:23], v[112:127]
    buffer_load_dwordx4 v213, s[52:55], s57 offen lds
    s_add_u32 s57, s57, 147456
    v_mul_f32 v142, s62, v142
    v_mul_f32 v143, s62, v143
    s_waitcnt lgkmcnt(4)
    v_mfma_f32_32x32x16_bf16 v[64:79], v[160:163], a[24:27], v[64:79]
    ds_read_b64_tr_b16 v[172:173], v219 offset:18944
    ds_read_b64_tr_b16 v[174:175], v219 offset:19200
    v_cvt_pk_bf16_f32 v176, v128, v129
    v_cvt_pk_bf16_f32 v177, v130, v131
    v_mfma_f32_32x32x16_bf16 v[96:111], v[160:163], a[28:31], v[96:111]
    v_cvt_pk_bf16_f32 v178, v132, v133
    v_cvt_pk_bf16_f32 v179, v134, v135
    s_waitcnt lgkmcnt(4)
    v_mfma_f32_32x32x16_bf16 v[80:95], v[164:167], a[24:27], v[80:95]
    ds_read_b64_tr_b16 v[160:161], v219 offset:20992
    ds_read_b64_tr_b16 v[162:163], v219 offset:21248
    s_add_u32 m0, s56, 94208
    v_cvt_pk_bf16_f32 v180, v136, v137
    v_cvt_pk_bf16_f32 v181, v138, v139
    v_mfma_f32_32x32x16_bf16 v[112:127], v[164:167], a[28:31], v[112:127]
    buffer_load_dwordx4 v213, s[52:55], s57 offen lds
    s_add_u32 s57, s57, 147456
    v_cvt_pk_bf16_f32 v182, v140, v141
    v_cvt_pk_bf16_f32 v183, v142, v143
    s_waitcnt lgkmcnt(4)
    v_mfma_f32_32x32x16_bf16 v[64:79], v[168:171], a[32:35], v[64:79]
    ds_read_b64_tr_b16 v[164:165], v219 offset:23040
    ds_read_b64_tr_b16 v[166:167], v219 offset:23296
    v_permlane32_swap_b32 v176, v178
    v_permlane32_swap_b32 v177, v179
    v_mfma_f32_32x32x16_bf16 v[96:111], v[168:171], a[36:39], v[96:111]
    s_add_u32 m0, s56, 98304
    s_add_u32 s34, s35, 0
    buffer_store_dwordx4 v[176:179], v215, s[24:27], s34 offen sc1
    v_permlane32_swap_b32 v180, v182
    s_waitcnt lgkmcnt(4)
    v_mfma_f32_32x32x16_bf16 v[80:95], v[172:175], a[32:35], v[80:95]
    ds_read_b64_tr_b16 v[168:169], v219 offset:25088
    ds_read_b64_tr_b16 v[170:171], v219 offset:25344
    buffer_load_dwordx4 v213, s[52:55], s57 offen lds
    s_add_u32 s57, s57, 147456
    v_permlane32_swap_b32 v181, v183
    v_mfma_f32_32x32x16_bf16 v[112:127], v[172:175], a[36:39], v[112:127]
    s_add_u32 s34, s35, 65536
    buffer_store_dwordx4 v[180:183], v215, s[24:27], s34 offen sc1
    v_mul_f32 v144, s62, v144
    s_waitcnt lgkmcnt(4)
    v_mfma_f32_32x32x16_bf16 v[64:79], v[160:163], a[40:43], v[64:79]
    ds_read_b64_tr_b16 v[172:173], v219 offset:27136
    ds_read_b64_tr_b16 v[174:175], v219 offset:27392
    v_mul_f32 v145, s62, v145
    v_mul_f32 v146, s62, v146
    v_mfma_f32_32x32x16_bf16 v[96:111], v[160:163], a[44:47], v[96:111]
    s_add_u32 m0, s56, 102400
    v_mul_f32 v147, s62, v147
    v_mul_f32 v148, s62, v148
    s_waitcnt lgkmcnt(4)
    v_mfma_f32_32x32x16_bf16 v[80:95], v[164:167], a[40:43], v[80:95]
    ds_read_b64_tr_b16 v[160:161], v219 offset:29184
    ds_read_b64_tr_b16 v[162:163], v219 offset:29440
    buffer_load_dwordx4 v213, s[52:55], s57 offen lds
    s_add_u32 s57, s57, 147456
    v_mul_f32 v149, s62, v149
    v_mul_f32 v150, s62, v150
    v_mfma_f32_32x32x16_bf16 v[112:127], v[164:167], a[44:47], v[112:127]
    v_mul_f32 v151, s62, v151
    v_mul_f32 v152, s62, v152
    s_waitcnt lgkmcnt(4)
    v_mfma_f32_32x32x16_bf16 v[64:79], v[168:171], a[48:51], v[64:79]
    ds_read_b64_tr_b16 v[164:165], v219 offset:31232
    ds_read_b64_tr_b16 v[166:167], v219 offset:31488
    s_add_u32 m0, s56, 106496
    v_mul_f32 v153, s62, v153
    v_mul_f32 v154, s62, v154
    v_mfma_f32_32x32x16_bf16 v[96:111], v[168:171], a[52:55], v[96:111]
    buffer_load_dwordx4 v213, s[52:55], s57 offen lds
    s_add_u32 s57, s57, 147456
    s_sub_u32 s57, s57, 5308288
    v_mul_f32 v155, s62, v155
    v_mul_f32 v156, s62, v156
    s_waitcnt lgkmcnt(4)
    v_mfma_f32_32x32x16_bf16 v[80:95], v[172:175], a[48:51], v[80:95]
    ds_read_b64_tr_b16 v[168:169], v219 offset:33280
    ds_read_b64_tr_b16 v[170:171], v219 offset:33536
    v_mul_f32 v157, s62, v157
    v_mul_f32 v158, s62, v158
    v_mfma_f32_32x32x16_bf16 v[112:127], v[172:175], a[52:55], v[112:127]
    v_mul_f32 v159, s62, v159
    v_cvt_pk_bf16_f32 v184, v144, v145
    s_waitcnt lgkmcnt(4)
    v_mfma_f32_32x32x16_bf16 v[64:79], v[160:163], a[56:59], v[64:79]
    ds_read_b64_tr_b16 v[172:173], v219 offset:35328
    ds_read_b64_tr_b16 v[174:175], v219 offset:35584
    v_cvt_pk_bf16_f32 v185, v146, v147
    v_cvt_pk_bf16_f32 v186, v148, v149
    v_mfma_f32_32x32x16_bf16 v[96:111], v[160:163], a[60:63], v[96:111]
    v_cvt_pk_bf16_f32 v187, v150, v151
    v_cvt_pk_bf16_f32 v188, v152, v153
    s_waitcnt lgkmcnt(4)
    v_mfma_f32_32x32x16_bf16 v[80:95], v[164:167], a[56:59], v[80:95]
    ds_read_b64_tr_b16 v[160:161], v216 offset:0
    ds_read_b64_tr_b16 v[162:163], v216 offset:256
    v_cvt_pk_bf16_f32 v189, v154, v155
    v_cvt_pk_bf16_f32 v190, v156, v157
    v_mfma_f32_32x32x16_bf16 v[112:127], v[164:167], a[60:63], v[112:127]
    v_cvt_pk_bf16_f32 v191, v158, v159
    v_permlane32_swap_b32 v184, v186
    s_waitcnt lgkmcnt(4)
    v_mfma_f32_32x32x16_bf16 v[64:79], v[168:171], a[64:67], v[64:79]
    ds_read_b64_tr_b16 v[164:165], v216 offset:2048
    ds_read_b64_tr_b16 v[166:167], v216 offset:2304
    v_permlane32_swap_b32 v185, v187
    s_add_u32 s34, s35, 512
    buffer_store_dwordx4 v[184:187], v215, s[24:27], s34 offen sc1
    v_mfma_f32_32x32x16_bf16 v[96:111], v[168:171], a[68:71], v[96:111]
    v_permlane32_swap_b32 v188, v190
    v_permlane32_swap_b32 v189, v191
    s_waitcnt lgkmcnt(4)
    v_mfma_f32_32x32x16_bf16 v[80:95], v[172:175], a[64:67], v[80:95]
    ds_read_b64_tr_b16 v[168:169], v216 offset:4096
    ds_read_b64_tr_b16 v[170:171], v216 offset:4352
    s_add_u32 s34, s35, 66048
    buffer_store_dwordx4 v[188:191], v215, s[24:27], s34 offen sc1
    v_mfma_f32_32x32x16_bf16 v[112:127], v[172:175], a[68:71], v[112:127]
    s_branch L_j1
L_cls1:
    buffer_load_dwordx4 a[0:3], v210, s[24:27], s64 offen offset:0 sc1
    buffer_load_dwordx4 a[4:7], v210, s[24:27], s65 offen offset:0 sc1
    buffer_load_dwordx4 a[8:11], v210, s[24:27], s64 offen offset:1024 sc1
    buffer_load_dwordx4 a[12:15], v210, s[24:27], s65 offen offset:1024 sc1
    buffer_load_dwordx4 a[16:19], v210, s[24:27], s64 offen offset:2048 sc1
    buffer_load_dwordx4 a[20:23], v210, s[24:27], s65 offen offset:2048 sc1
    buffer_load_dwordx4 a[24:27], v210, s[24:27], s64 offen offset:3072 sc1
    buffer_load_dwordx4 a[28:31], v210, s[24:27], s65 offen offset:3072 sc1
    s_add_u32 s64, s64, 4096
    s_add_u32 s65, s65, 4096
    buffer_load_dwordx4 a[32:35], v210, s[24:27], s64 offen offset:0 sc1
    buffer_load_dwordx4 a[36:39], v210, s[24:27], s65 offen offset:0 sc1
    buffer_load_dwordx4 a[40:43], v210, s[24:27], s64 offen offset:1024 sc1
    buffer_load_dwordx4 a[44:47], v210, s[24:27], s65 offen offset:1024 sc1
    buffer_load_dwordx4 a[48:51], v210, s[24:27], s64 offen offset:2048 sc1
    buffer_load_dwordx4 a[52:55], v210, s[24:27], s65 offen offset:2048 sc1
    buffer_load_dwordx4 a[56:59], v210, s[24:27], s64 offen offset:3072 sc1
    buffer_load_dwordx4 a[60:63], v210, s[24:27], s65 offen offset:3072 sc1
    s_add_u32 s64, s64, 4096
    s_add_u32 s65, s65, 4096
    s_barrier
    ds_read_b64_tr_b16 v[160:161], v216 offset:0
    ds_read_b64_tr_b16 v[162:163], v216 offset:256
    ds_read_b64_tr_b16 v[164:165], v216 offset:512
    ds_read_b64_tr_b16 v[166:167], v216 offset:768
    ds_read_b64_tr_b16 v[168:169], v204 offset:36864
    ds_read_b64_tr_b16 v[170:171], v204 offset:37120
    s_waitcnt vmcnt(15) lgkmcnt(4)
    v_mfma_f32_32x32x16_bf16 v[64:79], a[0:3], v[160:163], 0
    ds_read_b64_tr_b16 v[172:173], v216 offset:2048
    ds_read_b64_tr_b16 v[174:175], v216 offset:2304
    s_waitcnt vmcnt(14)
    v_mfma_f32_32x32x16_bf16 v[80:95], a[4:7], v[160:163], 0
    buffer_load_dwordx4 a[64:67], v210, s[24:27], s64 offen offset:0 sc1
    s_waitcnt lgkmcnt(4)
    v_mfma_f32_32x32x16_bf16 v[96:111], a[0:3], v[164:167], 0
    ds_read_b64_tr_b16 v[160:161], v216 offset:2560
    ds_read_b64_tr_b16 v[162:163], v216 offset:2816
    v_mfma_f32_32x32x16_bf16 v[112:127], a[4:7], v[164:167], 0
    buffer_load_dwordx4 a[68:71], v210, s[24:27], s65 offen offset:0 sc1
    s_waitcnt lgkmcnt(4)
    v_mfma_f32_32x32x16_bf16 v[128:143], a[0:3], v[168:171], 0
    ds_read_b64_tr_b16 v[164:165], v204 offset:37888
    ds_read_b64_tr_b16 v[166:167], v204 offset:38144
    v_mfma_f32_32x32x16_bf16 v[144:159], a[4:7], v[168:171], 0
    s_waitcnt vmcnt(15) lgkmcnt(4)
    v_mfma_f32_32x32x16_bf16 v[64:79], a[8:11], v[172:175], v[64:79]
    ds_read_b64_tr_b16 v[168:169], v216 offset:4096
    ds_read_b64_tr_b16 v[170:171], v216 offset:4352
    s_waitcnt vmcnt(14)
    v_mfma_f32_32x32x16_bf16 v[80:95], a[12:15], v[172:175], v[80:95]
    buffer_load_dwordx4 a[72:75], v210, s[24:27], s64 offen offset:1024 sc1
    s_waitcnt lgkmcnt(4)
    v_mfma_f32_32x32x16_bf16 v[96:111], a[8:11], v[160:163], v[96:111]
    ds_read_b64_tr_b16 v[172:173], v216 offset:4608
    ds_read_b64_tr_b16 v[174:175], v216 offset:4864
    v_mfma_f32_32x32x16_bf16 v[112:127], a[12:15], v[160:163], v[112:127]
    buffer_load_dwordx4 a[76:79], v210, s[24:27], s65 offen offset:1024 sc1
    s_waitcnt lgkmcnt(4)
    v_mfma_f32_32x32x16_bf16 v[128:143], a[8:11], v[164:167], v[128:143]
    ds_read_b64_tr_b16 v[160:161], v204 offset:38912
    ds_read_b64_tr_b16 v[162:163], v204 offset:39168
    v_mfma_f32_32x32x16_bf16 v[144:159], a[12:15], v[164:167], v[144:159]
    s_waitcnt vmcnt(15) lgkmcnt(4)
    v_mfma_f32_32x32x16_bf16 v[64:79], a[16:19], v[168:171], v[64:79]
    ds_read_b64_tr_b16 v[164:165], v216 offset:6144
    ds_read_b64_tr_b16 v[166:167], v216 offset:6400
    s_waitcnt vmcnt(14)
    v_mfma_f32_32x32x16_bf16 v[80:95], a[20:23], v[168:171], v[80:95]
    buffer_load_dwordx4 a[80:83], v210, s[24:27], s64 offen offset:2048 sc1
    s_waitcnt lgkmcnt(4)
    v_mfma_f32_32x32x16_bf16 v[96:111], a[16:19], v[172:175], v[96:111]
    ds_read_b64_tr_b16 v[168:169], v216 offset:6656
    ds_read_b64_tr_b16 v[170:171], v216 offset:6912
    v_mfma_f32_32x32x16_bf16 v[112:127], a[20:23], v[172:175], v[112:127]
    buffer_load_dwordx4 a[84:87], v210, s[24:27], s65 offen offset:2048 sc1
    s_waitcnt lgkmcnt(4)
    v_mfma_f32_32x32x16_bf16 v[128:143], a[16:19], v[160:163], v[128:143]
    ds_read_b64_tr_b16 v[172:173], v204 offset:39936
    ds_read_b64_tr_b16 v[174:175], v204 offset:40192
    v_mfma_f32_32x32x16_bf16 v[144:159], a[20:23], v[160:163], v[144:159]
    s_waitcnt vmcnt(15) lgkmcnt(4)
    v_mfma_f32_32x32x16_bf16 v[64:79], a[24:27], v[164:167], v[64:79]
    ds_read_b64_tr_b16 v[160:161], v216 offset:8192
    ds_read_b64_tr_b16 v[162:163], v216 offset:8448
    s_waitcnt vmcnt(14)
    v_mfma_f32_32x32x16_bf16 v[80:95], a[28:31], v[164:167], v[80:95]
    buffer_load_dwordx4 a[88:91], v210, s[24:27], s64 offen offset:3072 sc1
    s_waitcnt lgkmcnt(4)
    v_mfma_f32_32x32x16_bf16 v[96:111], a[24:27], v[168:171], v[96:111]
    ds_read_b64_tr_b16 v[164:165], v216 offset:8704
    ds_read_b64_tr_b16 v[166:167], v216 offset:8960
    v_mfma_f32_32x32x16_bf16 v[112:127], a[28:31], v[168:171], v[112:127]
    buffer_load_dwordx4 a[92:95], v210, s[24:27], s65 offen offset:3072 sc1
    s_add_u32 s64, s64, 4096
    s_add_u32 s65, s65, 4096
    s_waitcnt lgkmcnt(4)
    v_mfma_f32_32x32x16_bf16 v[128:143], a[24:27], v[172:175], v[128:143]
    ds_read_b64_tr_b16 v[168:169], v204 offset:40960
    ds_read_b64_tr_b16 v[170:171], v204 offset:41216
    v_mfma_f32_32x32x16_bf16 v[144:159], a[28:31], v[172:175], v[144:159]
    s_waitcnt vmcnt(15) lgkmcnt(4)
    v_mfma_f32_32x32x16_bf16 v[64:79], a[32:35], v[160:163], v[64:79]
    ds_read_b64_tr_b16 v[172:173], v216 offset:10240
    ds_read_b64_tr_b16 v[174:175], v216 offset:10496
    s_waitcnt vmcnt(14)
    v_mfma_f32_32x32x16_bf16 v[80:95], a[36:39], v[160:163], v[80:95]
    buffer_load_dwordx4 a[96:99], v210, s[24:27], s64 offen offset:0 sc1
    s_waitcnt lgkmcnt(4)
    v_mfma_f32_32x32x16_bf16 v[96:111], a[32:35], v[164:167], v[96:111]
    ds_read_b64_tr_b16 v[160:161], v216 offset:10752
    ds_read_b64_tr_b16 v[162:163], v216 offset:11008
    v_mfma_f32_32x32x16_bf16 v[112:127], a[36:39], v[164:167], v[112:127]
    buffer_load_dwordx4 a[100:103], v210, s[24:27], s65 offen offset:0 sc1
    s_waitcnt lgkmcnt(4)
    v_mfma_f32_32x32x16_bf16 v[128:143], a[32:35], v[168:171], v[128:143]
    ds_read_b64_tr_b16 v[164:165], v204 offset:41984
    ds_read_b64_tr_b16 v[166:167], v204 offset:42240
    v_mfma_f32_32x32x16_bf16 v[144:159], a[36:39], v[168:171], v[144:159]
    s_waitcnt vmcnt(15) lgkmcnt(4)
    v_mfma_f32_32x32x16_bf16 v[64:79], a[40:43], v[172:175], v[64:79]
    ds_read_b64_tr_b16 v[168:169], v216 offset:12288
    ds_read_b64_tr_b16 v[170:171], v216 offset:12544
    s_waitcnt vmcnt(14)
    v_mfma_f32_32x32x16_bf16 v[80:95], a[44:47], v[172:175], v[80:95]
    buffer_load_dwordx4 a[104:107], v210, s[24:27], s64 offen offset:1024 sc1
    s_waitcnt lgkmcnt(4)
    v_mfma_f32_32x32x16_bf16 v[96:111], a[40:43], v[160:163], v[96:111]
    ds_read_b64_tr_b16 v[172:173], v216 offset:12800
    ds_read_b64_tr_b16 v[174:175], v216 offset:13056
    v_mfma_f32_32x32x16_bf16 v[112:127], a[44:47], v[160:163], v[112:127]
    buffer_load_dwordx4 a[108:111], v210, s[24:27], s65 offen offset:1024 sc1
    s_waitcnt lgkmcnt(4)
    v_mfma_f32_32x32x16_bf16 v[128:143], a[40:43], v[164:167], v[128:143]
    ds_read_b64_tr_b16 v[160:161], v204 offset:43008
    ds_read_b64_tr_b16 v[162:163], v204 offset:43264
    v_mfma_f32_32x32x16_bf16 v[144:159], a[44:47], v[164:167], v[144:159]
    s_waitcnt vmcnt(15) lgkmcnt(4)
    v_mfma_f32_32x32x16_bf16 v[64:79], a[48:51], v[168:171], v[64:79]
    ds_read_b64_tr_b16 v[164:165], v216 offset:14336
    ds_read_b64_tr_b16 v[166:167], v216 offset:14592
    s_waitcnt vmcnt(14)
    v_mfma_f32_32x32x16_bf16 v[80:95], a[52:55], v[168:171], v[80:95]
    buffer_load_dwordx4 a[112:115], v210, s[24:27], s64 offen offset:2048 sc1
    s_waitcnt lgkmcnt(4)
    v_mfma_f32_32x32x16_bf16 v[96:111], a[48:51], v[172:175], v[96:111]
    ds_read_b64_tr_b16 v[168:169], v216 offset:14848
    ds_read_b64_tr_b16 v[170:171], v216 offset:15104
    v_mfma_f32_32x32x16_bf16 v[112:127], a[52:55], v[172:175], v[112:127]
    buffer_load_dwordx4 a[116:119], v210, s[24:27], s65 offen offset:2048 sc1
    s_waitcnt lgkmcnt(4)
    v_mfma_f32_32x32x16_bf16 v[128:143], a[48:51], v[160:163], v[128:143]
    ds_read_b64_tr_b16 v[172:173], v204 offset:44032
    ds_read_b64_tr_b16 v[174:175], v204 offset:44288
    v_mfma_f32_32x32x16_bf16 v[144:159], a[52:55], v[160:163], v[144:159]
    s_waitcnt vmcnt(15) lgkmcnt(4)
    v_mfma_f32_32x32x16_bf16 v[64:79], a[56:59], v[164:167], v[64:79]
    ds_read_b64_tr_b16 v[160:161], v216 offset:16384
    ds_read_b64_tr_b16 v[162:163], v216 offset:16640
    s_waitcnt vmcnt(14)
    v_mfma_f32_32x32x16_bf16 v[80:95], a[60:63], v[164:167], v[80:95]
    buffer_load_dwordx4 a[120:123], v210, s[24:27], s64 offen offset:3072 sc1
    s_waitcnt lgkmcnt(4)
    v_mfma_f32_32x32x16_bf16 v[96:111], a[56:59], v[168:171], v[96:111]
    ds_read_b64_tr_b16 v[164:165], v216 offset:16896
    ds_read_b64_tr_b16 v[166:167], v216 offset:17152
    v_mfma_f32_32x32x16_bf16 v[112:127], a[60:63], v[168:171], v[112:127]
    buffer_load_dwordx4 a[124:127], v210, s[24:27], s65 offen offset:3072 sc1
    s_add_u32 s64, s64, 4096
    s_add_u32 s65, s65, 4096
    s_waitcnt lgkmcnt(4)
    v_mfma_f32_32x32x16_bf16 v[128:143], a[56:59], v[172:175], v[128:143]
    ds_read_b64_tr_b16 v[168:169], v204 offset:45056
    ds_read_b64_tr_b16 v[170:171], v204 offset:45312
    v_mfma_f32_32x32x16_bf16 v[144:159], a[60:63], v[172:175], v[144:159]
    s_waitcnt vmcnt(15) lgkmcnt(4)
    v_mfma_f32_32x32x16_bf16 v[64:79], a[64:67], v[160:163], v[64:79]
    ds_read_b64_tr_b16 v[172:173], v216 offset:18432
    ds_read_b64_tr_b16 v[174:175], v216 offset:18688
    s_waitcnt vmcnt(14)
    v_mfma_f32_32x32x16_bf16 v[80:95], a[68:71], v[160:163], v[80:95]
    buffer_load_dwordx4 a[128:131], v210, s[24:27], s64 offen offset:0 sc1
    s_waitcnt lgkmcnt(4)
    v_mfma_f32_32x32x16_bf16 v[96:111], a[64:67], v[164:167], v[96:111]
    ds_read_b64_tr_b16 v[160:161], v216 offset:18944
    ds_read_b64_tr_b16 v[162:163], v216 offset:19200
    v_mfma_f32_32x32x16_bf16 v[112:127], a[68:71], v[164:167], v[112:127]
    buffer_load_dwordx4 a[132:135], v210, s[24:27], s65 offen offset:0 sc1
    s_waitcnt lgkmcnt(4)
    v_mfma_f32_32x32x16_bf16 v[128:143], a[64:67], v[168:171], v[128:143]
    ds_read_b64_tr_b16 v[164:165], v204 offset:46080
    ds_read_b64_tr_b16 v[166:167], v204 offset:46336
    v_mfma_f32_32x32x16_bf16 v[144:159], a[68:71], v[168:171], v[144:159]
    s_waitcnt vmcnt(15) lgkmcnt(4)
    v_mfma_f32_32x32x16_bf16 v[64:79], a[72:75], v[172:175], v[64:79]
    ds_read_b64_tr_b16 v[168:169], v216 offset:20480
    ds_read_b64_tr_b16 v[170:171], v216 offset:20736
    s_waitcnt vmcnt(14)
    v_mfma_f32_32x32x16_bf16 v[80:95], a[76:79], v[172:175], v[80:95]
    buffer_load_dwordx4 a[136:139], v210, s[24:27], s64 offen offset:1024 sc1
    s_waitcnt lgkmcnt(4)
    v_mfma_f32_32x32x16_bf16 v[96:111], a[72:75], v[160:163], v[96:111]
    ds_read_b64_tr_b16 v[172:173], v216 offset:20992
    ds_read_b64_tr_b16 v[174:175], v216 offset:21248
    v_mfma_f32_32x32x16_bf16 v[112:127], a[76:79], v[160:163], v[112:127]
    buffer_load_dwordx4 a[140:143], v210, s[24:27], s65 offen offset:1024 sc1
    s_waitcnt lgkmcnt(4)
    v_mfma_f32_32x32x16_bf16 v[128:143], a[72:75], v[164:167], v[128:143]
    ds_read_b64_tr_b16 v[160:161], v204 offset:47104
    ds_read_b64_tr_b16 v[162:163], v204 offset:47360
    v_mfma_f32_32x32x16_bf16 v[144:159], a[76:79], v[164:167], v[144:159]
    s_waitcnt vmcnt(15) lgkmcnt(4)
    v_mfma_f32_32x32x16_bf16 v[64:79], a[80:83], v[168:171], v[64:79]
    ds_read_b64_tr_b16 v[164:165], v216 offset:22528
    ds_read_b64_tr_b16 v[166:167], v216 offset:22784
    s_waitcnt vmcnt(14)
    v_mfma_f32_32x32x16_bf16 v[80:95], a[84:87], v[168:171], v[80:95]
    buffer_load_dwordx4 a[144:147], v210, s[24:27], s64 offen offset:2048 sc1
    s_waitcnt lgkmcnt(4)
    v_mfma_f32_32x32x16_bf16 v[96:111], a[80:83], v[172:175], v[96:111]
    ds_read_b64_tr_b16 v[168:169], v216 offset:23040
    ds_read_b64_tr_b16 v[170:171], v216 offset:23296
    v_mfma_f32_32x32x16_bf16 v[112:127], a[84:87], v[172:175], v[112:127]
    buffer_load_dwordx4 a[148:151], v210, s[24:27], s65 offen offset:2048 sc1
    s_waitcnt lgkmcnt(4)
    v_mfma_f32_32x32x16_bf16 v[128:143], a[80:83], v[160:163], v[128:143]
    ds_read_b64_tr_b16 v[172:173], v204 offset:48128
    ds_read_b64_tr_b16 v[174:175], v204 offset:48384
    v_mfma_f32_32x32x16_bf16 v[144:159], a[84:87], v[160:163], v[144:159]
    s_waitcnt vmcnt(15) lgkmcnt(4)
    v_mfma_f32_32x32x16_bf16 v[64:79], a[88:91], v[164:167], v[64:79]
    ds_read_b64_tr_b16 v[160:161], v216 offset:24576
    ds_read_b64_tr_b16 v[162:163], v216 offset:24832
    s_waitcnt vmcnt(14)
    v_mfma_f32_32x32x16_bf16 v[80:95], a[92:95], v[164:167], v[80:95]
    buffer_load_dwordx4 a[152:155], v210, s[24:27], s64 offen offset:3072 sc1
    s_waitcnt lgkmcnt(4)
    v_mfma_f32_32x32x16_bf16 v[96:111], a[88:91], v[168:171], v[96:111]
    ds_read_b64_tr_b16 v[164:165], v216 offset:25088
    ds_read_b64_tr_b16 v[166:167], v216 offset:25344
    v_mfma_f32_32x32x16_bf16 v[112:127], a[92:95], v[168:171], v[112:127]
    buffer_load_dwordx4 a[156:159], v210, s[24:27], s65 offen offset:3072 sc1
    s_add_u32 s64, s64, 4096
    s_add_u32 s65, s65, 4096
    s_waitcnt lgkmcnt(4)
    v_mfma_f32_32x32x16_bf16 v[128:143], a[88:91], v[172:175], v[128:143]
    ds_read_b64_tr_b16 v[168:169], v204 offset:49152
    ds_read_b64_tr_b16 v[170:171], v204 offset:49408
    v_mfma_f32_32x32x16_bf16 v[144:159], a[92:95], v[172:175], v[144:159]
    s_waitcnt vmcnt(15) lgkmcnt(4)
    v_mfma_f32_32x32x16_bf16 v[64:79], a[96:99], v[160:163], v[64:79]
    ds_read_b64_tr_b16 v[172:173], v216 offset:26624
    ds_read_b64_tr_b16 v[174:175], v216 offset:26880
    s_waitcnt vmcnt(14)
    v_mfma_f32_32x32x16_bf16 v[80:95], a[100:103], v[160:163], v[80:95]
    buffer_load_dwordx4 a[160:163], v210, s[24:27], s64 offen offset:0 sc1
    s_waitcnt lgkmcnt(4)
    v_mfma_f32_32x32x16_bf16 v[96:111], a[96:99], v[164:167], v[96:111]
    ds_read_b64_tr_b16 v[160:161], v216 offset:27136
    ds_read_b64_tr_b16 v[162:163], v216 offset:27392
    v_mfma_f32_32x32x16_bf16 v[112:127], a[100:103], v[164:167], v[112:127]
    buffer_load_dwordx4 a[164:167], v210, s[24:27], s65 offen offset:0 sc1
    s_waitcnt lgkmcnt(4)
    v_mfma_f32_32x32x16_bf16 v[128:143], a[96:99], v[168:171], v[128:143]
    ds_read_b64_tr_b16 v[164:165], v204 offset:50176
    ds_read_b64_tr_b16 v[166:167], v204 offset:50432
    v_mfma_f32_32x32x16_bf16 v[144:159], a[100:103], v[168:171], v[144:159]
    s_waitcnt vmcnt(15) lgkmcnt(4)
    v_mfma_f32_32x32x16_bf16 v[64:79], a[104:107], v[172:175], v[64:79]
    ds_read_b64_tr_b16 v[168:169], v216 offset:28672
    ds_read_b64_tr_b16 v[170:171], v216 offset:28928
    s_waitcnt vmcnt(14)
    v_mfma_f32_32x32x16_bf16 v[80:95], a[108:111], v[172:175], v[80:95]
    buffer_load_dwordx4 a[168:171], v210, s[24:27], s64 offen offset:1024 sc1
    s_waitcnt lgkmcnt(4)
    v_mfma_f32_32x32x16_bf16 v[96:111], a[104:107], v[160:163], v[96:111]
    ds_read_b64_tr_b16 v[172:173], v216 offset:29184
    ds_read_b64_tr_b16 v[174:175], v216 offset:29440
    v_mfma_f32_32x32x16_bf16 v[112:127], a[108:111], v[160:163], v[112:127]
    buffer_load_dwordx4 a[172:175], v210, s[24:27], s65 offen offset:1024 sc1
    s_waitcnt lgkmcnt(4)
    v_mfma_f32_32x32x16_bf16 v[128:143], a[104:107], v[164:167], v[128:143]
    ds_read_b64_tr_b16 v[160:161], v204 offset:51200
    ds_read_b64_tr_b16 v[162:163], v204 offset:51456
    v_mfma_f32_32x32x16_bf16 v[144:159], a[108:111], v[164:167], v[144:159]
    s_waitcnt vmcnt(15) lgkmcnt(4)
    v_mfma_f32_32x32x16_bf16 v[64:79], a[112:115], v[168:171], v[64:79]
    ds_read_b64_tr_b16 v[164:165], v216 offset:30720
    ds_read_b64_tr_b16 v[166:167], v216 offset:30976
    s_waitcnt vmcnt(14)
    v_mfma_f32_32x32x16_bf16 v[80:95], a[116:119], v[168:171], v[80:95]
    buffer_load_dwordx4 a[176:179], v210, s[24:27], s64 offen offset:2048 sc1
    s_waitcnt lgkmcnt(4)
    v_mfma_f32_32x32x16_bf16 v[96:111], a[112:115], v[172:175], v[96:111]
    ds_read_b64_tr_b16 v[168:169], v216 offset:31232
    ds_read_b64_tr_b16 v[170:171], v216 offset:31488
    v_mfma_f32_32x32x16_bf16 v[112:127], a[116:119], v[172:175], v[112:127]
    buffer_load_dwordx4 a[180:183], v210, s[24:27], s65 offen offset:2048 sc1
    s_waitcnt lgkmcnt(4)
    v_mfma_f32_32x32x16_bf16 v[128:143], a[112:115], v[160:163], v[128:143]
    ds_read_b64_tr_b16 v[172:173], v204 offset:52224
    ds_read_b64_tr_b16 v[174:175], v204 offset:52480
    v_mfma_f32_32x32x16_bf16 v[144:159], a[116:119], v[160:163], v[144:159]
    s_waitcnt vmcnt(15) lgkmcnt(4)
    v_mfma_f32_32x32x16_bf16 v[64:79], a[120:123], v[164:167], v[64:79]
    ds_read_b64_tr_b16 v[160:161], v216 offset:32768
    ds_read_b64_tr_b16 v[162:163], v216 offset:33024
    s_waitcnt vmcnt(14)
    v_mfma_f32_32x32x16_bf16 v[80:95], a[124:127], v[164:167], v[80:95]
    buffer_load_dwordx4 a[184:187], v210, s[24:27], s64 offen offset:3072 sc1
    s_waitcnt lgkmcnt(4)
    v_mfma_f32_32x32x16_bf16 v[96:111], a[120:123], v[168:171], v[96:111]
    ds_read_b64_tr_b16 v[164:165], v216 offset:33280
    ds_read_b64_tr_b16 v[166:167], v216 offset:33536
    v_mfma_f32_32x32x16_bf16 v[112:127], a[124:127], v[168:171], v[112:127]
    buffer_load_dwordx4 a[188:191], v210, s[24:27], s65 offen offset:3072 sc1
    s_add_u32 s64, s64, 4096
    s_add_u32 s65, s65, 4096
    s_waitcnt lgkmcnt(4)
    v_mfma_f32_32x32x16_bf16 v[128:143], a[120:123], v[172:175], v[128:143]
    ds_read_b64_tr_b16 v[168:169], v204 offset:53248
    ds_read_b64_tr_b16 v[170:171], v204 offset:53504
    v_mfma_f32_32x32x16_bf16 v[144:159], a[124:127], v[172:175], v[144:159]
    s_waitcnt vmcnt(15) lgkmcnt(4)
    v_mfma_f32_32x32x16_bf16 v[64:79], a[128:131], v[160:163], v[64:79]
    ds_read_b64_tr_b16 v[172:173], v216 offset:34816
    ds_read_b64_tr_b16 v[174:175], v216 offset:35072
    s_waitcnt vmcnt(14)
    v_mfma_f32_32x32x16_bf16 v[80:95], a[132:135], v[160:163], v[80:95]
    buffer_load_dwordx4 a[192:195], v210, s[24:27], s64 offen offset:0 sc1
    s_waitcnt lgkmcnt(4)
    v_mfma_f32_32x32x16_bf16 v[96:111], a[128:131], v[164:167], v[96:111]
    ds_read_b64_tr_b16 v[160:161], v216 offset:35328
    ds_read_b64_tr_b16 v[162:163], v216 offset:35584
    v_mfma_f32_32x32x16_bf16 v[112:127], a[132:135], v[164:167], v[112:127]
    buffer_load_dwordx4 a[196:199], v210, s[24:27], s65 offen offset:0 sc1
    s_waitcnt lgkmcnt(4)
    v_mfma_f32_32x32x16_bf16 v[128:143], a[128:131], v[168:171], v[128:143]
    ds_read_b64_tr_b16 v[164:165], v204 offset:54272
    ds_read_b64_tr_b16 v[166:167], v204 offset:54528
    v_mfma_f32_32x32x16_bf16 v[144:159], a[132:135], v[168:171], v[144:159]
    s_barrier
    s_waitcnt vmcnt(15) lgkmcnt(4)
    v_mfma_f32_32x32x16_bf16 v[64:79], a[136:139], v[172:175], v[64:79]
    ds_read_b64_tr_b16 v[168:169], v203 offset:0
    ds_read_b64_tr_b16 v[170:171], v203 offset:256
    s_waitcnt vmcnt(14)
    v_mfma_f32_32x32x16_bf16 v[80:95], a[140:143], v[172:175], v[80:95]
    buffer_load_dwordx4 a[200:203], v210, s[24:27], s64 offen offset:1024 sc1
    s_waitcnt lgkmcnt(4)
    v_mfma_f32_32x32x16_bf16 v[96:111], a[136:139], v[160:163], v[96:111]
    ds_read_b64_tr_b16 v[172:173], v203 offset:512
    ds_read_b64_tr_b16 v[174:175], v203 offset:768
    v_mfma_f32_32x32x16_bf16 v[112:127], a[140:143], v[160:163], v[112:127]
    buffer_load_dwordx4 a[204:207], v210, s[24:27], s65 offen offset:1024 sc1
    s_waitcnt lgkmcnt(4)
    v_mfma_f32_32x32x16_bf16 v[128:143], a[136:139], v[164:167], v[128:143]
    ds_read_b64_tr_b16 v[160:161], v205 offset:36864
    ds_read_b64_tr_b16 v[162:163], v205 offset:37120
    v_mfma_f32_32x32x16_bf16 v[144:159], a[140:143], v[164:167], v[144:159]
    s_barrier
    s_waitcnt vmcnt(15) lgkmcnt(4)
    v_mfma_f32_32x32x16_bf16 v[64:79], a[144:147], v[168:171], v[64:79]
    ds_read_b64_tr_b16 v[164:165], v203 offset:2048
    ds_read_b64_tr_b16 v[166:167], v203 offset:2304
    s_add_u32 m0, s56, 0
    s_waitcnt vmcnt(14)
    v_mfma_f32_32x32x16_bf16 v[80:95], a[148:151], v[168:171], v[80:95]
    buffer_load_dwordx4 a[208:211], v210, s[24:27], s64 offen offset:2048 sc1
    buffer_load_dwordx4 v213, s[52:55], s57 offen lds
    s_add_u32 s57, s57, 147456
    s_waitcnt lgkmcnt(4)
    v_mfma_f32_32x32x16_bf16 v[96:111], a[144:147], v[172:175], v[96:111]
    ds_read_b64_tr_b16 v[168:169], v203 offset:2560
    ds_read_b64_tr_b16 v[170:171], v203 offset:2816
    v_mfma_f32_32x32x16_bf16 v[112:127], a[148:151], v[172:175], v[112:127]
    buffer_load_dwordx4 a[212:215], v210, s[24:27], s65 offen offset:2048 sc1
    s_waitcnt lgkmcnt(4)
    v_mfma_f32_32x32x16_bf16 v[128:143], a[144:147], v[160:163], v[128:143]
    ds_read_b64_tr_b16 v[172:173], v205 offset:37888
    ds_read_b64_tr_b16 v[174:175], v205 offset:38144
    v_mfma_f32_32x32x16_bf16 v[144:159], a[148:151], v[160:163], v[144:159]
    s_waitcnt vmcnt(16) lgkmcnt(4)
    v_mfma_f32_32x32x16_bf16 v[64:79], a[152:155], v[164:167], v[64:79]
    ds_read_b64_tr_b16 v[160:161], v203 offset:4096
    ds_read_b64_tr_b16 v[162:163], v203 offset:4352
    s_waitcnt vmcnt(15)
    v_mfma_f32_32x32x16_bf16 v[80:95], a[156:159], v[164:167], v[80:95]
    buffer_load_dwordx4 a[216:219], v210, s[24:27], s64 offen offset:3072 sc1
    s_waitcnt lgkmcnt(4)
    v_mfma_f32_32x32x16_bf16 v[96:111], a[152:155], v[168:171], v[96:111]
    ds_read_b64_tr_b16 v[164:165], v203 offset:4608
    ds_read_b64_tr_b16 v[166:167], v203 offset:4864
    v_mfma_f32_32x32x16_bf16 v[112:127], a[156:159], v[168:171], v[112:127]
    buffer_load_dwordx4 a[220:223], v210, s[24:27], s65 offen offset:3072 sc1
    s_add_u32 s64, s64, 4096
    s_add_u32 s65, s65, 4096
    s_waitcnt lgkmcnt(4)
    v_mfma_f32_32x32x16_bf16 v[128:143], a[152:155], v[172:175], v[128:143]
    ds_read_b64_tr_b16 v[168:169], v205 offset:38912
    ds_read_b64_tr_b16 v[170:171], v205 offset:39168
    v_mfma_f32_32x32x16_bf16 v[144:159], a[156:159], v[172:175], v[144:159]
    s_add_u32 m0, s56, 4096
    s_waitcnt vmcnt(16) lgkmcnt(4)
    v_mfma_f32_32x32x16_bf16 v[64:79], a[160:163], v[160:163], v[64:79]
    ds_read_b64_tr_b16 v[172:173], v203 offset:6144
    ds_read_b64_tr_b16 v[174:175], v203 offset:6400
    buffer_load_dwordx4 v213, s[52:55], s57 offen lds
    s_add_u32 s57, s57, 147456
    s_waitcnt vmcnt(16)
    v_mfma_f32_32x32x16_bf16 v[80:95], a[164:167], v[160:163], v[80:95]
    buffer_load_dwordx4 a[224:227], v210, s[24:27], s64 offen offset:0 sc1
    s_waitcnt lgkmcnt(4)
    v_mfma_f32_32x32x16_bf16 v[96:111], a[160:163], v[164:167], v[96:111]
    ds_read_b64_tr_b16 v[160:161], v203 offset:6656
    ds_read_b64_tr_b16 v[162:163], v203 offset:6912
    v_mfma_f32_32x32x16_bf16 v[112:127], a[164:167], v[164:167], v[112:127]
    buffer_load_dwordx4 a[228:231], v210, s[24:27], s65 offen offset:0 sc1
    s_waitcnt lgkmcnt(4)
    v_mfma_f32_32x32x16_bf16 v[128:143], a[160:163], v[168:171], v[128:143]
    ds_read_b64_tr_b16 v[164:165], v205 offset:39936
    ds_read_b64_tr_b16 v[166:167], v205 offset:40192
    v_mfma_f32_32x32x16_bf16 v[144:159], a[164:167], v[168:171], v[144:159]
    s_waitcnt vmcnt(17) lgkmcnt(4)
    v_mfma_f32_32x32x16_bf16 v[64:79], a[168:171], v[172:175], v[64:79]
    ds_read_b64_tr_b16 v[168:169], v203 offset:8192
    ds_read_b64_tr_b16 v[170:171], v203 offset:8448
    s_waitcnt vmcnt(16)
    v_mfma_f32_32x32x16_bf16 v[80:95], a[172:175], v[172:175], v[80:95]
    buffer_load_dwordx4 a[232:235], v210, s[24:27], s64 offen offset:1024 sc1
    s_waitcnt lgkmcnt(4)
    v_mfma_f32_32x32x16_bf16 v[96:111], a[168:171], v[160:163], v[96:111]
    ds_read_b64_tr_b16 v[172:173], v203 offset:8704
    ds_read_b64_tr_b16 v[174:175], v203 offset:8960
    v_mfma_f32_32x32x16_bf16 v[112:127], a[172:175], v[160:163], v[112:127]
    buffer_load_dwordx4 a[236:239], v210, s[24:27], s65 offen offset:1024 sc1
    s_waitcnt lgkmcnt(4)
    v_mfma_f32_32x32x16_bf16 v[128:143], a[168:171], v[164:167], v[128:143]
    ds_read_b64_tr_b16 v[160:161], v205 offset:40960
    ds_read_b64_tr_b16 v[162:163], v205 offset:41216
    s_add_u32 m0, s56, 8192
    v_mfma_f32_32x32x16_bf16 v[144:159], a[172:175], v[164:167], v[144:159]
    buffer_load_dwordx4 v213, s[52:55], s57 offen lds
    s_add_u32 s57, s57, 147456
    s_waitcnt vmcnt(18) lgkmcnt(4)
    v_mfma_f32_32x32x16_bf16 v[64:79], a[176:179], v[168:171], v[64:79]
    ds_read_b64_tr_b16 v[164:165], v203 offset:10240
    ds_read_b64_tr_b16 v[166:167], v203 offset:10496
    s_waitcnt vmcnt(17)
    v_mfma_f32_32x32x16_bf16 v[80:95], a[180:183], v[168:171], v[80:95]
    buffer_load_dwordx4 a[240:243], v210, s[24:27], s64 offen offset:2048 sc1
    s_waitcnt lgkmcnt(4)
    v_mfma_f32_32x32x16_bf16 v[96:111], a[176:179], v[172:175], v[96:111]
    ds_read_b64_tr_b16 v[168:169], v203 offset:10752
    ds_read_b64_tr_b16 v[170:171], v203 offset:11008
    v_mfma_f32_32x32x16_bf16 v[112:127], a[180:183], v[172:175], v[112:127]
    buffer_load_dwordx4 a[244:247], v210, s[24:27], s65 offen offset:2048 sc1
    s_waitcnt lgkmcnt(4)
    v_mfma_f32_32x32x16_bf16 v[128:143], a[176:179], v[160:163], v[128:143]
    ds_read_b64_tr_b16 v[172:173], v205 offset:41984
    ds_read_b64_tr_b16 v[174:175], v205 offset:42240
    v_mfma_f32_32x32x16_bf16 v[144:159], a[180:183], v[160:163], v[144:159]
    s_waitcnt vmcnt(18) lgkmcnt(4)
    v_mfma_f32_32x32x16_bf16 v[64:79], a[184:187], v[164:167], v[64:79]
    ds_read_b64_tr_b16 v[160:161], v203 offset:12288
    ds_read_b64_tr_b16 v[162:163], v203 offset:12544
    s_waitcnt vmcnt(17)
    v_mfma_f32_32x32x16_bf16 v[80:95], a[188:191], v[164:167], v[80:95]
    buffer_load_dwordx4 a[248:251], v210, s[24:27], s64 offen offset:3072 sc1
    s_waitcnt lgkmcnt(4)
    v_mfma_f32_32x32x16_bf16 v[96:111], a[184:187], v[168:171], v[96:111]
    ds_read_b64_tr_b16 v[164:165], v203 offset:12800
    ds_read_b64_tr_b16 v[166:167], v203 offset:13056
    v_mfma_f32_32x32x16_bf16 v[112:127], a[188:191], v[168:171], v[112:127]
    buffer_load_dwordx4 a[252:255], v210, s[24:27], s65 offen offset:3072 sc1
    s_add_u32 s64, s64, 4096
    s_add_u32 s65, s65, 4096
    s_add_u32 m0, s56, 12288
    s_waitcnt lgkmcnt(4)
    v_mfma_f32_32x32x16_bf16 v[128:143], a[184:187], v[172:175], v[128:143]
    ds_read_b64_tr_b16 v[168:169], v205 offset:43008
    ds_read_b64_tr_b16 v[170:171], v205 offset:43264
    buffer_load_dwordx4 v213, s[52:55], s57 offen lds
    s_add_u32 s57, s57, 147456
    v_mfma_f32_32x32x16_bf16 v[144:159], a[188:191], v[172:175], v[144:159]
    s_waitcnt vmcnt(19) lgkmcnt(4)
    v_mfma_f32_32x32x16_bf16 v[64:79], a[192:195], v[160:163], v[64:79]
    ds_read_b64_tr_b16 v[172:173], v203 offset:14336
    ds_read_b64_tr_b16 v[174:175], v203 offset:14592
    s_waitcnt vmcnt(18)
    v_mfma_f32_32x32x16_bf16 v[80:95], a[196:199], v[160:163], v[80:95]
    buffer_load_dwordx4 v[224:227], v210, s[24:27], s64 offen offset:0 sc1
    s_waitcnt lgkmcnt(4)
    v_mfma_f32_32x32x16_bf16 v[96:111], a[192:195], v[164:167], v[96:111]
    ds_read_b64_tr_b16 v[160:161], v203 offset:14848
    ds_read_b64_tr_b16 v[162:163], v203 offset:15104
    v_mfma_f32_32x32x16_bf16 v[112:127], a[196:199], v[164:167], v[112:127]
    buffer_load_dwordx4 v[228:231], v210, s[24:27], s65 offen offset:0 sc1
    s_waitcnt lgkmcnt(4)
    v_mfma_f32_32x32x16_bf16 v[128:143], a[192:195], v[168:171], v[128:143]
    ds_read_b64_tr_b16 v[164:165], v205 offset:44032
    ds_read_b64_tr_b16 v[166:167], v205 offset:44288
    v_mfma_f32_32x32x16_bf16 v[144:159], a[196:199], v[168:171], v[144:159]
    s_waitcnt vmcnt(19) lgkmcnt(4)
    v_mfma_f32_32x32x16_bf16 v[64:79], a[200:203], v[172:175], v[64:79]
    ds_read_b64_tr_b16 v[168:169], v203 offset:16384
    ds_read_b64_tr_b16 v[170:171], v203 offset:16640
    s_waitcnt vmcnt(18)
    v_mfma_f32_32x32x16_bf16 v[80:95], a[204:207], v[172:175], v[80:95]
    buffer_load_dwordx4 v[232:235], v210, s[24:27], s64 offen offset:1024 sc1
    s_waitcnt lgkmcnt(4)
    v_mfma_f32_32x32x16_bf16 v[96:111], a[200:203], v[160:163], v[96:111]
    ds_read_b64_tr_b16 v[172:173], v203 offset:16896
    ds_read_b64_tr_b16 v[174:175], v203 offset:17152
    s_add_u32 m0, s56, 16384
    v_mfma_f32_32x32x16_bf16 v[112:127], a[204:207], v[160:163], v[112:127]
    buffer_load_dwordx4 v[236:239], v210, s[24:27], s65 offen offset:1024 sc1
    buffer_load_dwordx4 v213, s[52:55], s57 offen lds
    s_add_u32 s57, s57, 147456
    s_waitcnt lgkmcnt(4)
    v_mfma_f32_32x32x16_bf16 v[128:143], a[200:203], v[164:167], v[128:143]
    ds_read_b64_tr_b16 v[160:161], v205 offset:45056
    ds_read_b64_tr_b16 v[162:163], v205 offset:45312
    v_mfma_f32_32x32x16_bf16 v[144:159], a[204:207], v[164:167], v[144:159]
    s_waitcnt vmcnt(20) lgkmcnt(4)
    v_mfma_f32_32x32x16_bf16 v[64:79], a[208:211], v[168:171], v[64:79]
    ds_read_b64_tr_b16 v[164:165], v203 offset:18432
    ds_read_b64_tr_b16 v[166:167], v203 offset:18688
    s_waitcnt vmcnt(18)
    v_mfma_f32_32x32x16_bf16 v[80:95], a[212:215], v[168:171], v[80:95]
    buffer_load_dwordx4 v[240:243], v210, s[24:27], s64 offen offset:2048 sc1
    s_waitcnt lgkmcnt(4)
    v_mfma_f32_32x32x16_bf16 v[96:111], a[208:211], v[172:175], v[96:111]
    ds_read_b64_tr_b16 v[168:169], v203 offset:18944
    ds_read_b64_tr_b16 v[170:171], v203 offset:19200
    v_mfma_f32_32x32x16_bf16 v[112:127], a[212:215], v[172:175], v[112:127]
    buffer_load_dwordx4 v[244:247], v210, s[24:27], s65 offen offset:2048 sc1
    s_waitcnt lgkmcnt(4)
    v_mfma_f32_32x32x16_bf16 v[128:143], a[208:211], v[160:163], v[128:143]
    ds_read_b64_tr_b16 v[172:173], v205 offset:46080
    ds_read_b64_tr_b16 v[174:175], v205 offset:46336
    v_mfma_f32_32x32x16_bf16 v[144:159], a[212:215], v[160:163], v[144:159]
    s_waitcnt vmcnt(19) lgkmcnt(4)
    v_mfma_f32_32x32x16_bf16 v[64:79], a[216:219], v[164:167], v[64:79]
    ds_read_b64_tr_b16 v[160:161], v203 offset:20480
    ds_read_b64_tr_b16 v[162:163], v203 offset:20736
    s_waitcnt vmcnt(18)
    v_mfma_f32_32x32x16_bf16 v[80:95], a[220:223], v[164:167], v[80:95]
    buffer_load_dwordx4 v[248:251], v210, s[24:27], s64 offen offset:3072 sc1
    s_add_u32 m0, s56, 20480
    s_waitcnt lgkmcnt(4)
    v_mfma_f32_32x32x16_bf16 v[96:111], a[216:219], v[168:171], v[96:111]
    ds_read_b64_tr_b16 v[164:165], v203 offset:20992
    ds_read_b64_tr_b16 v[166:167], v203 offset:21248
    buffer_load_dwordx4 v213, s[52:55], s57 offen lds
    s_add_u32 s57, s57, 147456
    v_mfma_f32_32x32x16_bf16 v[112:127], a[220:223], v[168:171], v[112:127]
    buffer_load_dwordx4 v[252:255], v210, s[24:27], s65 offen offset:3072 sc1
    s_add_u32 s64, s64, 4096
    s_add_u32 s65, s65, 4096
    s_waitcnt lgkmcnt(4)
    v_mfma_f32_32x32x16_bf16 v[128:143], a[216:219], v[172:175], v[128:143]
    ds_read_b64_tr_b16 v[168:169], v205 offset:47104
    ds_read_b64_tr_b16 v[170:171], v205 offset:47360
    v_mfma_f32_32x32x16_bf16 v[144:159], a[220:223], v[172:175], v[144:159]
    s_waitcnt vmcnt(19) lgkmcnt(4)
    v_mfma_f32_32x32x16_bf16 v[64:79], a[224:227], v[160:163], v[64:79]
    ds_read_b64_tr_b16 v[172:173], v203 offset:22528
    ds_read_b64_tr_b16 v[174:175], v203 offset:22784
    s_waitcnt vmcnt(18)
    v_mfma_f32_32x32x16_bf16 v[80:95], a[228:231], v[160:163], v[80:95]
    s_waitcnt lgkmcnt(4)
    v_mfma_f32_32x32x16_bf16 v[96:111], a[224:227], v[164:167], v[96:111]
    ds_read_b64_tr_b16 v[160:161], v203 offset:23040
    ds_read_b64_tr_b16 v[162:163], v203 offset:23296
    v_mfma_f32_32x32x16_bf16 v[112:127], a[228:231], v[164:167], v[112:127]
    s_waitcnt lgkmcnt(4)
    v_mfma_f32_32x32x16_bf16 v[128:143], a[224:227], v[168:171], v[128:143]
    ds_read_b64_tr_b16 v[164:165], v205 offset:48128
    ds_read_b64_tr_b16 v[166:167], v205 offset:48384
    v_mfma_f32_32x32x16_bf16 v[144:159], a[228:231], v[168:171], v[144:159]
    s_waitcnt vmcnt(17) lgkmcnt(4)
    v_mfma_f32_32x32x16_bf16 v[64:79], a[232:235], v[172:175], v[64:79]
    ds_read_b64_tr_b16 v[168:169], v203 offset:24576
    ds_read_b64_tr_b16 v[170:171], v203 offset:24832
    s_add_u32 m0, s56, 24576
    s_waitcnt vmcnt(16)
    v_mfma_f32_32x32x16_bf16 v[80:95], a[236:239], v[172:175], v[80:95]
    buffer_load_dwordx4 v213, s[52:55], s57 offen lds
    s_add_u32 s57, s57, 147456
    s_waitcnt lgkmcnt(4)
    v_mfma_f32_32x32x16_bf16 v[96:111], a[232:235], v[160:163], v[96:111]
    ds_read_b64_tr_b16 v[172:173], v203 offset:25088
    ds_read_b64_tr_b16 v[174:175], v203 offset:25344
    v_mfma_f32_32x32x16_bf16 v[112:127], a[236:239], v[160:163], v[112:127]
    s_waitcnt lgkmcnt(4)
    v_mfma_f32_32x32x16_bf16 v[128:143], a[232:235], v[164:167], v[128:143]
    ds_read_b64_tr_b16 v[160:161], v205 offset:49152
    ds_read_b64_tr_b16 v[162:163], v205 offset:49408
    v_mfma_f32_32x32x16_bf16 v[144:159], a[236:239], v[164:167], v[144:159]
    s_waitcnt vmcnt(15) lgkmcnt(4)
    v_mfma_f32_32x32x16_bf16 v[64:79], a[240:243], v[168:171], v[64:79]
    ds_read_b64_tr_b16 v[164:165], v203 offset:26624
    ds_read_b64_tr_b16 v[166:167], v203 offset:26880
    s_waitcnt vmcnt(14)
    v_mfma_f32_32x32x16_bf16 v[80:95], a[244:247], v[168:171], v[80:95]
    s_waitcnt lgkmcnt(4)
    v_mfma_f32_32x32x16_bf16 v[96:111], a[240:243], v[172:175], v[96:111]
    ds_read_b64_tr_b16 v[168:169], v203 offset:27136
    ds_read_b64_tr_b16 v[170:171], v203 offset:27392
    v_mfma_f32_32x32x16_bf16 v[112:127], a[244:247], v[172:175], v[112:127]
    s_waitcnt lgkmcnt(4)
    v_mfma_f32_32x32x16_bf16 v[128:143], a[240:243], v[160:163], v[128:143]
    ds_read_b64_tr_b16 v[172:173], v205 offset:50176
    ds_read_b64_tr_b16 v[174:175], v205 offset:50432
    v_mfma_f32_32x32x16_bf16 v[144:159], a[244:247], v[160:163], v[144:159]
    s_add_u32 m0, s56, 28672
    s_waitcnt vmcnt(13) lgkmcnt(4)
    v_mfma_f32_32x32x16_bf16 v[64:79], a[248:251], v[164:167], v[64:79]
    ds_read_b64_tr_b16 v[160:161], v203 offset:28672
    ds_read_b64_tr_b16 v[162:163], v203 offset:28928
    buffer_load_dwordx4 v213, s[52:55], s57 offen lds
    s_add_u32 s57, s57, 147456
    s_waitcnt vmcnt(13)
    v_mfma_f32_32x32x16_bf16 v[80:95], a[252:255], v[164:167], v[80:95]
    s_waitcnt lgkmcnt(4)
    v_mfma_f32_32x32x16_bf16 v[96:111], a[248:251], v[168:171], v[96:111]
    ds_read_b64_tr_b16 v[164:165], v203 offset:29184
    ds_read_b64_tr_b16 v[166:167], v203 offset:29440
    v_mfma_f32_32x32x16_bf16 v[112:127], a[252:255], v[168:171], v[112:127]
    s_waitcnt lgkmcnt(4)
    v_mfma_f32_32x32x16_bf16 v[128:143], a[248:251], v[172:175], v[128:143]
    ds_read_b64_tr_b16 v[168:169], v205 offset:51200
    ds_read_b64_tr_b16 v[170:171], v205 offset:51456
    v_mfma_f32_32x32x16_bf16 v[144:159], a[252:255], v[172:175], v[144:159]
    s_waitcnt vmcnt(11) lgkmcnt(4)
    v_mfma_f32_32x32x16_bf16 v[64:79], v[224:227], v[160:163], v[64:79]
    ds_read_b64_tr_b16 v[172:173], v203 offset:30720
    ds_read_b64_tr_b16 v[174:175], v203 offset:30976
    s_waitcnt vmcnt(10)
    v_mfma_f32_32x32x16_bf16 v[80:95], v[228:231], v[160:163], v[80:95]
    s_waitcnt lgkmcnt(4)
    v_mfma_f32_32x32x16_bf16 v[96:111], v[224:227], v[164:167], v[96:111]
    ds_read_b64_tr_b16 v[160:161], v203 offset:31232
    ds_read_b64_tr_b16 v[162:163], v203 offset:31488
    v_mfma_f32_32x32x16_bf16 v[112:127], v[228:231], v[164:167], v[112:127]
    s_waitcnt lgkmcnt(4)
    v_mfma_f32_32x32x16_bf16 v[128:143], v[224:227], v[168:171], v[128:143]
    ds_read_b64_tr_b16 v[164:165], v205 offset:52224
    ds_read_b64_tr_b16 v[166:167], v205 offset:52480
    s_add_u32 m0, s56, 32768
    v_mfma_f32_32x32x16_bf16 v[144:159], v[228:231], v[168:171], v[144:159]
    buffer_load_dwordx4 v213, s[52:55], s57 offen lds
    s_add_u32 s57, s57, 147456
    s_waitcnt vmcnt(10) lgkmcnt(4)
    v_mfma_f32_32x32x16_bf16 v[64:79], v[232:235], v[172:175], v[64:79]
    ds_read_b64_tr_b16 v[168:169], v203 offset:32768
    ds_read_b64_tr_b16 v[170:171], v203 offset:33024
    s_waitcnt vmcnt(9)
    v_mfma_f32_32x32x16_bf16 v[80:95], v[236:239], v[172:175], v[80:95]
    s_waitcnt lgkmcnt(4)
    v_mfma_f32_32x32x16_bf16 v[96:111], v[232:235], v[160:163], v[96:111]
    ds_read_b64_tr_b16 v[172:173], v203 offset:33280
    ds_read_b64_tr_b16 v[174:175], v203 offset:33536
    v_mfma_f32_32x32x16_bf16 v[112:127], v[236:239], v[160:163], v[112:127]
    s_waitcnt lgkmcnt(4)
    v_mfma_f32_32x32x16_bf16 v[128:143], v[232:235], v[164:167], v[128:143]
    ds_read_b64_tr_b16 v[160:161], v205 offset:53248
    ds_read_b64_tr_b16 v[162:163], v205 offset:53504
    v_mfma_f32_32x32x16_bf16 v[144:159], v[236:239], v[164:167], v[144:159]
    s_waitcnt vmcnt(7) lgkmcnt(4)
    v_mfma_f32_32x32x16_bf16 v[64:79], v[240:243], v[168:171], v[64:79]
    ds_read_b64_tr_b16 v[164:165], v203 offset:34816
    ds_read_b64_tr_b16 v[166:167], v203 offset:35072
    s_waitcnt vmcnt(6)
    v_mfma_f32_32x32x16_bf16 v[80:95], v[244:247], v[168:171], v[80:95]
    s_waitcnt lgkmcnt(4)
    v_mfma_f32_32x32x16_bf16 v[96:111], v[240:243], v[172:175], v[96:111]
    ds_read_b64_tr_b16 v[168:169], v203 offset:35328
    ds_read_b64_tr_b16 v[170:171], v203 offset:35584
    v_mfma_f32_32x32x16_bf16 v[112:127], v[244:247], v[172:175], v[112:127]
    s_waitcnt lgkmcnt(4)
    v_mfma_f32_32x32x16_bf16 v[128:143], v[240:243], v[160:163], v[128:143]
    ds_read_b64_tr_b16 v[172:173], v205 offset:54272
    ds_read_b64_tr_b16 v[174:175], v205 offset:54528
    v_mfma_f32_32x32x16_bf16 v[144:159], v[244:247], v[160:163], v[144:159]
    s_waitcnt vmcnt(5) lgkmcnt(4)
    v_mfma_f32_32x32x16_bf16 v[64:79], v[248:251], v[164:167], v[64:79]
    ds_read_b64_tr_b16 v[160:161], v219 offset:0
    ds_read_b64_tr_b16 v[162:163], v219 offset:256
    s_waitcnt vmcnt(3)
    v_mfma_f32_32x32x16_bf16 v[80:95], v[252:255], v[164:167], v[80:95]
    s_waitcnt lgkmcnt(4)
    v_mfma_f32_32x32x16_bf16 v[96:111], v[248:251], v[168:171], v[96:111]
    ds_read_b64_tr_b16 v[164:165], v219 offset:2048
    ds_read_b64_tr_b16 v[166:167], v219 offset:2304
    v_mfma_f32_32x32x16_bf16 v[112:127], v[252:255], v[168:171], v[112:127]
    s_waitcnt lgkmcnt(4)
    v_mfma_f32_32x32x16_bf16 v[128:143], v[248:251], v[172:175], v[128:143]
    ds_read_b64_tr_b16 v[168:169], v219 offset:4096
    ds_read_b64_tr_b16 v[170:171], v219 offset:4352
    v_mfma_f32_32x32x16_bf16 v[144:159], v[252:255], v[172:175], v[144:159]
    s_waitcnt lgkmcnt(4)
    v_mfma_f32_32x32x16_bf16 v[0:15], v[160:163], a[0:3], 0
    s_waitcnt vmcnt(0)
    s_barrier
    ds_read_b64_tr_b16 v[172:173], v219 offset:6144
    ds_read_b64_tr_b16 v[174:175], v219 offset:6400
    v_mfma_f32_32x32x16_bf16 v[32:47], v[160:163], a[4:7], 0
    s_waitcnt lgkmcnt(4)
    v_mfma_f32_32x32x16_bf16 v[16:31], v[164:167], a[0:3], 0
    ds_read_b64_tr_b16 v[160:161], v219 offset:8192
    ds_read_b64_tr_b16 v[162:163], v219 offset:8448
    s_add_u32 m0, s56, 36864
    v_mfma_f32_32x32x16_bf16 v[48:63], v[164:167], a[4:7], 0
    buffer_load_dwordx4 v213, s[52:55], s57 offen lds
    s_add_u32 s57, s57, 147456
    s_add_u32 s34, s66, 0
    s_sub_u32 s34, s34, 36
    s_lshl_b32 s34, s34, 5
    v_and_b32 v192, 31, v208
    s_waitcnt lgkmcnt(4)
    v_mfma_f32_32x32x16_bf16 v[0:15], v[168:171], a[8:11], v[0:15]
    ds_read_b64_tr_b16 v[164:165], v219 offset:10240
    ds_read_b64_tr_b16 v[166:167], v219 offset:10496
    v_add_u32 v192, s34, v192
    v_mul_u32_u24 v193, 3641, v192
    v_mfma_f32_32x32x16_bf16 v[32:47], v[168:171], a[12:15], v[32:47]
    s_add_u32 m0, s56, 40960
    v_lshrrev_b32 v193, 16, v193
    v_mul_u32_u24 v194, 18, v193
    s_waitcnt lgkmcnt(4)
    v_mfma_f32_32x32x16_bf16 v[16:31], v[172:175], a[8:11], v[16:31]
    ds_read_b64_tr_b16 v[168:169], v219 offset:12288
    ds_read_b64_tr_b16 v[170:171], v219 offset:12544
    buffer_load_dwordx4 v213, s[52:55], s57 offen lds
    s_add_u32 s57, s57, 147456
    v_sub_u32 v194, v192, v194
    v_mul_u32_u24 v193, 77824, v193
    v_mfma_f32_32x32x16_bf16 v[48:63], v[172:175], a[12:15], v[48:63]
    v_lshlrev_b32 v194, 4, v194
    v_add_u32 v193, v193, v194
    s_waitcnt lgkmcnt(4)
    v_mfma_f32_32x32x16_bf16 v[0:15], v[160:163], a[16:19], v[0:15]
    ds_read_b64_tr_b16 v[172:173], v219 offset:14336
    ds_read_b64_tr_b16 v[174:175], v219 offset:14592
    s_add_u32 m0, s56, 45056
    v_add_u32 v207, v193, v206
    v_cvt_pk_bf16_f32 v176, v64, v65
    v_mfma_f32_32x32x16_bf16 v[32:47], v[160:163], a[20:23], v[32:47]
    buffer_load_dwordx4 v213, s[52:55], s57 offen lds
    s_add_u32 s57, s57, 147456
    v_cvt_pk_bf16_f32 v177, v66, v67
    v_cvt_pk_bf16_f32 v178, v68, v69
    s_waitcnt lgkmcnt(4)
    v_mfma_f32_32x32x16_bf16 v[16:31], v[164:167], a[16:19], v[16:31]
    ds_read_b64_tr_b16 v[160:161], v219 offset:16384
    ds_read_b64_tr_b16 v[162:163], v219 offset:16640
    v_cvt_pk_bf16_f32 v179, v70, v71
    v_cvt_pk_bf16_f32 v180, v72, v73
    v_mfma_f32_32x32x16_bf16 v[48:63], v[164:167], a[20:23], v[48:63]
    v_cvt_pk_bf16_f32 v181, v74, v75
    v_cvt_pk_bf16_f32 v182, v76, v77
    s_waitcnt lgkmcnt(4)
    v_mfma_f32_32x32x16_bf16 v[0:15], v[168:171], a[24:27], v[0:15]
    ds_read_b64_tr_b16 v[164:165], v219 offset:18432
    ds_read_b64_tr_b16 v[166:167], v219 offset:18688
    s_add_u32 m0, s56, 49152
    v_cvt_pk_bf16_f32 v183, v78, v79
    s_add_u32 s35, s61, 0
    buffer_store_dwordx4 v[176:179], v207, s[24:27], s35 offen sc1
    v_mfma_f32_32x32x16_bf16 v[32:47], v[168:171], a[28:31], v[32:47]
    buffer_load_dwordx4 v213, s[52:55], s57 offen lds
    s_add_u32 s57, s57, 147456
    s_add_u32 s35, s61, 608
    buffer_store_dwordx4 v[180:183], v207, s[24:27], s35 offen sc1
    v_cvt_pk_bf16_f32 v184, v80, v81
    s_waitcnt lgkmcnt(4)
    v_mfma_f32_32x32x16_bf16 v[16:31], v[172:175], a[24:27], v[16:31]
    ds_read_b64_tr_b16 v[168:169], v219 offset:20480
    ds_read_b64_tr_b16 v[170:171], v219 offset:20736
    v_cvt_pk_bf16_f32 v185, v82, v83
    v_cvt_pk_bf16_f32 v186, v84, v85
    v_mfma_f32_32x32x16_bf16 v[48:63], v[172:175], a[28:31], v[48:63]
    s_add_u32 m0, s56, 53248
    v_cvt_pk_bf16_f32 v187, v86, v87
    v_cvt_pk_bf16_f32 v188, v88, v89
    s_waitcnt lgkmcnt(4)
    v_mfma_f32_32x32x16_bf16 v[0:15], v[160:163], a[32:35], v[0:15]
    ds_read_b64_tr_b16 v[172:173], v219 offset:22528
    ds_read_b64_tr_b16 v[174:175], v219 offset:22784
    buffer_load_dwordx4 v213, s[52:55], s57 offen lds
    s_add_u32 s57, s57, 147456
    v_cvt_pk_bf16_f32 v189, v90, v91
    v_cvt_pk_bf16_f32 v190, v92, v93
    v_mfma_f32_32x32x16_bf16 v[32:47], v[160:163], a[36:39], v[32:47]
    v_cvt_pk_bf16_f32 v191, v94, v95
    s_add_u32 s35, s61, 1216
    buffer_store_dwordx4 v[184:187], v207, s[24:27], s35 offen sc1
    s_waitcnt lgkmcnt(4)
    v_mfma_f32_32x32x16_bf16 v[16:31], v[164:167], a[32:35], v[16:31]
    ds_read_b64_tr_b16 v[160:161], v219 offset:24576
    ds_read_b64_tr_b16 v[162:163], v219 offset:24832
    s_add_u32 s35, s61, 1824
    buffer_store_dwordx4 v[188:191], v207, s[24:27], s35 offen sc1
    v_mfma_f32_32x32x16_bf16 v[48:63], v[164:167], a[36:39], v[48:63]
    s_add_u32 m0, s56, 57344
    s_add_u32 s34, s66, 1
    s_sub_u32 s34, s34, 36
    s_lshl_b32 s34, s34, 5
    v_and_b32 v192, 31, v208
    s_waitcnt lgkmcnt(4)
    v_mfma_f32_32x32x16_bf16 v[0:15], v[168:171], a[40:43], v[0:15]
    ds_read_b64_tr_b16 v[164:165], v219 offset:26624
    ds_read_b64_tr_b16 v[166:167], v219 offset:26880
    buffer_load_dwordx4 v213, s[52:55], s57 offen lds
    s_add_u32 s57, s57, 147456
    v_add_u32 v192, s34, v192
    v_mul_u32_u24 v193, 3641, v192
    v_mfma_f32_32x32x16_bf16 v[32:47], v[168:171], a[44:47], v[32:47]
    v_lshrrev_b32 v193, 16, v193
    v_mul_u32_u24 v194, 18, v193
    s_waitcnt lgkmcnt(4)
    v_mfma_f32_32x32x16_bf16 v[16:31], v[172:175], a[40:43], v[16:31]
    ds_read_b64_tr_b16 v[168:169], v219 offset:28672
    ds_read_b64_tr_b16 v[170:171], v219 offset:28928
    s_add_u32 m0, s56, 61440
    v_sub_u32 v194, v192, v194
    v_mul_u32_u24 v193, 77824, v193
    v_mfma_f32_32x32x16_bf16 v[48:63], v[172:175], a[44:47], v[48:63]
    buffer_load_dwordx4 v213, s[52:55], s57 offen lds
    s_add_u32 s57, s57, 147456
    v_lshlrev_b32 v194, 4, v194
    v_add_u32 v193, v193, v194
    s_waitcnt lgkmcnt(4)
    v_mfma_f32_32x32x16_bf16 v[0:15], v[160:163], a[48:51], v[0:15]
    ds_read_b64_tr_b16 v[172:173], v219 offset:30720
    ds_read_b64_tr_b16 v[174:175], v219 offset:30976
    v_add_u32 v207, v193, v206
    v_cvt_pk_bf16_f32 v176, v96, v97
    v_mfma_f32_32x32x16_bf16 v[32:47], v[160:163], a[52:55], v[32:47]
    v_cvt_pk_bf16_f32 v177, v98, v99
    v_cvt_pk_bf16_f32 v178, v100, v101
    s_waitcnt lgkmcnt(4)
    v_mfma_f32_32x32x16_bf16 v[16:31], v[164:167], a[48:51], v[16:31]
    ds_read_b64_tr_b16 v[160:161], v219 offset:32768
    ds_read_b64_tr_b16 v[162:163], v219 offset:33024
    s_add_u32 m0, s56, 65536
    v_cvt_pk_bf16_f32 v179, v102, v103
    v_cvt_pk_bf16_f32 v180, v104, v105
    v_mfma_f32_32x32x16_bf16 v[48:63], v[164:167], a[52:55], v[48:63]
    buffer_load_dwordx4 v213, s[52:55], s57 offen lds
    s_add_u32 s57, s57, 147456
    v_cvt_pk_bf16_f32 v181, v106, v107
    v_cvt_pk_bf16_f32 v182, v108, v109
    s_waitcnt lgkmcnt(4)
    v_mfma_f32_32x32x16_bf16 v[0:15], v[168:171], a[56:59], v[0:15]
    ds_read_b64_tr_b16 v[164:165], v219 offset:34816
    ds_read_b64_tr_b16 v[166:167], v219 offset:35072
    v_cvt_pk_bf16_f32 v183, v110, v111
    s_add_u32 s35, s61, 0
    buffer_store_dwordx4 v[176:179], v207, s[24:27], s35 offen sc1
    v_mfma_f32_32x32x16_bf16 v[32:47], v[168:171], a[60:63], v[32:47]
    s_add_u32 m0, s56, 69632
    s_add_u32 s35, s61, 608
    buffer_store_dwordx4 v[180:183], v207, s[24:27], s35 offen sc1
    v_cvt_pk_bf16_f32 v184, v112, v113
    s_waitcnt lgkmcnt(4)
    v_mfma_f32_32x32x16_bf16 v[16:31], v[172:175], a[56:59], v[16:31]
    ds_read_b64_tr_b16 v[168:169], v219 offset:512
    ds_read_b64_tr_b16 v[170:171], v219 offset:768
    buffer_load_dwordx4 v213, s[52:55], s57 offen lds
    s_add_u32 s57, s57, 147456
    v_cvt_pk_bf16_f32 v185, v114, v115
    v_cvt_pk_bf16_f32 v186, v116, v117
    v_mfma_f32_32x32x16_bf16 v[48:63], v[172:175], a[60:63], v[48:63]
    v_cvt_pk_bf16_f32 v187, v118, v119
    v_cvt_pk_bf16_f32 v188, v120, v121
    s_waitcnt lgkmcnt(4)
    v_mfma_f32_32x32x16_bf16 v[0:15], v[160:163], a[64:67], v[0:15]
    ds_read_b64_tr_b16 v[172:173], v219 offset:2560
    ds_read_b64_tr_b16 v[174:175], v219 offset:2816
    v_cvt_pk_bf16_f32 v189, v122, v123
    v_cvt_pk_bf16_f32 v190, v124, v125
    v_mfma_f32_32x32x16_bf16 v[32:47], v[160:163], a[68:71], v[32:47]
    s_add_u32 m0, s56, 73728
    v_cvt_pk_bf16_f32 v191, v126, v127
    s_add_u32 s35, s61, 1216
    buffer_store_dwordx4 v[184:187], v207, s[24:27], s35 offen sc1
    s_waitcnt lgkmcnt(4)
    v_mfma_f32_32x32x16_bf16 v[16:31], v[164:167], a[64:67], v[16:31]
    ds_read_b64_tr_b16 v[160:161], v219 offset:4608
    ds_read_b64_tr_b16 v[162:163], v219 offset:4864
    buffer_load_dwordx4 v213, s[52:55], s57 offen lds
    s_add_u32 s57, s57, 147456
    s_add_u32 s35, s61, 1824
    buffer_store_dwordx4 v[188:191], v207, s[24:27], s35 offen sc1
    v_mfma_f32_32x32x16_bf16 v[48:63], v[164:167], a[68:71], v[48:63]
    s_waitcnt lgkmcnt(4)
    v_mfma_f32_32x32x16_bf16 v[64:79], v[168:171], a[0:3], 0
    ds_read_b64_tr_b16 v[164:165], v219 offset:6656
    ds_read_b64_tr_b16 v[166:167], v219 offset:6912
    s_add_u32 m0, s56, 77824
    v_mfma_f32_32x32x16_bf16 v[96:111], v[168:171], a[4:7], 0
    buffer_load_dwordx4 v213, s[52:55], s57 offen lds
    s_add_u32 s57, s57, 147456
    s_waitcnt lgkmcnt(4)
    v_mfma_f32_32x32x16_bf16 v[80:95], v[172:175], a[0:3], 0
    ds_read_b64_tr_b16 v[168:169], v219 offset:8704
    ds_read_b64_tr_b16 v[170:171], v219 offset:8960
    v_mfma_f32_32x32x16_bf16 v[112:127], v[172:175], a[4:7], 0
    s_add_u32 m0, s56, 81920
    s_add_u32 s34, s67, 0
    s_sub_u32 s34, s34, 36
    s_lshl_b32 s34, s34, 5
    s_waitcnt lgkmcnt(4)
    v_mfma_f32_32x32x16_bf16 v[64:79], v[160:163], a[8:11], v[64:79]
    ds_read_b64_tr_b16 v[172:173], v219 offset:10752
    ds_read_b64_tr_b16 v[174:175], v219 offset:11008
    buffer_load_dwordx4 v213, s[52:55], s57 offen lds
    s_add_u32 s57, s57, 147456
    v_and_b32 v192, 31, v208
    v_mfma_f32_32x32x16_bf16 v[96:111], v[160:163], a[12:15], v[96:111]
    v_add_u32 v192, s34, v192
    s_waitcnt lgkmcnt(4)
    v_mfma_f32_32x32x16_bf16 v[80:95], v[164:167], a[8:11], v[80:95]
    ds_read_b64_tr_b16 v[160:161], v219 offset:12800
    ds_read_b64_tr_b16 v[162:163], v219 offset:13056
    v_mul_u32_u24 v193, 3641, v192
    v_mfma_f32_32x32x16_bf16 v[112:127], v[164:167], a[12:15], v[112:127]
    s_add_u32 m0, s56, 86016
    v_lshrrev_b32 v193, 16, v193
    s_waitcnt lgkmcnt(4)
    v_mfma_f32_32x32x16_bf16 v[64:79], v[168:171], a[16:19], v[64:79]
    ds_read_b64_tr_b16 v[164:165], v219 offset:14848
    ds_read_b64_tr_b16 v[166:167], v219 offset:15104
    buffer_load_dwordx4 v213, s[52:55], s57 offen lds
    s_add_u32 s57, s57, 147456
    v_mul_u32_u24 v194, 18, v193
    v_mfma_f32_32x32x16_bf16 v[96:111], v[168:171], a[20:23], v[96:111]
    v_sub_u32 v194, v192, v194
    s_waitcnt lgkmcnt(4)
    v_mfma_f32_32x32x16_bf16 v[80:95], v[172:175], a[16:19], v[80:95]
    ds_read_b64_tr_b16 v[168:169], v219 offset:16896
    ds_read_b64_tr_b16 v[170:171], v219 offset:17152
    s_add_u32 m0, s56, 90112
    v_mul_u32_u24 v193, 77824, v193
    v_mfma_f32_32x32x16_bf16 v[112:127], v[172:175], a[20:23], v[112:127]
    buffer_load_dwordx4 v213, s[52:55], s57 offen lds
    s_add_u32 s57, s57, 147456
    v_lshlrev_b32 v194, 4, v194
    s_waitcnt lgkmcnt(4)
    v_mfma_f32_32x32x16_bf16 v[64:79], v[160:163], a[24:27], v[64:79]
    ds_read_b64_tr_b16 v[172:173], v219 offset:18944
    ds_read_b64_tr_b16 v[174:175], v219 offset:19200
    v_add_u32 v193, v193, v194
    v_mfma_f32_32x32x16_bf16 v[96:111], v[160:163], a[28:31], v[96:111]
    v_add_u32 v207, v193, v206
    s_waitcnt lgkmcnt(4)
    v_mfma_f32_32x32x16_bf16 v[80:95], v[164:167], a[24:27], v[80:95]
    ds_read_b64_tr_b16 v[160:161], v219 offset:20992
    ds_read_b64_tr_b16 v[162:163], v219 offset:21248
    s_add_u32 m0, s56, 94208
    v_cvt_pk_bf16_f32 v176, v128, v129
    v_mfma_f32_32x32x16_bf16 v[112:127], v[164:167], a[28:31], v[112:127]
    buffer_load_dwordx4 v213, s[52:55], s57 offen lds
    s_add_u32 s57, s57, 147456
    v_cvt_pk_bf16_f32 v177, v130, v131
    s_waitcnt lgkmcnt(4)
    v_mfma_f32_32x32x16_bf16 v[64:79], v[168:171], a[32:35], v[64:79]
    ds_read_b64_tr_b16 v[164:165], v219 offset:23040
    ds_read_b64_tr_b16 v[166:167], v219 offset:23296
    v_cvt_pk_bf16_f32 v178, v132, v133
    v_mfma_f32_32x32x16_bf16 v[96:111], v[168:171], a[36:39], v[96:111]
    s_add_u32 m0, s56, 98304
    v_cvt_pk_bf16_f32 v179, v134, v135
    s_waitcnt lgkmcnt(4)
    v_mfma_f32_32x32x16_bf16 v[80:95], v[172:175], a[32:35], v[80:95]
    ds_read_b64_tr_b16 v[168:169], v219 offset:25088
    ds_read_b64_tr_b16 v[170:171], v219 offset:25344
    buffer_load_dwordx4 v213, s[52:55], s57 offen lds
    s_add_u32 s57, s57, 147456
    v_cvt_pk_bf16_f32 v180, v136, v137
    v_mfma_f32_32x32x16_bf16 v[112:127], v[172:175], a[36:39], v[112:127]
    v_cvt_pk_bf16_f32 v181, v138, v139
    s_waitcnt lgkmcnt(4)
    v_mfma_f32_32x32x16_bf16 v[64:79], v[160:163], a[40:43], v[64:79]
    ds_read_b64_tr_b16 v[172:173], v219 offset:27136
    ds_read_b64_tr_b16 v[174:175], v219 offset:27392
    v_cvt_pk_bf16_f32 v182, v140, v141
    v_mfma_f32_32x32x16_bf16 v[96:111], v[160:163], a[44:47], v[96:111]
    s_add_u32 m0, s56, 102400
    v_cvt_pk_bf16_f32 v183, v142, v143
    s_waitcnt lgkmcnt(4)
    v_mfma_f32_32x32x16_bf16 v[80:95], v[164:167], a[40:43], v[80:95]
    ds_read_b64_tr_b16 v[160:161], v219 offset:29184
    ds_read_b64_tr_b16 v[162:163], v219 offset:29440
    buffer_load_dwordx4 v213, s[52:55], s57 offen lds
    s_add_u32 s57, s57, 147456
    s_add_u32 s35, s61, 0
    buffer_store_dwordx4 v[176:179], v207, s[24:27], s35 offen sc1
    v_mfma_f32_32x32x16_bf16 v[112:127], v[164:167], a[44:47], v[112:127]
    s_add_u32 s35, s61, 608
    buffer_store_dwordx4 v[180:183], v207, s[24:27], s35 offen sc1
    s_waitcnt lgkmcnt(4)
    v_mfma_f32_32x32x16_bf16 v[64:79], v[168:171], a[48:51], v[64:79]
    ds_read_b64_tr_b16 v[164:165], v219 offset:31232
    ds_read_b64_tr_b16 v[166:167], v219 offset:31488
    s_add_u32 m0, s56, 106496
    v_cvt_pk_bf16_f32 v184, v144, v145
    v_mfma_f32_32x32x16_bf16 v[96:111], v[168:171], a[52:55], v[96:111]
    buffer_load_dwordx4 v213, s[52:55], s57 offen lds
    s_add_u32 s57, s57, 147456
    s_sub_u32 s57, s57, 5308288
    v_cvt_pk_bf16_f32 v185, v146, v147
    s_waitcnt lgkmcnt(4)
    v_mfma_f32_32x32x16_bf16 v[80:95], v[172:175], a[48:51], v[80:95]
    ds_read_b64_tr_b16 v[168:169], v219 offset:33280
    ds_read_b64_tr_b16 v[170:171], v219 offset:33536
    v_cvt_pk_bf16_f32 v186, v148, v149
    v_mfma_f32_32x32x16_bf16 v[112:127], v[172:175], a[52:55], v[112:127]
    v_cvt_pk_bf16_f32 v187, v150, v151
    s_waitcnt lgkmcnt(4)
    v_mfma_f32_32x32x16_bf16 v[64:79], v[160:163], a[56:59], v[64:79]
    ds_read_b64_tr_b16 v[172:173], v219 offset:35328
    ds_read_b64_tr_b16 v[174:175], v219 offset:35584
    v_cvt_pk_bf16_f32 v188, v152, v153
    v_mfma_f32_32x32x16_bf16 v[96:111], v[160:163], a[60:63], v[96:111]
    v_cvt_pk_bf16_f32 v189, v154, v155
    s_waitcnt lgkmcnt(4)
    v_mfma_f32_32x32x16_bf16 v[80:95], v[164:167], a[56:59], v[80:95]
    ds_read_b64_tr_b16 v[160:161], v216 offset:0
    ds_read_b64_tr_b16 v[162:163], v216 offset:256
    v_cvt_pk_bf16_f32 v190, v156, v157
    v_mfma_f32_32x32x16_bf16 v[112:127], v[164:167], a[60:63], v[112:127]
    v_cvt_pk_bf16_f32 v191, v158, v159
    s_waitcnt lgkmcnt(4)
    v_mfma_f32_32x32x16_bf16 v[64:79], v[168:171], a[64:67], v[64:79]
    ds_read_b64_tr_b16 v[164:165], v216 offset:2048
    ds_read_b64_tr_b16 v[166:167], v216 offset:2304
    s_add_u32 s35, s61, 1216
    buffer_store_dwordx4 v[184:187], v207, s[24:27], s35 offen sc1
    v_mfma_f32_32x32x16_bf16 v[96:111], v[168:171], a[68:71], v[96:111]
    s_add_u32 s35, s61, 1824
    buffer_store_dwordx4 v[188:191], v207, s[24:27], s35 offen sc1
    s_waitcnt lgkmcnt(4)
    v_mfma_f32_32x32x16_bf16 v[80:95], v[172:175], a[64:67], v[80:95]
    ds_read_b64_tr_b16 v[168:169], v216 offset:4096
    ds_read_b64_tr_b16 v[170:171], v216 offset:4352
    v_mfma_f32_32x32x16_bf16 v[112:127], v[172:175], a[68:71], v[112:127]
    s_branch L_j1
L_cls2:
    buffer_load_dwordx4 a[0:3], v210, s[24:27], s64 offen offset:0 sc1
    buffer_load_dwordx4 a[4:7], v210, s[24:27], s65 offen offset:0 sc1
    buffer_load_dwordx4 a[8:11], v210, s[24:27], s64 offen offset:1024 sc1
    buffer_load_dwordx4 a[12:15], v210, s[24:27], s65 offen offset:1024 sc1
    buffer_load_dwordx4 a[16:19], v210, s[24:27], s64 offen offset:2048 sc1
    buffer_load_dwordx4 a[20:23], v210, s[24:27], s65 offen offset:2048 sc1
    buffer_load_dwordx4 a[24:27], v210, s[24:27], s64 offen offset:3072 sc1
    buffer_load_dwordx4 a[28:31], v210, s[24:27], s65 offen offset:3072 sc1
    s_add_u32 s64, s64, 4096
    s_add_u32 s65, s65, 4096
    buffer_load_dwordx4 a[32:35], v210, s[24:27], s64 offen offset:0 sc1
    buffer_load_dwordx4 a[36:39], v210, s[24:27], s65 offen offset:0 sc1
    buffer_load_dwordx4 a[40:43], v210, s[24:27], s64 offen offset:1024 sc1
    buffer_load_dwordx4 a[44:47], v210, s[24:27], s65 offen offset:1024 sc1
    buffer_load_dwordx4 a[48:51], v210, s[24:27], s64 offen offset:2048 sc1
    buffer_load_dwordx4 a[52:55], v210, s[24:27], s65 offen offset:2048 sc1
    buffer_load_dwordx4 a[56:59], v210, s[24:27], s64 offen offset:3072 sc1
    buffer_load_dwordx4 a[60:63], v210, s[24:27], s65 offen offset:3072 sc1
    s_add_u32 s64, s64, 4096
    s_add_u32 s65, s65, 4096
    s_barrier
    ds_read_b64_tr_b16 v[160:161], v204 offset:0
    ds_read_b64_tr_b16 v[162:163], v204 offset:256
    ds_read_b64_tr_b16 v[164:165], v204 offset:18432
    ds_read_b64_tr_b16 v[166:167], v204 offset:18688
    ds_read_b64_tr_b16 v[168:169], v204 offset:36864
    ds_read_b64_tr_b16 v[170:171], v204 offset:37120
    s_waitcnt vmcnt(15) lgkmcnt(4)
    v_mfma_f32_32x32x16_bf16 v[64:79], v[160:163], a[0:3], 0
    ds_read_b64_tr_b16 v[172:173], v204 offset:1024
    ds_read_b64_tr_b16 v[174:175], v204 offset:1280
    s_waitcnt vmcnt(14)
    v_mfma_f32_32x32x16_bf16 v[80:95], v[160:163], a[4:7], 0
    buffer_load_dwordx4 a[64:67], v210, s[24:27], s64 offen offset:0 sc1
    s_waitcnt lgkmcnt(4)
    v_mfma_f32_32x32x16_bf16 v[96:111], v[164:167], a[0:3], 0
    ds_read_b64_tr_b16 v[160:161], v204 offset:19456
    ds_read_b64_tr_b16 v[162:163], v204 offset:19712
    v_mfma_f32_32x32x16_bf16 v[112:127], v[164:167], a[4:7], 0
    buffer_load_dwordx4 a[68:71], v210, s[24:27], s65 offen offset:0 sc1
    s_waitcnt lgkmcnt(4)
    v_mfma_f32_32x32x16_bf16 v[128:143], a[0:3], v[168:171], 0
    ds_read_b64_tr_b16 v[164:165], v204 offset:37888
    ds_read_b64_tr_b16 v[166:167], v204 offset:38144
    v_mfma_f32_32x32x16_bf16 v[144:159], a[4:7], v[168:171], 0
    s_waitcnt vmcnt(15) lgkmcnt(4)
    v_mfma_f32_32x32x16_bf16 v[64:79], v[172:175], a[8:11], v[64:79]
    ds_read_b64_tr_b16 v[168:169], v204 offset:2048
    ds_read_b64_tr_b16 v[170:171], v204 offset:2304
    s_waitcnt vmcnt(14)
    v_mfma_f32_32x32x16_bf16 v[80:95], v[172:175], a[12:15], v[80:95]
    buffer_load_dwordx4 a[72:75], v210, s[24:27], s64 offen offset:1024 sc1
    s_waitcnt lgkmcnt(4)
    v_mfma_f32_32x32x16_bf16 v[96:111], v[160:163], a[8:11], v[96:111]
    ds_read_b64_tr_b16 v[172:173], v204 offset:20480
    ds_read_b64_tr_b16 v[174:175], v204 offset:20736
    v_mfma_f32_32x32x16_bf16 v[112:127], v[160:163], a[12:15], v[112:127]
    buffer_load_dwordx4 a[76:79], v210, s[24:27], s65 offen offset:1024 sc1
    s_waitcnt lgkmcnt(4)
    v_mfma_f32_32x32x16_bf16 v[128:143], a[8:11], v[164:167], v[128:143]
    ds_read_b64_tr_b16 v[160:161], v204 offset:38912
    ds_read_b64_tr_b16 v[162:163], v204 offset:39168
    v_mfma_f32_32x32x16_bf16 v[144:159], a[12:15], v[164:167], v[144:159]
    s_waitcnt vmcnt(15) lgkmcnt(4)
    v_mfma_f32_32x32x16_bf16 v[64:79], v[168:171], a[16:19], v[64:79]
    ds_read_b64_tr_b16 v[164:165], v204 offset:3072
    ds_read_b64_tr_b16 v[166:167], v204 offset:3328
    s_waitcnt vmcnt(14)
    v_mfma_f32_32x32x16_bf16 v[80:95], v[168:171], a[20:23], v[80:95]
    buffer_load_dwordx4 a[80:83], v210, s[24:27], s64 offen offset:2048 sc1
    s_waitcnt lgkmcnt(4)
    v_mfma_f32_32x32x16_bf16 v[96:111], v[172:175], a[16:19], v[96:111]
    ds_read_b64_tr_b16 v[168:169], v204 offset:21504
    ds_read_b64_tr_b16 v[170:171], v204 offset:21760
    v_mfma_f32_32x32x16_bf16 v[112:127], v[172:175], a[20:23], v[112:127]
    buffer_load_dwordx4 a[84:87], v210, s[24:27], s65 offen offset:2048 sc1
    s_waitcnt lgkmcnt(4)
    v_mfma_f32_32x32x16_bf16 v[128:143], a[16:19], v[160:163], v[128:143]
    ds_read_b64_tr_b16 v[172:173], v204 offset:39936
    ds_read_b64_tr_b16 v[174:175], v204 offset:40192
    v_mfma_f32_32x32x16_bf16 v[144:159], a[20:23], v[160:163], v[144:159]
    s_waitcnt vmcnt(15) lgkmcnt(4)
    v_mfma_f32_32x32x16_bf16 v[64:79], v[164:167], a[24:27], v[64:79]
    ds_read_b64_tr_b16 v[160:161], v204 offset:4096
    ds_read_b64_tr_b16 v[162:163], v204 offset:4352
    s_waitcnt vmcnt(14)
    v_mfma_f32_32x32x16_bf16 v[80:95], v[164:167], a[28:31], v[80:95]
    buffer_load_dwordx4 a[88:91], v210, s[24:27], s64 offen offset:3072 sc1
    s_waitcnt lgkmcnt(4)
    v_mfma_f32_32x32x16_bf16 v[96:111], v[168:171], a[24:27], v[96:111]
    ds_read_b64_tr_b16 v[164:165], v204 offset:22528
    ds_read_b64_tr_b16 v[166:167], v204 offset:22784
    v_mfma_f32_32x32x16_bf16 v[112:127], v[168:171], a[28:31], v[112:127]
    buffer_load_dwordx4 a[92:95], v210, s[24:27], s65 offen offset:3072 sc1
    s_add_u32 s64, s64, 4096
    s_add_u32 s65, s65, 4096
    s_waitcnt lgkmcnt(4)
    v_mfma_f32_32x32x16_bf16 v[128:143], a[24:27], v[172:175], v[128:143]
    ds_read_b64_tr_b16 v[168:169], v204 offset:40960
    ds_read_b64_tr_b16 v[170:171], v204 offset:41216
    v_mfma_f32_32x32x16_bf16 v[144:159], a[28:31], v[172:175], v[144:159]
    s_waitcnt vmcnt(15) lgkmcnt(4)
    v_mfma_f32_32x32x16_bf16 v[64:79], v[160:163], a[32:35], v[64:79]
    ds_read_b64_tr_b16 v[172:173], v204 offset:5120
    ds_read_b64_tr_b16 v[174:175], v204 offset:5376
    s_waitcnt vmcnt(14)
    v_mfma_f32_32x32x16_bf16 v[80:95], v[160:163], a[36:39], v[80:95]
    buffer_load_dwordx4 a[96:99], v210, s[24:27], s64 offen offset:0 sc1
    s_waitcnt lgkmcnt(4)
    v_mfma_f32_32x32x16_bf16 v[96:111], v[164:167], a[32:35], v[96:111]
    ds_read_b64_tr_b16 v[160:161], v204 offset:23552
    ds_read_b64_tr_b16 v[162:163], v204 offset:23808
    v_mfma_f32_32x32x16_bf16 v[112:127], v[164:167], a[36:39], v[112:127]
    buffer_load_dwordx4 a[100:103], v210, s[24:27], s65 offen offset:0 sc1
    s_waitcnt lgkmcnt(4)
    v_mfma_f32_32x32x16_bf16 v[128:143], a[32:35], v[168:171], v[128:143]
    ds_read_b64_tr_b16 v[164:165], v204 offset:41984
    ds_read_b64_tr_b16 v[166:167], v204 offset:42240
    v_mfma_f32_32x32x16_bf16 v[144:159], a[36:39], v[168:171], v[144:159]
    s_waitcnt vmcnt(15) lgkmcnt(4)
    v_mfma_f32_32x32x16_bf16 v[64:79], v[172:175], a[40:43], v[64:79]
    ds_read_b64_tr_b16 v[168:169], v204 offset:6144
    ds_read_b64_tr_b16 v[170:171], v204 offset:6400
    s_waitcnt vmcnt(14)
    v_mfma_f32_32x32x16_bf16 v[80:95], v[172:175], a[44:47], v[80:95]
    buffer_load_dwordx4 a[104:107], v210, s[24:27], s64 offen offset:1024 sc1
    s_waitcnt lgkmcnt(4)
    v_mfma_f32_32x32x16_bf16 v[96:111], v[160:163], a[40:43], v[96:111]
    ds_read_b64_tr_b16 v[172:173], v204 offset:24576
    ds_read_b64_tr_b16 v[174:175], v204 offset:24832
    v_mfma_f32_32x32x16_bf16 v[112:127], v[160:163], a[44:47], v[112:127]
    buffer_load_dwordx4 a[108:111], v210, s[24:27], s65 offen offset:1024 sc1
    s_waitcnt lgkmcnt(4)
    v_mfma_f32_32x32x16_bf16 v[128:143], a[40:43], v[164:167], v[128:143]
    ds_read_b64_tr_b16 v[160:161], v204 offset:43008
    ds_read_b64_tr_b16 v[162:163], v204 offset:43264
    v_mfma_f32_32x32x16_bf16 v[144:159], a[44:47], v[164:167], v[144:159]
    s_waitcnt vmcnt(15) lgkmcnt(4)
    v_mfma_f32_32x32x16_bf16 v[64:79], v[168:171], a[48:51], v[64:79]
    ds_read_b64_tr_b16 v[164:165], v204 offset:7168
    ds_read_b64_tr_b16 v[166:167], v204 offset:7424
    s_waitcnt vmcnt(14)
    v_mfma_f32_32x32x16_bf16 v[80:95], v[168:171], a[52:55], v[80:95]
    buffer_load_dwordx4 a[112:115], v210, s[24:27], s64 offen offset:2048 sc1
    s_waitcnt lgkmcnt(4)
    v_mfma_f32_32x32x16_bf16 v[96:111], v[172:175], a[48:51], v[96:111]
    ds_read_b64_tr_b16 v[168:169], v204 offset:25600
    ds_read_b64_tr_b16 v[170:171], v204 offset:25856
    v_mfma_f32_32x32x16_bf16 v[112:127], v[172:175], a[52:55], v[112:127]
    buffer_load_dwordx4 a[116:119], v210, s[24:27], s65 offen offset:2048 sc1
    s_waitcnt lgkmcnt(4)
    v_mfma_f32_32x32x16_bf16 v[128:143], a[48:51], v[160:163], v[128:143]
    ds_read_b64_tr_b16 v[172:173], v204 offset:44032
    ds_read_b64_tr_b16 v[174:175], v204 offset:44288
    v_mfma_f32_32x32x16_bf16 v[144:159], a[52:55], v[160:163], v[144:159]
    s_waitcnt vmcnt(15) lgkmcnt(4)
    v_mfma_f32_32x32x16_bf16 v[64:79], v[164:167], a[56:59], v[64:79]
    ds_read_b64_tr_b16 v[160:161], v204 offset:8192
    ds_read_b64_tr_b16 v[162:163], v204 offset:8448
    s_waitcnt vmcnt(14)
    v_mfma_f32_32x32x16_bf16 v[80:95], v[164:167], a[60:63], v[80:95]
    buffer_load_dwordx4 a[120:123], v210, s[24:27], s64 offen offset:3072 sc1
    s_waitcnt lgkmcnt(4)
    v_mfma_f32_32x32x16_bf16 v[96:111], v[168:171], a[56:59], v[96:111]
    ds_read_b64_tr_b16 v[164:165], v204 offset:26624
    ds_read_b64_tr_b16 v[166:167], v204 offset:26880
    v_mfma_f32_32x32x16_bf16 v[112:127], v[168:171], a[60:63], v[112:127]
    buffer_load_dwordx4 a[124:127], v210, s[24:27], s65 offen offset:3072 sc1
    s_add_u32 s64, s64, 4096
    s_add_u32 s65, s65, 4096
    s_waitcnt lgkmcnt(4)
    v_mfma_f32_32x32x16_bf16 v[128:143], a[56:59], v[172:175], v[128:143]
    ds_read_b64_tr_b16 v[168:169], v204 offset:45056
    ds_read_b64_tr_b16 v[170:171], v204 offset:45312
    v_mfma_f32_32x32x16_bf16 v[144:159], a[60:63], v[172:175], v[144:159]
    s_waitcnt vmcnt(15) lgkmcnt(4)
    v_mfma_f32_32x32x16_bf16 v[64:79], v[160:163], a[64:67], v[64:79]
    ds_read_b64_tr_b16 v[172:173], v204 offset:9216
    ds_read_b64_tr_b16 v[174:175], v204 offset:9472
    s_waitcnt vmcnt(14)
    v_mfma_f32_32x32x16_bf16 v[80:95], v[160:163], a[68:71], v[80:95]
    buffer_load_dwordx4 a[128:131], v210, s[24:27], s64 offen offset:0 sc1
    s_waitcnt lgkmcnt(4)
    v_mfma_f32_32x32x16_bf16 v[96:111], v[164:167], a[64:67], v[96:111]
    ds_read_b64_tr_b16 v[160:161], v204 offset:27648
    ds_read_b64_tr_b16 v[162:163], v204 offset:27904
    v_mfma_f32_32x32x16_bf16 v[112:127], v[164:167], a[68:71], v[112:127]
    buffer_load_dwordx4 a[132:135], v210, s[24:27], s65 offen offset:0 sc1
    s_waitcnt lgkmcnt(4)
    v_mfma_f32_32x32x16_bf16 v[128:143], a[64:67], v[168:171], v[128:143]
    ds_read_b64_tr_b16 v[164:165], v204 offset:46080
    ds_read_b64_tr_b16 v[166:167], v204 offset:46336
    v_mfma_f32_32x32x16_bf16 v[144:159], a[68:71], v[168:171], v[144:159]
    s_waitcnt vmcnt(15) lgkmcnt(4)
    v_mfma_f32_32x32x16_bf16 v[64:79], v[172:175], a[72:75], v[64:79]
    ds_read_b64_tr_b16 v[168:169], v204 offset:10240
    ds_read_b64_tr_b16 v[170:171], v204 offset:10496
    s_waitcnt vmcnt(14)
    v_mfma_f32_32x32x16_bf16 v[80:95], v[172:175], a[76:79], v[80:95]
    buffer_load_dwordx4 a[136:139], v210, s[24:27], s64 offen offset:1024 sc1
    s_waitcnt lgkmcnt(4)
    v_mfma_f32_32x32x16_bf16 v[96:111], v[160:163], a[72:75], v[96:111]
    ds_read_b64_tr_b16 v[172:173], v204 offset:28672
    ds_read_b64_tr_b16 v[174:175], v204 offset:28928
    v_mfma_f32_32x32x16_bf16 v[112:127], v[160:163], a[76:79], v[112:127]
    buffer_load_dwordx4 a[140:143], v210, s[24:27], s65 offen offset:1024 sc1
    s_waitcnt lgkmcnt(4)
    v_mfma_f32_32x32x16_bf16 v[128:143], a[72:75], v[164:167], v[128:143]
    ds_read_b64_tr_b16 v[160:161], v204 offset:47104
    ds_read_b64_tr_b16 v[162:163], v204 offset:47360
    v_mfma_f32_32x32x16_bf16 v[144:159], a[76:79], v[164:167], v[144:159]
    s_waitcnt vmcnt(15) lgkmcnt(4)
    v_mfma_f32_32x32x16_bf16 v[64:79], v[168:171], a[80:83], v[64:79]
    ds_read_b64_tr_b16 v[164:165], v204 offset:11264
    ds_read_b64_tr_b16 v[166:167], v204 offset:11520
    s_waitcnt vmcnt(14)
    v_mfma_f32_32x32x16_bf16 v[80:95], v[168:171], a[84:87], v[80:95]
    buffer_load_dwordx4 a[144:147], v210, s[24:27], s64 offen offset:2048 sc1
    s_waitcnt lgkmcnt(4)
    v_mfma_f32_32x32x16_bf16 v[96:111], v[172:175], a[80:83], v[96:111]
    ds_read_b64_tr_b16 v[168:169], v204 offset:29696
    ds_read_b64_tr_b16 v[170:171], v204 offset:29952
    v_mfma_f32_32x32x16_bf16 v[112:127], v[172:175], a[84:87], v[112:127]
    buffer_load_dwordx4 a[148:151], v210, s[24:27], s65 offen offset:2048 sc1
    s_waitcnt lgkmcnt(4)
    v_mfma_f32_32x32x16_bf16 v[128:143], a[80:83], v[160:163], v[128:143]
    ds_read_b64_tr_b16 v[172:173], v204 offset:48128
    ds_read_b64_tr_b16 v[174:175], v204 offset:48384
    v_mfma_f32_32x32x16_bf16 v[144:159], a[84:87], v[160:163], v[144:159]
    s_waitcnt vmcnt(15) lgkmcnt(4)
    v_mfma_f32_32x32x16_bf16 v[64:79], v[164:167], a[88:91], v[64:79]
    ds_read_b64_tr_b16 v[160:161], v204 offset:12288
    ds_read_b64_tr_b16 v[162:163], v204 offset:12544
    s_waitcnt vmcnt(14)
    v_mfma_f32_32x32x16_bf16 v[80:95], v[164:167], a[92:95], v[80:95]
    buffer_load_dwordx4 a[152:155], v210, s[24:27], s64 offen offset:3072 sc1
    s_waitcnt lgkmcnt(4)
    v_mfma_f32_32x32x16_bf16 v[96:111], v[168:171], a[88:91], v[96:111]
    ds_read_b64_tr_b16 v[164:165], v204 offset:30720
    ds_read_b64_tr_b16 v[166:167], v204 offset:30976
    v_mfma_f32_32x32x16_bf16 v[112:127], v[168:171], a[92:95], v[112:127]
    buffer_load_dwordx4 a[156:159], v210, s[24:27], s65 offen offset:3072 sc1
    s_add_u32 s64, s64, 4096
    s_add_u32 s65, s65, 4096
    s_waitcnt lgkmcnt(4)
    v_mfma_f32_32x32x16_bf16 v[128:143], a[88:91], v[172:175], v[128:143]
    ds_read_b64_tr_b16 v[168:169], v204 offset:49152
    ds_read_b64_tr_b16 v[170:171], v204 offset:49408
    v_mfma_f32_32x32x16_bf16 v[144:159], a[92:95], v[172:175], v[144:159]
    s_waitcnt vmcnt(15) lgkmcnt(4)
    v_mfma_f32_32x32x16_bf16 v[64:79], v[160:163], a[96:99], v[64:79]
    ds_read_b64_tr_b16 v[172:173], v204 offset:13312
    ds_read_b64_tr_b16 v[174:175], v204 offset:13568
    s_waitcnt vmcnt(14)
    v_mfma_f32_32x32x16_bf16 v[80:95], v[160:163], a[100:103], v[80:95]
    buffer_load_dwordx4 a[160:163], v210, s[24:27], s64 offen offset:0 sc1
    s_waitcnt lgkmcnt(4)
    v_mfma_f32_32x32x16_bf16 v[96:111], v[164:167], a[96:99], v[96:111]
    ds_read_b64_tr_b16 v[160:161], v204 offset:31744
    ds_read_b64_tr_b16 v[162:163], v204 offset:32000
    v_mfma_f32_32x32x16_bf16 v[112:127], v[164:167], a[100:103], v[112:127]
    buffer_load_dwordx4 a[164:167], v210, s[24:27], s65 offen offset:0 sc1
    s_waitcnt lgkmcnt(4)
    v_mfma_f32_32x32x16_bf16 v[128:143], a[96:99], v[168:171], v[128:143]
    ds_read_b64_tr_b16 v[164:165], v204 offset:50176
    ds_read_b64_tr_b16 v[166:167], v204 offset:50432
    v_mfma_f32_32x32x16_bf16 v[144:159], a[100:103], v[168:171], v[144:159]
    s_waitcnt vmcnt(15) lgkmcnt(4)
    v_mfma_f32_32x32x16_bf16 v[64:79], v[172:175], a[104:107], v[64:79]
    ds_read_b64_tr_b16 v[168:169], v204 offset:14336
    ds_read_b64_tr_b16 v[170:171], v204 offset:14592
    s_waitcnt vmcnt(14)
    v_mfma_f32_32x32x16_bf16 v[80:95], v[172:175], a[108:111], v[80:95]
    buffer_load_dwordx4 a[168:171], v210, s[24:27], s64 offen offset:1024 sc1
    s_waitcnt lgkmcnt(4)
    v_mfma_f32_32x32x16_bf16 v[96:111], v[160:163], a[104:107], v[96:111]
    ds_read_b64_tr_b16 v[172:173], v204 offset:32768
    ds_read_b64_tr_b16 v[174:175], v204 offset:33024
    v_mfma_f32_32x32x16_bf16 v[112:127], v[160:163], a[108:111], v[112:127]
    buffer_load_dwordx4 a[172:175], v210, s[24:27], s65 offen offset:1024 sc1
    s_waitcnt lgkmcnt(4)
    v_mfma_f32_32x32x16_bf16 v[128:143], a[104:107], v[164:167], v[128:143]
    ds_read_b64_tr_b16 v[160:161], v204 offset:51200
    ds_read_b64_tr_b16 v[162:163], v204 offset:51456
    v_mfma_f32_32x32x16_bf16 v[144:159], a[108:111], v[164:167], v[144:159]
    s_waitcnt vmcnt(15) lgkmcnt(4)
    v_mfma_f32_32x32x16_bf16 v[64:79], v[168:171], a[112:115], v[64:79]
    ds_read_b64_tr_b16 v[164:165], v204 offset:15360
    ds_read_b64_tr_b16 v[166:167], v204 offset:15616
    s_waitcnt vmcnt(14)
    v_mfma_f32_32x32x16_bf16 v[80:95], v[168:171], a[116:119], v[80:95]
    buffer_load_dwordx4 a[176:179], v210, s[24:27], s64 offen offset:2048 sc1
    s_waitcnt lgkmcnt(4)
    v_mfma_f32_32x32x16_bf16 v[96:111], v[172:175], a[112:115], v[96:111]
    ds_read_b64_tr_b16 v[168:169], v204 offset:33792
    ds_read_b64_tr_b16 v[170:171], v204 offset:34048
    v_mfma_f32_32x32x16_bf16 v[112:127], v[172:175], a[116:119], v[112:127]
    buffer_load_dwordx4 a[180:183], v210, s[24:27], s65 offen offset:2048 sc1
    s_waitcnt lgkmcnt(4)
    v_mfma_f32_32x32x16_bf16 v[128:143], a[112:115], v[160:163], v[128:143]
    ds_read_b64_tr_b16 v[172:173], v204 offset:52224
    ds_read_b64_tr_b16 v[174:175], v204 offset:52480
    v_mfma_f32_32x32x16_bf16 v[144:159], a[116:119], v[160:163], v[144:159]
    s_waitcnt vmcnt(15) lgkmcnt(4)
    v_mfma_f32_32x32x16_bf16 v[64:79], v[164:167], a[120:123], v[64:79]
    ds_read_b64_tr_b16 v[160:161], v204 offset:16384
    ds_read_b64_tr_b16 v[162:163], v204 offset:16640
    s_waitcnt vmcnt(14)
    v_mfma_f32_32x32x16_bf16 v[80:95], v[164:167], a[124:127], v[80:95]
    buffer_load_dwordx4 a[184:187], v210, s[24:27], s64 offen offset:3072 sc1
    s_waitcnt lgkmcnt(4)
    v_mfma_f32_32x32x16_bf16 v[96:111], v[168:171], a[120:123], v[96:111]
    ds_read_b64_tr_b16 v[164:165], v204 offset:34816
    ds_read_b64_tr_b16 v[166:167], v204 offset:35072
    v_mfma_f32_32x32x16_bf16 v[112:127], v[168:171], a[124:127], v[112:127]
    buffer_load_dwordx4 a[188:191], v210, s[24:27], s65 offen offset:3072 sc1
    s_add_u32 s64, s64, 4096
    s_add_u32 s65, s65, 4096
    s_waitcnt lgkmcnt(4)
    v_mfma_f32_32x32x16_bf16 v[128:143], a[120:123], v[172:175], v[128:143]
    ds_read_b64_tr_b16 v[168:169], v204 offset:53248
    ds_read_b64_tr_b16 v[170:171], v204 offset:53504
    v_mfma_f32_32x32x16_bf16 v[144:159], a[124:127], v[172:175], v[144:159]
    s_waitcnt vmcnt(15) lgkmcnt(4)
    v_mfma_f32_32x32x16_bf16 v[64:79], v[160:163], a[128:131], v[64:79]
    ds_read_b64_tr_b16 v[172:173], v204 offset:17408
    ds_read_b64_tr_b16 v[174:175], v204 offset:17664
    s_waitcnt vmcnt(14)
    v_mfma_f32_32x32x16_bf16 v[80:95], v[160:163], a[132:135], v[80:95]
    buffer_load_dwordx4 a[192:195], v210, s[24:27], s64 offen offset:0 sc1
    s_waitcnt lgkmcnt(4)
    v_mfma_f32_32x32x16_bf16 v[96:111], v[164:167], a[128:131], v[96:111]
    ds_read_b64_tr_b16 v[160:161], v204 offset:35840
    ds_read_b64_tr_b16 v[162:163], v204 offset:36096
    v_mfma_f32_32x32x16_bf16 v[112:127], v[164:167], a[132:135], v[112:127]
    buffer_load_dwordx4 a[196:199], v210, s[24:27], s65 offen offset:0 sc1
    s_waitcnt lgkmcnt(4)
    v_mfma_f32_32x32x16_bf16 v[128:143], a[128:131], v[168:171], v[128:143]
    ds_read_b64_tr_b16 v[164:165], v204 offset:54272
    ds_read_b64_tr_b16 v[166:167], v204 offset:54528
    v_mfma_f32_32x32x16_bf16 v[144:159], a[132:135], v[168:171], v[144:159]
    s_barrier
    s_waitcnt vmcnt(15) lgkmcnt(4)
    v_mfma_f32_32x32x16_bf16 v[64:79], v[172:175], a[136:139], v[64:79]
    ds_read_b64_tr_b16 v[168:169], v205 offset:0
    ds_read_b64_tr_b16 v[170:171], v205 offset:256
    s_waitcnt vmcnt(14)
    v_mfma_f32_32x32x16_bf16 v[80:95], v[172:175], a[140:143], v[80:95]
    buffer_load_dwordx4 a[200:203], v210, s[24:27], s64 offen offset:1024 sc1
    s_waitcnt lgkmcnt(4)
    v_mfma_f32_32x32x16_bf16 v[96:111], v[160:163], a[136:139], v[96:111]
    ds_read_b64_tr_b16 v[172:173], v205 offset:18432
    ds_read_b64_tr_b16 v[174:175], v205 offset:18688
    v_mfma_f32_32x32x16_bf16 v[112:127], v[160:163], a[140:143], v[112:127]
    buffer_load_dwordx4 a[204:207], v210, s[24:27], s65 offen offset:1024 sc1
    s_waitcnt lgkmcnt(4)
    v_mfma_f32_32x32x16_bf16 v[128:143], a[136:139], v[164:167], v[128:143]
    ds_read_b64_tr_b16 v[160:161], v205 offset:36864
    ds_read_b64_tr_b16 v[162:163], v205 offset:37120
    v_mfma_f32_32x32x16_bf16 v[144:159], a[140:143], v[164:167], v[144:159]
    s_barrier
    s_waitcnt vmcnt(15) lgkmcnt(4)
    v_mfma_f32_32x32x16_bf16 v[64:79], v[168:171], a[144:147], v[64:79]
    ds_read_b64_tr_b16 v[164:165], v205 offset:1024
    ds_read_b64_tr_b16 v[166:167], v205 offset:1280
    s_add_u32 m0, s56, 0
    s_waitcnt vmcnt(14)
    v_mfma_f32_32x32x16_bf16 v[80:95], v[168:171], a[148:151], v[80:95]
    buffer_load_dwordx4 a[208:211], v210, s[24:27], s64 offen offset:2048 sc1
    buffer_load_dwordx4 v213, s[52:55], s57 offen lds
    s_add_u32 s57, s57, 147456
    s_waitcnt lgkmcnt(4)
    v_mfma_f32_32x32x16_bf16 v[96:111], v[172:175], a[144:147], v[96:111]
    ds_read_b64_tr_b16 v[168:169], v205 offset:19456
    ds_read_b64_tr_b16 v[170:171], v205 offset:19712
    v_mfma_f32_32x32x16_bf16 v[112:127], v[172:175], a[148:151], v[112:127]
    buffer_load_dwordx4 a[212:215], v210, s[24:27], s65 offen offset:2048 sc1
    s_waitcnt lgkmcnt(4)
    v_mfma_f32_32x32x16_bf16 v[128:143], a[144:147], v[160:163], v[128:143]
    ds_read_b64_tr_b16 v[172:173], v205 offset:37888
    ds_read_b64_tr_b16 v[174:175], v205 offset:38144
    v_mfma_f32_32x32x16_bf16 v[144:159], a[148:151], v[160:163], v[144:159]
    s_waitcnt vmcnt(16) lgkmcnt(4)
    v_mfma_f32_32x32x16_bf16 v[64:79], v[164:167], a[152:155], v[64:79]
    ds_read_b64_tr_b16 v[160:161], v205 offset:2048
    ds_read_b64_tr_b16 v[162:163], v205 offset:2304
    s_waitcnt vmcnt(15)
    v_mfma_f32_32x32x16_bf16 v[80:95], v[164:167], a[156:159], v[80:95]
    buffer_load_dwordx4 a[216:219], v210, s[24:27], s64 offen offset:3072 sc1
    s_waitcnt lgkmcnt(4)
    v_mfma_f32_32x32x16_bf16 v[96:111], v[168:171], a[152:155], v[96:111]
    ds_read_b64_tr_b16 v[164:165], v205 offset:20480
    ds_read_b64_tr_b16 v[166:167], v205 offset:20736
    v_mfma_f32_32x32x16_bf16 v[112:127], v[168:171], a[156:159], v[112:127]
    buffer_load_dwordx4 a[220:223], v210, s[24:27], s65 offen offset:3072 sc1
    s_add_u32 s64, s64, 4096
    s_add_u32 s65, s65, 4096
    s_waitcnt lgkmcnt(4)
    v_mfma_f32_32x32x16_bf16 v[128:143], a[152:155], v[172:175], v[128:143]
    ds_read_b64_tr_b16 v[168:169], v205 offset:38912
    ds_read_b64_tr_b16 v[170:171], v205 offset:39168
    v_mfma_f32_32x32x16_bf16 v[144:159], a[156:159], v[172:175], v[144:159]
    s_add_u32 m0, s56, 4096
    s_waitcnt vmcnt(16) lgkmcnt(4)
    v_mfma_f32_32x32x16_bf16 v[64:79], v[160:163], a[160:163], v[64:79]
    ds_read_b64_tr_b16 v[172:173], v205 offset:3072
    ds_read_b64_tr_b16 v[174:175], v205 offset:3328
    buffer_load_dwordx4 v213, s[52:55], s57 offen lds
    s_add_u32 s57, s57, 147456
    s_waitcnt vmcnt(16)
    v_mfma_f32_32x32x16_bf16 v[80:95], v[160:163], a[164:167], v[80:95]
    buffer_load_dwordx4 a[224:227], v210, s[24:27], s64 offen offset:0 sc1
    s_waitcnt lgkmcnt(4)
    v_mfma_f32_32x32x16_bf16 v[96:111], v[164:167], a[160:163], v[96:111]
    ds_read_b64_tr_b16 v[160:161], v205 offset:21504
    ds_read_b64_tr_b16 v[162:163], v205 offset:21760
    v_mfma_f32_32x32x16_bf16 v[112:127], v[164:167], a[164:167], v[112:127]
    buffer_load_dwordx4 a[228:231], v210, s[24:27], s65 offen offset:0 sc1
    s_waitcnt lgkmcnt(4)
    v_mfma_f32_32x32x16_bf16 v[128:143], a[160:163], v[168:171], v[128:143]
    ds_read_b64_tr_b16 v[164:165], v205 offset:39936
    ds_read_b64_tr_b16 v[166:167], v205 offset:40192
    v_mfma_f32_32x32x16_bf16 v[144:159], a[164:167], v[168:171], v[144:159]
    s_waitcnt vmcnt(17) lgkmcnt(4)
    v_mfma_f32_32x32x16_bf16 v[64:79], v[172:175], a[168:171], v[64:79]
    ds_read_b64_tr_b16 v[168:169], v205 offset:4096
    ds_read_b64_tr_b16 v[170:171], v205 offset:4352
    s_waitcnt vmcnt(16)
    v_mfma_f32_32x32x16_bf16 v[80:95], v[172:175], a[172:175], v[80:95]
    buffer_load_dwordx4 a[232:235], v210, s[24:27], s64 offen offset:1024 sc1
    s_waitcnt lgkmcnt(4)
    v_mfma_f32_32x32x16_bf16 v[96:111], v[160:163], a[168:171], v[96:111]
    ds_read_b64_tr_b16 v[172:173], v205 offset:22528
    ds_read_b64_tr_b16 v[174:175], v205 offset:22784
    v_mfma_f32_32x32x16_bf16 v[112:127], v[160:163], a[172:175], v[112:127]
    buffer_load_dwordx4 a[236:239], v210, s[24:27], s65 offen offset:1024 sc1
    s_waitcnt lgkmcnt(4)
    v_mfma_f32_32x32x16_bf16 v[128:143], a[168:171], v[164:167], v[128:143]
    ds_read_b64_tr_b16 v[160:161], v205 offset:40960
    ds_read_b64_tr_b16 v[162:163], v205 offset:41216
    s_add_u32 m0, s56, 8192
    v_mfma_f32_32x32x16_bf16 v[144:159], a[172:175], v[164:167], v[144:159]
    buffer_load_dwordx4 v213, s[52:55], s57 offen lds
    s_add_u32 s57, s57, 147456
    s_waitcnt vmcnt(18) lgkmcnt(4)
    v_mfma_f32_32x32x16_bf16 v[64:79], v[168:171], a[176:179], v[64:79]
    ds_read_b64_tr_b16 v[164:165], v205 offset:5120
    ds_read_b64_tr_b16 v[166:167], v205 offset:5376
    s_waitcnt vmcnt(17)
    v_mfma_f32_32x32x16_bf16 v[80:95], v[168:171], a[180:183], v[80:95]
    buffer_load_dwordx4 a[240:243], v210, s[24:27], s64 offen offset:2048 sc1
    s_waitcnt lgkmcnt(4)
    v_mfma_f32_32x32x16_bf16 v[96:111], v[172:175], a[176:179], v[96:111]
    ds_read_b64_tr_b16 v[168:169], v205 offset:23552
    ds_read_b64_tr_b16 v[170:171], v205 offset:23808
    v_mfma_f32_32x32x16_bf16 v[112:127], v[172:175], a[180:183], v[112:127]
    buffer_load_dwordx4 a[244:247], v210, s[24:27], s65 offen offset:2048 sc1
    s_waitcnt lgkmcnt(4)
    v_mfma_f32_32x32x16_bf16 v[128:143], a[176:179], v[160:163], v[128:143]
    ds_read_b64_tr_b16 v[172:173], v205 offset:41984
    ds_read_b64_tr_b16 v[174:175], v205 offset:42240
    v_mfma_f32_32x32x16_bf16 v[144:159], a[180:183], v[160:163], v[144:159]
    s_waitcnt vmcnt(18) lgkmcnt(4)
    v_mfma_f32_32x32x16_bf16 v[64:79], v[164:167], a[184:187], v[64:79]
    ds_read_b64_tr_b16 v[160:161], v205 offset:6144
    ds_read_b64_tr_b16 v[162:163], v205 offset:6400
    s_waitcnt vmcnt(17)
    v_mfma_f32_32x32x16_bf16 v[80:95], v[164:167], a[188:191], v[80:95]
    buffer_load_dwordx4 a[248:251], v210, s[24:27], s64 offen offset:3072 sc1
    s_waitcnt lgkmcnt(4)
    v_mfma_f32_32x32x16_bf16 v[96:111], v[168:171], a[184:187], v[96:111]
    ds_read_b64_tr_b16 v[164:165], v205 offset:24576
    ds_read_b64_tr_b16 v[166:167], v205 offset:24832
    v_mfma_f32_32x32x16_bf16 v[112:127], v[168:171], a[188:191], v[112:127]
    buffer_load_dwordx4 a[252:255], v210, s[24:27], s65 offen offset:3072 sc1
    s_add_u32 s64, s64, 4096
    s_add_u32 s65, s65, 4096
    s_add_u32 m0, s56, 12288
    s_waitcnt lgkmcnt(4)
    v_mfma_f32_32x32x16_bf16 v[128:143], a[184:187], v[172:175], v[128:143]
    ds_read_b64_tr_b16 v[168:169], v205 offset:43008
    ds_read_b64_tr_b16 v[170:171], v205 offset:43264
    buffer_load_dwordx4 v213, s[52:55], s57 offen lds
    s_add_u32 s57, s57, 147456
    v_mfma_f32_32x32x16_bf16 v[144:159], a[188:191], v[172:175], v[144:159]
    s_waitcnt vmcnt(19) lgkmcnt(4)
    v_mfma_f32_32x32x16_bf16 v[64:79], v[160:163], a[192:195], v[64:79]
    ds_read_b64_tr_b16 v[172:173], v205 offset:7168
    ds_read_b64_tr_b16 v[174:175], v205 offset:7424
    s_waitcnt vmcnt(18)
    v_mfma_f32_32x32x16_bf16 v[80:95], v[160:163], a[196:199], v[80:95]
    buffer_load_dwordx4 v[224:227], v210, s[24:27], s64 offen offset:0 sc1
    s_waitcnt lgkmcnt(4)
    v_mfma_f32_32x32x16_bf16 v[96:111], v[164:167], a[192:195], v[96:111]
    ds_read_b64_tr_b16 v[160:161], v205 offset:25600
    ds_read_b64_tr_b16 v[162:163], v205 offset:25856
    v_mfma_f32_32x32x16_bf16 v[112:127], v[164:167], a[196:199], v[112:127]
    buffer_load_dwordx4 v[228:231], v210, s[24:27], s65 offen offset:0 sc1
    s_waitcnt lgkmcnt(4)
    v_mfma_f32_32x32x16_bf16 v[128:143], a[192:195], v[168:171], v[128:143]
    ds_read_b64_tr_b16 v[164:165], v205 offset:44032
    ds_read_b64_tr_b16 v[166:167], v205 offset:44288
    v_mfma_f32_32x32x16_bf16 v[144:159], a[196:199], v[168:171], v[144:159]
    s_waitcnt vmcnt(19) lgkmcnt(4)
    v_mfma_f32_32x32x16_bf16 v[64:79], v[172:175], a[200:203], v[64:79]
    ds_read_b64_tr_b16 v[168:169], v205 offset:8192
    ds_read_b64_tr_b16 v[170:171], v205 offset:8448
    s_waitcnt vmcnt(18)
    v_mfma_f32_32x32x16_bf16 v[80:95], v[172:175], a[204:207], v[80:95]
    buffer_load_dwordx4 v[232:235], v210, s[24:27], s64 offen offset:1024 sc1
    s_waitcnt lgkmcnt(4)
    v_mfma_f32_32x32x16_bf16 v[96:111], v[160:163], a[200:203], v[96:111]
    ds_read_b64_tr_b16 v[172:173], v205 offset:26624
    ds_read_b64_tr_b16 v[174:175], v205 offset:26880
    s_add_u32 m0, s56, 16384
    v_mfma_f32_32x32x16_bf16 v[112:127], v[160:163], a[204:207], v[112:127]
    buffer_load_dwordx4 v[236:239], v210, s[24:27], s65 offen offset:1024 sc1
    buffer_load_dwordx4 v213, s[52:55], s57 offen lds
    s_add_u32 s57, s57, 147456
    s_waitcnt lgkmcnt(4)
    v_mfma_f32_32x32x16_bf16 v[128:143], a[200:203], v[164:167], v[128:143]
    ds_read_b64_tr_b16 v[160:161], v205 offset:45056
    ds_read_b64_tr_b16 v[162:163], v205 offset:45312
    v_mfma_f32_32x32x16_bf16 v[144:159], a[204:207], v[164:167], v[144:159]
    s_waitcnt vmcnt(20) lgkmcnt(4)
    v_mfma_f32_32x32x16_bf16 v[64:79], v[168:171], a[208:211], v[64:79]
    ds_read_b64_tr_b16 v[164:165], v205 offset:9216
    ds_read_b64_tr_b16 v[166:167], v205 offset:9472
    s_waitcnt vmcnt(18)
    v_mfma_f32_32x32x16_bf16 v[80:95], v[168:171], a[212:215], v[80:95]
    buffer_load_dwordx4 v[240:243], v210, s[24:27], s64 offen offset:2048 sc1
    s_waitcnt lgkmcnt(4)
    v_mfma_f32_32x32x16_bf16 v[96:111], v[172:175], a[208:211], v[96:111]
    ds_read_b64_tr_b16 v[168:169], v205 offset:27648
    ds_read_b64_tr_b16 v[170:171], v205 offset:27904
    v_mfma_f32_32x32x16_bf16 v[112:127], v[172:175], a[212:215], v[112:127]
    buffer_load_dwordx4 v[244:247], v210, s[24:27], s65 offen offset:2048 sc1
    s_waitcnt lgkmcnt(4)
    v_mfma_f32_32x32x16_bf16 v[128:143], a[208:211], v[160:163], v[128:143]
    ds_read_b64_tr_b16 v[172:173], v205 offset:46080
    ds_read_b64_tr_b16 v[174:175], v205 offset:46336
    v_mfma_f32_32x32x16_bf16 v[144:159], a[212:215], v[160:163], v[144:159]
    s_waitcnt vmcnt(19) lgkmcnt(4)
    v_mfma_f32_32x32x16_bf16 v[64:79], v[164:167], a[216:219], v[64:79]
    ds_read_b64_tr_b16 v[160:161], v205 offset:10240
    ds_read_b64_tr_b16 v[162:163], v205 offset:10496
    s_waitcnt vmcnt(18)
    v_mfma_f32_32x32x16_bf16 v[80:95], v[164:167], a[220:223], v[80:95]
    buffer_load_dwordx4 v[248:251], v210, s[24:27], s64 offen offset:3072 sc1
    s_add_u32 m0, s56, 20480
    s_waitcnt lgkmcnt(4)
    v_mfma_f32_32x32x16_bf16 v[96:111], v[168:171], a[216:219], v[96:111]
    ds_read_b64_tr_b16 v[164:165], v205 offset:28672
    ds_read_b64_tr_b16 v[166:167], v205 offset:28928
    buffer_load_dwordx4 v213, s[52:55], s57 offen lds
    s_add_u32 s57, s57, 147456
    v_mfma_f32_32x32x16_bf16 v[112:127], v[168:171], a[220:223], v[112:127]
    buffer_load_dwordx4 v[252:255], v210, s[24:27], s65 offen offset:3072 sc1
    s_add_u32 s64, s64, 4096
    s_add_u32 s65, s65, 4096
    s_waitcnt lgkmcnt(4)
    v_mfma_f32_32x32x16_bf16 v[128:143], a[216:219], v[172:175], v[128:143]
    ds_read_b64_tr_b16 v[168:169], v205 offset:47104
    ds_read_b64_tr_b16 v[170:171], v205 offset:47360
    v_mfma_f32_32x32x16_bf16 v[144:159], a[220:223], v[172:175], v[144:159]
    s_waitcnt vmcnt(19) lgkmcnt(4)
    v_mfma_f32_32x32x16_bf16 v[64:79], v[160:163], a[224:227], v[64:79]
    ds_read_b64_tr_b16 v[172:173], v205 offset:11264
    ds_read_b64_tr_b16 v[174:175], v205 offset:11520
    s_waitcnt vmcnt(18)
    v_mfma_f32_32x32x16_bf16 v[80:95], v[160:163], a[228:231], v[80:95]
    s_waitcnt lgkmcnt(4)
    v_mfma_f32_32x32x16_bf16 v[96:111], v[164:167], a[224:227], v[96:111]
    ds_read_b64_tr_b16 v[160:161], v205 offset:29696
    ds_read_b64_tr_b16 v[162:163], v205 offset:29952
    v_mfma_f32_32x32x16_bf16 v[112:127], v[164:167], a[228:231], v[112:127]
    s_waitcnt lgkmcnt(4)
    v_mfma_f32_32x32x16_bf16 v[128:143], a[224:227], v[168:171], v[128:143]
    ds_read_b64_tr_b16 v[164:165], v205 offset:48128
    ds_read_b64_tr_b16 v[166:167], v205 offset:48384
    v_mfma_f32_32x32x16_bf16 v[144:159], a[228:231], v[168:171], v[144:159]
    s_waitcnt vmcnt(17) lgkmcnt(4)
    v_mfma_f32_32x32x16_bf16 v[64:79], v[172:175], a[232:235], v[64:79]
    ds_read_b64_tr_b16 v[168:169], v205 offset:12288
    ds_read_b64_tr_b16 v[170:171], v205 offset:12544
    s_add_u32 m0, s56, 24576
    s_waitcnt vmcnt(16)
    v_mfma_f32_32x32x16_bf16 v[80:95], v[172:175], a[236:239], v[80:95]
    buffer_load_dwordx4 v213, s[52:55], s57 offen lds
    s_add_u32 s57, s57, 147456
    s_waitcnt lgkmcnt(4)
    v_mfma_f32_32x32x16_bf16 v[96:111], v[160:163], a[232:235], v[96:111]
    ds_read_b64_tr_b16 v[172:173], v205 offset:30720
    ds_read_b64_tr_b16 v[174:175], v205 offset:30976
    v_mfma_f32_32x32x16_bf16 v[112:127], v[160:163], a[236:239], v[112:127]
    s_waitcnt lgkmcnt(4)
    v_mfma_f32_32x32x16_bf16 v[128:143], a[232:235], v[164:167], v[128:143]
    ds_read_b64_tr_b16 v[160:161], v205 offset:49152
    ds_read_b64_tr_b16 v[162:163], v205 offset:49408
    v_mfma_f32_32x32x16_bf16 v[144:159], a[236:239], v[164:167], v[144:159]
    s_waitcnt vmcnt(15) lgkmcnt(4)
    v_mfma_f32_32x32x16_bf16 v[64:79], v[168:171], a[240:243], v[64:79]
    ds_read_b64_tr_b16 v[164:165], v205 offset:13312
    ds_read_b64_tr_b16 v[166:167], v205 offset:13568
    s_waitcnt vmcnt(14)
    v_mfma_f32_32x32x16_bf16 v[80:95], v[168:171], a[244:247], v[80:95]
    s_waitcnt lgkmcnt(4)
    v_mfma_f32_32x32x16_bf16 v[96:111], v[172:175], a[240:243], v[96:111]
    ds_read_b64_tr_b16 v[168:169], v205 offset:31744
    ds_read_b64_tr_b16 v[170:171], v205 offset:32000
    v_mfma_f32_32x32x16_bf16 v[112:127], v[172:175], a[244:247], v[112:127]
    s_waitcnt lgkmcnt(4)
    v_mfma_f32_32x32x16_bf16 v[128:143], a[240:243], v[160:163], v[128:143]
    ds_read_b64_tr_b16 v[172:173], v205 offset:50176
    ds_read_b64_tr_b16 v[174:175], v205 offset:50432
    v_mfma_f32_32x32x16_bf16 v[144:159], a[244:247], v[160:163], v[144:159]
    s_add_u32 m0, s56, 28672
    s_waitcnt vmcnt(13) lgkmcnt(4)
    v_mfma_f32_32x32x16_bf16 v[64:79], v[164:167], a[248:251], v[64:79]
    ds_read_b64_tr_b16 v[160:161], v205 offset:14336
    ds_read_b64_tr_b16 v[162:163], v205 offset:14592
    buffer_load_dwordx4 v213, s[52:55], s57 offen lds
    s_add_u32 s57, s57, 147456
    s_waitcnt vmcnt(13)
    v_mfma_f32_32x32x16_bf16 v[80:95], v[164:167], a[252:255], v[80:95]
    s_waitcnt lgkmcnt(4)
    v_mfma_f32_32x32x16_bf16 v[96:111], v[168:171], a[248:251], v[96:111]
    ds_read_b64_tr_b16 v[164:165], v205 offset:32768
    ds_read_b64_tr_b16 v[166:167], v205 offset:33024
    v_mfma_f32_32x32x16_bf16 v[112:127], v[168:171], a[252:255], v[112:127]
    s_waitcnt lgkmcnt(4)
    v_mfma_f32_32x32x16_bf16 v[128:143], a[248:251], v[172:175], v[128:143]
    ds_read_b64_tr_b16 v[168:169], v205 offset:51200
    ds_read_b64_tr_b16 v[170:171], v205 offset:51456
    v_mfma_f32_32x32x16_bf16 v[144:159], a[252:255], v[172:175], v[144:159]
    s_waitcnt vmcnt(11) lgkmcnt(4)
    v_mfma_f32_32x32x16_bf16 v[64:79], v[160:163], v[224:227], v[64:79]
    ds_read_b64_tr_b16 v[172:173], v205 offset:15360
    ds_read_b64_tr_b16 v[174:175], v205 offset:15616
    s_waitcnt vmcnt(10)
    v_mfma_f32_32x32x16_bf16 v[80:95], v[160:163], v[228:231], v[80:95]
    s_waitcnt lgkmcnt(4)
    v_mfma_f32_32x32x16_bf16 v[96:111], v[164:167], v[224:227], v[96:111]
    ds_read_b64_tr_b16 v[160:161], v205 offset:33792
    ds_read_b64_tr_b16 v[162:163], v205 offset:34048
    v_mfma_f32_32x32x16_bf16 v[112:127], v[164:167], v[228:231], v[112:127]
    s_waitcnt lgkmcnt(4)
    v_mfma_f32_32x32x16_bf16 v[128:143], v[224:227], v[168:171], v[128:143]
    ds_read_b64_tr_b16 v[164:165], v205 offset:52224
    ds_read_b64_tr_b16 v[166:167], v205 offset:52480
    s_add_u32 m0, s56, 32768
    v_mfma_f32_32x32x16_bf16 v[144:159], v[228:231], v[168:171], v[144:159]
    buffer_load_dwordx4 v213, s[52:55], s57 offen lds
    s_add_u32 s57, s57, 147456
    s_waitcnt vmcnt(10) lgkmcnt(4)
    v_mfma_f32_32x32x16_bf16 v[64:79], v[172:175], v[232:235], v[64:79]
    ds_read_b64_tr_b16 v[168:169], v205 offset:16384
    ds_read_b64_tr_b16 v[170:171], v205 offset:16640
    s_waitcnt vmcnt(9)
    v_mfma_f32_32x32x16_bf16 v[80:95], v[172:175], v[236:239], v[80:95]
    s_waitcnt lgkmcnt(4)
    v_mfma_f32_32x32x16_bf16 v[96:111], v[160:163], v[232:235], v[96:111]
    ds_read_b64_tr_b16 v[172:173], v205 offset:34816
    ds_read_b64_tr_b16 v[174:175], v205 offset:35072
    v_mfma_f32_32x32x16_bf16 v[112:127], v[160:163], v[236:239], v[112:127]
    s_waitcnt lgkmcnt(4)
    v_mfma_f32_32x32x16_bf16 v[128:143], v[232:235], v[164:167], v[128:143]
    ds_read_b64_tr_b16 v[160:161], v205 offset:53248
    ds_read_b64_tr_b16 v[162:163], v205 offset:53504
    v_mfma_f32_32x32x16_bf16 v[144:159], v[236:239], v[164:167], v[144:159]
    s_waitcnt vmcnt(7) lgkmcnt(4)
    v_mfma_f32_32x32x16_bf16 v[64:79], v[168:171], v[240:243], v[64:79]
    ds_read_b64_tr_b16 v[164:165], v205 offset:17408
    ds_read_b64_tr_b16 v[166:167], v205 offset:17664
    s_waitcnt vmcnt(6)
    v_mfma_f32_32x32x16_bf16 v[80:95], v[168:171], v[244:247], v[80:95]
    s_waitcnt lgkmcnt(4)
    v_mfma_f32_32x32x16_bf16 v[96:111], v[172:175], v[240:243], v[96:111]
    ds_read_b64_tr_b16 v[168:169], v205 offset:35840
    ds_read_b64_tr_b16 v[170:171], v205 offset:36096
    v_mfma_f32_32x32x16_bf16 v[112:127], v[172:175], v[244:247], v[112:127]
    s_waitcnt lgkmcnt(4)
    v_mfma_f32_32x32x16_bf16 v[128:143], v[240:243], v[160:163], v[128:143]
    ds_read_b64_tr_b16 v[172:173], v205 offset:54272
    ds_read_b64_tr_b16 v[174:175], v205 offset:54528
    v_mfma_f32_32x32x16_bf16 v[144:159], v[244:247], v[160:163], v[144:159]
    s_waitcnt vmcnt(5) lgkmcnt(4)
    v_mfma_f32_32x32x16_bf16 v[64:79], v[164:167], v[248:251], v[64:79]
    ds_read_b64_tr_b16 v[160:161], v219 offset:0
    ds_read_b64_tr_b16 v[162:163], v219 offset:256
    s_waitcnt vmcnt(3)
    v_mfma_f32_32x32x16_bf16 v[80:95], v[164:167], v[252:255], v[80:95]
    s_waitcnt lgkmcnt(4)
    v_mfma_f32_32x32x16_bf16 v[96:111], v[168:171], v[248:251], v[96:111]
    ds_read_b64_tr_b16 v[164:165], v219 offset:2048
    ds_read_b64_tr_b16 v[166:167], v219 offset:2304
    v_mfma_f32_32x32x16_bf16 v[112:127], v[168:171], v[252:255], v[112:127]
    s_waitcnt lgkmcnt(4)
    v_mfma_f32_32x32x16_bf16 v[128:143], v[248:251], v[172:175], v[128:143]
    ds_read_b64_tr_b16 v[168:169], v219 offset:4096
    ds_read_b64_tr_b16 v[170:171], v219 offset:4352
    v_mfma_f32_32x32x16_bf16 v[144:159], v[252:255], v[172:175], v[144:159]
    s_waitcnt lgkmcnt(4)
    v_mfma_f32_32x32x16_bf16 v[0:15], v[160:163], a[0:3], 0
    s_waitcnt vmcnt(0)
    s_barrier
    ds_read_b64_tr_b16 v[172:173], v219 offset:6144
    ds_read_b64_tr_b16 v[174:175], v219 offset:6400
    v_mfma_f32_32x32x16_bf16 v[32:47], v[160:163], a[4:7], 0
    s_waitcnt lgkmcnt(4)
    v_mfma_f32_32x32x16_bf16 v[16:31], v[164:167], a[0:3], 0
    ds_read_b64_tr_b16 v[160:161], v219 offset:8192
    ds_read_b64_tr_b16 v[162:163], v219 offset:8448
    s_add_u32 m0, s56, 36864
    v_mfma_f32_32x32x16_bf16 v[48:63], v[164:167], a[4:7], 0
    buffer_load_dwordx4 v213, s[52:55], s57 offen lds
    s_add_u32 s57, s57, 147456
    v_mul_f32 v64, v64, v96
    v_mul_f32 v65, v65, v97
    s_waitcnt lgkmcnt(4)
    v_mfma_f32_32x32x16_bf16 v[0:15], v[168:171], a[8:11], v[0:15]
    ds_read_b64_tr_b16 v[164:165], v219 offset:10240
    ds_read_b64_tr_b16 v[166:167], v219 offset:10496
    v_mul_f32 v66, v66, v98
    v_mul_f32 v67, v67, v99
    v_mfma_f32_32x32x16_bf16 v[32:47], v[168:171], a[12:15], v[32:47]
    s_add_u32 m0, s56, 40960
    v_mul_f32 v68, v68, v100
    s_waitcnt lgkmcnt(4)
    v_mfma_f32_32x32x16_bf16 v[16:31], v[172:175], a[8:11], v[16:31]
    ds_read_b64_tr_b16 v[168:169], v219 offset:12288
    ds_read_b64_tr_b16 v[170:171], v219 offset:12544
    buffer_load_dwordx4 v213, s[52:55], s57 offen lds
    s_add_u32 s57, s57, 147456
    v_mul_f32 v69, v69, v101
    v_mul_f32 v70, v70, v102
    v_mfma_f32_32x32x16_bf16 v[48:63], v[172:175], a[12:15], v[48:63]
    v_mul_f32 v71, v71, v103
    v_mul_f32 v72, v72, v104
    s_waitcnt lgkmcnt(4)
    v_mfma_f32_32x32x16_bf16 v[0:15], v[160:163], a[16:19], v[0:15]
    ds_read_b64_tr_b16 v[172:173], v219 offset:14336
    ds_read_b64_tr_b16 v[174:175], v219 offset:14592
    s_add_u32 m0, s56, 45056
    v_mul_f32 v73, v73, v105
    v_mfma_f32_32x32x16_bf16 v[32:47], v[160:163], a[20:23], v[32:47]
    buffer_load_dwordx4 v213, s[52:55], s57 offen lds
    s_add_u32 s57, s57, 147456
    v_mul_f32 v74, v74, v106
    v_mul_f32 v75, v75, v107
    s_waitcnt lgkmcnt(4)
    v_mfma_f32_32x32x16_bf16 v[16:31], v[164:167], a[16:19], v[16:31]
    ds_read_b64_tr_b16 v[160:161], v219 offset:16384
    ds_read_b64_tr_b16 v[162:163], v219 offset:16640
    v_mul_f32 v76, v76, v108
    v_mfma_f32_32x32x16_bf16 v[48:63], v[164:167], a[20:23], v[48:63]
    v_mul_f32 v77, v77, v109
    v_mul_f32 v78, v78, v110
    s_waitcnt lgkmcnt(4)
    v_mfma_f32_32x32x16_bf16 v[0:15], v[168:171], a[24:27], v[0:15]
    ds_read_b64_tr_b16 v[164:165], v219 offset:18432
    ds_read_b64_tr_b16 v[166:167], v219 offset:18688
    s_add_u32 m0, s56, 49152
    v_mul_f32 v79, v79, v111
    v_cvt_pk_bf16_f32 v176, v64, v65
    v_mfma_f32_32x32x16_bf16 v[32:47], v[168:171], a[28:31], v[32:47]
    buffer_load_dwordx4 v213, s[52:55], s57 offen lds
    s_add_u32 s57, s57, 147456
    v_cvt_pk_bf16_f32 v177, v66, v67
    s_waitcnt lgkmcnt(4)
    v_mfma_f32_32x32x16_bf16 v[16:31], v[172:175], a[24:27], v[16:31]
    ds_read_b64_tr_b16 v[168:169], v219 offset:20480
    ds_read_b64_tr_b16 v[170:171], v219 offset:20736
    v_cvt_pk_bf16_f32 v178, v68, v69
    v_cvt_pk_bf16_f32 v179, v70, v71
    v_mfma_f32_32x32x16_bf16 v[48:63], v[172:175], a[28:31], v[48:63]
    s_add_u32 m0, s56, 53248
    v_cvt_pk_bf16_f32 v180, v72, v73
    v_cvt_pk_bf16_f32 v181, v74, v75
    s_waitcnt lgkmcnt(4)
    v_mfma_f32_32x32x16_bf16 v[0:15], v[160:163], a[32:35], v[0:15]
    ds_read_b64_tr_b16 v[172:173], v219 offset:22528
    ds_read_b64_tr_b16 v[174:175], v219 offset:22784
    buffer_load_dwordx4 v213, s[52:55], s57 offen lds
    s_add_u32 s57, s57, 147456
    v_cvt_pk_bf16_f32 v182, v76, v77
    v_mfma_f32_32x32x16_bf16 v[32:47], v[160:163], a[36:39], v[32:47]
    v_cvt_pk_bf16_f32 v183, v78, v79
    buffer_store_dwordx4 v[176:179], v210, s[24:27], s71 offen offset:0 sc1
    s_waitcnt lgkmcnt(4)
    v_mfma_f32_32x32x16_bf16 v[16:31], v[164:167], a[32:35], v[16:31]
    ds_read_b64_tr_b16 v[160:161], v219 offset:24576
    ds_read_b64_tr_b16 v[162:163], v219 offset:24832
    buffer_store_dwordx4 v[180:183], v210, s[24:27], s71 offen offset:1024 sc1
    v_mfma_f32_32x32x16_bf16 v[48:63], v[164:167], a[36:39], v[48:63]
    s_add_u32 m0, s56, 57344
    v_mul_f32 v80, v80, v112
    v_mul_f32 v81, v81, v113
    s_waitcnt lgkmcnt(4)
    v_mfma_f32_32x32x16_bf16 v[0:15], v[168:171], a[40:43], v[0:15]
    ds_read_b64_tr_b16 v[164:165], v219 offset:26624
    ds_read_b64_tr_b16 v[166:167], v219 offset:26880
    buffer_load_dwordx4 v213, s[52:55], s57 offen lds
    s_add_u32 s57, s57, 147456
    v_mul_f32 v82, v82, v114
    v_mul_f32 v83, v83, v115
    v_mfma_f32_32x32x16_bf16 v[32:47], v[168:171], a[44:47], v[32:47]
    v_mul_f32 v84, v84, v116
    s_waitcnt lgkmcnt(4)
    v_mfma_f32_32x32x16_bf16 v[16:31], v[172:175], a[40:43], v[16:31]
    ds_read_b64_tr_b16 v[168:169], v219 offset:28672
    ds_read_b64_tr_b16 v[170:171], v219 offset:28928
    s_add_u32 m0, s56, 61440
    v_mul_f32 v85, v85, v117
    v_mul_f32 v86, v86, v118
    v_mfma_f32_32x32x16_bf16 v[48:63], v[172:175], a[44:47], v[48:63]
    buffer_load_dwordx4 v213, s[52:55], s57 offen lds
    s_add_u32 s57, s57, 147456
    v_mul_f32 v87, v87, v119
    v_mul_f32 v88, v88, v120
    s_waitcnt lgkmcnt(4)
    v_mfma_f32_32x32x16_bf16 v[0:15], v[160:163], a[48:51], v[0:15]
    ds_read_b64_tr_b16 v[172:173], v219 offset:30720
    ds_read_b64_tr_b16 v[174:175], v219 offset:30976
    v_mul_f32 v89, v89, v121
    v_mfma_f32_32x32x16_bf16 v[32:47], v[160:163], a[52:55], v[32:47]
    v_mul_f32 v90, v90, v122
    v_mul_f32 v91, v91, v123
    s_waitcnt lgkmcnt(4)
    v_mfma_f32_32x32x16_bf16 v[16:31], v[164:167], a[48:51], v[16:31]
    ds_read_b64_tr_b16 v[160:161], v219 offset:32768
    ds_read_b64_tr_b16 v[162:163], v219 offset:33024
    s_add_u32 m0, s56, 65536
    v_mul_f32 v92, v92, v124
    v_mfma_f32_32x32x16_bf16 v[48:63], v[164:167], a[52:55], v[48:63]
    buffer_load_dwordx4 v213, s[52:55], s57 offen lds
    s_add_u32 s57, s57, 147456
    v_mul_f32 v93, v93, v125
    v_mul_f32 v94, v94, v126
    s_waitcnt lgkmcnt(4)
    v_mfma_f32_32x32x16_bf16 v[0:15], v[168:171], a[56:59], v[0:15]
    ds_read_b64_tr_b16 v[164:165], v219 offset:34816
    ds_read_b64_tr_b16 v[166:167], v219 offset:35072
    v_mul_f32 v95, v95, v127
    v_cvt_pk_bf16_f32 v184, v80, v81
    v_mfma_f32_32x32x16_bf16 v[32:47], v[168:171], a[60:63], v[32:47]
    s_add_u32 m0, s56, 69632
    v_cvt_pk_bf16_f32 v185, v82, v83
    s_waitcnt lgkmcnt(4)
    v_mfma_f32_32x32x16_bf16 v[16:31], v[172:175], a[56:59], v[16:31]
    ds_read_b64_tr_b16 v[168:169], v219 offset:512
    ds_read_b64_tr_b16 v[170:171], v219 offset:768
    buffer_load_dwordx4 v213, s[52:55], s57 offen lds
    s_add_u32 s57, s57, 147456
    v_cvt_pk_bf16_f32 v186, v84, v85
    v_cvt_pk_bf16_f32 v187, v86, v87
    v_mfma_f32_32x32x16_bf16 v[48:63], v[172:175], a[60:63], v[48:63]
    v_cvt_pk_bf16_f32 v188, v88, v89
    v_cvt_pk_bf16_f32 v189, v90, v91
    s_waitcnt lgkmcnt(4)
    v_mfma_f32_32x32x16_bf16 v[0:15], v[160:163], a[64:67], v[0:15]
    ds_read_b64_tr_b16 v[172:173], v219 offset:2560
    ds_read_b64_tr_b16 v[174:175], v219 offset:2816
    v_cvt_pk_bf16_f32 v190, v92, v93
    v_mfma_f32_32x32x16_bf16 v[32:47], v[160:163], a[68:71], v[32:47]
    s_add_u32 m0, s56, 73728
    v_cvt_pk_bf16_f32 v191, v94, v95
    buffer_store_dwordx4 v[184:187], v210, s[24:27], s72 offen offset:0 sc1
    s_waitcnt lgkmcnt(4)
    v_mfma_f32_32x32x16_bf16 v[16:31], v[164:167], a[64:67], v[16:31]
    ds_read_b64_tr_b16 v[160:161], v219 offset:4608
    ds_read_b64_tr_b16 v[162:163], v219 offset:4864
    buffer_load_dwordx4 v213, s[52:55], s57 offen lds
    s_add_u32 s57, s57, 147456
    buffer_store_dwordx4 v[188:191], v210, s[24:27], s72 offen offset:1024 sc1
    v_mfma_f32_32x32x16_bf16 v[48:63], v[164:167], a[68:71], v[48:63]
    s_waitcnt lgkmcnt(4)
    v_mfma_f32_32x32x16_bf16 v[64:79], v[168:171], a[0:3], 0
    ds_read_b64_tr_b16 v[164:165], v219 offset:6656
    ds_read_b64_tr_b16 v[166:167], v219 offset:6912
    s_add_u32 m0, s56, 77824
    v_mfma_f32_32x32x16_bf16 v[96:111], v[168:171], a[4:7], 0
    buffer_load_dwordx4 v213, s[52:55], s57 offen lds
    s_add_u32 s57, s57, 147456
    s_waitcnt lgkmcnt(4)
    v_mfma_f32_32x32x16_bf16 v[80:95], v[172:175], a[0:3], 0
    ds_read_b64_tr_b16 v[168:169], v219 offset:8704
    ds_read_b64_tr_b16 v[170:171], v219 offset:8960
    v_mfma_f32_32x32x16_bf16 v[112:127], v[172:175], a[4:7], 0
    s_add_u32 m0, s56, 81920
    s_add_u32 s34, s67, 0
    s_sub_u32 s34, s34, 36
    s_lshl_b32 s34, s34, 5
    s_waitcnt lgkmcnt(4)
    v_mfma_f32_32x32x16_bf16 v[64:79], v[160:163], a[8:11], v[64:79]
    ds_read_b64_tr_b16 v[172:173], v219 offset:10752
    ds_read_b64_tr_b16 v[174:175], v219 offset:11008
    buffer_load_dwordx4 v213, s[52:55], s57 offen lds
    s_add_u32 s57, s57, 147456
    v_and_b32 v192, 31, v208
    v_mfma_f32_32x32x16_bf16 v[96:111], v[160:163], a[12:15], v[96:111]
    v_add_u32 v192, s34, v192
    s_waitcnt lgkmcnt(4)
    v_mfma_f32_32x32x16_bf16 v[80:95], v[164:167], a[8:11], v[80:95]
    ds_read_b64_tr_b16 v[160:161], v219 offset:12800
    ds_read_b64_tr_b16 v[162:163], v219 offset:13056
    v_mul_u32_u24 v193, 3641, v192
    v_mfma_f32_32x32x16_bf16 v[112:127], v[164:167], a[12:15], v[112:127]
    s_add_u32 m0, s56, 86016
    v_lshrrev_b32 v193, 16, v193
    s_waitcnt lgkmcnt(4)
    v_mfma_f32_32x32x16_bf16 v[64:79], v[168:171], a[16:19], v[64:79]
    ds_read_b64_tr_b16 v[164:165], v219 offset:14848
    ds_read_b64_tr_b16 v[166:167], v219 offset:15104
    buffer_load_dwordx4 v213, s[52:55], s57 offen lds
    s_add_u32 s57, s57, 147456
    v_mul_u32_u24 v194, 18, v193
    v_mfma_f32_32x32x16_bf16 v[96:111], v[168:171], a[20:23], v[96:111]
    v_sub_u32 v194, v192, v194
    s_waitcnt lgkmcnt(4)
    v_mfma_f32_32x32x16_bf16 v[80:95], v[172:175], a[16:19], v[80:95]
    ds_read_b64_tr_b16 v[168:169], v219 offset:16896
    ds_read_b64_tr_b16 v[170:171], v219 offset:17152
    s_add_u32 m0, s56, 90112
    v_mul_u32_u24 v193, 77824, v193
    v_mfma_f32_32x32x16_bf16 v[112:127], v[172:175], a[20:23], v[112:127]
    buffer_load_dwordx4 v213, s[52:55], s57 offen lds
    s_add_u32 s57, s57, 147456
    v_lshlrev_b32 v194, 4, v194
    s_waitcnt lgkmcnt(4)
    v_mfma_f32_32x32x16_bf16 v[64:79], v[160:163], a[24:27], v[64:79]
    ds_read_b64_tr_b16 v[172:173], v219 offset:18944
    ds_read_b64_tr_b16 v[174:175], v219 offset:19200
    v_add_u32 v193, v193, v194
    v_mfma_f32_32x32x16_bf16 v[96:111], v[160:163], a[28:31], v[96:111]
    v_add_u32 v207, v193, v206
    s_waitcnt lgkmcnt(4)
    v_mfma_f32_32x32x16_bf16 v[80:95], v[164:167], a[24:27], v[80:95]
    ds_read_b64_tr_b16 v[160:161], v219 offset:20992
    ds_read_b64_tr_b16 v[162:163], v219 offset:21248
    s_add_u32 m0, s56, 94208
    v_cvt_pk_bf16_f32 v176, v128, v129
    v_mfma_f32_32x32x16_bf16 v[112:127], v[164:167], a[28:31], v[112:127]
    buffer_load_dwordx4 v213, s[52:55], s57 offen lds
    s_add_u32 s57, s57, 147456
    v_cvt_pk_bf16_f32 v177, v130, v131
    s_waitcnt lgkmcnt(4)
    v_mfma_f32_32x32x16_bf16 v[64:79], v[168:171], a[32:35], v[64:79]
    ds_read_b64_tr_b16 v[164:165], v219 offset:23040
    ds_read_b64_tr_b16 v[166:167], v219 offset:23296
    v_cvt_pk_bf16_f32 v178, v132, v133
    v_mfma_f32_32x32x16_bf16 v[96:111], v[168:171], a[36:39], v[96:111]
    s_add_u32 m0, s56, 98304
    v_cvt_pk_bf16_f32 v179, v134, v135
    s_waitcnt lgkmcnt(4)
    v_mfma_f32_32x32x16_bf16 v[80:95], v[172:175], a[32:35], v[80:95]
    ds_read_b64_tr_b16 v[168:169], v219 offset:25088
    ds_read_b64_tr_b16 v[170:171], v219 offset:25344
    buffer_load_dwordx4 v213, s[52:55], s57 offen lds
    s_add_u32 s57, s57, 147456
    v_cvt_pk_bf16_f32 v180, v136, v137
    v_mfma_f32_32x32x16_bf16 v[112:127], v[172:175], a[36:39], v[112:127]
    v_cvt_pk_bf16_f32 v181, v138, v139
    s_waitcnt lgkmcnt(4)
    v_mfma_f32_32x32x16_bf16 v[64:79], v[160:163], a[40:43], v[64:79]
    ds_read_b64_tr_b16 v[172:173], v219 offset:27136
    ds_read_b64_tr_b16 v[174:175], v219 offset:27392
    v_cvt_pk_bf16_f32 v182, v140, v141
    v_mfma_f32_32x32x16_bf16 v[96:111], v[160:163], a[44:47], v[96:111]
    s_add_u32 m0, s56, 102400
    v_cvt_pk_bf16_f32 v183, v142, v143
    s_waitcnt lgkmcnt(4)
    v_mfma_f32_32x32x16_bf16 v[80:95], v[164:167], a[40:43], v[80:95]
    ds_read_b64_tr_b16 v[160:161], v219 offset:29184
    ds_read_b64_tr_b16 v[162:163], v219 offset:29440
    buffer_load_dwordx4 v213, s[52:55], s57 offen lds
    s_add_u32 s57, s57, 147456
    s_add_u32 s35, s61, 0
    buffer_store_dwordx4 v[176:179], v207, s[24:27], s35 offen sc1
    v_mfma_f32_32x32x16_bf16 v[112:127], v[164:167], a[44:47], v[112:127]
    s_add_u32 s35, s61, 608
    buffer_store_dwordx4 v[180:183], v207, s[24:27], s35 offen sc1
    s_waitcnt lgkmcnt(4)
    v_mfma_f32_32x32x16_bf16 v[64:79], v[168:171], a[48:51], v[64:79]
    ds_read_b64_tr_b16 v[164:165], v219 offset:31232
    ds_read_b64_tr_b16 v[166:167], v219 offset:31488
    s_add_u32 m0, s56, 106496
    v_cvt_pk_bf16_f32 v184, v144, v145
    v_mfma_f32_32x32x16_bf16 v[96:111], v[168:171], a[52:55], v[96:111]
    buffer_load_dwordx4 v213, s[52:55], s57 offen lds
    s_add_u32 s57, s57, 147456
    s_sub_u32 s57, s57, 5308288
    v_cvt_pk_bf16_f32 v185, v146, v147
    s_waitcnt lgkmcnt(4)
    v_mfma_f32_32x32x16_bf16 v[80:95], v[172:175], a[48:51], v[80:95]
    ds_read_b64_tr_b16 v[168:169], v219 offset:33280
    ds_read_b64_tr_b16 v[170:171], v219 offset:33536
    v_cvt_pk_bf16_f32 v186, v148, v149
    v_mfma_f32_32x32x16_bf16 v[112:127], v[172:175], a[52:55], v[112:127]
    v_cvt_pk_bf16_f32 v187, v150, v151
    s_waitcnt lgkmcnt(4)
    v_mfma_f32_32x32x16_bf16 v[64:79], v[160:163], a[56:59], v[64:79]
    ds_read_b64_tr_b16 v[172:173], v219 offset:35328
    ds_read_b64_tr_b16 v[174:175], v219 offset:35584
    v_cvt_pk_bf16_f32 v188, v152, v153
    v_mfma_f32_32x32x16_bf16 v[96:111], v[160:163], a[60:63], v[96:111]
    v_cvt_pk_bf16_f32 v189, v154, v155
    s_waitcnt lgkmcnt(4)
    v_mfma_f32_32x32x16_bf16 v[80:95], v[164:167], a[56:59], v[80:95]
    ds_read_b64_tr_b16 v[160:161], v216 offset:0
    ds_read_b64_tr_b16 v[162:163], v216 offset:256
    v_cvt_pk_bf16_f32 v190, v156, v157
    v_mfma_f32_32x32x16_bf16 v[112:127], v[164:167], a[60:63], v[112:127]
    v_cvt_pk_bf16_f32 v191, v158, v159
    s_waitcnt lgkmcnt(4)
    v_mfma_f32_32x32x16_bf16 v[64:79], v[168:171], a[64:67], v[64:79]
    ds_read_b64_tr_b16 v[164:165], v216 offset:2048
    ds_read_b64_tr_b16 v[166:167], v216 offset:2304
    s_add_u32 s35, s61, 1216
    buffer_store_dwordx4 v[184:187], v207, s[24:27], s35 offen sc1
    v_mfma_f32_32x32x16_bf16 v[96:111], v[168:171], a[68:71], v[96:111]
    s_add_u32 s35, s61, 1824
    buffer_store_dwordx4 v[188:191], v207, s[24:27], s35 offen sc1
    s_waitcnt lgkmcnt(4)
    v_mfma_f32_32x32x16_bf16 v[80:95], v[172:175], a[64:67], v[80:95]
    ds_read_b64_tr_b16 v[168:169], v216 offset:4096
    ds_read_b64_tr_b16 v[170:171], v216 offset:4352
    v_mfma_f32_32x32x16_bf16 v[112:127], v[172:175], a[68:71], v[112:127]
    s_branch L_j1
L_cls3:
    buffer_load_dwordx4 a[0:3], v210, s[24:27], s64 offen offset:0 sc1
    buffer_load_dwordx4 a[4:7], v210, s[24:27], s65 offen offset:0 sc1
    buffer_load_dwordx4 a[8:11], v210, s[24:27], s64 offen offset:1024 sc1
    buffer_load_dwordx4 a[12:15], v210, s[24:27], s65 offen offset:1024 sc1
    buffer_load_dwordx4 a[16:19], v210, s[24:27], s64 offen offset:2048 sc1
    buffer_load_dwordx4 a[20:23], v210, s[24:27], s65 offen offset:2048 sc1
    buffer_load_dwordx4 a[24:27], v210, s[24:27], s64 offen offset:3072 sc1
    buffer_load_dwordx4 a[28:31], v210, s[24:27], s65 offen offset:3072 sc1
    s_add_u32 s64, s64, 4096
    s_add_u32 s65, s65, 4096
    buffer_load_dwordx4 a[32:35], v210, s[24:27], s64 offen offset:0 sc1
    buffer_load_dwordx4 a[36:39], v210, s[24:27], s65 offen offset:0 sc1
    buffer_load_dwordx4 a[40:43], v210, s[24:27], s64 offen offset:1024 sc1
    buffer_load_dwordx4 a[44:47], v210, s[24:27], s65 offen offset:1024 sc1
    buffer_load_dwordx4 a[48:51], v210, s[24:27], s64 offen offset:2048 sc1
    buffer_load_dwordx4 a[52:55], v210, s[24:27], s65 offen offset:2048 sc1
    buffer_load_dwordx4 a[56:59], v210, s[24:27], s64 offen offset:3072 sc1
    buffer_load_dwordx4 a[60:63], v210, s[24:27], s65 offen offset:3072 sc1
    s_add_u32 s64, s64, 4096
    s_add_u32 s65, s65, 4096
    s_barrier
    ds_read_b64_tr_b16 v[160:161], v204 offset:0
    ds_read_b64_tr_b16 v[162:163], v204 offset:256
    ds_read_b64_tr_b16 v[164:165], v204 offset:18432
    ds_read_b64_tr_b16 v[166:167], v204 offset:18688
    ds_read_b64_tr_b16 v[168:169], v204 offset:1024
    ds_read_b64_tr_b16 v[170:171], v204 offset:1280
    s_waitcnt vmcnt(15) lgkmcnt(4)
    v_mfma_f32_32x32x16_bf16 v[64:79], v[160:163], a[0:3], 0
    ds_read_b64_tr_b16 v[172:173], v204 offset:19456
    ds_read_b64_tr_b16 v[174:175], v204 offset:19712
    s_waitcnt vmcnt(14)
    v_mfma_f32_32x32x16_bf16 v[80:95], v[160:163], a[4:7], 0
    buffer_load_dwordx4 a[64:67], v210, s[24:27], s64 offen offset:0 sc1
    s_waitcnt lgkmcnt(4)
    v_mfma_f32_32x32x16_bf16 v[96:111], v[164:167], a[0:3], 0
    ds_read_b64_tr_b16 v[160:161], v204 offset:2048
    ds_read_b64_tr_b16 v[162:163], v204 offset:2304
    v_mfma_f32_32x32x16_bf16 v[112:127], v[164:167], a[4:7], 0
    buffer_load_dwordx4 a[68:71], v210, s[24:27], s65 offen offset:0 sc1
    s_waitcnt vmcnt(15) lgkmcnt(4)
    v_mfma_f32_32x32x16_bf16 v[64:79], v[168:171], a[8:11], v[64:79]
    ds_read_b64_tr_b16 v[164:165], v204 offset:20480
    ds_read_b64_tr_b16 v[166:167], v204 offset:20736
    s_waitcnt vmcnt(14)
    v_mfma_f32_32x32x16_bf16 v[80:95], v[168:171], a[12:15], v[80:95]
    buffer_load_dwordx4 a[72:75], v210, s[24:27], s64 offen offset:1024 sc1
    s_waitcnt lgkmcnt(4)
    v_mfma_f32_32x32x16_bf16 v[96:111], v[172:175], a[8:11], v[96:111]
    ds_read_b64_tr_b16 v[168:169], v204 offset:3072
    ds_read_b64_tr_b16 v[170:171], v204 offset:3328
    v_mfma_f32_32x32x16_bf16 v[112:127], v[172:175], a[12:15], v[112:127]
    buffer_load_dwordx4 a[76:79], v210, s[24:27], s65 offen offset:1024 sc1
    s_waitcnt vmcnt(15) lgkmcnt(4)
    v_mfma_f32_32x32x16_bf16 v[64:79], v[160:163], a[16:19], v[64:79]
    ds_read_b64_tr_b16 v[172:173], v204 offset:21504
    ds_read_b64_tr_b16 v[174:175], v204 offset:21760
    s_waitcnt vmcnt(14)
    v_mfma_f32_32x32x16_bf16 v[80:95], v[160:163], a[20:23], v[80:95]
    buffer_load_dwordx4 a[80:83], v210, s[24:27], s64 offen offset:2048 sc1
    s_waitcnt lgkmcnt(4)
    v_mfma_f32_32x32x16_bf16 v[96:111], v[164:167], a[16:19], v[96:111]
    ds_read_b64_tr_b16 v[160:161], v204 offset:4096
    ds_read_b64_tr_b16 v[162:163], v204 offset:4352
    v_mfma_f32_32x32x16_bf16 v[112:127], v[164:167], a[20:23], v[112:127]
    buffer_load_dwordx4 a[84:87], v210, s[24:27], s65 offen offset:2048 sc1
    s_waitcnt vmcnt(15) lgkmcnt(4)
    v_mfma_f32_32x32x16_bf16 v[64:79], v[168:171], a[24:27], v[64:79]
    ds_read_b64_tr_b16 v[164:165], v204 offset:22528
    ds_read_b64_tr_b16 v[166:167], v204 offset:22784
    s_waitcnt vmcnt(14)
    v_mfma_f32_32x32x16_bf16 v[80:95], v[168:171], a[28:31], v[80:95]
    buffer_load_dwordx4 a[88:91], v210, s[24:27], s64 offen offset:3072 sc1
    s_waitcnt lgkmcnt(4)
    v_mfma_f32_32x32x16_bf16 v[96:111], v[172:175], a[24:27], v[96:111]
    ds_read_b64_tr_b16 v[168:169], v204 offset:5120
    ds_read_b64_tr_b16 v[170:171], v204 offset:5376
    v_mfma_f32_32x32x16_bf16 v[112:127], v[172:175], a[28:31], v[112:127]
    buffer_load_dwordx4 a[92:95], v210, s[24:27], s65 offen offset:3072 sc1
    s_add_u32 s64, s64, 4096
    s_add_u32 s65, s65, 4096
    s_waitcnt vmcnt(15) lgkmcnt(4)
    v_mfma_f32_32x32x16_bf16 v[64:79], v[160:163], a[32:35], v[64:79]
    ds_read_b64_tr_b16 v[172:173], v204 offset:23552
    ds_read_b64_tr_b16 v[174:175], v204 offset:23808
    s_waitcnt vmcnt(14)
    v_mfma_f32_32x32x16_bf16 v[80:95], v[160:163], a[36:39], v[80:95]
    buffer_load_dwordx4 a[96:99], v210, s[24:27], s64 offen offset:0 sc1
    s_waitcnt lgkmcnt(4)
    v_mfma_f32_32x32x16_bf16 v[96:111], v[164:167], a[32:35], v[96:111]
    ds_read_b64_tr_b16 v[160:161], v204 offset:6144
    ds_read_b64_tr_b16 v[162:163], v204 offset:6400
    v_mfma_f32_32x32x16_bf16 v[112:127], v[164:167], a[36:39], v[112:127]
    buffer_load_dwordx4 a[100:103], v210, s[24:27], s65 offen offset:0 sc1
    s_waitcnt vmcnt(15) lgkmcnt(4)
    v_mfma_f32_32x32x16_bf16 v[64:79], v[168:171], a[40:43], v[64:79]
    ds_read_b64_tr_b16 v[164:165], v204 offset:24576
    ds_read_b64_tr_b16 v[166:167], v204 offset:24832
    s_waitcnt vmcnt(14)
    v_mfma_f32_32x32x16_bf16 v[80:95], v[168:171], a[44:47], v[80:95]
    buffer_load_dwordx4 a[104:107], v210, s[24:27], s64 offen offset:1024 sc1
    s_waitcnt lgkmcnt(4)
    v_mfma_f32_32x32x16_bf16 v[96:111], v[172:175], a[40:43], v[96:111]
    ds_read_b64_tr_b16 v[168:169], v204 offset:7168
    ds_read_b64_tr_b16 v[170:171], v204 offset:7424
    v_mfma_f32_32x32x16_bf16 v[112:127], v[172:175], a[44:47], v[112:127]
    buffer_load_dwordx4 a[108:111], v210, s[24:27], s65 offen offset:1024 sc1
    s_waitcnt vmcnt(15) lgkmcnt(4)
    v_mfma_f32_32x32x16_bf16 v[64:79], v[160:163], a[48:51], v[64:79]
    ds_read_b64_tr_b16 v[172:173], v204 offset:25600
    ds_read_b64_tr_b16 v[174:175], v204 offset:25856
    s_waitcnt vmcnt(14)
    v_mfma_f32_32x32x16_bf16 v[80:95], v[160:163], a[52:55], v[80:95]
    buffer_load_dwordx4 a[112:115], v210, s[24:27], s64 offen offset:2048 sc1
    s_waitcnt lgkmcnt(4)
    v_mfma_f32_32x32x16_bf16 v[96:111], v[164:167], a[48:51], v[96:111]
    ds_read_b64_tr_b16 v[160:161], v204 offset:8192
    ds_read_b64_tr_b16 v[162:163], v204 offset:8448
    v_mfma_f32_32x32x16_bf16 v[112:127], v[164:167], a[52:55], v[112:127]
    buffer_load_dwordx4 a[116:119], v210, s[24:27], s65 offen offset:2048 sc1
    s_waitcnt vmcnt(15) lgkmcnt(4)
    v_mfma_f32_32x32x16_bf16 v[64:79], v[168:171], a[56:59], v[64:79]
    ds_read_b64_tr_b16 v[164:165], v204 offset:26624
    ds_read_b64_tr_b16 v[166:167], v204 offset:26880
    s_waitcnt vmcnt(14)
    v_mfma_f32_32x32x16_bf16 v[80:95], v[168:171], a[60:63], v[80:95]
    buffer_load_dwordx4 a[120:123], v210, s[24:27], s64 offen offset:3072 sc1
    s_waitcnt lgkmcnt(4)
    v_mfma_f32_32x32x16_bf16 v[96:111], v[172:175], a[56:59], v[96:111]
    ds_read_b64_tr_b16 v[168:169], v204 offset:9216
    ds_read_b64_tr_b16 v[170:171], v204 offset:9472
    v_mfma_f32_32x32x16_bf16 v[112:127], v[172:175], a[60:63], v[112:127]
    buffer_load_dwordx4 a[124:127], v210, s[24:27], s65 offen offset:3072 sc1
    s_add_u32 s64, s64, 4096
    s_add_u32 s65, s65, 4096
    s_waitcnt vmcnt(15) lgkmcnt(4)
    v_mfma_f32_32x32x16_bf16 v[64:79], v[160:163], a[64:67], v[64:79]
    ds_read_b64_tr_b16 v[172:173], v204 offset:27648
    ds_read_b64_tr_b16 v[174:175], v204 offset:27904
    s_waitcnt vmcnt(14)
    v_mfma_f32_32x32x16_bf16 v[80:95], v[160:163], a[68:71], v[80:95]
    buffer_load_dwordx4 a[128:131], v210, s[24:27], s64 offen offset:0 sc1
    s_waitcnt lgkmcnt(4)
    v_mfma_f32_32x32x16_bf16 v[96:111], v[164:167], a[64:67], v[96:111]
    ds_read_b64_tr_b16 v[160:161], v204 offset:10240
    ds_read_b64_tr_b16 v[162:163], v204 offset:10496
    v_mfma_f32_32x32x16_bf16 v[112:127], v[164:167], a[68:71], v[112:127]
    buffer_load_dwordx4 a[132:135], v210, s[24:27], s65 offen offset:0 sc1
    s_waitcnt vmcnt(15) lgkmcnt(4)
    v_mfma_f32_32x32x16_bf16 v[64:79], v[168:171], a[72:75], v[64:79]
    ds_read_b64_tr_b16 v[164:165], v204 offset:28672
    ds_read_b64_tr_b16 v[166:167], v204 offset:28928
    s_waitcnt vmcnt(14)
    v_mfma_f32_32x32x16_bf16 v[80:95], v[168:171], a[76:79], v[80:95]
    buffer_load_dwordx4 a[136:139], v210, s[24:27], s64 offen offset:1024 sc1
    s_waitcnt lgkmcnt(4)
    v_mfma_f32_32x32x16_bf16 v[96:111], v[172:175], a[72:75], v[96:111]
    ds_read_b64_tr_b16 v[168:169], v204 offset:11264
    ds_read_b64_tr_b16 v[170:171], v204 offset:11520
    v_mfma_f32_32x32x16_bf16 v[112:127], v[172:175], a[76:79], v[112:127]
    buffer_load_dwordx4 a[140:143], v210, s[24:27], s65 offen offset:1024 sc1
    s_waitcnt vmcnt(15) lgkmcnt(4)
    v_mfma_f32_32x32x16_bf16 v[64:79], v[160:163], a[80:83], v[64:79]
    ds_read_b64_tr_b16 v[172:173], v204 offset:29696
    ds_read_b64_tr_b16 v[174:175], v204 offset:29952
    s_waitcnt vmcnt(14)
    v_mfma_f32_32x32x16_bf16 v[80:95], v[160:163], a[84:87], v[80:95]
    buffer_load_dwordx4 a[144:147], v210, s[24:27], s64 offen offset:2048 sc1
    s_waitcnt lgkmcnt(4)
    v_mfma_f32_32x32x16_bf16 v[96:111], v[164:167], a[80:83], v[96:111]
    ds_read_b64_tr_b16 v[160:161], v204 offset:12288
    ds_read_b64_tr_b16 v[162:163], v204 offset:12544
    v_mfma_f32_32x32x16_bf16 v[112:127], v[164:167], a[84:87], v[112:127]
    buffer_load_dwordx4 a[148:151], v210, s[24:27], s65 offen offset:2048 sc1
    s_waitcnt vmcnt(15) lgkmcnt(4)
    v_mfma_f32_32x32x16_bf16 v[64:79], v[168:171], a[88:91], v[64:79]
    ds_read_b64_tr_b16 v[164:165], v204 offset:30720
    ds_read_b64_tr_b16 v[166:167], v204 offset:30976
    s_waitcnt vmcnt(14)
    v_mfma_f32_32x32x16_bf16 v[80:95], v[168:171], a[92:95], v[80:95]
    buffer_load_dwordx4 a[152:155], v210, s[24:27], s64 offen offset:3072 sc1
    s_waitcnt lgkmcnt(4)
    v_mfma_f32_32x32x16_bf16 v[96:111], v[172:175], a[88:91], v[96:111]
    ds_read_b64_tr_b16 v[168:169], v204 offset:13312
    ds_read_b64_tr_b16 v[170:171], v204 offset:13568
    v_mfma_f32_32x32x16_bf16 v[112:127], v[172:175], a[92:95], v[112:127]
    buffer_load_dwordx4 a[156:159], v210, s[24:27], s65 offen offset:3072 sc1
    s_add_u32 s64, s64, 4096
    s_add_u32 s65, s65, 4096
    s_waitcnt vmcnt(15) lgkmcnt(4)
    v_mfma_f32_32x32x16_bf16 v[64:79], v[160:163], a[96:99], v[64:79]
    ds_read_b64_tr_b16 v[172:173], v204 offset:31744
    ds_read_b64_tr_b16 v[174:175], v204 offset:32000
    s_waitcnt vmcnt(14)
    v_mfma_f32_32x32x16_bf16 v[80:95], v[160:163], a[100:103], v[80:95]
    buffer_load_dwordx4 a[160:163], v210, s[24:27], s64 offen offset:0 sc1
    s_waitcnt lgkmcnt(4)
    v_mfma_f32_32x32x16_bf16 v[96:111], v[164:167], a[96:99], v[96:111]
    ds_read_b64_tr_b16 v[160:161], v204 offset:14336
    ds_read_b64_tr_b16 v[162:163], v204 offset:14592
    v_mfma_f32_32x32x16_bf16 v[112:127], v[164:167], a[100:103], v[112:127]
    buffer_load_dwordx4 a[164:167], v210, s[24:27], s65 offen offset:0 sc1
    s_waitcnt vmcnt(15) lgkmcnt(4)
    v_mfma_f32_32x32x16_bf16 v[64:79], v[168:171], a[104:107], v[64:79]
    ds_read_b64_tr_b16 v[164:165], v204 offset:32768
    ds_read_b64_tr_b16 v[166:167], v204 offset:33024
    s_waitcnt vmcnt(14)
    v_mfma_f32_32x32x16_bf16 v[80:95], v[168:171], a[108:111], v[80:95]
    buffer_load_dwordx4 a[168:171], v210, s[24:27], s64 offen offset:1024 sc1
    s_waitcnt lgkmcnt(4)
    v_mfma_f32_32x32x16_bf16 v[96:111], v[172:175], a[104:107], v[96:111]
    ds_read_b64_tr_b16 v[168:169], v204 offset:15360
    ds_read_b64_tr_b16 v[170:171], v204 offset:15616
    v_mfma_f32_32x32x16_bf16 v[112:127], v[172:175], a[108:111], v[112:127]
    buffer_load_dwordx4 a[172:175], v210, s[24:27], s65 offen offset:1024 sc1
    s_waitcnt vmcnt(15) lgkmcnt(4)
    v_mfma_f32_32x32x16_bf16 v[64:79], v[160:163], a[112:115], v[64:79]
    ds_read_b64_tr_b16 v[172:173], v204 offset:33792
    ds_read_b64_tr_b16 v[174:175], v204 offset:34048
    s_waitcnt vmcnt(14)
    v_mfma_f32_32x32x16_bf16 v[80:95], v[160:163], a[116:119], v[80:95]
    buffer_load_dwordx4 a[176:179], v210, s[24:27], s64 offen offset:2048 sc1
    s_waitcnt lgkmcnt(4)
    v_mfma_f32_32x32x16_bf16 v[96:111], v[164:167], a[112:115], v[96:111]
    ds_read_b64_tr_b16 v[160:161], v204 offset:16384
    ds_read_b64_tr_b16 v[162:163], v204 offset:16640
    v_mfma_f32_32x32x16_bf16 v[112:127], v[164:167], a[116:119], v[112:127]
    buffer_load_dwordx4 a[180:183], v210, s[24:27], s65 offen offset:2048 sc1
    s_waitcnt vmcnt(15) lgkmcnt(4)
    v_mfma_f32_32x32x16_bf16 v[64:79], v[168:171], a[120:123], v[64:79]
    ds_read_b64_tr_b16 v[164:165], v204 offset:34816
    ds_read_b64_tr_b16 v[166:167], v204 offset:35072
    s_waitcnt vmcnt(14)
    v_mfma_f32_32x32x16_bf16 v[80:95], v[168:171], a[124:127], v[80:95]
    buffer_load_dwordx4 a[184:187], v210, s[24:27], s64 offen offset:3072 sc1
    s_waitcnt lgkmcnt(4)
    v_mfma_f32_32x32x16_bf16 v[96:111], v[172:175], a[120:123], v[96:111]
    ds_read_b64_tr_b16 v[168:169], v204 offset:17408
    ds_read_b64_tr_b16 v[170:171], v204 offset:17664
    v_mfma_f32_32x32x16_bf16 v[112:127], v[172:175], a[124:127], v[112:127]
    buffer_load_dwordx4 a[188:191], v210, s[24:27], s65 offen offset:3072 sc1
    s_add_u32 s64, s64, 4096
    s_add_u32 s65, s65, 4096
    s_waitcnt vmcnt(15) lgkmcnt(4)
    v_mfma_f32_32x32x16_bf16 v[64:79], v[160:163], a[128:131], v[64:79]
    ds_read_b64_tr_b16 v[172:173], v204 offset:35840
    ds_read_b64_tr_b16 v[174:175], v204 offset:36096
    s_waitcnt vmcnt(14)
    v_mfma_f32_32x32x16_bf16 v[80:95], v[160:163], a[132:135], v[80:95]
    buffer_load_dwordx4 a[192:195], v210, s[24:27], s64 offen offset:0 sc1
    s_barrier
    s_waitcnt lgkmcnt(4)
    v_mfma_f32_32x32x16_bf16 v[96:111], v[164:167], a[128:131], v[96:111]
    ds_read_b64_tr_b16 v[160:161], v205 offset:0
    ds_read_b64_tr_b16 v[162:163], v205 offset:256
    v_mfma_f32_32x32x16_bf16 v[112:127], v[164:167], a[132:135], v[112:127]
    buffer_load_dwordx4 a[196:199], v210, s[24:27], s65 offen offset:0 sc1
    s_waitcnt vmcnt(15) lgkmcnt(4)
    v_mfma_f32_32x32x16_bf16 v[64:79], v[168:171], a[136:139], v[64:79]
    ds_read_b64_tr_b16 v[164:165], v205 offset:18432
    ds_read_b64_tr_b16 v[166:167], v205 offset:18688
    s_waitcnt vmcnt(14)
    v_mfma_f32_32x32x16_bf16 v[80:95], v[168:171], a[140:143], v[80:95]
    buffer_load_dwordx4 a[200:203], v210, s[24:27], s64 offen offset:1024 sc1
    s_waitcnt lgkmcnt(4)
    v_mfma_f32_32x32x16_bf16 v[96:111], v[172:175], a[136:139], v[96:111]
    ds_read_b64_tr_b16 v[168:169], v205 offset:1024
    ds_read_b64_tr_b16 v[170:171], v205 offset:1280
    v_mfma_f32_32x32x16_bf16 v[112:127], v[172:175], a[140:143], v[112:127]
    buffer_load_dwordx4 a[204:207], v210, s[24:27], s65 offen offset:1024 sc1
    s_barrier
    s_waitcnt vmcnt(15) lgkmcnt(4)
    v_mfma_f32_32x32x16_bf16 v[64:79], v[160:163], a[144:147], v[64:79]
    ds_read_b64_tr_b16 v[172:173], v205 offset:19456
    ds_read_b64_tr_b16 v[174:175], v205 offset:19712
    s_add_u32 m0, s56, 0
    s_waitcnt vmcnt(14)
    v_mfma_f32_32x32x16_bf16 v[80:95], v[160:163], a[148:151], v[80:95]
    buffer_load_dwordx4 a[208:211], v210, s[24:27], s64 offen offset:2048 sc1
    buffer_load_dwordx4 v213, s[52:55], s57 offen lds
    s_add_u32 s57, s57, 147456
    s_waitcnt lgkmcnt(4)
    v_mfma_f32_32x32x16_bf16 v[96:111], v[164:167], a[144:147], v[96:111]
    ds_read_b64_tr_b16 v[160:161], v205 offset:2048
    ds_read_b64_tr_b16 v[162:163], v205 offset:2304
    v_mfma_f32_32x32x16_bf16 v[112:127], v[164:167], a[148:151], v[112:127]
    buffer_load_dwordx4 a[212:215], v210, s[24:27], s65 offen offset:2048 sc1
    s_waitcnt vmcnt(16) lgkmcnt(4)
    v_mfma_f32_32x32x16_bf16 v[64:79], v[168:171], a[152:155], v[64:79]
    ds_read_b64_tr_b16 v[164:165], v205 offset:20480
    ds_read_b64_tr_b16 v[166:167], v205 offset:20736
    s_waitcnt vmcnt(15)
    v_mfma_f32_32x32x16_bf16 v[80:95], v[168:171], a[156:159], v[80:95]
    buffer_load_dwordx4 a[216:219], v210, s[24:27], s64 offen offset:3072 sc1
    s_waitcnt lgkmcnt(4)
    v_mfma_f32_32x32x16_bf16 v[96:111], v[172:175], a[152:155], v[96:111]
    ds_read_b64_tr_b16 v[168:169], v205 offset:3072
    ds_read_b64_tr_b16 v[170:171], v205 offset:3328
    v_mfma_f32_32x32x16_bf16 v[112:127], v[172:175], a[156:159], v[112:127]
    buffer_load_dwordx4 a[220:223], v210, s[24:27], s65 offen offset:3072 sc1
    s_add_u32 s64, s64, 4096
    s_add_u32 s65, s65, 4096
    s_add_u32 m0, s56, 4096
    s_waitcnt vmcnt(16) lgkmcnt(4)
    v_mfma_f32_32x32x16_bf16 v[64:79], v[160:163], a[160:163], v[64:79]
    ds_read_b64_tr_b16 v[172:173], v205 offset:21504
    ds_read_b64_tr_b16 v[174:175], v205 offset:21760
    buffer_load_dwordx4 v213, s[52:55], s57 offen lds
    s_add_u32 s57, s57, 147456
    s_waitcnt vmcnt(16)
    v_mfma_f32_32x32x16_bf16 v[80:95], v[160:163], a[164:167], v[80:95]
    buffer_load_dwordx4 a[224:227], v210, s[24:27], s64 offen offset:0 sc1
    s_waitcnt lgkmcnt(4)
    v_mfma_f32_32x32x16_bf16 v[96:111], v[164:167], a[160:163], v[96:111]
    ds_read_b64_tr_b16 v[160:161], v205 offset:4096
    ds_read_b64_tr_b16 v[162:163], v205 offset:4352
    v_mfma_f32_32x32x16_bf16 v[112:127], v[164:167], a[164:167], v[112:127]
    buffer_load_dwordx4 a[228:231], v210, s[24:27], s65 offen offset:0 sc1
    s_waitcnt vmcnt(17) lgkmcnt(4)
    v_mfma_f32_32x32x16_bf16 v[64:79], v[168:171], a[168:171], v[64:79]
    ds_read_b64_tr_b16 v[164:165], v205 offset:22528
    ds_read_b64_tr_b16 v[166:167], v205 offset:22784
    s_waitcnt vmcnt(16)
    v_mfma_f32_32x32x16_bf16 v[80:95], v[168:171], a[172:175], v[80:95]
    buffer_load_dwordx4 a[232:235], v210, s[24:27], s64 offen offset:1024 sc1
    s_waitcnt lgkmcnt(4)
    v_mfma_f32_32x32x16_bf16 v[96:111], v[172:175], a[168:171], v[96:111]
    ds_read_b64_tr_b16 v[168:169], v205 offset:5120
    ds_read_b64_tr_b16 v[170:171], v205 offset:5376
    s_add_u32 m0, s56, 8192
    v_mfma_f32_32x32x16_bf16 v[112:127], v[172:175], a[172:175], v[112:127]
    buffer_load_dwordx4 a[236:239], v210, s[24:27], s65 offen offset:1024 sc1
    buffer_load_dwordx4 v213, s[52:55], s57 offen lds
    s_add_u32 s57, s57, 147456
    s_waitcnt vmcnt(18) lgkmcnt(4)
    v_mfma_f32_32x32x16_bf16 v[64:79], v[160:163], a[176:179], v[64:79]
    ds_read_b64_tr_b16 v[172:173], v205 offset:23552
    ds_read_b64_tr_b16 v[174:175], v205 offset:23808
    s_waitcnt vmcnt(17)
    v_mfma_f32_32x32x16_bf16 v[80:95], v[160:163], a[180:183], v[80:95]
    buffer_load_dwordx4 a[240:243], v210, s[24:27], s64 offen offset:2048 sc1
    s_waitcnt lgkmcnt(4)
    v_mfma_f32_32x32x16_bf16 v[96:111], v[164:167], a[176:179], v[96:111]
    ds_read_b64_tr_b16 v[160:161], v205 offset:6144
    ds_read_b64_tr_b16 v[162:163], v205 offset:6400
    v_mfma_f32_32x32x16_bf16 v[112:127], v[164:167], a[180:183], v[112:127]
    buffer_load_dwordx4 a[244:247], v210, s[24:27], s65 offen offset:2048 sc1
    s_waitcnt vmcnt(18) lgkmcnt(4)
    v_mfma_f32_32x32x16_bf16 v[64:79], v[168:171], a[184:187], v[64:79]
    ds_read_b64_tr_b16 v[164:165], v205 offset:24576
    ds_read_b64_tr_b16 v[166:167], v205 offset:24832
    s_waitcnt vmcnt(17)
    v_mfma_f32_32x32x16_bf16 v[80:95], v[168:171], a[188:191], v[80:95]
    buffer_load_dwordx4 a[248:251], v210, s[24:27], s64 offen offset:3072 sc1
    s_add_u32 m0, s56, 12288
    s_waitcnt lgkmcnt(4)
    v_mfma_f32_32x32x16_bf16 v[96:111], v[172:175], a[184:187], v[96:111]
    ds_read_b64_tr_b16 v[168:169], v205 offset:7168
    ds_read_b64_tr_b16 v[170:171], v205 offset:7424
    buffer_load_dwordx4 v213, s[52:55], s57 offen lds
    s_add_u32 s57, s57, 147456
    v_mfma_f32_32x32x16_bf16 v[112:127], v[172:175], a[188:191], v[112:127]
    buffer_load_dwordx4 a[252:255], v210, s[24:27], s65 offen offset:3072 sc1
    s_add_u32 s64, s64, 4096
    s_add_u32 s65, s65, 4096
    s_waitcnt vmcnt(19) lgkmcnt(4)
    v_mfma_f32_32x32x16_bf16 v[64:79], v[160:163], a[192:195], v[64:79]
    ds_read_b64_tr_b16 v[172:173], v205 offset:25600
    ds_read_b64_tr_b16 v[174:175], v205 offset:25856
    s_waitcnt vmcnt(18)
    v_mfma_f32_32x32x16_bf16 v[80:95], v[160:163], a[196:199], v[80:95]
    buffer_load_dwordx4 v[224:227], v210, s[24:27], s64 offen offset:0 sc1
    s_waitcnt lgkmcnt(4)
    v_mfma_f32_32x32x16_bf16 v[96:111], v[164:167], a[192:195], v[96:111]
    ds_read_b64_tr_b16 v[160:161], v205 offset:8192
    ds_read_b64_tr_b16 v[162:163], v205 offset:8448
    v_mfma_f32_32x32x16_bf16 v[112:127], v[164:167], a[196:199], v[112:127]
    buffer_load_dwordx4 v[228:231], v210, s[24:27], s65 offen offset:0 sc1
    s_waitcnt vmcnt(19) lgkmcnt(4)
    v_mfma_f32_32x32x16_bf16 v[64:79], v[168:171], a[200:203], v[64:79]
    ds_read_b64_tr_b16 v[164:165], v205 offset:26624
    ds_read_b64_tr_b16 v[166:167], v205 offset:26880
    s_add_u32 m0, s56, 16384
    s_waitcnt vmcnt(18)
    v_mfma_f32_32x32x16_bf16 v[80:95], v[168:171], a[204:207], v[80:95]
    buffer_load_dwordx4 v[232:235], v210, s[24:27], s64 offen offset:1024 sc1
    buffer_load_dwordx4 v213, s[52:55], s57 offen lds
    s_add_u32 s57, s57, 147456
    s_waitcnt lgkmcnt(4)
    v_mfma_f32_32x32x16_bf16 v[96:111], v[172:175], a[200:203], v[96:111]
    ds_read_b64_tr_b16 v[168:169], v205 offset:9216
    ds_read_b64_tr_b16 v[170:171], v205 offset:9472
    v_mfma_f32_32x32x16_bf16 v[112:127], v[172:175], a[204:207], v[112:127]
    buffer_load_dwordx4 v[236:239], v210, s[24:27], s65 offen offset:1024 sc1
    s_waitcnt vmcnt(20) lgkmcnt(4)
    v_mfma_f32_32x32x16_bf16 v[64:79], v[160:163], a[208:211], v[64:79]
    ds_read_b64_tr_b16 v[172:173], v205 offset:27648
    ds_read_b64_tr_b16 v[174:175], v205 offset:27904
    s_waitcnt vmcnt(18)
    v_mfma_f32_32x32x16_bf16 v[80:95], v[160:163], a[212:215], v[80:95]
    buffer_load_dwordx4 v[240:243], v210, s[24:27], s64 offen offset:2048 sc1
    s_waitcnt lgkmcnt(4)
    v_mfma_f32_32x32x16_bf16 v[96:111], v[164:167], a[208:211], v[96:111]
    ds_read_b64_tr_b16 v[160:161], v205 offset:10240
    ds_read_b64_tr_b16 v[162:163], v205 offset:10496
    v_mfma_f32_32x32x16_bf16 v[112:127], v[164:167], a[212:215], v[112:127]
    buffer_load_dwordx4 v[244:247], v210, s[24:27], s65 offen offset:2048 sc1
    s_add_u32 m0, s56, 20480
    s_waitcnt vmcnt(19) lgkmcnt(4)
    v_mfma_f32_32x32x16_bf16 v[64:79], v[168:171], a[216:219], v[64:79]
    ds_read_b64_tr_b16 v[164:165], v205 offset:28672
    ds_read_b64_tr_b16 v[166:167], v205 offset:28928
    buffer_load_dwordx4 v213, s[52:55], s57 offen lds
    s_add_u32 s57, s57, 147456
    s_waitcnt vmcnt(19)
    v_mfma_f32_32x32x16_bf16 v[80:95], v[168:171], a[220:223], v[80:95]
    buffer_load_dwordx4 v[248:251], v210, s[24:27], s64 offen offset:3072 sc1
    s_waitcnt lgkmcnt(4)
    v_mfma_f32_32x32x16_bf16 v[96:111], v[172:175], a[216:219], v[96:111]
    ds_read_b64_tr_b16 v[168:169], v205 offset:11264
    ds_read_b64_tr_b16 v[170:171], v205 offset:11520
    v_mfma_f32_32x32x16_bf16 v[112:127], v[172:175], a[220:223], v[112:127]
    buffer_load_dwordx4 v[252:255], v210, s[24:27], s65 offen offset:3072 sc1
    s_add_u32 s64, s64, 4096
    s_add_u32 s65, s65, 4096
    s_waitcnt vmcnt(19) lgkmcnt(4)
    v_mfma_f32_32x32x16_bf16 v[64:79], v[160:163], a[224:227], v[64:79]
    ds_read_b64_tr_b16 v[172:173], v205 offset:29696
    ds_read_b64_tr_b16 v[174:175], v205 offset:29952
    s_waitcnt vmcnt(18)
    v_mfma_f32_32x32x16_bf16 v[80:95], v[160:163], a[228:231], v[80:95]
    s_waitcnt lgkmcnt(4)
    v_mfma_f32_32x32x16_bf16 v[96:111], v[164:167], a[224:227], v[96:111]
    ds_read_b64_tr_b16 v[160:161], v205 offset:12288
    ds_read_b64_tr_b16 v[162:163], v205 offset:12544
    s_add_u32 m0, s56, 24576
    v_mfma_f32_32x32x16_bf16 v[112:127], v[164:167], a[228:231], v[112:127]
    buffer_load_dwordx4 v213, s[52:55], s57 offen lds
    s_add_u32 s57, s57, 147456
    s_waitcnt vmcnt(18) lgkmcnt(4)
    v_mfma_f32_32x32x16_bf16 v[64:79], v[168:171], a[232:235], v[64:79]
    ds_read_b64_tr_b16 v[164:165], v205 offset:30720
    ds_read_b64_tr_b16 v[166:167], v205 offset:30976
    s_waitcnt vmcnt(17)
    v_mfma_f32_32x32x16_bf16 v[80:95], v[168:171], a[236:239], v[80:95]
    s_waitcnt lgkmcnt(4)
    v_mfma_f32_32x32x16_bf16 v[96:111], v[172:175], a[232:235], v[96:111]
    ds_read_b64_tr_b16 v[168:169], v205 offset:13312
    ds_read_b64_tr_b16 v[170:171], v205 offset:13568
    v_mfma_f32_32x32x16_bf16 v[112:127], v[172:175], a[236:239], v[112:127]
    s_waitcnt vmcnt(15) lgkmcnt(4)
    v_mfma_f32_32x32x16_bf16 v[64:79], v[160:163], a[240:243], v[64:79]
    ds_read_b64_tr_b16 v[172:173], v205 offset:31744
    ds_read_b64_tr_b16 v[174:175], v205 offset:32000
    s_waitcnt vmcnt(14)
    v_mfma_f32_32x32x16_bf16 v[80:95], v[160:163], a[244:247], v[80:95]
    s_add_u32 m0, s56, 28672
    s_waitcnt lgkmcnt(4)
    v_mfma_f32_32x32x16_bf16 v[96:111], v[164:167], a[240:243], v[96:111]
    ds_read_b64_tr_b16 v[160:161], v205 offset:14336
    ds_read_b64_tr_b16 v[162:163], v205 offset:14592
    buffer_load_dwordx4 v213, s[52:55], s57 offen lds
    s_add_u32 s57, s57, 147456
    v_mfma_f32_32x32x16_bf16 v[112:127], v[164:167], a[244:247], v[112:127]
    s_waitcnt vmcnt(14) lgkmcnt(4)
    v_mfma_f32_32x32x16_bf16 v[64:79], v[168:171], a[248:251], v[64:79]
    ds_read_b64_tr_b16 v[164:165], v205 offset:32768
    ds_read_b64_tr_b16 v[166:167], v205 offset:33024
    s_waitcnt vmcnt(12)
    v_mfma_f32_32x32x16_bf16 v[80:95], v[168:171], a[252:255], v[80:95]
    s_waitcnt lgkmcnt(4)
    v_mfma_f32_32x32x16_bf16 v[96:111], v[172:175], a[248:251], v[96:111]
    ds_read_b64_tr_b16 v[168:169], v205 offset:15360
    ds_read_b64_tr_b16 v[170:171], v205 offset:15616
    v_mfma_f32_32x32x16_bf16 v[112:127], v[172:175], a[252:255], v[112:127]
    s_waitcnt vmcnt(11) lgkmcnt(4)
    v_mfma_f32_32x32x16_bf16 v[64:79], v[160:163], v[224:227], v[64:79]
    ds_read_b64_tr_b16 v[172:173], v205 offset:33792
    ds_read_b64_tr_b16 v[174:175], v205 offset:34048
    s_add_u32 m0, s56, 32768
    s_waitcnt vmcnt(10)
    v_mfma_f32_32x32x16_bf16 v[80:95], v[160:163], v[228:231], v[80:95]
    buffer_load_dwordx4 v213, s[52:55], s57 offen lds
    s_add_u32 s57, s57, 147456
    s_waitcnt lgkmcnt(4)
    v_mfma_f32_32x32x16_bf16 v[96:111], v[164:167], v[224:227], v[96:111]
    ds_read_b64_tr_b16 v[160:161], v205 offset:16384
    ds_read_b64_tr_b16 v[162:163], v205 offset:16640
    v_mfma_f32_32x32x16_bf16 v[112:127], v[164:167], v[228:231], v[112:127]
    s_waitcnt vmcnt(10) lgkmcnt(4)
    v_mfma_f32_32x32x16_bf16 v[64:79], v[168:171], v[232:235], v[64:79]
    ds_read_b64_tr_b16 v[164:165], v205 offset:34816
    ds_read_b64_tr_b16 v[166:167], v205 offset:35072
    s_waitcnt vmcnt(8)
    v_mfma_f32_32x32x16_bf16 v[80:95], v[168:171], v[236:239], v[80:95]
    s_waitcnt lgkmcnt(4)
    v_mfma_f32_32x32x16_bf16 v[96:111], v[172:175], v[232:235], v[96:111]
    ds_read_b64_tr_b16 v[168:169], v205 offset:17408
    ds_read_b64_tr_b16 v[170:171], v205 offset:17664
    v_mfma_f32_32x32x16_bf16 v[112:127], v[172:175], v[236:239], v[112:127]
    s_waitcnt vmcnt(7) lgkmcnt(4)
    v_mfma_f32_32x32x16_bf16 v[64:79], v[160:163], v[240:243], v[64:79]
    ds_read_b64_tr_b16 v[172:173], v205 offset:35840
    ds_read_b64_tr_b16 v[174:175], v205 offset:36096
    s_waitcnt vmcnt(6)
    v_mfma_f32_32x32x16_bf16 v[80:95], v[160:163], v[244:247], v[80:95]
    s_waitcnt lgkmcnt(4)
    v_mfma_f32_32x32x16_bf16 v[96:111], v[164:167], v[240:243], v[96:111]
    ds_read_b64_tr_b16 v[160:161], v219 offset:0
    ds_read_b64_tr_b16 v[162:163], v219 offset:256
    v_mfma_f32_32x32x16_bf16 v[112:127], v[164:167], v[244:247], v[112:127]
    s_waitcnt vmcnt(4) lgkmcnt(4)
    v_mfma_f32_32x32x16_bf16 v[64:79], v[168:171], v[248:251], v[64:79]
    ds_read_b64_tr_b16 v[164:165], v219 offset:2048
    ds_read_b64_tr_b16 v[166:167], v219 offset:2304
    s_waitcnt vmcnt(3)
    v_mfma_f32_32x32x16_bf16 v[80:95], v[168:171], v[252:255], v[80:95]
    s_waitcnt lgkmcnt(4)
    v_mfma_f32_32x32x16_bf16 v[96:111], v[172:175], v[248:251], v[96:111]
    ds_read_b64_tr_b16 v[168:169], v219 offset:4096
    ds_read_b64_tr_b16 v[170:171], v219 offset:4352
    v_mfma_f32_32x32x16_bf16 v[112:127], v[172:175], v[252:255], v[112:127]
    s_waitcnt lgkmcnt(4)
    v_mfma_f32_32x32x16_bf16 v[0:15], v[160:163], a[0:3], 0
    s_waitcnt vmcnt(0)
    s_barrier
    ds_read_b64_tr_b16 v[172:173], v219 offset:6144
    ds_read_b64_tr_b16 v[174:175], v219 offset:6400
    v_mfma_f32_32x32x16_bf16 v[32:47], v[160:163], a[4:7], 0
    s_waitcnt lgkmcnt(4)
    v_mfma_f32_32x32x16_bf16 v[16:31], v[164:167], a[0:3], 0
    ds_read_b64_tr_b16 v[160:161], v219 offset:8192
    ds_read_b64_tr_b16 v[162:163], v219 offset:8448
    s_add_u32 m0, s56, 36864
    v_mfma_f32_32x32x16_bf16 v[48:63], v[164:167], a[4:7], 0
    buffer_load_dwordx4 v213, s[52:55], s57 offen lds
    s_add_u32 s57, s57, 147456
    v_mul_f32 v64, v64, v96
    v_mul_f32 v65, v65, v97
    s_waitcnt lgkmcnt(4)
    v_mfma_f32_32x32x16_bf16 v[0:15], v[168:171], a[8:11], v[0:15]
    ds_read_b64_tr_b16 v[164:165], v219 offset:10240
    ds_read_b64_tr_b16 v[166:167], v219 offset:10496
    v_mul_f32 v66, v66, v98
    v_mul_f32 v67, v67, v99
    v_mfma_f32_32x32x16_bf16 v[32:47], v[168:171], a[12:15], v[32:47]
    s_add_u32 m0, s56, 40960
    v_mul_f32 v68, v68, v100
    s_waitcnt lgkmcnt(4)
    v_mfma_f32_32x32x16_bf16 v[16:31], v[172:175], a[8:11], v[16:31]
    ds_read_b64_tr_b16 v[168:169], v219 offset:12288
    ds_read_b64_tr_b16 v[170:171], v219 offset:12544
    buffer_load_dwordx4 v213, s[52:55], s57 offen lds
    s_add_u32 s57, s57, 147456
    v_mul_f32 v69, v69, v101
    v_mul_f32 v70, v70, v102
    v_mfma_f32_32x32x16_bf16 v[48:63], v[172:175], a[12:15], v[48:63]
    v_mul_f32 v71, v71, v103
    v_mul_f32 v72, v72, v104
    s_waitcnt lgkmcnt(4)
    v_mfma_f32_32x32x16_bf16 v[0:15], v[160:163], a[16:19], v[0:15]
    ds_read_b64_tr_b16 v[172:173], v219 offset:14336
    ds_read_b64_tr_b16 v[174:175], v219 offset:14592
    s_add_u32 m0, s56, 45056
    v_mul_f32 v73, v73, v105
    v_mfma_f32_32x32x16_bf16 v[32:47], v[160:163], a[20:23], v[32:47]
    buffer_load_dwordx4 v213, s[52:55], s57 offen lds
    s_add_u32 s57, s57, 147456
    v_mul_f32 v74, v74, v106
    v_mul_f32 v75, v75, v107
    s_waitcnt lgkmcnt(4)
    v_mfma_f32_32x32x16_bf16 v[16:31], v[164:167], a[16:19], v[16:31]
    ds_read_b64_tr_b16 v[160:161], v219 offset:16384
    ds_read_b64_tr_b16 v[162:163], v219 offset:16640
    v_mul_f32 v76, v76, v108
    v_mfma_f32_32x32x16_bf16 v[48:63], v[164:167], a[20:23], v[48:63]
    v_mul_f32 v77, v77, v109
    v_mul_f32 v78, v78, v110
    s_waitcnt lgkmcnt(4)
    v_mfma_f32_32x32x16_bf16 v[0:15], v[168:171], a[24:27], v[0:15]
    ds_read_b64_tr_b16 v[164:165], v219 offset:18432
    ds_read_b64_tr_b16 v[166:167], v219 offset:18688
    s_add_u32 m0, s56, 49152
    v_mul_f32 v79, v79, v111
    v_cvt_pk_bf16_f32 v176, v64, v65
    v_mfma_f32_32x32x16_bf16 v[32:47], v[168:171], a[28:31], v[32:47]
    buffer_load_dwordx4 v213, s[52:55], s57 offen lds
    s_add_u32 s57, s57, 147456
    v_cvt_pk_bf16_f32 v177, v66, v67
    s_waitcnt lgkmcnt(4)
    v_mfma_f32_32x32x16_bf16 v[16:31], v[172:175], a[24:27], v[16:31]
    ds_read_b64_tr_b16 v[168:169], v219 offset:20480
    ds_read_b64_tr_b16 v[170:171], v219 offset:20736
    v_cvt_pk_bf16_f32 v178, v68, v69
    v_cvt_pk_bf16_f32 v179, v70, v71
    v_mfma_f32_32x32x16_bf16 v[48:63], v[172:175], a[28:31], v[48:63]
    s_add_u32 m0, s56, 53248
    v_cvt_pk_bf16_f32 v180, v72, v73
    v_cvt_pk_bf16_f32 v181, v74, v75
    s_waitcnt lgkmcnt(4)
    v_mfma_f32_32x32x16_bf16 v[0:15], v[160:163], a[32:35], v[0:15]
    ds_read_b64_tr_b16 v[172:173], v219 offset:22528
    ds_read_b64_tr_b16 v[174:175], v219 offset:22784
    buffer_load_dwordx4 v213, s[52:55], s57 offen lds
    s_add_u32 s57, s57, 147456
    v_cvt_pk_bf16_f32 v182, v76, v77
    v_mfma_f32_32x32x16_bf16 v[32:47], v[160:163], a[36:39], v[32:47]
    v_cvt_pk_bf16_f32 v183, v78, v79
    buffer_store_dwordx4 v[176:179], v210, s[24:27], s71 offen offset:0 sc1
    s_waitcnt lgkmcnt(4)
    v_mfma_f32_32x32x16_bf16 v[16:31], v[164:167], a[32:35], v[16:31]
    ds_read_b64_tr_b16 v[160:161], v219 offset:24576
    ds_read_b64_tr_b16 v[162:163], v219 offset:24832
    buffer_store_dwordx4 v[180:183], v210, s[24:27], s71 offen offset:1024 sc1
    v_mfma_f32_32x32x16_bf16 v[48:63], v[164:167], a[36:39], v[48:63]
    s_add_u32 m0, s56, 57344
    v_mul_f32 v80, v80, v112
    v_mul_f32 v81, v81, v113
    s_waitcnt lgkmcnt(4)
    v_mfma_f32_32x32x16_bf16 v[0:15], v[168:171], a[40:43], v[0:15]
    ds_read_b64_tr_b16 v[164:165], v219 offset:26624
    ds_read_b64_tr_b16 v[166:167], v219 offset:26880
    buffer_load_dwordx4 v213, s[52:55], s57 offen lds
    s_add_u32 s57, s57, 147456
    v_mul_f32 v82, v82, v114
    v_mul_f32 v83, v83, v115
    v_mfma_f32_32x32x16_bf16 v[32:47], v[168:171], a[44:47], v[32:47]
    v_mul_f32 v84, v84, v116
    s_waitcnt lgkmcnt(4)
    v_mfma_f32_32x32x16_bf16 v[16:31], v[172:175], a[40:43], v[16:31]
    ds_read_b64_tr_b16 v[168:169], v219 offset:28672
    ds_read_b64_tr_b16 v[170:171], v219 offset:28928
    s_add_u32 m0, s56, 61440
    v_mul_f32 v85, v85, v117
    v_mul_f32 v86, v86, v118
    v_mfma_f32_32x32x16_bf16 v[48:63], v[172:175], a[44:47], v[48:63]
    buffer_load_dwordx4 v213, s[52:55], s57 offen lds
    s_add_u32 s57, s57, 147456
    v_mul_f32 v87, v87, v119
    v_mul_f32 v88, v88, v120
    s_waitcnt lgkmcnt(4)
    v_mfma_f32_32x32x16_bf16 v[0:15], v[160:163], a[48:51], v[0:15]
    ds_read_b64_tr_b16 v[172:173], v219 offset:30720
    ds_read_b64_tr_b16 v[174:175], v219 offset:30976
    v_mul_f32 v89, v89, v121
    v_mfma_f32_32x32x16_bf16 v[32:47], v[160:163], a[52:55], v[32:47]
    v_mul_f32 v90, v90, v122
    v_mul_f32 v91, v91, v123
    s_waitcnt lgkmcnt(4)
    v_mfma_f32_32x32x16_bf16 v[16:31], v[164:167], a[48:51], v[16:31]
    ds_read_b64_tr_b16 v[160:161], v219 offset:32768
    ds_read_b64_tr_b16 v[162:163], v219 offset:33024
    s_add_u32 m0, s56, 65536
    v_mul_f32 v92, v92, v124
    v_mfma_f32_32x32x16_bf16 v[48:63], v[164:167], a[52:55], v[48:63]
    buffer_load_dwordx4 v213, s[52:55], s57 offen lds
    s_add_u32 s57, s57, 147456
    v_mul_f32 v93, v93, v125
    v_mul_f32 v94, v94, v126
    s_waitcnt lgkmcnt(4)
    v_mfma_f32_32x32x16_bf16 v[0:15], v[168:171], a[56:59], v[0:15]
    ds_read_b64_tr_b16 v[164:165], v219 offset:34816
    ds_read_b64_tr_b16 v[166:167], v219 offset:35072
    v_mul_f32 v95, v95, v127
    v_cvt_pk_bf16_f32 v184, v80, v81
    v_mfma_f32_32x32x16_bf16 v[32:47], v[168:171], a[60:63], v[32:47]
    s_add_u32 m0, s56, 69632
    v_cvt_pk_bf16_f32 v185, v82, v83
    s_waitcnt lgkmcnt(4)
    v_mfma_f32_32x32x16_bf16 v[16:31], v[172:175], a[56:59], v[16:31]
    ds_read_b64_tr_b16 v[168:169], v219 offset:512
    ds_read_b64_tr_b16 v[170:171], v219 offset:768
    buffer_load_dwordx4 v213, s[52:55], s57 offen lds
    s_add_u32 s57, s57, 147456
    v_cvt_pk_bf16_f32 v186, v84, v85
    v_cvt_pk_bf16_f32 v187, v86, v87
    v_mfma_f32_32x32x16_bf16 v[48:63], v[172:175], a[60:63], v[48:63]
    v_cvt_pk_bf16_f32 v188, v88, v89
    v_cvt_pk_bf16_f32 v189, v90, v91
    s_waitcnt lgkmcnt(4)
    v_mfma_f32_32x32x16_bf16 v[0:15], v[160:163], a[64:67], v[0:15]
    ds_read_b64_tr_b16 v[172:173], v219 offset:2560
    ds_read_b64_tr_b16 v[174:175], v219 offset:2816
    v_cvt_pk_bf16_f32 v190, v92, v93
    v_mfma_f32_32x32x16_bf16 v[32:47], v[160:163], a[68:71], v[32:47]
    s_add_u32 m0, s56, 73728
    v_cvt_pk_bf16_f32 v191, v94, v95
    buffer_store_dwordx4 v[184:187], v210, s[24:27], s72 offen offset:0 sc1
    s_waitcnt lgkmcnt(4)
    v_mfma_f32_32x32x16_bf16 v[16:31], v[164:167], a[64:67], v[16:31]
    ds_read_b64_tr_b16 v[160:161], v219 offset:4608
    ds_read_b64_tr_b16 v[162:163], v219 offset:4864
    buffer_load_dwordx4 v213, s[52:55], s57 offen lds
    s_add_u32 s57, s57, 147456
    buffer_store_dwordx4 v[188:191], v210, s[24:27], s72 offen offset:1024 sc1
    v_mfma_f32_32x32x16_bf16 v[48:63], v[164:167], a[68:71], v[48:63]
    s_waitcnt lgkmcnt(4)
    v_mfma_f32_32x32x16_bf16 v[64:79], v[168:171], a[0:3], 0
    ds_read_b64_tr_b16 v[164:165], v219 offset:6656
    ds_read_b64_tr_b16 v[166:167], v219 offset:6912
    s_add_u32 m0, s56, 77824
    v_mfma_f32_32x32x16_bf16 v[96:111], v[168:171], a[4:7], 0
    buffer_load_dwordx4 v213, s[52:55], s57 offen lds
    s_add_u32 s57, s57, 147456
    s_waitcnt lgkmcnt(4)
    v_mfma_f32_32x32x16_bf16 v[80:95], v[172:175], a[0:3], 0
    ds_read_b64_tr_b16 v[168:169], v219 offset:8704
    ds_read_b64_tr_b16 v[170:171], v219 offset:8960
    v_mfma_f32_32x32x16_bf16 v[112:127], v[172:175], a[4:7], 0
    s_add_u32 m0, s56, 81920
    s_waitcnt lgkmcnt(4)
    v_mfma_f32_32x32x16_bf16 v[64:79], v[160:163], a[8:11], v[64:79]
    ds_read_b64_tr_b16 v[172:173], v219 offset:10752
    ds_read_b64_tr_b16 v[174:175], v219 offset:11008
    buffer_load_dwordx4 v213, s[52:55], s57 offen lds
    s_add_u32 s57, s57, 147456
    v_mfma_f32_32x32x16_bf16 v[96:111], v[160:163], a[12:15], v[96:111]
    s_waitcnt lgkmcnt(4)
    v_mfma_f32_32x32x16_bf16 v[80:95], v[164:167], a[8:11], v[80:95]
    ds_read_b64_tr_b16 v[160:161], v219 offset:12800
    ds_read_b64_tr_b16 v[162:163], v219 offset:13056
    v_mfma_f32_32x32x16_bf16 v[112:127], v[164:167], a[12:15], v[112:127]
    s_add_u32 m0, s56, 86016
    s_waitcnt lgkmcnt(4)
    v_mfma_f32_32x32x16_bf16 v[64:79], v[168:171], a[16:19], v[64:79]
    ds_read_b64_tr_b16 v[164:165], v219 offset:14848
    ds_read_b64_tr_b16 v[166:167], v219 offset:15104
    buffer_load_dwordx4 v213, s[52:55], s57 offen lds
    s_add_u32 s57, s57, 147456
    v_mfma_f32_32x32x16_bf16 v[96:111], v[168:171], a[20:23], v[96:111]
    s_waitcnt lgkmcnt(4)
    v_mfma_f32_32x32x16_bf16 v[80:95], v[172:175], a[16:19], v[80:95]
    ds_read_b64_tr_b16 v[168:169], v219 offset:16896
    ds_read_b64_tr_b16 v[170:171], v219 offset:17152
    s_add_u32 m0, s56, 90112
    v_mfma_f32_32x32x16_bf16 v[112:127], v[172:175], a[20:23], v[112:127]
    buffer_load_dwordx4 v213, s[52:55], s57 offen lds
    s_add_u32 s57, s57, 147456
    s_waitcnt lgkmcnt(4)
    v_mfma_f32_32x32x16_bf16 v[64:79], v[160:163], a[24:27], v[64:79]
    ds_read_b64_tr_b16 v[172:173], v219 offset:18944
    ds_read_b64_tr_b16 v[174:175], v219 offset:19200
    v_mfma_f32_32x32x16_bf16 v[96:111], v[160:163], a[28:31], v[96:111]
    s_waitcnt lgkmcnt(4)
    v_mfma_f32_32x32x16_bf16 v[80:95], v[164:167], a[24:27], v[80:95]
    ds_read_b64_tr_b16 v[160:161], v219 offset:20992
    ds_read_b64_tr_b16 v[162:163], v219 offset:21248
    s_add_u32 m0, s56, 94208
    v_mfma_f32_32x32x16_bf16 v[112:127], v[164:167], a[28:31], v[112:127]
    buffer_load_dwordx4 v213, s[52:55], s57 offen lds
    s_add_u32 s57, s57, 147456
    s_waitcnt lgkmcnt(4)
    v_mfma_f32_32x32x16_bf16 v[64:79], v[168:171], a[32:35], v[64:79]
    ds_read_b64_tr_b16 v[164:165], v219 offset:23040
    ds_read_b64_tr_b16 v[166:167], v219 offset:23296
    v_mfma_f32_32x32x16_bf16 v[96:111], v[168:171], a[36:39], v[96:111]
    s_add_u32 m0, s56, 98304
    s_waitcnt lgkmcnt(4)
    v_mfma_f32_32x32x16_bf16 v[80:95], v[172:175], a[32:35], v[80:95]
    ds_read_b64_tr_b16 v[168:169], v219 offset:25088
    ds_read_b64_tr_b16 v[170:171], v219 offset:25344
    buffer_load_dwordx4 v213, s[52:55], s57 offen lds
    s_add_u32 s57, s57, 147456
    v_mfma_f32_32x32x16_bf16 v[112:127], v[172:175], a[36:39], v[112:127]
    s_waitcnt lgkmcnt(4)
    v_mfma_f32_32x32x16_bf16 v[64:79], v[160:163], a[40:43], v[64:79]
    ds_read_b64_tr_b16 v[172:173], v219 offset:27136
    ds_read_b64_tr_b16 v[174:175], v219 offset:27392
    v_mfma_f32_32x32x16_bf16 v[96:111], v[160:163], a[44:47], v[96:111]
    s_add_u32 m0, s56, 102400
    s_waitcnt lgkmcnt(4)
    v_mfma_f32_32x32x16_bf16 v[80:95], v[164:167], a[40:43], v[80:95]
    ds_read_b64_tr_b16 v[160:161], v219 offset:29184
    ds_read_b64_tr_b16 v[162:163], v219 offset:29440
    buffer_load_dwordx4 v213, s[52:55], s57 offen lds
    s_add_u32 s57, s57, 147456
    v_mfma_f32_32x32x16_bf16 v[112:127], v[164:167], a[44:47], v[112:127]
    s_waitcnt lgkmcnt(4)
    v_mfma_f32_32x32x16_bf16 v[64:79], v[168:171], a[48:51], v[64:79]
    ds_read_b64_tr_b16 v[164:165], v219 offset:31232
    ds_read_b64_tr_b16 v[166:167], v219 offset:31488
    s_add_u32 m0, s56, 106496
    v_mfma_f32_32x32x16_bf16 v[96:111], v[168:171], a[52:55], v[96:111]
    buffer_load_dwordx4 v213, s[52:55], s57 offen lds
    s_add_u32 s57, s57, 147456
    s_sub_u32 s57, s57, 5308288
    s_waitcnt lgkmcnt(4)
    v_mfma_f32_32x32x16_bf16 v[80:95], v[172:175], a[48:51], v[80:95]
    ds_read_b64_tr_b16 v[168:169], v219 offset:33280
    ds_read_b64_tr_b16 v[170:171], v219 offset:33536
    v_mfma_f32_32x32x16_bf16 v[112:127], v[172:175], a[52:55], v[112:127]
    s_waitcnt lgkmcnt(4)
    v_mfma_f32_32x32x16_bf16 v[64:79], v[160:163], a[56:59], v[64:79]
    ds_read_b64_tr_b16 v[172:173], v219 offset:35328
    ds_read_b64_tr_b16 v[174:175], v219 offset:35584
    v_mfma_f32_32x32x16_bf16 v[96:111], v[160:163], a[60:63], v[96:111]
    s_waitcnt lgkmcnt(4)
    v_mfma_f32_32x32x16_bf16 v[80:95], v[164:167], a[56:59], v[80:95]
    ds_read_b64_tr_b16 v[160:161], v216 offset:0
    ds_read_b64_tr_b16 v[162:163], v216 offset:256
    v_mfma_f32_32x32x16_bf16 v[112:127], v[164:167], a[60:63], v[112:127]
    s_waitcnt lgkmcnt(4)
    v_mfma_f32_32x32x16_bf16 v[64:79], v[168:171], a[64:67], v[64:79]
    ds_read_b64_tr_b16 v[164:165], v216 offset:2048
    ds_read_b64_tr_b16 v[166:167], v216 offset:2304
    v_mfma_f32_32x32x16_bf16 v[96:111], v[168:171], a[68:71], v[96:111]
    s_waitcnt lgkmcnt(4)
    v_mfma_f32_32x32x16_bf16 v[80:95], v[172:175], a[64:67], v[80:95]
    ds_read_b64_tr_b16 v[168:169], v216 offset:4096
    ds_read_b64_tr_b16 v[170:171], v216 offset:4352
    v_mfma_f32_32x32x16_bf16 v[112:127], v[172:175], a[68:71], v[112:127]
L_j1:
    s_waitcnt lgkmcnt(4)
    v_mfma_f32_32x32x16_bf16 v[0:15], v[160:163], a[72:75], v[0:15]
    s_waitcnt vmcnt(0)
    s_barrier
    v_mov_b32 v196, s32
    v_mov_b32 v197, s33
    s_lshl_b32 s34, s2, 7
    s_add_u32 s34, s34, 49815552
    buffer_store_dwordx2 v[196:197], v209, s[24:27], s34 offen sc1
    ds_read_b64_tr_b16 v[172:173], v216 offset:6144
    ds_read_b64_tr_b16 v[174:175], v216 offset:6400
    v_mfma_f32_32x32x16_bf16 v[32:47], v[160:163], a[76:79], v[32:47]
    s_waitcnt lgkmcnt(4)
    v_mfma_f32_32x32x16_bf16 v[16:31], v[164:167], a[72:75], v[16:31]
    ds_read_b64_tr_b16 v[160:161], v216 offset:8192
    ds_read_b64_tr_b16 v[162:163], v216 offset:8448
    s_add_u32 m0, s56, 110592
    v_mfma_f32_32x32x16_bf16 v[48:63], v[164:167], a[76:79], v[48:63]
    buffer_load_dwordx4 v213, s[52:55], s57 offen lds
    s_add_u32 s57, s57, 147456
    s_waitcnt lgkmcnt(4)
    v_mfma_f32_32x32x16_bf16 v[0:15], v[168:171], a[80:83], v[0:15]
    ds_read_b64_tr_b16 v[164:165], v216 offset:10240
    ds_read_b64_tr_b16 v[166:167], v216 offset:10496
    v_mfma_f32_32x32x16_bf16 v[32:47], v[168:171], a[84:87], v[32:47]
    s_waitcnt lgkmcnt(4)
    v_mfma_f32_32x32x16_bf16 v[16:31], v[172:175], a[80:83], v[16:31]
    ds_read_b64_tr_b16 v[168:169], v216 offset:12288
    ds_read_b64_tr_b16 v[170:171], v216 offset:12544
    v_mfma_f32_32x32x16_bf16 v[48:63], v[172:175], a[84:87], v[48:63]
    s_waitcnt lgkmcnt(4)
    v_mfma_f32_32x32x16_bf16 v[0:15], v[160:163], a[88:91], v[0:15]
    ds_read_b64_tr_b16 v[172:173], v216 offset:14336
    ds_read_b64_tr_b16 v[174:175], v216 offset:14592
    s_add_u32 m0, s56, 114688
    v_mfma_f32_32x32x16_bf16 v[32:47], v[160:163], a[92:95], v[32:47]
    buffer_load_dwordx4 v213, s[52:55], s57 offen lds
    s_add_u32 s57, s57, 147456
    s_waitcnt lgkmcnt(4)
    v_mfma_f32_32x32x16_bf16 v[16:31], v[164:167], a[88:91], v[16:31]
    ds_read_b64_tr_b16 v[160:161], v216 offset:16384
    ds_read_b64_tr_b16 v[162:163], v216 offset:16640
    v_mfma_f32_32x32x16_bf16 v[48:63], v[164:167], a[92:95], v[48:63]
    s_waitcnt lgkmcnt(4)
    v_mfma_f32_32x32x16_bf16 v[0:15], v[168:171], a[96:99], v[0:15]
    ds_read_b64_tr_b16 v[164:165], v216 offset:18432
    ds_read_b64_tr_b16 v[166:167], v216 offset:18688
    v_mfma_f32_32x32x16_bf16 v[32:47], v[168:171], a[100:103], v[32:47]
    s_waitcnt lgkmcnt(4)
    v_mfma_f32_32x32x16_bf16 v[16:31], v[172:175], a[96:99], v[16:31]
    ds_read_b64_tr_b16 v[168:169], v216 offset:20480
    ds_read_b64_tr_b16 v[170:171], v216 offset:20736
    v_mfma_f32_32x32x16_bf16 v[48:63], v[172:175], a[100:103], v[48:63]
    s_add_u32 m0, s56, 118784
    s_waitcnt lgkmcnt(4)
    v_mfma_f32_32x32x16_bf16 v[0:15], v[160:163], a[104:107], v[0:15]
    ds_read_b64_tr_b16 v[172:173], v216 offset:22528
    ds_read_b64_tr_b16 v[174:175], v216 offset:22784
    buffer_load_dwordx4 v213, s[52:55], s57 offen lds
    s_add_u32 s57, s57, 147456
    v_mfma_f32_32x32x16_bf16 v[32:47], v[160:163], a[108:111], v[32:47]
    s_waitcnt lgkmcnt(4)
    v_mfma_f32_32x32x16_bf16 v[16:31], v[164:167], a[104:107], v[16:31]
    ds_read_b64_tr_b16 v[160:161], v216 offset:24576
    ds_read_b64_tr_b16 v[162:163], v216 offset:24832
    v_mfma_f32_32x32x16_bf16 v[48:63], v[164:167], a[108:111], v[48:63]
    s_waitcnt lgkmcnt(4)
    v_mfma_f32_32x32x16_bf16 v[0:15], v[168:171], a[112:115], v[0:15]
    ds_read_b64_tr_b16 v[164:165], v216 offset:26624
    ds_read_b64_tr_b16 v[166:167], v216 offset:26880
    v_mfma_f32_32x32x16_bf16 v[32:47], v[168:171], a[116:119], v[32:47]
    s_waitcnt lgkmcnt(4)
    v_mfma_f32_32x32x16_bf16 v[16:31], v[172:175], a[112:115], v[16:31]
    ds_read_b64_tr_b16 v[168:169], v216 offset:28672
    ds_read_b64_tr_b16 v[170:171], v216 offset:28928
    s_add_u32 m0, s56, 122880
    v_mfma_f32_32x32x16_bf16 v[48:63], v[172:175], a[116:119], v[48:63]
    buffer_load_dwordx4 v213, s[52:55], s57 offen lds
    s_add_u32 s57, s57, 147456
    s_waitcnt lgkmcnt(4)
    v_mfma_f32_32x32x16_bf16 v[0:15], v[160:163], a[120:123], v[0:15]
    ds_read_b64_tr_b16 v[172:173], v216 offset:30720
    ds_read_b64_tr_b16 v[174:175], v216 offset:30976
    v_mfma_f32_32x32x16_bf16 v[32:47], v[160:163], a[124:127], v[32:47]
    s_waitcnt lgkmcnt(4)
    v_mfma_f32_32x32x16_bf16 v[16:31], v[164:167], a[120:123], v[16:31]
    ds_read_b64_tr_b16 v[160:161], v216 offset:32768
    ds_read_b64_tr_b16 v[162:163], v216 offset:33024
    v_mfma_f32_32x32x16_bf16 v[48:63], v[164:167], a[124:127], v[48:63]
    s_waitcnt lgkmcnt(4)
    v_mfma_f32_32x32x16_bf16 v[0:15], v[168:171], a[128:131], v[0:15]
    ds_read_b64_tr_b16 v[164:165], v216 offset:34816
    ds_read_b64_tr_b16 v[166:167], v216 offset:35072
    v_mfma_f32_32x32x16_bf16 v[32:47], v[168:171], a[132:135], v[32:47]
    s_add_u32 m0, s56, 126976
    s_waitcnt lgkmcnt(4)
    v_mfma_f32_32x32x16_bf16 v[16:31], v[172:175], a[128:131], v[16:31]
    ds_read_b64_tr_b16 v[168:169], v216 offset:512
    ds_read_b64_tr_b16 v[170:171], v216 offset:768
    buffer_load_dwordx4 v213, s[52:55], s57 offen lds
    s_add_u32 s57, s57, 147456
    v_mfma_f32_32x32x16_bf16 v[48:63], v[172:175], a[132:135], v[48:63]
    s_waitcnt lgkmcnt(4)
    v_mfma_f32_32x32x16_bf16 v[0:15], v[160:163], a[136:139], v[0:15]
    ds_read_b64_tr_b16 v[172:173], v216 offset:2560
    ds_read_b64_tr_b16 v[174:175], v216 offset:2816
    v_mfma_f32_32x32x16_bf16 v[32:47], v[160:163], a[140:143], v[32:47]
    s_waitcnt lgkmcnt(4)
    v_mfma_f32_32x32x16_bf16 v[16:31], v[164:167], a[136:139], v[16:31]
    ds_read_b64_tr_b16 v[160:161], v216 offset:4608
    ds_read_b64_tr_b16 v[162:163], v216 offset:4864
    v_mfma_f32_32x32x16_bf16 v[48:63], v[164:167], a[140:143], v[48:63]
    s_waitcnt lgkmcnt(4)
    v_mfma_f32_32x32x16_bf16 v[64:79], v[168:171], a[72:75], v[64:79]
    ds_read_b64_tr_b16 v[164:165], v216 offset:6656
    ds_read_b64_tr_b16 v[166:167], v216 offset:6912
    s_add_u32 m0, s56, 131072
    v_mfma_f32_32x32x16_bf16 v[96:111], v[168:171], a[76:79], v[96:111]
    buffer_load_dwordx4 v213, s[52:55], s57 offen lds
    s_add_u32 s57, s57, 147456
    s_waitcnt lgkmcnt(4)
    v_mfma_f32_32x32x16_bf16 v[80:95], v[172:175], a[72:75], v[80:95]
    ds_read_b64_tr_b16 v[168:169], v216 offset:8704
    ds_read_b64_tr_b16 v[170:171], v216 offset:8960
    v_mfma_f32_32x32x16_bf16 v[112:127], v[172:175], a[76:79], v[112:127]
    s_waitcnt lgkmcnt(4)
    v_mfma_f32_32x32x16_bf16 v[64:79], v[160:163], a[80:83], v[64:79]
    ds_read_b64_tr_b16 v[172:173], v216 offset:10752
    ds_read_b64_tr_b16 v[174:175], v216 offset:11008
    v_mfma_f32_32x32x16_bf16 v[96:111], v[160:163], a[84:87], v[96:111]
    s_waitcnt lgkmcnt(4)
    v_mfma_f32_32x32x16_bf16 v[80:95], v[164:167], a[80:83], v[80:95]
    ds_read_b64_tr_b16 v[160:161], v216 offset:12800
    ds_read_b64_tr_b16 v[162:163], v216 offset:13056
    v_mfma_f32_32x32x16_bf16 v[112:127], v[164:167], a[84:87], v[112:127]
    s_add_u32 m0, s56, 135168
    s_waitcnt lgkmcnt(4)
    v_mfma_f32_32x32x16_bf16 v[64:79], v[168:171], a[88:91], v[64:79]
    ds_read_b64_tr_b16 v[164:165], v216 offset:14848
    ds_read_b64_tr_b16 v[166:167], v216 offset:15104
    buffer_load_dwordx4 v213, s[52:55], s57 offen lds
    s_add_u32 s57, s57, 147456
    v_mfma_f32_32x32x16_bf16 v[96:111], v[168:171], a[92:95], v[96:111]
    s_waitcnt lgkmcnt(4)
    v_mfma_f32_32x32x16_bf16 v[80:95], v[172:175], a[88:91], v[80:95]
    ds_read_b64_tr_b16 v[168:169], v216 offset:16896
    ds_read_b64_tr_b16 v[170:171], v216 offset:17152
    v_mfma_f32_32x32x16_bf16 v[112:127], v[172:175], a[92:95], v[112:127]
    s_waitcnt lgkmcnt(4)
    v_mfma_f32_32x32x16_bf16 v[64:79], v[160:163], a[96:99], v[64:79]
    ds_read_b64_tr_b16 v[172:173], v216 offset:18944
    ds_read_b64_tr_b16 v[174:175], v216 offset:19200
    v_mfma_f32_32x32x16_bf16 v[96:111], v[160:163], a[100:103], v[96:111]
    s_waitcnt lgkmcnt(4)
    v_mfma_f32_32x32x16_bf16 v[80:95], v[164:167], a[96:99], v[80:95]
    ds_read_b64_tr_b16 v[160:161], v216 offset:20992
    ds_read_b64_tr_b16 v[162:163], v216 offset:21248
    s_add_u32 m0, s56, 139264
    v_mfma_f32_32x32x16_bf16 v[112:127], v[164:167], a[100:103], v[112:127]
    buffer_load_dwordx4 v213, s[52:55], s57 offen lds
    s_add_u32 s57, s57, 147456
    s_waitcnt lgkmcnt(4)
    v_mfma_f32_32x32x16_bf16 v[64:79], v[168:171], a[104:107], v[64:79]
    ds_read_b64_tr_b16 v[164:165], v216 offset:23040
    ds_read_b64_tr_b16 v[166:167], v216 offset:23296
    v_mfma_f32_32x32x16_bf16 v[96:111], v[168:171], a[108:111], v[96:111]
    s_waitcnt lgkmcnt(4)
    v_mfma_f32_32x32x16_bf16 v[80:95], v[172:175], a[104:107], v[80:95]
    ds_read_b64_tr_b16 v[168:169], v216 offset:25088
    ds_read_b64_tr_b16 v[170:171], v216 offset:25344
    v_mfma_f32_32x32x16_bf16 v[112:127], v[172:175], a[108:111], v[112:127]
    s_waitcnt lgkmcnt(4)
    v_mfma_f32_32x32x16_bf16 v[64:79], v[160:163], a[112:115], v[64:79]
    ds_read_b64_tr_b16 v[172:173], v216 offset:27136
    ds_read_b64_tr_b16 v[174:175], v216 offset:27392
    v_mfma_f32_32x32x16_bf16 v[96:111], v[160:163], a[116:119], v[96:111]
    s_add_u32 m0, s56, 143360
    s_waitcnt lgkmcnt(4)
    v_mfma_f32_32x32x16_bf16 v[80:95], v[164:167], a[112:115], v[80:95]
    ds_read_b64_tr_b16 v[160:161], v216 offset:29184
    ds_read_b64_tr_b16 v[162:163], v216 offset:29440
    buffer_load_dwordx4 v213, s[52:55], s57 offen lds
    s_add_u32 s57, s57, 147456
    v_mfma_f32_32x32x16_bf16 v[112:127], v[164:167], a[116:119], v[112:127]
    s_waitcnt lgkmcnt(4)
    v_mfma_f32_32x32x16_bf16 v[64:79], v[168:171], a[120:123], v[64:79]
    ds_read_b64_tr_b16 v[164:165], v216 offset:31232
    ds_read_b64_tr_b16 v[166:167], v216 offset:31488
    v_mfma_f32_32x32x16_bf16 v[96:111], v[168:171], a[124:127], v[96:111]
    s_waitcnt lgkmcnt(4)
    v_mfma_f32_32x32x16_bf16 v[80:95], v[172:175], a[120:123], v[80:95]
    ds_read_b64_tr_b16 v[168:169], v216 offset:33280
    ds_read_b64_tr_b16 v[170:171], v216 offset:33536
    v_mfma_f32_32x32x16_bf16 v[112:127], v[172:175], a[124:127], v[112:127]
    s_waitcnt lgkmcnt(4)
    v_mfma_f32_32x32x16_bf16 v[64:79], v[160:163], a[128:131], v[64:79]
    ds_read_b64_tr_b16 v[172:173], v216 offset:35328
    ds_read_b64_tr_b16 v[174:175], v216 offset:35584
    v_mfma_f32_32x32x16_bf16 v[96:111], v[160:163], a[132:135], v[96:111]
    s_waitcnt lgkmcnt(4)
    v_mfma_f32_32x32x16_bf16 v[80:95], v[164:167], a[128:131], v[80:95]
    ds_read_b64_tr_b16 v[160:161], v217 offset:0
    ds_read_b64_tr_b16 v[162:163], v217 offset:256
    v_mfma_f32_32x32x16_bf16 v[112:127], v[164:167], a[132:135], v[112:127]
    s_waitcnt lgkmcnt(4)
    v_mfma_f32_32x32x16_bf16 v[64:79], v[168:171], a[136:139], v[64:79]
    ds_read_b64_tr_b16 v[164:165], v217 offset:2048
    ds_read_b64_tr_b16 v[166:167], v217 offset:2304
    v_mfma_f32_32x32x16_bf16 v[96:111], v[168:171], a[140:143], v[96:111]
    s_waitcnt lgkmcnt(4)
    v_mfma_f32_32x32x16_bf16 v[80:95], v[172:175], a[136:139], v[80:95]
    ds_read_b64_tr_b16 v[168:169], v217 offset:4096
    ds_read_b64_tr_b16 v[170:171], v217 offset:4352
    v_mfma_f32_32x32x16_bf16 v[112:127], v[172:175], a[140:143], v[112:127]
    s_waitcnt lgkmcnt(4)
    v_mfma_f32_32x32x16_bf16 v[0:15], v[160:163], a[144:147], v[0:15]
    s_barrier
    ds_read_b64_tr_b16 v[172:173], v217 offset:6144
    ds_read_b64_tr_b16 v[174:175], v217 offset:6400
    v_mfma_f32_32x32x16_bf16 v[32:47], v[160:163], a[148:151], v[32:47]
    s_waitcnt lgkmcnt(4)
    v_mfma_f32_32x32x16_bf16 v[16:31], v[164:167], a[144:147], v[16:31]
    ds_read_b64_tr_b16 v[160:161], v217 offset:8192
    ds_read_b64_tr_b16 v[162:163], v217 offset:8448
    s_add_u32 m0, s56, 0
    v_mfma_f32_32x32x16_bf16 v[48:63], v[164:167], a[148:151], v[48:63]
    buffer_load_dwordx4 v213, s[52:55], s57 offen lds
    s_add_u32 s57, s57, 147456
    s_waitcnt lgkmcnt(4)
    v_mfma_f32_32x32x16_bf16 v[0:15], v[168:171], a[152:155], v[0:15]
    ds_read_b64_tr_b16 v[164:165], v217 offset:10240
    ds_read_b64_tr_b16 v[166:167], v217 offset:10496
    v_mfma_f32_32x32x16_bf16 v[32:47], v[168:171], a[156:159], v[32:47]
    s_waitcnt lgkmcnt(4)
    v_mfma_f32_32x32x16_bf16 v[16:31], v[172:175], a[152:155], v[16:31]
    ds_read_b64_tr_b16 v[168:169], v217 offset:12288
    ds_read_b64_tr_b16 v[170:171], v217 offset:12544
    v_mfma_f32_32x32x16_bf16 v[48:63], v[172:175], a[156:159], v[48:63]
    s_waitcnt lgkmcnt(4)
    v_mfma_f32_32x32x16_bf16 v[0:15], v[160:163], a[160:163], v[0:15]
    ds_read_b64_tr_b16 v[172:173], v217 offset:14336
    ds_read_b64_tr_b16 v[174:175], v217 offset:14592
    s_add_u32 m0, s56, 4096
    v_mfma_f32_32x32x16_bf16 v[32:47], v[160:163], a[164:167], v[32:47]
    buffer_load_dwordx4 v213, s[52:55], s57 offen lds
    s_add_u32 s57, s57, 147456
    s_waitcnt lgkmcnt(4)
    v_mfma_f32_32x32x16_bf16 v[16:31], v[164:167], a[160:163], v[16:31]
    ds_read_b64_tr_b16 v[160:161], v217 offset:16384
    ds_read_b64_tr_b16 v[162:163], v217 offset:16640
    v_mfma_f32_32x32x16_bf16 v[48:63], v[164:167], a[164:167], v[48:63]
    s_waitcnt lgkmcnt(4)
    v_mfma_f32_32x32x16_bf16 v[0:15], v[168:171], a[168:171], v[0:15]
    ds_read_b64_tr_b16 v[164:165], v217 offset:18432
    ds_read_b64_tr_b16 v[166:167], v217 offset:18688
    v_mfma_f32_32x32x16_bf16 v[32:47], v[168:171], a[172:175], v[32:47]
    s_waitcnt lgkmcnt(4)
    v_mfma_f32_32x32x16_bf16 v[16:31], v[172:175], a[168:171], v[16:31]
    ds_read_b64_tr_b16 v[168:169], v217 offset:20480
    ds_read_b64_tr_b16 v[170:171], v217 offset:20736
    v_mfma_f32_32x32x16_bf16 v[48:63], v[172:175], a[172:175], v[48:63]
    s_add_u32 m0, s56, 8192
    s_waitcnt lgkmcnt(4)
    v_mfma_f32_32x32x16_bf16 v[0:15], v[160:163], a[176:179], v[0:15]
    ds_read_b64_tr_b16 v[172:173], v217 offset:22528
    ds_read_b64_tr_b16 v[174:175], v217 offset:22784
    buffer_load_dwordx4 v213, s[52:55], s57 offen lds
    s_add_u32 s57, s57, 147456
    v_mfma_f32_32x32x16_bf16 v[32:47], v[160:163], a[180:183], v[32:47]
    s_waitcnt lgkmcnt(4)
    v_mfma_f32_32x32x16_bf16 v[16:31], v[164:167], a[176:179], v[16:31]
    ds_read_b64_tr_b16 v[160:161], v217 offset:24576
    ds_read_b64_tr_b16 v[162:163], v217 offset:24832
    v_mfma_f32_32x32x16_bf16 v[48:63], v[164:167], a[180:183], v[48:63]
    s_waitcnt lgkmcnt(4)
    v_mfma_f32_32x32x16_bf16 v[0:15], v[168:171], a[184:187], v[0:15]
    ds_read_b64_tr_b16 v[164:165], v217 offset:26624
    ds_read_b64_tr_b16 v[166:167], v217 offset:26880
    v_mfma_f32_32x32x16_bf16 v[32:47], v[168:171], a[188:191], v[32:47]
    s_waitcnt lgkmcnt(4)
    v_mfma_f32_32x32x16_bf16 v[16:31], v[172:175], a[184:187], v[16:31]
    ds_read_b64_tr_b16 v[168:169], v217 offset:28672
    ds_read_b64_tr_b16 v[170:171], v217 offset:28928
    s_add_u32 m0, s56, 12288
    v_mfma_f32_32x32x16_bf16 v[48:63], v[172:175], a[188:191], v[48:63]
    buffer_load_dwordx4 v213, s[52:55], s57 offen lds
    s_add_u32 s57, s57, 147456
    s_waitcnt lgkmcnt(4)
    v_mfma_f32_32x32x16_bf16 v[0:15], v[160:163], a[192:195], v[0:15]
    ds_read_b64_tr_b16 v[172:173], v217 offset:30720
    ds_read_b64_tr_b16 v[174:175], v217 offset:30976
    v_mfma_f32_32x32x16_bf16 v[32:47], v[160:163], a[196:199], v[32:47]
    s_waitcnt lgkmcnt(4)
    v_mfma_f32_32x32x16_bf16 v[16:31], v[164:167], a[192:195], v[16:31]
    ds_read_b64_tr_b16 v[160:161], v217 offset:32768
    ds_read_b64_tr_b16 v[162:163], v217 offset:33024
    v_mfma_f32_32x32x16_bf16 v[48:63], v[164:167], a[196:199], v[48:63]
    s_waitcnt lgkmcnt(4)
    v_mfma_f32_32x32x16_bf16 v[0:15], v[168:171], a[200:203], v[0:15]
    ds_read_b64_tr_b16 v[164:165], v217 offset:34816
    ds_read_b64_tr_b16 v[166:167], v217 offset:35072
    v_mfma_f32_32x32x16_bf16 v[32:47], v[168:171], a[204:207], v[32:47]
    s_add_u32 m0, s56, 16384
    s_waitcnt lgkmcnt(4)
    v_mfma_f32_32x32x16_bf16 v[16:31], v[172:175], a[200:203], v[16:31]
    ds_read_b64_tr_b16 v[168:169], v217 offset:512
    ds_read_b64_tr_b16 v[170:171], v217 offset:768
    buffer_load_dwordx4 v213, s[52:55], s57 offen lds
    s_add_u32 s57, s57, 147456
    v_mfma_f32_32x32x16_bf16 v[48:63], v[172:175], a[204:207], v[48:63]
    s_waitcnt lgkmcnt(4)
    v_mfma_f32_32x32x16_bf16 v[0:15], v[160:163], a[208:211], v[0:15]
    ds_read_b64_tr_b16 v[172:173], v217 offset:2560
    ds_read_b64_tr_b16 v[174:175], v217 offset:2816
    v_mfma_f32_32x32x16_bf16 v[32:47], v[160:163], a[212:215], v[32:47]
    s_waitcnt lgkmcnt(4)
    v_mfma_f32_32x32x16_bf16 v[16:31], v[164:167], a[208:211], v[16:31]
    ds_read_b64_tr_b16 v[160:161], v217 offset:4608
    ds_read_b64_tr_b16 v[162:163], v217 offset:4864
    v_mfma_f32_32x32x16_bf16 v[48:63], v[164:167], a[212:215], v[48:63]
    s_waitcnt lgkmcnt(4)
    v_mfma_f32_32x32x16_bf16 v[64:79], v[168:171], a[144:147], v[64:79]
    ds_read_b64_tr_b16 v[164:165], v217 offset:6656
    ds_read_b64_tr_b16 v[166:167], v217 offset:6912
    s_add_u32 m0, s56, 20480
    v_mfma_f32_32x32x16_bf16 v[96:111], v[168:171], a[148:151], v[96:111]
    buffer_load_dwordx4 v213, s[52:55], s57 offen lds
    s_add_u32 s57, s57, 147456
    s_waitcnt lgkmcnt(4)
    v_mfma_f32_32x32x16_bf16 v[80:95], v[172:175], a[144:147], v[80:95]
    ds_read_b64_tr_b16 v[168:169], v217 offset:8704
    ds_read_b64_tr_b16 v[170:171], v217 offset:8960
    v_mfma_f32_32x32x16_bf16 v[112:127], v[172:175], a[148:151], v[112:127]
    s_waitcnt lgkmcnt(4)
    v_mfma_f32_32x32x16_bf16 v[64:79], v[160:163], a[152:155], v[64:79]
    ds_read_b64_tr_b16 v[172:173], v217 offset:10752
    ds_read_b64_tr_b16 v[174:175], v217 offset:11008
    v_mfma_f32_32x32x16_bf16 v[96:111], v[160:163], a[156:159], v[96:111]
    s_waitcnt lgkmcnt(4)
    v_mfma_f32_32x32x16_bf16 v[80:95], v[164:167], a[152:155], v[80:95]
    ds_read_b64_tr_b16 v[160:161], v217 offset:12800
    ds_read_b64_tr_b16 v[162:163], v217 offset:13056
    v_mfma_f32_32x32x16_bf16 v[112:127], v[164:167], a[156:159], v[112:127]
    s_add_u32 m0, s56, 24576
    s_waitcnt lgkmcnt(4)
    v_mfma_f32_32x32x16_bf16 v[64:79], v[168:171], a[160:163], v[64:79]
    ds_read_b64_tr_b16 v[164:165], v217 offset:14848
    ds_read_b64_tr_b16 v[166:167], v217 offset:15104
    buffer_load_dwordx4 v213, s[52:55], s57 offen lds
    s_add_u32 s57, s57, 147456
    v_mfma_f32_32x32x16_bf16 v[96:111], v[168:171], a[164:167], v[96:111]
    s_waitcnt lgkmcnt(4)
    v_mfma_f32_32x32x16_bf16 v[80:95], v[172:175], a[160:163], v[80:95]
    ds_read_b64_tr_b16 v[168:169], v217 offset:16896
    ds_read_b64_tr_b16 v[170:171], v217 offset:17152
    v_mfma_f32_32x32x16_bf16 v[112:127], v[172:175], a[164:167], v[112:127]
    s_waitcnt lgkmcnt(4)
    v_mfma_f32_32x32x16_bf16 v[64:79], v[160:163], a[168:171], v[64:79]
    ds_read_b64_tr_b16 v[172:173], v217 offset:18944
    ds_read_b64_tr_b16 v[174:175], v217 offset:19200
    v_mfma_f32_32x32x16_bf16 v[96:111], v[160:163], a[172:175], v[96:111]
    s_waitcnt lgkmcnt(4)
    v_mfma_f32_32x32x16_bf16 v[80:95], v[164:167], a[168:171], v[80:95]
    ds_read_b64_tr_b16 v[160:161], v217 offset:20992
    ds_read_b64_tr_b16 v[162:163], v217 offset:21248
    s_add_u32 m0, s56, 28672
    v_mfma_f32_32x32x16_bf16 v[112:127], v[164:167], a[172:175], v[112:127]
    buffer_load_dwordx4 v213, s[52:55], s57 offen lds
    s_add_u32 s57, s57, 147456
    s_waitcnt lgkmcnt(4)
    v_mfma_f32_32x32x16_bf16 v[64:79], v[168:171], a[176:179], v[64:79]
    ds_read_b64_tr_b16 v[164:165], v217 offset:23040
    ds_read_b64_tr_b16 v[166:167], v217 offset:23296
    v_mfma_f32_32x32x16_bf16 v[96:111], v[168:171], a[180:183], v[96:111]
    s_waitcnt lgkmcnt(4)
    v_mfma_f32_32x32x16_bf16 v[80:95], v[172:175], a[176:179], v[80:95]
    ds_read_b64_tr_b16 v[168:169], v217 offset:25088
    ds_read_b64_tr_b16 v[170:171], v217 offset:25344
    v_mfma_f32_32x32x16_bf16 v[112:127], v[172:175], a[180:183], v[112:127]
    s_waitcnt lgkmcnt(4)
    v_mfma_f32_32x32x16_bf16 v[64:79], v[160:163], a[184:187], v[64:79]
    ds_read_b64_tr_b16 v[172:173], v217 offset:27136
    ds_read_b64_tr_b16 v[174:175], v217 offset:27392
    v_mfma_f32_32x32x16_bf16 v[96:111], v[160:163], a[188:191], v[96:111]
    s_add_u32 m0, s56, 32768
    s_waitcnt lgkmcnt(4)
    v_mfma_f32_32x32x16_bf16 v[80:95], v[164:167], a[184:187], v[80:95]
    ds_read_b64_tr_b16 v[160:161], v217 offset:29184
    ds_read_b64_tr_b16 v[162:163], v217 offset:29440
    buffer_load_dwordx4 v213, s[52:55], s57 offen lds
    s_add_u32 s57, s57, 147456
    v_mfma_f32_32x32x16_bf16 v[112:127], v[164:167], a[188:191], v[112:127]
    s_waitcnt lgkmcnt(4)
    v_mfma_f32_32x32x16_bf16 v[64:79], v[168:171], a[192:195], v[64:79]
    ds_read_b64_tr_b16 v[164:165], v217 offset:31232
    ds_read_b64_tr_b16 v[166:167], v217 offset:31488
    v_mfma_f32_32x32x16_bf16 v[96:111], v[168:171], a[196:199], v[96:111]
    s_waitcnt lgkmcnt(4)
    v_mfma_f32_32x32x16_bf16 v[80:95], v[172:175], a[192:195], v[80:95]
    ds_read_b64_tr_b16 v[168:169], v217 offset:33280
    ds_read_b64_tr_b16 v[170:171], v217 offset:33536
    v_mfma_f32_32x32x16_bf16 v[112:127], v[172:175], a[196:199], v[112:127]
    s_waitcnt lgkmcnt(4)
    v_mfma_f32_32x32x16_bf16 v[64:79], v[160:163], a[200:203], v[64:79]
    ds_read_b64_tr_b16 v[172:173], v217 offset:35328
    ds_read_b64_tr_b16 v[174:175], v217 offset:35584
    v_mfma_f32_32x32x16_bf16 v[96:111], v[160:163], a[204:207], v[96:111]
    s_waitcnt lgkmcnt(4)
    v_mfma_f32_32x32x16_bf16 v[80:95], v[164:167], a[200:203], v[80:95]
    ds_read_b64_tr_b16 v[160:161], v218 offset:0
    ds_read_b64_tr_b16 v[162:163], v218 offset:256
    v_mfma_f32_32x32x16_bf16 v[112:127], v[164:167], a[204:207], v[112:127]
    s_waitcnt lgkmcnt(4)
    v_mfma_f32_32x32x16_bf16 v[64:79], v[168:171], a[208:211], v[64:79]
    ds_read_b64_tr_b16 v[164:165], v218 offset:2048
    ds_read_b64_tr_b16 v[166:167], v218 offset:2304
    v_mfma_f32_32x32x16_bf16 v[96:111], v[168:171], a[212:215], v[96:111]
    s_waitcnt lgkmcnt(4)
    v_mfma_f32_32x32x16_bf16 v[80:95], v[172:175], a[208:211], v[80:95]
    ds_read_b64_tr_b16 v[168:169], v218 offset:4096
    ds_read_b64_tr_b16 v[170:171], v218 offset:4352
    v_mfma_f32_32x32x16_bf16 v[112:127], v[172:175], a[212:215], v[112:127]
    s_waitcnt lgkmcnt(4)
    v_mfma_f32_32x32x16_bf16 v[0:15], v[160:163], a[216:219], v[0:15]
    s_waitcnt vmcnt(9)
    s_barrier
    ds_read_b64_tr_b16 v[172:173], v218 offset:6144
    ds_read_b64_tr_b16 v[174:175], v218 offset:6400
    v_mfma_f32_32x32x16_bf16 v[32:47], v[160:163], a[220:223], v[32:47]
    s_waitcnt lgkmcnt(4)
    v_mfma_f32_32x32x16_bf16 v[16:31], v[164:167], a[216:219], v[16:31]
    ds_read_b64_tr_b16 v[160:161], v218 offset:8192
    ds_read_b64_tr_b16 v[162:163], v218 offset:8448
    s_add_u32 m0, s56, 36864
    v_mfma_f32_32x32x16_bf16 v[48:63], v[164:167], a[220:223], v[48:63]
    buffer_load_dwordx4 v213, s[52:55], s57 offen lds
    s_add_u32 s57, s57, 147456
    s_waitcnt lgkmcnt(4)
    v_mfma_f32_32x32x16_bf16 v[0:15], v[168:171], a[224:227], v[0:15]
    ds_read_b64_tr_b16 v[164:165], v218 offset:10240
    ds_read_b64_tr_b16 v[166:167], v218 offset:10496
    v_mfma_f32_32x32x16_bf16 v[32:47], v[168:171], a[228:231], v[32:47]
    s_waitcnt lgkmcnt(4)
    v_mfma_f32_32x32x16_bf16 v[16:31], v[172:175], a[224:227], v[16:31]
    ds_read_b64_tr_b16 v[168:169], v218 offset:12288
    ds_read_b64_tr_b16 v[170:171], v218 offset:12544
    v_mfma_f32_32x32x16_bf16 v[48:63], v[172:175], a[228:231], v[48:63]
    s_waitcnt lgkmcnt(4)
    v_mfma_f32_32x32x16_bf16 v[0:15], v[160:163], a[232:235], v[0:15]
    ds_read_b64_tr_b16 v[172:173], v218 offset:14336
    ds_read_b64_tr_b16 v[174:175], v218 offset:14592
    s_add_u32 m0, s56, 40960
    v_mfma_f32_32x32x16_bf16 v[32:47], v[160:163], a[236:239], v[32:47]
    buffer_load_dwordx4 v213, s[52:55], s57 offen lds
    s_add_u32 s57, s57, 147456
    s_waitcnt lgkmcnt(4)
    v_mfma_f32_32x32x16_bf16 v[16:31], v[164:167], a[232:235], v[16:31]
    ds_read_b64_tr_b16 v[160:161], v218 offset:16384
    ds_read_b64_tr_b16 v[162:163], v218 offset:16640
    v_mfma_f32_32x32x16_bf16 v[48:63], v[164:167], a[236:239], v[48:63]
    s_waitcnt lgkmcnt(4)
    v_mfma_f32_32x32x16_bf16 v[0:15], v[168:171], a[240:243], v[0:15]
    ds_read_b64_tr_b16 v[164:165], v218 offset:18432
    ds_read_b64_tr_b16 v[166:167], v218 offset:18688
    v_mfma_f32_32x32x16_bf16 v[32:47], v[168:171], a[244:247], v[32:47]
    s_waitcnt lgkmcnt(4)
    v_mfma_f32_32x32x16_bf16 v[16:31], v[172:175], a[240:243], v[16:31]
    ds_read_b64_tr_b16 v[168:169], v218 offset:20480
    ds_read_b64_tr_b16 v[170:171], v218 offset:20736
    v_mfma_f32_32x32x16_bf16 v[48:63], v[172:175], a[244:247], v[48:63]
    s_add_u32 m0, s56, 45056
    s_waitcnt lgkmcnt(4)
    v_mfma_f32_32x32x16_bf16 v[0:15], v[160:163], a[248:251], v[0:15]
    ds_read_b64_tr_b16 v[172:173], v218 offset:22528
    ds_read_b64_tr_b16 v[174:175], v218 offset:22784
    buffer_load_dwordx4 v213, s[52:55], s57 offen lds
    s_add_u32 s57, s57, 147456
    v_mfma_f32_32x32x16_bf16 v[32:47], v[160:163], a[252:255], v[32:47]
    s_waitcnt lgkmcnt(4)
    v_mfma_f32_32x32x16_bf16 v[16:31], v[164:167], a[248:251], v[16:31]
    ds_read_b64_tr_b16 v[160:161], v218 offset:24576
    ds_read_b64_tr_b16 v[162:163], v218 offset:24832
    v_mfma_f32_32x32x16_bf16 v[48:63], v[164:167], a[252:255], v[48:63]
    s_waitcnt lgkmcnt(4)
    v_mfma_f32_32x32x16_bf16 v[0:15], v[168:171], v[224:227], v[0:15]
    ds_read_b64_tr_b16 v[164:165], v218 offset:26624
    ds_read_b64_tr_b16 v[166:167], v218 offset:26880
    v_mfma_f32_32x32x16_bf16 v[32:47], v[168:171], v[228:231], v[32:47]
    s_waitcnt lgkmcnt(4)
    v_mfma_f32_32x32x16_bf16 v[16:31], v[172:175], v[224:227], v[16:31]
    ds_read_b64_tr_b16 v[168:169], v218 offset:28672
    ds_read_b64_tr_b16 v[170:171], v218 offset:28928
    s_add_u32 m0, s56, 49152
    v_mfma_f32_32x32x16_bf16 v[48:63], v[172:175], v[228:231], v[48:63]
    buffer_load_dwordx4 v213, s[52:55], s57 offen lds
    s_add_u32 s57, s57, 147456
    s_waitcnt lgkmcnt(4)
    v_mfma_f32_32x32x16_bf16 v[0:15], v[160:163], v[232:235], v[0:15]
    ds_read_b64_tr_b16 v[172:173], v218 offset:30720
    ds_read_b64_tr_b16 v[174:175], v218 offset:30976
    v_mfma_f32_32x32x16_bf16 v[32:47], v[160:163], v[236:239], v[32:47]
    s_waitcnt lgkmcnt(4)
    v_mfma_f32_32x32x16_bf16 v[16:31], v[164:167], v[232:235], v[16:31]
    ds_read_b64_tr_b16 v[160:161], v218 offset:32768
    ds_read_b64_tr_b16 v[162:163], v218 offset:33024
    v_mfma_f32_32x32x16_bf16 v[48:63], v[164:167], v[236:239], v[48:63]
    s_waitcnt lgkmcnt(4)
    v_mfma_f32_32x32x16_bf16 v[0:15], v[168:171], v[240:243], v[0:15]
    ds_read_b64_tr_b16 v[164:165], v218 offset:34816
    ds_read_b64_tr_b16 v[166:167], v218 offset:35072
    v_mfma_f32_32x32x16_bf16 v[32:47], v[168:171], v[244:247], v[32:47]
    s_add_u32 m0, s56, 53248
    s_waitcnt lgkmcnt(4)
    v_mfma_f32_32x32x16_bf16 v[16:31], v[172:175], v[240:243], v[16:31]
    ds_read_b64_tr_b16 v[168:169], v218 offset:512
    ds_read_b64_tr_b16 v[170:171], v218 offset:768
    buffer_load_dwordx4 v213, s[52:55], s57 offen lds
    s_add_u32 s57, s57, 147456
    v_mfma_f32_32x32x16_bf16 v[48:63], v[172:175], v[244:247], v[48:63]
    s_waitcnt lgkmcnt(4)
    v_mfma_f32_32x32x16_bf16 v[0:15], v[160:163], v[248:251], v[0:15]
    ds_read_b64_tr_b16 v[172:173], v218 offset:2560
    ds_read_b64_tr_b16 v[174:175], v218 offset:2816
    v_mfma_f32_32x32x16_bf16 v[32:47], v[160:163], v[252:255], v[32:47]
    s_waitcnt lgkmcnt(4)
    v_mfma_f32_32x32x16_bf16 v[16:31], v[164:167], v[248:251], v[16:31]
    ds_read_b64_tr_b16 v[160:161], v218 offset:4608
    ds_read_b64_tr_b16 v[162:163], v218 offset:4864
    v_mfma_f32_32x32x16_bf16 v[48:63], v[164:167], v[252:255], v[48:63]
    s_waitcnt lgkmcnt(4)
    v_mfma_f32_32x32x16_bf16 v[64:79], v[168:171], a[216:219], v[64:79]
    ds_read_b64_tr_b16 v[164:165], v218 offset:6656
    ds_read_b64_tr_b16 v[166:167], v218 offset:6912
    s_add_u32 m0, s56, 57344
    v_mfma_f32_32x32x16_bf16 v[96:111], v[168:171], a[220:223], v[96:111]
    buffer_load_dwordx4 v213, s[52:55], s57 offen lds
    s_add_u32 s57, s57, 147456
    s_waitcnt lgkmcnt(4)
    v_mfma_f32_32x32x16_bf16 v[80:95], v[172:175], a[216:219], v[80:95]
    ds_read_b64_tr_b16 v[168:169], v218 offset:8704
    ds_read_b64_tr_b16 v[170:171], v218 offset:8960
    v_mfma_f32_32x32x16_bf16 v[112:127], v[172:175], a[220:223], v[112:127]
    v_mul_f32 v0, v0, v16
    v_mul_f32 v1, v1, v17
    s_waitcnt lgkmcnt(4)
    v_mfma_f32_32x32x16_bf16 v[64:79], v[160:163], a[224:227], v[64:79]
    ds_read_b64_tr_b16 v[172:173], v218 offset:10752
    ds_read_b64_tr_b16 v[174:175], v218 offset:11008
    v_mul_f32 v2, v2, v18
    v_mul_f32 v3, v3, v19
    v_mfma_f32_32x32x16_bf16 v[96:111], v[160:163], a[228:231], v[96:111]
    v_mul_f32 v4, v4, v20
    v_mul_f32 v5, v5, v21
    s_waitcnt lgkmcnt(4)
    v_mfma_f32_32x32x16_bf16 v[80:95], v[164:167], a[224:227], v[80:95]
    ds_read_b64_tr_b16 v[160:161], v218 offset:12800
    ds_read_b64_tr_b16 v[162:163], v218 offset:13056
    v_mul_f32 v6, v6, v22
    v_mfma_f32_32x32x16_bf16 v[112:127], v[164:167], a[228:231], v[112:127]
    s_add_u32 m0, s56, 61440
    v_mul_f32 v7, v7, v23
    v_mul_f32 v8, v8, v24
    s_waitcnt lgkmcnt(4)
    v_mfma_f32_32x32x16_bf16 v[64:79], v[168:171], a[232:235], v[64:79]
    ds_read_b64_tr_b16 v[164:165], v218 offset:14848
    ds_read_b64_tr_b16 v[166:167], v218 offset:15104
    buffer_load_dwordx4 v213, s[52:55], s57 offen lds
    s_add_u32 s57, s57, 147456
    v_mul_f32 v9, v9, v25
    v_mul_f32 v10, v10, v26
    v_mfma_f32_32x32x16_bf16 v[96:111], v[168:171], a[236:239], v[96:111]
    v_mul_f32 v11, v11, v27
    s_waitcnt lgkmcnt(4)
    v_mfma_f32_32x32x16_bf16 v[80:95], v[172:175], a[232:235], v[80:95]
    ds_read_b64_tr_b16 v[168:169], v218 offset:16896
    ds_read_b64_tr_b16 v[170:171], v218 offset:17152
    v_mul_f32 v12, v12, v28
    v_mul_f32 v13, v13, v29
    v_mfma_f32_32x32x16_bf16 v[112:127], v[172:175], a[236:239], v[112:127]
    v_mul_f32 v14, v14, v30
    v_mul_f32 v15, v15, v31
    s_waitcnt lgkmcnt(4)
    v_mfma_f32_32x32x16_bf16 v[64:79], v[160:163], a[240:243], v[64:79]
    ds_read_b64_tr_b16 v[172:173], v218 offset:18944
    ds_read_b64_tr_b16 v[174:175], v218 offset:19200
    v_cvt_pk_bf16_f32 v176, v0, v1
    v_mfma_f32_32x32x16_bf16 v[96:111], v[160:163], a[244:247], v[96:111]
    v_cvt_pk_bf16_f32 v177, v2, v3
    v_cvt_pk_bf16_f32 v178, v4, v5
    s_waitcnt lgkmcnt(4)
    v_mfma_f32_32x32x16_bf16 v[80:95], v[164:167], a[240:243], v[80:95]
    ds_read_b64_tr_b16 v[160:161], v218 offset:20992
    ds_read_b64_tr_b16 v[162:163], v218 offset:21248
    s_add_u32 m0, s56, 65536
    v_cvt_pk_bf16_f32 v179, v6, v7
    v_cvt_pk_bf16_f32 v180, v8, v9
    v_mfma_f32_32x32x16_bf16 v[112:127], v[164:167], a[244:247], v[112:127]
    buffer_load_dwordx4 v213, s[52:55], s57 offen lds
    s_add_u32 s57, s57, 147456
    v_cvt_pk_bf16_f32 v181, v10, v11
    s_waitcnt lgkmcnt(4)
    v_mfma_f32_32x32x16_bf16 v[64:79], v[168:171], a[248:251], v[64:79]
    ds_read_b64_tr_b16 v[164:165], v218 offset:23040
    ds_read_b64_tr_b16 v[166:167], v218 offset:23296
    v_cvt_pk_bf16_f32 v182, v12, v13
    v_cvt_pk_bf16_f32 v183, v14, v15
    v_mfma_f32_32x32x16_bf16 v[96:111], v[168:171], a[252:255], v[96:111]
    buffer_store_dwordx4 v[176:179], v210, s[24:27], s58 offen offset:0 sc1
    buffer_store_dwordx4 v[180:183], v210, s[24:27], s58 offen offset:1024 sc1
    s_waitcnt lgkmcnt(4)
    v_mfma_f32_32x32x16_bf16 v[80:95], v[172:175], a[248:251], v[80:95]
    ds_read_b64_tr_b16 v[168:169], v218 offset:25088
    ds_read_b64_tr_b16 v[170:171], v218 offset:25344
    v_mul_f32 v32, v32, v48
    v_mfma_f32_32x32x16_bf16 v[112:127], v[172:175], a[252:255], v[112:127]
    v_mul_f32 v33, v33, v49
    v_mul_f32 v34, v34, v50
    s_waitcnt lgkmcnt(4)
    v_mfma_f32_32x32x16_bf16 v[64:79], v[160:163], v[224:227], v[64:79]
    ds_read_b64_tr_b16 v[172:173], v218 offset:27136
    ds_read_b64_tr_b16 v[174:175], v218 offset:27392
    v_mul_f32 v35, v35, v51
    v_mul_f32 v36, v36, v52
    v_mfma_f32_32x32x16_bf16 v[96:111], v[160:163], v[228:231], v[96:111]
    s_add_u32 m0, s56, 69632
    v_mul_f32 v37, v37, v53
    v_mul_f32 v38, v38, v54
    s_waitcnt lgkmcnt(4)
    v_mfma_f32_32x32x16_bf16 v[80:95], v[164:167], v[224:227], v[80:95]
    ds_read_b64_tr_b16 v[160:161], v218 offset:29184
    ds_read_b64_tr_b16 v[162:163], v218 offset:29440
    buffer_load_dwordx4 v213, s[52:55], s57 offen lds
    s_add_u32 s57, s57, 147456
    v_mul_f32 v39, v39, v55
    v_mfma_f32_32x32x16_bf16 v[112:127], v[164:167], v[228:231], v[112:127]
    v_mul_f32 v40, v40, v56
    v_mul_f32 v41, v41, v57
    s_waitcnt lgkmcnt(4)
    v_mfma_f32_32x32x16_bf16 v[64:79], v[168:171], v[232:235], v[64:79]
    ds_read_b64_tr_b16 v[164:165], v218 offset:31232
    ds_read_b64_tr_b16 v[166:167], v218 offset:31488
    v_mul_f32 v42, v42, v58
    v_mul_f32 v43, v43, v59
    v_mfma_f32_32x32x16_bf16 v[96:111], v[168:171], v[236:239], v[96:111]
    v_mul_f32 v44, v44, v60
    s_waitcnt lgkmcnt(4)
    v_mfma_f32_32x32x16_bf16 v[80:95], v[172:175], v[232:235], v[80:95]
    ds_read_b64_tr_b16 v[168:169], v218 offset:33280
    ds_read_b64_tr_b16 v[170:171], v218 offset:33536
    v_mul_f32 v45, v45, v61
    v_mul_f32 v46, v46, v62
    v_mfma_f32_32x32x16_bf16 v[112:127], v[172:175], v[236:239], v[112:127]
    v_mul_f32 v47, v47, v63
    v_cvt_pk_bf16_f32 v184, v32, v33
    s_waitcnt lgkmcnt(4)
    v_mfma_f32_32x32x16_bf16 v[64:79], v[160:163], v[240:243], v[64:79]
    ds_read_b64_tr_b16 v[172:173], v218 offset:35328
    ds_read_b64_tr_b16 v[174:175], v218 offset:35584
    v_cvt_pk_bf16_f32 v185, v34, v35
    v_mfma_f32_32x32x16_bf16 v[96:111], v[160:163], v[244:247], v[96:111]
    v_cvt_pk_bf16_f32 v186, v36, v37
    v_cvt_pk_bf16_f32 v187, v38, v39
    s_waitcnt lgkmcnt(4)
    v_mfma_f32_32x32x16_bf16 v[80:95], v[164:167], v[240:243], v[80:95]
    ds_read_b64_tr_b16 v[160:161], v219 offset:0
    ds_read_b64_tr_b16 v[162:163], v219 offset:256
    v_cvt_pk_bf16_f32 v188, v40, v41
    v_cvt_pk_bf16_f32 v189, v42, v43
    v_mfma_f32_32x32x16_bf16 v[112:127], v[164:167], v[244:247], v[112:127]
    v_cvt_pk_bf16_f32 v190, v44, v45
    s_waitcnt lgkmcnt(4)
    v_mfma_f32_32x32x16_bf16 v[64:79], v[168:171], v[248:251], v[64:79]
    ds_read_b64_tr_b16 v[164:165], v219 offset:2048
    ds_read_b64_tr_b16 v[166:167], v219 offset:2304
    v_cvt_pk_bf16_f32 v191, v46, v47
    buffer_store_dwordx4 v[184:187], v210, s[24:27], s59 offen offset:0 sc1
    v_mfma_f32_32x32x16_bf16 v[96:111], v[168:171], v[252:255], v[96:111]
    buffer_store_dwordx4 v[188:191], v210, s[24:27], s59 offen offset:1024 sc1
    s_add_u32 s58, s58, 2048
    s_waitcnt lgkmcnt(4)
    v_mfma_f32_32x32x16_bf16 v[80:95], v[172:175], v[248:251], v[80:95]
    ds_read_b64_tr_b16 v[168:169], v219 offset:4096
    ds_read_b64_tr_b16 v[170:171], v219 offset:4352
    s_add_u32 s59, s59, 2048
    v_mfma_f32_32x32x16_bf16 v[112:127], v[172:175], v[252:255], v[112:127]
    s_waitcnt lgkmcnt(4)
    v_mfma_f32_32x32x16_bf16 v[0:15], v[160:163], a[0:3], 0
    s_waitcnt vmcnt(13)
    s_barrier
    ds_read_b64_tr_b16 v[172:173], v219 offset:6144
    ds_read_b64_tr_b16 v[174:175], v219 offset:6400
    v_mfma_f32_32x32x16_bf16 v[32:47], v[160:163], a[4:7], 0
    s_waitcnt lgkmcnt(4)
    v_mfma_f32_32x32x16_bf16 v[16:31], v[164:167], a[0:3], 0
    ds_read_b64_tr_b16 v[160:161], v219 offset:8192
    ds_read_b64_tr_b16 v[162:163], v219 offset:8448
    s_add_u32 m0, s56, 73728
    v_mfma_f32_32x32x16_bf16 v[48:63], v[164:167], a[4:7], 0
    buffer_load_dwordx4 v213, s[52:55], s57 offen lds
    s_add_u32 s57, s57, 147456
    v_mul_f32 v64, v64, v80
    v_mul_f32 v65, v65, v81
    s_waitcnt lgkmcnt(4)
    v_mfma_f32_32x32x16_bf16 v[0:15], v[168:171], a[8:11], v[0:15]
    ds_read_b64_tr_b16 v[164:165], v219 offset:10240
    ds_read_b64_tr_b16 v[166:167], v219 offset:10496
    v_mul_f32 v66, v66, v82
    v_mul_f32 v67, v67, v83
    v_mfma_f32_32x32x16_bf16 v[32:47], v[168:171], a[12:15], v[32:47]
    v_mul_f32 v68, v68, v84
    v_mul_f32 v69, v69, v85
    s_waitcnt lgkmcnt(4)
    v_mfma_f32_32x32x16_bf16 v[16:31], v[172:175], a[8:11], v[16:31]
    ds_read_b64_tr_b16 v[168:169], v219 offset:12288
    ds_read_b64_tr_b16 v[170:171], v219 offset:12544
    v_mul_f32 v70, v70, v86
    v_mfma_f32_32x32x16_bf16 v[48:63], v[172:175], a[12:15], v[48:63]
    v_mul_f32 v71, v71, v87
    v_mul_f32 v72, v72, v88
    s_waitcnt lgkmcnt(4)
    v_mfma_f32_32x32x16_bf16 v[0:15], v[160:163], a[16:19], v[0:15]
    ds_read_b64_tr_b16 v[172:173], v219 offset:14336
    ds_read_b64_tr_b16 v[174:175], v219 offset:14592
    s_add_u32 m0, s56, 77824
    v_mul_f32 v73, v73, v89
    v_mul_f32 v74, v74, v90
    v_mfma_f32_32x32x16_bf16 v[32:47], v[160:163], a[20:23], v[32:47]
    buffer_load_dwordx4 v213, s[52:55], s57 offen lds
    s_add_u32 s57, s57, 147456
    v_mul_f32 v75, v75, v91
    s_waitcnt lgkmcnt(4)
    v_mfma_f32_32x32x16_bf16 v[16:31], v[164:167], a[16:19], v[16:31]
    ds_read_b64_tr_b16 v[160:161], v219 offset:16384
    ds_read_b64_tr_b16 v[162:163], v219 offset:16640
    v_mul_f32 v76, v76, v92
    v_mul_f32 v77, v77, v93
    v_mfma_f32_32x32x16_bf16 v[48:63], v[164:167], a[20:23], v[48:63]
    v_mul_f32 v78, v78, v94
    v_mul_f32 v79, v79, v95
    s_waitcnt lgkmcnt(4)
    v_mfma_f32_32x32x16_bf16 v[0:15], v[168:171], a[24:27], v[0:15]
    ds_read_b64_tr_b16 v[164:165], v219 offset:18432
    ds_read_b64_tr_b16 v[166:167], v219 offset:18688
    v_cvt_pk_bf16_f32 v176, v64, v65
    v_mfma_f32_32x32x16_bf16 v[32:47], v[168:171], a[28:31], v[32:47]
    v_cvt_pk_bf16_f32 v177, v66, v67
    v_cvt_pk_bf16_f32 v178, v68, v69
    s_waitcnt lgkmcnt(4)
    v_mfma_f32_32x32x16_bf16 v[16:31], v[172:175], a[24:27], v[16:31]
    ds_read_b64_tr_b16 v[168:169], v219 offset:20480
    ds_read_b64_tr_b16 v[170:171], v219 offset:20736
    v_cvt_pk_bf16_f32 v179, v70, v71
    v_cvt_pk_bf16_f32 v180, v72, v73
    v_mfma_f32_32x32x16_bf16 v[48:63], v[172:175], a[28:31], v[48:63]
    s_add_u32 m0, s56, 81920
    v_cvt_pk_bf16_f32 v181, v74, v75
    s_waitcnt lgkmcnt(4)
    v_mfma_f32_32x32x16_bf16 v[0:15], v[160:163], a[32:35], v[0:15]
    ds_read_b64_tr_b16 v[172:173], v219 offset:22528
    ds_read_b64_tr_b16 v[174:175], v219 offset:22784
    buffer_load_dwordx4 v213, s[52:55], s57 offen lds
    s_add_u32 s57, s57, 147456
    v_cvt_pk_bf16_f32 v182, v76, v77
    v_cvt_pk_bf16_f32 v183, v78, v79
    v_mfma_f32_32x32x16_bf16 v[32:47], v[160:163], a[36:39], v[32:47]
    buffer_store_dwordx4 v[176:179], v210, s[24:27], s58 offen offset:0 sc1
    buffer_store_dwordx4 v[180:183], v210, s[24:27], s58 offen offset:1024 sc1
    s_waitcnt lgkmcnt(4)
    v_mfma_f32_32x32x16_bf16 v[16:31], v[164:167], a[32:35], v[16:31]
    ds_read_b64_tr_b16 v[160:161], v219 offset:24576
    ds_read_b64_tr_b16 v[162:163], v219 offset:24832
    v_mul_f32 v96, v96, v112
    v_mfma_f32_32x32x16_bf16 v[48:63], v[164:167], a[36:39], v[48:63]
    v_mul_f32 v97, v97, v113
    v_mul_f32 v98, v98, v114
    s_waitcnt lgkmcnt(4)
    v_mfma_f32_32x32x16_bf16 v[0:15], v[168:171], a[40:43], v[0:15]
    ds_read_b64_tr_b16 v[164:165], v219 offset:26624
    ds_read_b64_tr_b16 v[166:167], v219 offset:26880
    v_mul_f32 v99, v99, v115
    v_mul_f32 v100, v100, v116
    v_mfma_f32_32x32x16_bf16 v[32:47], v[168:171], a[44:47], v[32:47]
    v_mul_f32 v101, v101, v117
    v_mul_f32 v102, v102, v118
    s_waitcnt lgkmcnt(4)
    v_mfma_f32_32x32x16_bf16 v[16:31], v[172:175], a[40:43], v[16:31]
    ds_read_b64_tr_b16 v[168:169], v219 offset:28672
    ds_read_b64_tr_b16 v[170:171], v219 offset:28928
    s_add_u32 m0, s56, 86016
    v_mul_f32 v103, v103, v119
    v_mfma_f32_32x32x16_bf16 v[48:63], v[172:175], a[44:47], v[48:63]
    buffer_load_dwordx4 v213, s[52:55], s57 offen lds
    s_add_u32 s57, s57, 147456
    v_mul_f32 v104, v104, v120
    v_mul_f32 v105, v105, v121
    s_waitcnt lgkmcnt(4)
    v_mfma_f32_32x32x16_bf16 v[0:15], v[160:163], a[48:51], v[0:15]
    ds_read_b64_tr_b16 v[172:173], v219 offset:30720
    ds_read_b64_tr_b16 v[174:175], v219 offset:30976
    v_mul_f32 v106, v106, v122
    v_mul_f32 v107, v107, v123
    v_mfma_f32_32x32x16_bf16 v[32:47], v[160:163], a[52:55], v[32:47]
    v_mul_f32 v108, v108, v124
    s_waitcnt lgkmcnt(4)
    v_mfma_f32_32x32x16_bf16 v[16:31], v[164:167], a[48:51], v[16:31]
    ds_read_b64_tr_b16 v[160:161], v219 offset:32768
    ds_read_b64_tr_b16 v[162:163], v219 offset:33024
    v_mul_f32 v109, v109, v125
    v_mul_f32 v110, v110, v126
    v_mfma_f32_32x32x16_bf16 v[48:63], v[164:167], a[52:55], v[48:63]
    v_mul_f32 v111, v111, v127
    v_cvt_pk_bf16_f32 v184, v96, v97
    s_waitcnt lgkmcnt(4)
    v_mfma_f32_32x32x16_bf16 v[0:15], v[168:171], a[56:59], v[0:15]
    ds_read_b64_tr_b16 v[164:165], v219 offset:34816
    ds_read_b64_tr_b16 v[166:167], v219 offset:35072
    v_cvt_pk_bf16_f32 v185, v98, v99
    v_mfma_f32_32x32x16_bf16 v[32:47], v[168:171], a[60:63], v[32:47]
    s_add_u32 m0, s56, 90112
    v_cvt_pk_bf16_f32 v186, v100, v101
    v_cvt_pk_bf16_f32 v187, v102, v103
    s_waitcnt lgkmcnt(4)
    v_mfma_f32_32x32x16_bf16 v[16:31], v[172:175], a[56:59], v[16:31]
    ds_read_b64_tr_b16 v[168:169], v219 offset:512
    ds_read_b64_tr_b16 v[170:171], v219 offset:768
    buffer_load_dwordx4 v213, s[52:55], s57 offen lds
    s_add_u32 s57, s57, 147456
    v_cvt_pk_bf16_f32 v188, v104, v105
    v_cvt_pk_bf16_f32 v189, v106, v107
    v_mfma_f32_32x32x16_bf16 v[48:63], v[172:175], a[60:63], v[48:63]
    v_cvt_pk_bf16_f32 v190, v108, v109
    s_waitcnt lgkmcnt(4)
    v_mfma_f32_32x32x16_bf16 v[0:15], v[160:163], a[64:67], v[0:15]
    ds_read_b64_tr_b16 v[172:173], v219 offset:2560
    ds_read_b64_tr_b16 v[174:175], v219 offset:2816
    v_cvt_pk_bf16_f32 v191, v110, v111
    buffer_store_dwordx4 v[184:187], v210, s[24:27], s59 offen offset:0 sc1
    v_mfma_f32_32x32x16_bf16 v[32:47], v[160:163], a[68:71], v[32:47]
    buffer_store_dwordx4 v[188:191], v210, s[24:27], s59 offen offset:1024 sc1
    s_add_u32 s58, s58, 2048
    s_waitcnt lgkmcnt(4)
    v_mfma_f32_32x32x16_bf16 v[16:31], v[164:167], a[64:67], v[16:31]
    ds_read_b64_tr_b16 v[160:161], v219 offset:4608
    ds_read_b64_tr_b16 v[162:163], v219 offset:4864
    s_add_u32 s59, s59, 2048
    v_mfma_f32_32x32x16_bf16 v[48:63], v[164:167], a[68:71], v[48:63]
    s_waitcnt lgkmcnt(4)
    v_mfma_f32_32x32x16_bf16 v[64:79], v[168:171], a[0:3], 0
    ds_read_b64_tr_b16 v[164:165], v219 offset:6656
    ds_read_b64_tr_b16 v[166:167], v219 offset:6912
    s_add_u32 m0, s56, 94208
    v_mfma_f32_32x32x16_bf16 v[96:111], v[168:171], a[4:7], 0
    buffer_load_dwordx4 v213, s[52:55], s57 offen lds
    s_add_u32 s57, s57, 147456
    s_waitcnt lgkmcnt(4)
    v_mfma_f32_32x32x16_bf16 v[80:95], v[172:175], a[0:3], 0
    ds_read_b64_tr_b16 v[168:169], v219 offset:8704
    ds_read_b64_tr_b16 v[170:171], v219 offset:8960
    v_mfma_f32_32x32x16_bf16 v[112:127], v[172:175], a[4:7], 0
    s_waitcnt lgkmcnt(4)
    v_mfma_f32_32x32x16_bf16 v[64:79], v[160:163], a[8:11], v[64:79]
    ds_read_b64_tr_b16 v[172:173], v219 offset:10752
    ds_read_b64_tr_b16 v[174:175], v219 offset:11008
    v_mfma_f32_32x32x16_bf16 v[96:111], v[160:163], a[12:15], v[96:111]
    s_waitcnt lgkmcnt(4)
    v_mfma_f32_32x32x16_bf16 v[80:95], v[164:167], a[8:11], v[80:95]
    ds_read_b64_tr_b16 v[160:161], v219 offset:12800
    ds_read_b64_tr_b16 v[162:163], v219 offset:13056
    v_mfma_f32_32x32x16_bf16 v[112:127], v[164:167], a[12:15], v[112:127]
    s_add_u32 m0, s56, 98304
    s_waitcnt lgkmcnt(4)
    v_mfma_f32_32x32x16_bf16 v[64:79], v[168:171], a[16:19], v[64:79]
    ds_read_b64_tr_b16 v[164:165], v219 offset:14848
    ds_read_b64_tr_b16 v[166:167], v219 offset:15104
    buffer_load_dwordx4 v213, s[52:55], s57 offen lds
    s_add_u32 s57, s57, 147456
    v_mfma_f32_32x32x16_bf16 v[96:111], v[168:171], a[20:23], v[96:111]
    s_waitcnt lgkmcnt(4)
    v_mfma_f32_32x32x16_bf16 v[80:95], v[172:175], a[16:19], v[80:95]
    ds_read_b64_tr_b16 v[168:169], v219 offset:16896
    ds_read_b64_tr_b16 v[170:171], v219 offset:17152
    v_mfma_f32_32x32x16_bf16 v[112:127], v[172:175], a[20:23], v[112:127]
    s_waitcnt lgkmcnt(4)
    v_mfma_f32_32x32x16_bf16 v[64:79], v[160:163], a[24:27], v[64:79]
    ds_read_b64_tr_b16 v[172:173], v219 offset:18944
    ds_read_b64_tr_b16 v[174:175], v219 offset:19200
    v_mfma_f32_32x32x16_bf16 v[96:111], v[160:163], a[28:31], v[96:111]
    s_waitcnt lgkmcnt(4)
    v_mfma_f32_32x32x16_bf16 v[80:95], v[164:167], a[24:27], v[80:95]
    ds_read_b64_tr_b16 v[160:161], v219 offset:20992
    ds_read_b64_tr_b16 v[162:163], v219 offset:21248
    s_add_u32 m0, s56, 102400
    v_mfma_f32_32x32x16_bf16 v[112:127], v[164:167], a[28:31], v[112:127]
    buffer_load_dwordx4 v213, s[52:55], s57 offen lds
    s_add_u32 s57, s57, 147456
    s_waitcnt lgkmcnt(4)
    v_mfma_f32_32x32x16_bf16 v[64:79], v[168:171], a[32:35], v[64:79]
    ds_read_b64_tr_b16 v[164:165], v219 offset:23040
    ds_read_b64_tr_b16 v[166:167], v219 offset:23296
    v_mfma_f32_32x32x16_bf16 v[96:111], v[168:171], a[36:39], v[96:111]
    s_waitcnt lgkmcnt(4)
    v_mfma_f32_32x32x16_bf16 v[80:95], v[172:175], a[32:35], v[80:95]
    ds_read_b64_tr_b16 v[168:169], v219 offset:25088
    ds_read_b64_tr_b16 v[170:171], v219 offset:25344
    v_mfma_f32_32x32x16_bf16 v[112:127], v[172:175], a[36:39], v[112:127]
    s_waitcnt lgkmcnt(4)
    v_mfma_f32_32x32x16_bf16 v[64:79], v[160:163], a[40:43], v[64:79]
    ds_read_b64_tr_b16 v[172:173], v219 offset:27136
    ds_read_b64_tr_b16 v[174:175], v219 offset:27392
    v_mfma_f32_32x32x16_bf16 v[96:111], v[160:163], a[44:47], v[96:111]
    s_add_u32 m0, s56, 106496
    s_waitcnt lgkmcnt(4)
    v_mfma_f32_32x32x16_bf16 v[80:95], v[164:167], a[40:43], v[80:95]
    ds_read_b64_tr_b16 v[160:161], v219 offset:29184
    ds_read_b64_tr_b16 v[162:163], v219 offset:29440
    buffer_load_dwordx4 v213, s[52:55], s57 offen lds
    s_add_u32 s57, s57, 147456
    v_mfma_f32_32x32x16_bf16 v[112:127], v[164:167], a[44:47], v[112:127]
    s_waitcnt lgkmcnt(4)
    v_mfma_f32_32x32x16_bf16 v[64:79], v[168:171], a[48:51], v[64:79]
    ds_read_b64_tr_b16 v[164:165], v219 offset:31232
    ds_read_b64_tr_b16 v[166:167], v219 offset:31488
    v_mfma_f32_32x32x16_bf16 v[96:111], v[168:171], a[52:55], v[96:111]
    s_waitcnt lgkmcnt(4)
    v_mfma_f32_32x32x16_bf16 v[80:95], v[172:175], a[48:51], v[80:95]
    ds_read_b64_tr_b16 v[168:169], v219 offset:33280
    ds_read_b64_tr_b16 v[170:171], v219 offset:33536
    v_mfma_f32_32x32x16_bf16 v[112:127], v[172:175], a[52:55], v[112:127]
    s_waitcnt lgkmcnt(4)
    v_mfma_f32_32x32x16_bf16 v[64:79], v[160:163], a[56:59], v[64:79]
    ds_read_b64_tr_b16 v[172:173], v219 offset:35328
    ds_read_b64_tr_b16 v[174:175], v219 offset:35584
    v_mfma_f32_32x32x16_bf16 v[96:111], v[160:163], a[60:63], v[96:111]
    s_waitcnt lgkmcnt(4)
    v_mfma_f32_32x32x16_bf16 v[80:95], v[164:167], a[56:59], v[80:95]
    ds_read_b64_tr_b16 v[160:161], v216 offset:0
    ds_read_b64_tr_b16 v[162:163], v216 offset:256
    v_mfma_f32_32x32x16_bf16 v[112:127], v[164:167], a[60:63], v[112:127]
    s_waitcnt lgkmcnt(4)
    v_mfma_f32_32x32x16_bf16 v[64:79], v[168:171], a[64:67], v[64:79]
    ds_read_b64_tr_b16 v[164:165], v216 offset:2048
    ds_read_b64_tr_b16 v[166:167], v216 offset:2304
    v_mfma_f32_32x32x16_bf16 v[96:111], v[168:171], a[68:71], v[96:111]
    s_waitcnt lgkmcnt(4)
    v_mfma_f32_32x32x16_bf16 v[80:95], v[172:175], a[64:67], v[80:95]
    ds_read_b64_tr_b16 v[168:169], v216 offset:4096
    ds_read_b64_tr_b16 v[170:171], v216 offset:4352
    v_mfma_f32_32x32x16_bf16 v[112:127], v[172:175], a[68:71], v[112:127]
    s_waitcnt lgkmcnt(4)
    v_mfma_f32_32x32x16_bf16 v[0:15], v[160:163], a[72:75], v[0:15]
    s_waitcnt vmcnt(15)
    s_barrier
    ds_read_b64_tr_b16 v[172:173], v216 offset:6144
    ds_read_b64_tr_b16 v[174:175], v216 offset:6400
    v_mfma_f32_32x32x16_bf16 v[32:47], v[160:163], a[76:79], v[32:47]
    s_waitcnt lgkmcnt(4)
    v_mfma_f32_32x32x16_bf16 v[16:31], v[164:167], a[72:75], v[16:31]
    ds_read_b64_tr_b16 v[160:161], v216 offset:8192
    ds_read_b64_tr_b16 v[162:163], v216 offset:8448
    v_mfma_f32_32x32x16_bf16 v[48:63], v[164:167], a[76:79], v[48:63]
    s_waitcnt lgkmcnt(4)
    v_mfma_f32_32x32x16_bf16 v[0:15], v[168:171], a[80:83], v[0:15]
    ds_read_b64_tr_b16 v[164:165], v216 offset:10240
    ds_read_b64_tr_b16 v[166:167], v216 offset:10496
    s_and_b32 s60, s2, 7
    v_mfma_f32_32x32x16_bf16 v[32:47], v[168:171], a[84:87], v[32:47]
    s_lshl_b32 s60, s60, 2
    s_waitcnt lgkmcnt(4)
    v_mfma_f32_32x32x16_bf16 v[16:31], v[172:175], a[80:83], v[16:31]
    ds_read_b64_tr_b16 v[168:169], v216 offset:12288
    ds_read_b64_tr_b16 v[170:171], v216 offset:12544
    s_add_u32 s60, s60, s31
    v_mfma_f32_32x32x16_bf16 v[48:63], v[172:175], a[84:87], v[48:63]
    s_lshr_b32 s61, s2, 5
    s_waitcnt lgkmcnt(4)
    v_mfma_f32_32x32x16_bf16 v[0:15], v[160:163], a[88:91], v[0:15]
    ds_read_b64_tr_b16 v[172:173], v216 offset:14336
    ds_read_b64_tr_b16 v[174:175], v216 offset:14592
    s_and_b32 s62, s60, 3
    v_mfma_f32_32x32x16_bf16 v[32:47], v[160:163], a[92:95], v[32:47]
    s_mul_i32 s34, s60, 18
    s_waitcnt lgkmcnt(4)
    v_mfma_f32_32x32x16_bf16 v[16:31], v[164:167], a[88:91], v[16:31]
    ds_read_b64_tr_b16 v[160:161], v216 offset:16384
    ds_read_b64_tr_b16 v[162:163], v216 offset:16640
    s_lshr_b32 s34, s34, 3
    v_mfma_f32_32x32x16_bf16 v[48:63], v[164:167], a[92:95], v[48:63]
    s_lshl_b32 s34, s34, 15
    s_waitcnt lgkmcnt(4)
    v_mfma_f32_32x32x16_bf16 v[0:15], v[168:171], a[96:99], v[0:15]
    ds_read_b64_tr_b16 v[164:165], v216 offset:18432
    ds_read_b64_tr_b16 v[166:167], v216 offset:18688
    s_add_u32 s43, s34, 4718592
    v_mfma_f32_32x32x16_bf16 v[32:47], v[168:171], a[100:103], v[32:47]
    s_add_u32 s42, s34, 2359296
    s_waitcnt lgkmcnt(4)
    v_mfma_f32_32x32x16_bf16 v[16:31], v[172:175], a[96:99], v[16:31]
    ds_read_b64_tr_b16 v[168:169], v216 offset:20480
    ds_read_b64_tr_b16 v[170:171], v216 offset:20736
    s_lshl_b32 s35, s61, 12
    v_mfma_f32_32x32x16_bf16 v[48:63], v[172:175], a[100:103], v[48:63]
    s_add_u32 s42, s42, s35
    s_waitcnt lgkmcnt(4)
    v_mfma_f32_32x32x16_bf16 v[0:15], v[160:163], a[104:107], v[0:15]
    ds_read_b64_tr_b16 v[172:173], v216 offset:22528
    ds_read_b64_tr_b16 v[174:175], v216 offset:22784
    v_mfma_f32_32x32x16_bf16 v[32:47], v[160:163], a[108:111], v[32:47]
    s_lshl_b32 s35, s28, 10
    s_waitcnt lgkmcnt(4)
    v_mfma_f32_32x32x16_bf16 v[16:31], v[164:167], a[104:107], v[16:31]
    ds_read_b64_tr_b16 v[160:161], v216 offset:24576
    ds_read_b64_tr_b16 v[162:163], v216 offset:24832
    s_add_u32 s42, s42, s35
    v_mfma_f32_32x32x16_bf16 v[48:63], v[164:167], a[108:111], v[48:63]
    s_add_u32 s63, s43, s35
    s_waitcnt lgkmcnt(4)
    v_mfma_f32_32x32x16_bf16 v[0:15], v[168:171], a[112:115], v[0:15]
    ds_read_b64_tr_b16 v[164:165], v216 offset:26624
    ds_read_b64_tr_b16 v[166:167], v216 offset:26880
    s_add_u32 s64, s63, 32768
    v_mfma_f32_32x32x16_bf16 v[32:47], v[168:171], a[116:119], v[32:47]
    s_add_u32 s65, s63, 65536
    s_waitcnt lgkmcnt(4)
    v_mfma_f32_32x32x16_bf16 v[16:31], v[172:175], a[112:115], v[16:31]
    ds_read_b64_tr_b16 v[168:169], v216 offset:28672
    ds_read_b64_tr_b16 v[170:171], v216 offset:28928
    s_mov_b32 s69, s35
    v_mfma_f32_32x32x16_bf16 v[48:63], v[172:175], a[116:119], v[48:63]
    s_add_u32 s70, s35, 4096
    s_waitcnt lgkmcnt(4)
    v_mfma_f32_32x32x16_bf16 v[0:15], v[160:163], a[120:123], v[0:15]
    ds_read_b64_tr_b16 v[172:173], v216 offset:30720
    ds_read_b64_tr_b16 v[174:175], v216 offset:30976
    s_add_u32 s71, s35, 8192
    v_mfma_f32_32x32x16_bf16 v[32:47], v[160:163], a[124:127], v[32:47]
    s_mul_i32 s44, s60, 77824
    s_waitcnt lgkmcnt(4)
    v_mfma_f32_32x32x16_bf16 v[16:31], v[164:167], a[120:123], v[16:31]
    ds_read_b64_tr_b16 v[160:161], v216 offset:32768
    ds_read_b64_tr_b16 v[162:163], v216 offset:33024
    s_add_u32 s44, s44, 7081984
    v_mfma_f32_32x32x16_bf16 v[48:63], v[164:167], a[124:127], v[48:63]
    s_add_u32 s35, s28, 0
    s_waitcnt lgkmcnt(4)
    v_mfma_f32_32x32x16_bf16 v[0:15], v[168:171], a[128:131], v[0:15]
    ds_read_b64_tr_b16 v[164:165], v216 offset:34816
    ds_read_b64_tr_b16 v[166:167], v216 offset:35072
    s_min_u32 s35, s35, 9
    v_mfma_f32_32x32x16_bf16 v[32:47], v[168:171], a[132:135], v[32:47]
    s_waitcnt lgkmcnt(4)
    v_mfma_f32_32x32x16_bf16 v[16:31], v[172:175], a[128:131], v[16:31]
    ds_read_b64_tr_b16 v[168:169], v216 offset:512
    ds_read_b64_tr_b16 v[170:171], v216 offset:768
    s_lshl_b32 s35, s35, 10
    v_mfma_f32_32x32x16_bf16 v[48:63], v[172:175], a[132:135], v[48:63]
    s_add_u32 s66, s44, s35
    s_waitcnt lgkmcnt(4)
    v_mfma_f32_32x32x16_bf16 v[0:15], v[160:163], a[136:139], v[0:15]
    ds_read_b64_tr_b16 v[172:173], v216 offset:2560
    ds_read_b64_tr_b16 v[174:175], v216 offset:2816
    s_add_u32 s72, s35, 12288
    v_mfma_f32_32x32x16_bf16 v[32:47], v[160:163], a[140:143], v[32:47]
    s_add_u32 s35, s28, 4
    s_waitcnt lgkmcnt(4)
    v_mfma_f32_32x32x16_bf16 v[16:31], v[164:167], a[136:139], v[16:31]
    ds_read_b64_tr_b16 v[160:161], v216 offset:4608
    ds_read_b64_tr_b16 v[162:163], v216 offset:4864
    s_min_u32 s35, s35, 9
    v_mfma_f32_32x32x16_bf16 v[48:63], v[164:167], a[140:143], v[48:63]
    s_lshl_b32 s35, s35, 10
    s_waitcnt lgkmcnt(4)
    v_mfma_f32_32x32x16_bf16 v[64:79], v[168:171], a[72:75], v[64:79]
    ds_read_b64_tr_b16 v[164:165], v216 offset:6656
    ds_read_b64_tr_b16 v[166:167], v216 offset:6912
    s_add_u32 s67, s44, s35
    v_mfma_f32_32x32x16_bf16 v[96:111], v[168:171], a[76:79], v[96:111]
    s_add_u32 s73, s35, 12288
    s_waitcnt lgkmcnt(4)
    v_mfma_f32_32x32x16_bf16 v[80:95], v[172:175], a[72:75], v[80:95]
    ds_read_b64_tr_b16 v[168:169], v216 offset:8704
    ds_read_b64_tr_b16 v[170:171], v216 offset:8960
    s_add_u32 s35, s28, 8
    v_mfma_f32_32x32x16_bf16 v[112:127], v[172:175], a[76:79], v[112:127]
    s_min_u32 s35, s35, 9
    s_waitcnt lgkmcnt(4)
    v_mfma_f32_32x32x16_bf16 v[64:79], v[160:163], a[80:83], v[64:79]
    ds_read_b64_tr_b16 v[172:173], v216 offset:10752
    ds_read_b64_tr_b16 v[174:175], v216 offset:11008
    s_lshl_b32 s35, s35, 10
    v_mfma_f32_32x32x16_bf16 v[96:111], v[160:163], a[84:87], v[96:111]
    s_add_u32 s68, s44, s35
    s_waitcnt lgkmcnt(4)
    v_mfma_f32_32x32x16_bf16 v[80:95], v[164:167], a[80:83], v[80:95]
    ds_read_b64_tr_b16 v[160:161], v216 offset:12800
    ds_read_b64_tr_b16 v[162:163], v216 offset:13056
    v_mfma_f32_32x32x16_bf16 v[112:127], v[164:167], a[84:87], v[112:127]
    s_add_u32 s74, s35, 12288
    s_waitcnt lgkmcnt(4)
    v_mfma_f32_32x32x16_bf16 v[64:79], v[168:171], a[88:91], v[64:79]
    ds_read_b64_tr_b16 v[164:165], v216 offset:14848
    ds_read_b64_tr_b16 v[166:167], v216 offset:15104
    s_mov_b32 s75, 0
    v_mfma_f32_32x32x16_bf16 v[96:111], v[168:171], a[92:95], v[96:111]
    s_mov_b32 s80, -1
    s_waitcnt lgkmcnt(4)
    v_mfma_f32_32x32x16_bf16 v[80:95], v[172:175], a[88:91], v[80:95]
    ds_read_b64_tr_b16 v[168:169], v216 offset:16896
    ds_read_b64_tr_b16 v[170:171], v216 offset:17152
    s_mov_b32 s81, 0
    v_mfma_f32_32x32x16_bf16 v[112:127], v[172:175], a[92:95], v[112:127]
    s_mov_b32 s82, 0
    s_waitcnt lgkmcnt(4)
    v_mfma_f32_32x32x16_bf16 v[64:79], v[160:163], a[96:99], v[64:79]
    ds_read_b64_tr_b16 v[172:173], v216 offset:18944
    ds_read_b64_tr_b16 v[174:175], v216 offset:19200
    s_mov_b32 s83, -1
    v_mfma_f32_32x32x16_bf16 v[96:111], v[160:163], a[100:103], v[96:111]
    s_lshl_b32 s35, s28, 13
    s_waitcnt lgkmcnt(4)
    v_mfma_f32_32x32x16_bf16 v[80:95], v[164:167], a[96:99], v[80:95]
    ds_read_b64_tr_b16 v[160:161], v216 offset:20992
    ds_read_b64_tr_b16 v[162:163], v216 offset:21248
    s_add_u32 s35, s35, 49815552
    v_mfma_f32_32x32x16_bf16 v[112:127], v[164:167], a[100:103], v[112:127]
    s_mov_b32 s47, s35
    s_waitcnt lgkmcnt(4)
    v_mfma_f32_32x32x16_bf16 v[64:79], v[168:171], a[104:107], v[64:79]
    ds_read_b64_tr_b16 v[164:165], v216 offset:23040
    ds_read_b64_tr_b16 v[166:167], v216 offset:23296
    v_lshlrev_b32 v149, 7, v208
    v_mfma_f32_32x32x16_bf16 v[96:111], v[168:171], a[108:111], v[96:111]
    buffer_load_dwordx2 v[144:145], v149, s[24:27], s47 offen sc1
    s_waitcnt lgkmcnt(4)
    v_mfma_f32_32x32x16_bf16 v[80:95], v[172:175], a[104:107], v[80:95]
    ds_read_b64_tr_b16 v[168:169], v216 offset:25088
    ds_read_b64_tr_b16 v[170:171], v216 offset:25344
    v_and_b32 v150, 31, v208
    v_mfma_f32_32x32x16_bf16 v[112:127], v[172:175], a[108:111], v[112:127]
    s_waitcnt lgkmcnt(4)
    v_mfma_f32_32x32x16_bf16 v[64:79], v[160:163], a[112:115], v[64:79]
    ds_read_b64_tr_b16 v[172:173], v216 offset:27136
    ds_read_b64_tr_b16 v[174:175], v216 offset:27392
    v_lshlrev_b32 v146, 4, v150
    v_mfma_f32_32x32x16_bf16 v[96:111], v[160:163], a[116:119], v[96:111]
    v_lshrrev_b32 v151, 5, v208
    s_waitcnt lgkmcnt(4)
    v_mfma_f32_32x32x16_bf16 v[80:95], v[164:167], a[112:115], v[80:95]
    ds_read_b64_tr_b16 v[160:161], v216 offset:29184
    ds_read_b64_tr_b16 v[162:163], v216 offset:29440
    v_lshlrev_b32 v152, 12, v151
    v_mfma_f32_32x32x16_bf16 v[112:127], v[164:167], a[116:119], v[112:127]
    v_add_u32 v147, v146, v152
    s_waitcnt lgkmcnt(4)
    v_mfma_f32_32x32x16_bf16 v[64:79], v[168:171], a[120:123], v[64:79]
    ds_read_b64_tr_b16 v[164:165], v216 offset:31232
    ds_read_b64_tr_b16 v[166:167], v216 offset:31488
    v_min_u32 v152, 18, v150
    v_mfma_f32_32x32x16_bf16 v[96:111], v[168:171], a[124:127], v[96:111]
    v_add_u32 v153, -20, v150
    s_waitcnt lgkmcnt(4)
    v_mfma_f32_32x32x16_bf16 v[80:95], v[172:175], a[120:123], v[80:95]
    ds_read_b64_tr_b16 v[168:169], v216 offset:33280
    ds_read_b64_tr_b16 v[170:171], v216 offset:33536
    v_cmp_gt_u32 vcc, 8, v153
    v_mfma_f32_32x32x16_bf16 v[112:127], v[172:175], a[124:127], v[112:127]
    s_nop 0
    v_cndmask_b32 v152, v152, 0, vcc
    s_waitcnt lgkmcnt(4)
    v_mfma_f32_32x32x16_bf16 v[64:79], v[160:163], a[128:131], v[64:79]
    ds_read_b64_tr_b16 v[172:173], v216 offset:35328
    ds_read_b64_tr_b16 v[174:175], v216 offset:35584
    v_lshlrev_b32 v152, 4, v152
    v_mfma_f32_32x32x16_bf16 v[96:111], v[160:163], a[132:135], v[96:111]
    v_mul_u32_u24 v153, 304, v151
    s_waitcnt lgkmcnt(4)
    v_mfma_f32_32x32x16_bf16 v[80:95], v[164:167], a[128:131], v[80:95]
    ds_read_b64_tr_b16 v[160:161], v217 offset:0
    ds_read_b64_tr_b16 v[162:163], v217 offset:256
    v_add_u32 v148, v152, v153
    v_mfma_f32_32x32x16_bf16 v[112:127], v[164:167], a[132:135], v[112:127]
    s_waitcnt lgkmcnt(4)
    v_mfma_f32_32x32x16_bf16 v[64:79], v[168:171], a[136:139], v[64:79]
    ds_read_b64_tr_b16 v[164:165], v217 offset:2048
    ds_read_b64_tr_b16 v[166:167], v217 offset:2304
    v_mfma_f32_32x32x16_bf16 v[96:111], v[168:171], a[140:143], v[96:111]
    s_waitcnt lgkmcnt(4)
    v_mfma_f32_32x32x16_bf16 v[80:95], v[172:175], a[136:139], v[80:95]
    ds_read_b64_tr_b16 v[168:169], v217 offset:4096
    ds_read_b64_tr_b16 v[170:171], v217 offset:4352
    v_mfma_f32_32x32x16_bf16 v[112:127], v[172:175], a[140:143], v[112:127]
    s_waitcnt vmcnt(0)
    v_cmp_ne_u64 vcc, s[32:33], v[144:145]
    s_cbranch_vccz L_f1ok
    s_mov_b32 s36, 0
L_poll_3:
    buffer_load_dwordx2 v[144:145], v149, s[24:27], s47 offen sc1
    s_waitcnt vmcnt(0)
    v_cmp_ne_u64 vcc, s[32:33], v[144:145]
    s_add_u32 s36, s36, 1
    s_cbranch_vccz L_polld_4
    s_cmp_lt_u32 s36, 0x20000
    s_cbranch_scc1 L_poll_3
L_polld_4:
L_f1ok:
    s_waitcnt lgkmcnt(4)
    v_mfma_f32_32x32x16_bf16 v[0:15], v[160:163], a[144:147], v[0:15]
    s_barrier
    ds_read_b64_tr_b16 v[172:173], v217 offset:6144
    ds_read_b64_tr_b16 v[174:175], v217 offset:6400
    v_mfma_f32_32x32x16_bf16 v[32:47], v[160:163], a[148:151], v[32:47]
    s_waitcnt lgkmcnt(4)
    v_mfma_f32_32x32x16_bf16 v[16:31], v[164:167], a[144:147], v[16:31]
    ds_read_b64_tr_b16 v[160:161], v217 offset:8192
    ds_read_b64_tr_b16 v[162:163], v217 offset:8448
    buffer_load_dwordx4 v[128:131], v215, s[24:27], s42 offen offset:0 sc1
    v_mfma_f32_32x32x16_bf16 v[48:63], v[164:167], a[148:151], v[48:63]
    s_waitcnt lgkmcnt(4)
    v_mfma_f32_32x32x16_bf16 v[0:15], v[168:171], a[152:155], v[0:15]
    ds_read_b64_tr_b16 v[164:165], v217 offset:10240
    ds_read_b64_tr_b16 v[166:167], v217 offset:10496
    buffer_load_dwordx4 v[136:139], v215, s[24:27], s42 offen offset:512 sc1
    v_mfma_f32_32x32x16_bf16 v[32:47], v[168:171], a[156:159], v[32:47]
    s_waitcnt lgkmcnt(4)
    v_mfma_f32_32x32x16_bf16 v[16:31], v[172:175], a[152:155], v[16:31]
    ds_read_b64_tr_b16 v[168:169], v217 offset:12288
    ds_read_b64_tr_b16 v[170:171], v217 offset:12544
    s_add_u32 s42, s42, 65536
    v_mfma_f32_32x32x16_bf16 v[48:63], v[172:175], a[156:159], v[48:63]
    s_waitcnt lgkmcnt(4)
    v_mfma_f32_32x32x16_bf16 v[0:15], v[160:163], a[160:163], v[0:15]
    ds_read_b64_tr_b16 v[172:173], v217 offset:14336
    ds_read_b64_tr_b16 v[174:175], v217 offset:14592
    buffer_load_dwordx4 v[132:135], v146, s[24:27], s42 offen offset:0 sc1
    v_mfma_f32_32x32x16_bf16 v[32:47], v[160:163], a[164:167], v[32:47]
    s_waitcnt lgkmcnt(4)
    v_mfma_f32_32x32x16_bf16 v[16:31], v[164:167], a[160:163], v[16:31]
    ds_read_b64_tr_b16 v[160:161], v217 offset:16384
    ds_read_b64_tr_b16 v[162:163], v217 offset:16640
    buffer_load_dwordx4 v[140:143], v146, s[24:27], s42 offen offset:512 sc1
    v_mfma_f32_32x32x16_bf16 v[48:63], v[164:167], a[164:167], v[48:63]
    s_waitcnt lgkmcnt(4)
    v_mfma_f32_32x32x16_bf16 v[0:15], v[168:171], a[168:171], v[0:15]
    ds_read_b64_tr_b16 v[164:165], v217 offset:18432
    ds_read_b64_tr_b16 v[166:167], v217 offset:18688
    s_add_u32 m0, s75, s69
    s_nop 0
    buffer_load_dwordx4 v210, s[24:27], s63 offen sc1 lds
    s_add_u32 s63, s63, 4096
    v_mfma_f32_32x32x16_bf16 v[32:47], v[168:171], a[172:175], v[32:47]
    s_waitcnt lgkmcnt(4)
    v_mfma_f32_32x32x16_bf16 v[16:31], v[172:175], a[168:171], v[16:31]
    ds_read_b64_tr_b16 v[168:169], v217 offset:20480
    ds_read_b64_tr_b16 v[170:171], v217 offset:20736
    v_mfma_f32_32x32x16_bf16 v[48:63], v[172:175], a[172:175], v[48:63]
    s_waitcnt lgkmcnt(4)
    v_mfma_f32_32x32x16_bf16 v[0:15], v[160:163], a[176:179], v[0:15]
    ds_read_b64_tr_b16 v[172:173], v217 offset:22528
    ds_read_b64_tr_b16 v[174:175], v217 offset:22784
    s_add_u32 m0, s75, s70
    s_nop 0
    buffer_load_dwordx4 v210, s[24:27], s64 offen sc1 lds
    s_add_u32 s64, s64, 4096
    v_mfma_f32_32x32x16_bf16 v[32:47], v[160:163], a[180:183], v[32:47]
    s_waitcnt lgkmcnt(4)
    v_mfma_f32_32x32x16_bf16 v[16:31], v[164:167], a[176:179], v[16:31]
    ds_read_b64_tr_b16 v[160:161], v217 offset:24576
    ds_read_b64_tr_b16 v[162:163], v217 offset:24832
    v_mfma_f32_32x32x16_bf16 v[48:63], v[164:167], a[180:183], v[48:63]
    s_waitcnt lgkmcnt(4)
    v_mfma_f32_32x32x16_bf16 v[0:15], v[168:171], a[184:187], v[0:15]
    ds_read_b64_tr_b16 v[164:165], v217 offset:26624
    ds_read_b64_tr_b16 v[166:167], v217 offset:26880
    v_mfma_f32_32x32x16_bf16 v[32:47], v[168:171], a[188:191], v[32:47]
    s_add_u32 m0, s75, s71
    s_nop 0
    buffer_load_dwordx4 v210, s[24:27], s65 offen sc1 lds
    s_add_u32 s65, s65, 4096
    s_waitcnt lgkmcnt(4)
    v_mfma_f32_32x32x16_bf16 v[16:31], v[172:175], a[184:187], v[16:31]
    ds_read_b64_tr_b16 v[168:169], v217 offset:28672
    ds_read_b64_tr_b16 v[170:171], v217 offset:28928
    v_mfma_f32_32x32x16_bf16 v[48:63], v[172:175], a[188:191], v[48:63]
    s_waitcnt lgkmcnt(4)
    v_mfma_f32_32x32x16_bf16 v[0:15], v[160:163], a[192:195], v[0:15]
    ds_read_b64_tr_b16 v[172:173], v217 offset:30720
    ds_read_b64_tr_b16 v[174:175], v217 offset:30976
    v_mfma_f32_32x32x16_bf16 v[32:47], v[160:163], a[196:199], v[32:47]
    s_add_u32 m0, s75, s72
    s_nop 0
    buffer_load_dwordx4 v210, s[24:27], s66 offen sc1 lds
    s_add_u32 s66, s66, 9728
    s_waitcnt lgkmcnt(4)
    v_mfma_f32_32x32x16_bf16 v[16:31], v[164:167], a[192:195], v[16:31]
    ds_read_b64_tr_b16 v[160:161], v217 offset:32768
    ds_read_b64_tr_b16 v[162:163], v217 offset:33024
    v_mfma_f32_32x32x16_bf16 v[48:63], v[164:167], a[196:199], v[48:63]
    s_waitcnt lgkmcnt(4)
    v_mfma_f32_32x32x16_bf16 v[0:15], v[168:171], a[200:203], v[0:15]
    ds_read_b64_tr_b16 v[164:165], v217 offset:34816
    ds_read_b64_tr_b16 v[166:167], v217 offset:35072
    v_mfma_f32_32x32x16_bf16 v[32:47], v[168:171], a[204:207], v[32:47]
    s_waitcnt lgkmcnt(4)
    v_mfma_f32_32x32x16_bf16 v[16:31], v[172:175], a[200:203], v[16:31]
    ds_read_b64_tr_b16 v[168:169], v217 offset:512
    ds_read_b64_tr_b16 v[170:171], v217 offset:768
    s_add_u32 m0, s75, s73
    s_nop 0
    buffer_load_dwordx4 v210, s[24:27], s67 offen sc1 lds
    s_add_u32 s67, s67, 9728
    v_mfma_f32_32x32x16_bf16 v[48:63], v[172:175], a[204:207], v[48:63]
    s_waitcnt lgkmcnt(4)
    v_mfma_f32_32x32x16_bf16 v[0:15], v[160:163], a[208:211], v[0:15]
    ds_read_b64_tr_b16 v[172:173], v217 offset:2560
    ds_read_b64_tr_b16 v[174:175], v217 offset:2816
    v_mfma_f32_32x32x16_bf16 v[32:47], v[160:163], a[212:215], v[32:47]
    s_waitcnt lgkmcnt(4)
    v_mfma_f32_32x32x16_bf16 v[16:31], v[164:167], a[208:211], v[16:31]
    ds_read_b64_tr_b16 v[160:161], v217 offset:4608
    ds_read_b64_tr_b16 v[162:163], v217 offset:4864
    s_add_u32 m0, s75, s74
    s_nop 0
    buffer_load_dwordx4 v210, s[24:27], s68 offen sc1 lds
    s_add_u32 s68, s68, 9728
    s_sub_u32 s75, s75, 36864
    s_cselect_b32 s75, 110592, s75
    v_mfma_f32_32x32x16_bf16 v[48:63], v[164:167], a[212:215], v[48:63]
    s_waitcnt lgkmcnt(4)
    v_mfma_f32_32x32x16_bf16 v[64:79], v[168:171], a[144:147], v[64:79]
    ds_read_b64_tr_b16 v[164:165], v217 offset:6656
    ds_read_b64_tr_b16 v[166:167], v217 offset:6912
    v_mfma_f32_32x32x16_bf16 v[96:111], v[168:171], a[148:151], v[96:111]
    s_waitcnt lgkmcnt(4)
    v_mfma_f32_32x32x16_bf16 v[80:95], v[172:175], a[144:147], v[80:95]
    ds_read_b64_tr_b16 v[168:169], v217 offset:8704
    ds_read_b64_tr_b16 v[170:171], v217 offset:8960
    v_mfma_f32_32x32x16_bf16 v[112:127], v[172:175], a[148:151], v[112:127]
    s_add_u32 m0, s75, s69
    s_nop 0
    buffer_load_dwordx4 v210, s[24:27], s63 offen sc1 lds
    s_add_u32 s63, s63, 4096
    s_waitcnt lgkmcnt(4)
    v_mfma_f32_32x32x16_bf16 v[64:79], v[160:163], a[152:155], v[64:79]
    ds_read_b64_tr_b16 v[172:173], v217 offset:10752
    ds_read_b64_tr_b16 v[174:175], v217 offset:11008
    v_mfma_f32_32x32x16_bf16 v[96:111], v[160:163], a[156:159], v[96:111]
    s_waitcnt lgkmcnt(4)
    v_mfma_f32_32x32x16_bf16 v[80:95], v[164:167], a[152:155], v[80:95]
    ds_read_b64_tr_b16 v[160:161], v217 offset:12800
    ds_read_b64_tr_b16 v[162:163], v217 offset:13056
    v_mfma_f32_32x32x16_bf16 v[112:127], v[164:167], a[156:159], v[112:127]
    s_add_u32 m0, s75, s70
    s_nop 0
    buffer_load_dwordx4 v210, s[24:27], s64 offen sc1 lds
    s_add_u32 s64, s64, 4096
    s_waitcnt lgkmcnt(4)
    v_mfma_f32_32x32x16_bf16 v[64:79], v[168:171], a[160:163], v[64:79]
    ds_read_b64_tr_b16 v[164:165], v217 offset:14848
    ds_read_b64_tr_b16 v[166:167], v217 offset:15104
    v_mfma_f32_32x32x16_bf16 v[96:111], v[168:171], a[164:167], v[96:111]
    s_waitcnt lgkmcnt(4)
    v_mfma_f32_32x32x16_bf16 v[80:95], v[172:175], a[160:163], v[80:95]
    ds_read_b64_tr_b16 v[168:169], v217 offset:16896
    ds_read_b64_tr_b16 v[170:171], v217 offset:17152
    v_mfma_f32_32x32x16_bf16 v[112:127], v[172:175], a[164:167], v[112:127]
    s_waitcnt lgkmcnt(4)
    v_mfma_f32_32x32x16_bf16 v[64:79], v[160:163], a[168:171], v[64:79]
    ds_read_b64_tr_b16 v[172:173], v217 offset:18944
    ds_read_b64_tr_b16 v[174:175], v217 offset:19200
    s_add_u32 m0, s75, s71
    s_nop 0
    buffer_load_dwordx4 v210, s[24:27], s65 offen sc1 lds
    s_add_u32 s65, s65, 4096
    v_mfma_f32_32x32x16_bf16 v[96:111], v[160:163], a[172:175], v[96:111]
    s_waitcnt lgkmcnt(4)
    v_mfma_f32_32x32x16_bf16 v[80:95], v[164:167], a[168:171], v[80:95]
    ds_read_b64_tr_b16 v[160:161], v217 offset:20992
    ds_read_b64_tr_b16 v[162:163], v217 offset:21248
    v_mfma_f32_32x32x16_bf16 v[112:127], v[164:167], a[172:175], v[112:127]
    s_waitcnt lgkmcnt(4)
    v_mfma_f32_32x32x16_bf16 v[64:79], v[168:171], a[176:179], v[64:79]
    ds_read_b64_tr_b16 v[164:165], v217 offset:23040
    ds_read_b64_tr_b16 v[166:167], v217 offset:23296
    s_add_u32 m0, s75, s72
    s_nop 0
    buffer_load_dwordx4 v210, s[24:27], s66 offen sc1 lds
    s_add_u32 s66, s66, 9728
    v_mfma_f32_32x32x16_bf16 v[96:111], v[168:171], a[180:183], v[96:111]
    s_waitcnt lgkmcnt(4)
    v_mfma_f32_32x32x16_bf16 v[80:95], v[172:175], a[176:179], v[80:95]
    ds_read_b64_tr_b16 v[168:169], v217 offset:25088
    ds_read_b64_tr_b16 v[170:171], v217 offset:25344
    v_mfma_f32_32x32x16_bf16 v[112:127], v[172:175], a[180:183], v[112:127]
    s_waitcnt lgkmcnt(4)
    v_mfma_f32_32x32x16_bf16 v[64:79], v[160:163], a[184:187], v[64:79]
    ds_read_b64_tr_b16 v[172:173], v217 offset:27136
    ds_read_b64_tr_b16 v[174:175], v217 offset:27392
    v_mfma_f32_32x32x16_bf16 v[96:111], v[160:163], a[188:191], v[96:111]
    s_add_u32 m0, s75, s73
    s_nop 0
    buffer_load_dwordx4 v210, s[24:27], s67 offen sc1 lds
    s_add_u32 s67, s67, 9728
    s_waitcnt lgkmcnt(4)
    v_mfma_f32_32x32x16_bf16 v[80:95], v[164:167], a[184:187], v[80:95]
    ds_read_b64_tr_b16 v[160:161], v217 offset:29184
    ds_read_b64_tr_b16 v[162:163], v217 offset:29440
    v_mfma_f32_32x32x16_bf16 v[112:127], v[164:167], a[188:191], v[112:127]
    s_waitcnt lgkmcnt(4)
    v_mfma_f32_32x32x16_bf16 v[64:79], v[168:171], a[192:195], v[64:79]
    ds_read_b64_tr_b16 v[164:165], v217 offset:31232
    ds_read_b64_tr_b16 v[166:167], v217 offset:31488
    v_mfma_f32_32x32x16_bf16 v[96:111], v[168:171], a[196:199], v[96:111]
    s_add_u32 m0, s75, s74
    s_nop 0
    buffer_load_dwordx4 v210, s[24:27], s68 offen sc1 lds
    s_add_u32 s68, s68, 9728
    s_sub_u32 s75, s75, 36864
    s_cselect_b32 s75, 110592, s75
    s_waitcnt lgkmcnt(4)
    v_mfma_f32_32x32x16_bf16 v[80:95], v[172:175], a[192:195], v[80:95]
    ds_read_b64_tr_b16 v[168:169], v217 offset:33280
    ds_read_b64_tr_b16 v[170:171], v217 offset:33536
    v_mfma_f32_32x32x16_bf16 v[112:127], v[172:175], a[196:199], v[112:127]
    s_waitcnt lgkmcnt(4)
    v_mfma_f32_32x32x16_bf16 v[64:79], v[160:163], a[200:203], v[64:79]
    ds_read_b64_tr_b16 v[172:173], v217 offset:35328
    ds_read_b64_tr_b16 v[174:175], v217 offset:35584
    v_mfma_f32_32x32x16_bf16 v[96:111], v[160:163], a[204:207], v[96:111]
    s_waitcnt lgkmcnt(4)
    v_mfma_f32_32x32x16_bf16 v[80:95], v[164:167], a[200:203], v[80:95]
    ds_read_b64_tr_b16 v[160:161], v218 offset:0
    ds_read_b64_tr_b16 v[162:163], v218 offset:256
    v_mfma_f32_32x32x16_bf16 v[112:127], v[164:167], a[204:207], v[112:127]
    s_waitcnt lgkmcnt(4)
    v_mfma_f32_32x32x16_bf16 v[64:79], v[168:171], a[208:211], v[64:79]
    ds_read_b64_tr_b16 v[164:165], v218 offset:2048
    ds_read_b64_tr_b16 v[166:167], v218 offset:2304
    v_mfma_f32_32x32x16_bf16 v[96:111], v[168:171], a[212:215], v[96:111]
    s_waitcnt lgkmcnt(4)
    v_mfma_f32_32x32x16_bf16 v[80:95], v[172:175], a[208:211], v[80:95]
    ds_read_b64_tr_b16 v[168:169], v218 offset:4096
    ds_read_b64_tr_b16 v[170:171], v218 offset:4352
    v_mfma_f32_32x32x16_bf16 v[112:127], v[172:175], a[212:215], v[112:127]
    s_waitcnt lgkmcnt(4)
    v_mfma_f32_32x32x16_bf16 v[0:15], v[160:163], a[216:219], v[0:15]
    s_waitcnt vmcnt(0)
    s_barrier
    ds_read_b64_tr_b16 v[172:173], v218 offset:6144
    ds_read_b64_tr_b16 v[174:175], v218 offset:6400
    v_mfma_f32_32x32x16_bf16 v[32:47], v[160:163], a[220:223], v[32:47]
    s_waitcnt lgkmcnt(4)
    v_mfma_f32_32x32x16_bf16 v[16:31], v[164:167], a[216:219], v[16:31]
    ds_read_b64_tr_b16 v[160:161], v218 offset:8192
    ds_read_b64_tr_b16 v[162:163], v218 offset:8448
    v_mfma_f32_32x32x16_bf16 v[48:63], v[164:167], a[220:223], v[48:63]
    s_waitcnt lgkmcnt(4)
    v_mfma_f32_32x32x16_bf16 v[0:15], v[168:171], a[224:227], v[0:15]
    ds_read_b64_tr_b16 v[164:165], v218 offset:10240
    ds_read_b64_tr_b16 v[166:167], v218 offset:10496
    s_cmp_gt_u32 s62, 0
    s_cselect_b64 s[40:41], s[82:83], -1
    v_mfma_f32_32x32x16_bf16 v[32:47], v[168:171], a[228:231], v[32:47]
    v_cndmask_b32 v128, 0, v128, s[40:41]
    s_waitcnt lgkmcnt(4)
    v_mfma_f32_32x32x16_bf16 v[16:31], v[172:175], a[224:227], v[16:31]
    ds_read_b64_tr_b16 v[168:169], v218 offset:12288
    ds_read_b64_tr_b16 v[170:171], v218 offset:12544
    v_cndmask_b32 v136, 0, v136, s[40:41]
    v_mfma_f32_32x32x16_bf16 v[48:63], v[172:175], a[228:231], v[48:63]
    s_waitcnt lgkmcnt(4)
    v_mfma_f32_32x32x16_bf16 v[0:15], v[160:163], a[232:235], v[0:15]
    ds_read_b64_tr_b16 v[172:173], v218 offset:14336
    ds_read_b64_tr_b16 v[174:175], v218 offset:14592
    s_cmp_gt_u32 s62, 1
    s_cselect_b64 s[40:41], s[82:83], -1
    v_mfma_f32_32x32x16_bf16 v[32:47], v[160:163], a[236:239], v[32:47]
    v_cndmask_b32 v129, 0, v129, s[40:41]
    s_waitcnt lgkmcnt(4)
    v_mfma_f32_32x32x16_bf16 v[16:31], v[164:167], a[232:235], v[16:31]
    ds_read_b64_tr_b16 v[160:161], v218 offset:16384
    ds_read_b64_tr_b16 v[162:163], v218 offset:16640
    v_mfma_f32_32x32x16_bf16 v[48:63], v[164:167], a[236:239], v[48:63]
    v_cndmask_b32 v137, 0, v137, s[40:41]
    s_waitcnt lgkmcnt(4)
    v_mfma_f32_32x32x16_bf16 v[0:15], v[168:171], a[240:243], v[0:15]
    ds_read_b64_tr_b16 v[164:165], v218 offset:18432
    ds_read_b64_tr_b16 v[166:167], v218 offset:18688
    s_cmp_gt_u32 s62, 2
    s_cselect_b64 s[40:41], s[82:83], -1
    v_mfma_f32_32x32x16_bf16 v[32:47], v[168:171], a[244:247], v[32:47]
    s_waitcnt lgkmcnt(4)
    v_mfma_f32_32x32x16_bf16 v[16:31], v[172:175], a[240:243], v[16:31]
    ds_read_b64_tr_b16 v[168:169], v218 offset:20480
    ds_read_b64_tr_b16 v[170:171], v218 offset:20736
    v_cndmask_b32 v130, 0, v130, s[40:41]
    v_mfma_f32_32x32x16_bf16 v[48:63], v[172:175], a[244:247], v[48:63]
    v_cndmask_b32 v138, 0, v138, s[40:41]
    s_waitcnt lgkmcnt(4)
    v_mfma_f32_32x32x16_bf16 v[0:15], v[160:163], a[248:251], v[0:15]
    ds_read_b64_tr_b16 v[172:173], v218 offset:22528
    ds_read_b64_tr_b16 v[174:175], v218 offset:22784
    s_cmp_ge_u32 s62, 0
    s_cselect_b64 s[40:41], s[80:81], 0
    v_mfma_f32_32x32x16_bf16 v[32:47], v[160:163], a[252:255], v[32:47]
    s_waitcnt lgkmcnt(4)
    v_mfma_f32_32x32x16_bf16 v[16:31], v[164:167], a[248:251], v[16:31]
    ds_read_b64_tr_b16 v[160:161], v218 offset:24576
    ds_read_b64_tr_b16 v[162:163], v218 offset:24832
    v_cndmask_b32 v132, 0, v132, s[40:41]
    v_mfma_f32_32x32x16_bf16 v[48:63], v[164:167], a[252:255], v[48:63]
    v_cndmask_b32 v140, 0, v140, s[40:41]
    s_waitcnt lgkmcnt(4)
    v_mfma_f32_32x32x16_bf16 v[0:15], v[168:171], v[224:227], v[0:15]
    ds_read_b64_tr_b16 v[164:165], v218 offset:26624
    ds_read_b64_tr_b16 v[166:167], v218 offset:26880
    v_mfma_f32_32x32x16_bf16 v[32:47], v[168:171], v[228:231], v[32:47]
    s_cmp_ge_u32 s62, 1
    s_cselect_b64 s[40:41], s[80:81], 0
    s_waitcnt lgkmcnt(4)
    v_mfma_f32_32x32x16_bf16 v[16:31], v[172:175], v[224:227], v[16:31]
    ds_read_b64_tr_b16 v[168:169], v218 offset:28672
    ds_read_b64_tr_b16 v[170:171], v218 offset:28928
    v_cndmask_b32 v133, 0, v133, s[40:41]
    v_mfma_f32_32x32x16_bf16 v[48:63], v[172:175], v[228:231], v[48:63]
    s_waitcnt lgkmcnt(4)
    v_mfma_f32_32x32x16_bf16 v[0:15], v[160:163], v[232:235], v[0:15]
    ds_read_b64_tr_b16 v[172:173], v218 offset:30720
    ds_read_b64_tr_b16 v[174:175], v218 offset:30976
    v_cndmask_b32 v141, 0, v141, s[40:41]
    v_mfma_f32_32x32x16_bf16 v[32:47], v[160:163], v[236:239], v[32:47]
    s_cmp_ge_u32 s62, 2
    s_cselect_b64 s[40:41], s[80:81], 0
    s_waitcnt lgkmcnt(4)
    v_mfma_f32_32x32x16_bf16 v[16:31], v[164:167], v[232:235], v[16:31]
    ds_read_b64_tr_b16 v[160:161], v218 offset:32768
    ds_read_b64_tr_b16 v[162:163], v218 offset:33024
    v_cndmask_b32 v134, 0, v134, s[40:41]
    v_mfma_f32_32x32x16_bf16 v[48:63], v[164:167], v[236:239], v[48:63]
    s_waitcnt lgkmcnt(4)
    v_mfma_f32_32x32x16_bf16 v[0:15], v[168:171], v[240:243], v[0:15]
    ds_read_b64_tr_b16 v[164:165], v218 offset:34816
    ds_read_b64_tr_b16 v[166:167], v218 offset:35072
    v_cndmask_b32 v142, 0, v142, s[40:41]
    v_mfma_f32_32x32x16_bf16 v[32:47], v[168:171], v[244:247], v[32:47]
    s_cmp_ge_u32 s62, 3
    s_cselect_b64 s[40:41], s[80:81], 0
    s_waitcnt lgkmcnt(4)
    v_mfma_f32_32x32x16_bf16 v[16:31], v[172:175], v[240:243], v[16:31]
    ds_read_b64_tr_b16 v[168:169], v218 offset:512
    ds_read_b64_tr_b16 v[170:171], v218 offset:768
    v_mfma_f32_32x32x16_bf16 v[48:63], v[172:175], v[244:247], v[48:63]
    v_cndmask_b32 v135, 0, v135, s[40:41]
    s_waitcnt lgkmcnt(4)
    v_mfma_f32_32x32x16_bf16 v[0:15], v[160:163], v[248:251], v[0:15]
    ds_read_b64_tr_b16 v[172:173], v218 offset:2560
    ds_read_b64_tr_b16 v[174:175], v218 offset:2816
    v_cndmask_b32 v143, 0, v143, s[40:41]
    v_mfma_f32_32x32x16_bf16 v[32:47], v[160:163], v[252:255], v[32:47]
    s_waitcnt lgkmcnt(4)
    v_mfma_f32_32x32x16_bf16 v[16:31], v[164:167], v[248:251], v[16:31]
    ds_read_b64_tr_b16 v[160:161], v218 offset:4608
    ds_read_b64_tr_b16 v[162:163], v218 offset:4864
    v_mfma_f32_32x32x16_bf16 v[48:63], v[164:167], v[252:255], v[48:63]
    s_waitcnt lgkmcnt(4)
    v_mfma_f32_32x32x16_bf16 v[64:79], v[168:171], a[216:219], v[64:79]
    ds_read_b64_tr_b16 v[164:165], v218 offset:6656
    ds_read_b64_tr_b16 v[166:167], v218 offset:6912
    v_add_u32 v149, 8192, v146
    v_mfma_f32_32x32x16_bf16 v[96:111], v[168:171], a[220:223], v[96:111]
    s_waitcnt lgkmcnt(4)
    v_mfma_f32_32x32x16_bf16 v[80:95], v[172:175], a[216:219], v[80:95]
    ds_read_b64_tr_b16 v[168:169], v218 offset:8704
    ds_read_b64_tr_b16 v[170:171], v218 offset:8960
    v_mfma_f32_32x32x16_bf16 v[112:127], v[172:175], a[220:223], v[112:127]
    v_mul_f32 v0, v0, v16
    v_mul_f32 v1, v1, v17
    s_waitcnt lgkmcnt(4)
    v_mfma_f32_32x32x16_bf16 v[64:79], v[160:163], a[224:227], v[64:79]
    ds_read_b64_tr_b16 v[172:173], v218 offset:10752
    ds_read_b64_tr_b16 v[174:175], v218 offset:11008
    v_mul_f32 v2, v2, v18
    v_mul_f32 v3, v3, v19
    ds_read_b128 a[0:3], v147 offset:0
    v_mfma_f32_32x32x16_bf16 v[96:111], v[160:163], a[228:231], v[96:111]
    v_mul_f32 v4, v4, v20
    v_mul_f32 v5, v5, v21
    s_waitcnt lgkmcnt(5)
    v_mfma_f32_32x32x16_bf16 v[80:95], v[164:167], a[224:227], v[80:95]
    ds_read_b64_tr_b16 v[160:161], v218 offset:12800
    ds_read_b64_tr_b16 v[162:163], v218 offset:13056
    v_mul_f32 v6, v6, v22
    v_mfma_f32_32x32x16_bf16 v[112:127], v[164:167], a[228:231], v[112:127]
    v_mul_f32 v7, v7, v23
    v_mul_f32 v8, v8, v24
    s_waitcnt lgkmcnt(5)
    v_mfma_f32_32x32x16_bf16 v[64:79], v[168:171], a[232:235], v[64:79]
    ds_read_b64_tr_b16 v[164:165], v218 offset:14848
    ds_read_b64_tr_b16 v[166:167], v218 offset:15104
    v_mul_f32 v9, v9, v25
    v_mul_f32 v10, v10, v26
    v_mfma_f32_32x32x16_bf16 v[96:111], v[168:171], a[236:239], v[96:111]
    v_mul_f32 v11, v11, v27
    ds_read_b128 a[4:7], v149 offset:0
    s_waitcnt lgkmcnt(6)
    v_mfma_f32_32x32x16_bf16 v[80:95], v[172:175], a[232:235], v[80:95]
    ds_read_b64_tr_b16 v[168:169], v218 offset:16896
    ds_read_b64_tr_b16 v[170:171], v218 offset:17152
    v_mul_f32 v12, v12, v28
    v_mul_f32 v13, v13, v29
    v_mfma_f32_32x32x16_bf16 v[112:127], v[172:175], a[236:239], v[112:127]
    v_mul_f32 v14, v14, v30
    v_mul_f32 v15, v15, v31
    s_waitcnt lgkmcnt(5)
    v_mfma_f32_32x32x16_bf16 v[64:79], v[160:163], a[240:243], v[64:79]
    ds_read_b64_tr_b16 v[172:173], v218 offset:18944
    ds_read_b64_tr_b16 v[174:175], v218 offset:19200
    v_cvt_pk_bf16_f32 v176, v0, v1
    v_mfma_f32_32x32x16_bf16 v[96:111], v[160:163], a[244:247], v[96:111]
    v_cvt_pk_bf16_f32 v177, v2, v3
    v_cvt_pk_bf16_f32 v178, v4, v5
    s_waitcnt lgkmcnt(5)
    v_mfma_f32_32x32x16_bf16 v[80:95], v[164:167], a[240:243], v[80:95]
    ds_read_b64_tr_b16 v[160:161], v218 offset:20992
    ds_read_b64_tr_b16 v[162:163], v218 offset:21248
    v_cvt_pk_bf16_f32 v179, v6, v7
    v_cvt_pk_bf16_f32 v180, v8, v9
    ds_read_b128 a[8:11], v147 offset:512
    v_mfma_f32_32x32x16_bf16 v[112:127], v[164:167], a[244:247], v[112:127]
    v_cvt_pk_bf16_f32 v181, v10, v11
    s_waitcnt lgkmcnt(5)
    v_mfma_f32_32x32x16_bf16 v[64:79], v[168:171], a[248:251], v[64:79]
    ds_read_b64_tr_b16 v[164:165], v218 offset:23040
    ds_read_b64_tr_b16 v[166:167], v218 offset:23296
    v_cvt_pk_bf16_f32 v182, v12, v13
    v_cvt_pk_bf16_f32 v183, v14, v15
    v_mfma_f32_32x32x16_bf16 v[96:111], v[168:171], a[252:255], v[96:111]
    buffer_store_dwordx4 v[176:179], v210, s[24:27], s58 offen offset:0 sc1
    buffer_store_dwordx4 v[180:183], v210, s[24:27], s58 offen offset:1024 sc1
    s_waitcnt lgkmcnt(5)
    v_mfma_f32_32x32x16_bf16 v[80:95], v[172:175], a[248:251], v[80:95]
    ds_read_b64_tr_b16 v[168:169], v218 offset:25088
    ds_read_b64_tr_b16 v[170:171], v218 offset:25344
    v_mul_f32 v32, v32, v48
    v_mfma_f32_32x32x16_bf16 v[112:127], v[172:175], a[252:255], v[112:127]
    v_mul_f32 v33, v33, v49
    v_mul_f32 v34, v34, v50
    ds_read_b128 a[12:15], v149 offset:512
    s_waitcnt lgkmcnt(6)
    v_mfma_f32_32x32x16_bf16 v[64:79], v[160:163], v[224:227], v[64:79]
    ds_read_b64_tr_b16 v[172:173], v218 offset:27136
    ds_read_b64_tr_b16 v[174:175], v218 offset:27392
    v_mul_f32 v35, v35, v51
    v_mul_f32 v36, v36, v52
    v_mfma_f32_32x32x16_bf16 v[96:111], v[160:163], v[228:231], v[96:111]
    v_mul_f32 v37, v37, v53
    v_mul_f32 v38, v38, v54
    s_waitcnt lgkmcnt(5)
    v_mfma_f32_32x32x16_bf16 v[80:95], v[164:167], v[224:227], v[80:95]
    ds_read_b64_tr_b16 v[160:161], v218 offset:29184
    ds_read_b64_tr_b16 v[162:163], v218 offset:29440
    v_mul_f32 v39, v39, v55
    v_mfma_f32_32x32x16_bf16 v[112:127], v[164:167], v[228:231], v[112:127]
    v_mul_f32 v40, v40, v56
    v_mul_f32 v41, v41, v57
    s_waitcnt lgkmcnt(5)
    v_mfma_f32_32x32x16_bf16 v[64:79], v[168:171], v[232:235], v[64:79]
    ds_read_b64_tr_b16 v[164:165], v218 offset:31232
    ds_read_b64_tr_b16 v[166:167], v218 offset:31488
    v_mul_f32 v42, v42, v58
    v_mul_f32 v43, v43, v59
    v_mfma_f32_32x32x16_bf16 v[96:111], v[168:171], v[236:239], v[96:111]
    v_mul_f32 v44, v44, v60
    s_waitcnt lgkmcnt(4)
    v_mfma_f32_32x32x16_bf16 v[80:95], v[172:175], v[232:235], v[80:95]
    ds_read_b64_tr_b16 v[168:169], v218 offset:33280
    ds_read_b64_tr_b16 v[170:171], v218 offset:33536
    v_mul_f32 v45, v45, v61
    v_mul_f32 v46, v46, v62
    v_mfma_f32_32x32x16_bf16 v[112:127], v[172:175], v[236:239], v[112:127]
    v_mul_f32 v47, v47, v63
    v_cvt_pk_bf16_f32 v184, v32, v33
    s_waitcnt lgkmcnt(4)
    v_mfma_f32_32x32x16_bf16 v[64:79], v[160:163], v[240:243], v[64:79]
    ds_read_b64_tr_b16 v[172:173], v218 offset:35328
    ds_read_b64_tr_b16 v[174:175], v218 offset:35584
    v_cvt_pk_bf16_f32 v185, v34, v35
    v_mfma_f32_32x32x16_bf16 v[96:111], v[160:163], v[244:247], v[96:111]
    v_cvt_pk_bf16_f32 v186, v36, v37
    v_cvt_pk_bf16_f32 v187, v38, v39
    s_waitcnt lgkmcnt(4)
    v_mfma_f32_32x32x16_bf16 v[80:95], v[164:167], v[240:243], v[80:95]
    v_cvt_pk_bf16_f32 v188, v40, v41
    v_cvt_pk_bf16_f32 v189, v42, v43
    v_mfma_f32_32x32x16_bf16 v[112:127], v[164:167], v[244:247], v[112:127]
    v_cvt_pk_bf16_f32 v190, v44, v45
    s_waitcnt lgkmcnt(2)
    v_mfma_f32_32x32x16_bf16 v[64:79], v[168:171], v[248:251], v[64:79]
    v_cvt_pk_bf16_f32 v191, v46, v47
    buffer_store_dwordx4 v[184:187], v210, s[24:27], s59 offen offset:0 sc1
    v_mfma_f32_32x32x16_bf16 v[96:111], v[168:171], v[252:255], v[96:111]
    buffer_store_dwordx4 v[188:191], v210, s[24:27], s59 offen offset:1024 sc1
    s_add_u32 s58, s58, 2048
    s_waitcnt lgkmcnt(0)
    v_mfma_f32_32x32x16_bf16 v[80:95], v[172:175], v[248:251], v[80:95]
    s_add_u32 s59, s59, 2048
    v_mfma_f32_32x32x16_bf16 v[112:127], v[172:175], v[252:255], v[112:127]
    v_mfma_f32_32x32x16_bf16 v[0:15], a[0:3], v[128:131], 0
    s_nop 8
    v_mul_f32 v64, v64, v80
    v_mul_f32 v65, v65, v81
    v_mul_f32 v66, v66, v82
    v_mul_f32 v67, v67, v83
    v_mul_f32 v68, v68, v84
    v_mul_f32 v69, v69, v85
    v_mul_f32 v70, v70, v86
    v_mfma_f32_32x32x16_bf16 v[16:31], a[0:3], v[136:139], 0
    v_mul_f32 v71, v71, v87
    v_mul_f32 v72, v72, v88
    v_mul_f32 v73, v73, v89
    v_mul_f32 v74, v74, v90
    v_mul_f32 v75, v75, v91
    v_mul_f32 v76, v76, v92
    v_mul_f32 v77, v77, v93
    v_mfma_f32_32x32x16_bf16 v[0:15], a[4:7], v[132:135], v[0:15]
    v_mul_f32 v78, v78, v94
    v_mul_f32 v79, v79, v95
    v_cvt_pk_bf16_f32 v176, v64, v65
    v_cvt_pk_bf16_f32 v177, v66, v67
    v_cvt_pk_bf16_f32 v178, v68, v69
    v_cvt_pk_bf16_f32 v179, v70, v71
    v_cvt_pk_bf16_f32 v180, v72, v73
    v_mfma_f32_32x32x16_bf16 v[16:31], a[4:7], v[140:143], v[16:31]
    v_cvt_pk_bf16_f32 v181, v74, v75
    v_cvt_pk_bf16_f32 v182, v76, v77
    v_cvt_pk_bf16_f32 v183, v78, v79
    buffer_store_dwordx4 v[176:179], v210, s[24:27], s58 offen offset:0 sc1
    buffer_store_dwordx4 v[180:183], v210, s[24:27], s58 offen offset:1024 sc1
    v_mul_f32 v96, v96, v112
    v_mfma_f32_32x32x16_bf16 v[32:47], a[8:11], v[128:131], 0
    v_mul_f32 v97, v97, v113
    v_mul_f32 v98, v98, v114
    v_mul_f32 v99, v99, v115
    v_mul_f32 v100, v100, v116
    v_mul_f32 v101, v101, v117
    v_mul_f32 v102, v102, v118
    v_mul_f32 v103, v103, v119
    v_mfma_f32_32x32x16_bf16 v[48:63], a[8:11], v[136:139], 0
    v_mul_f32 v104, v104, v120
    v_mul_f32 v105, v105, v121
    v_mul_f32 v106, v106, v122
    v_mul_f32 v107, v107, v123
    v_mul_f32 v108, v108, v124
    v_mul_f32 v109, v109, v125
    v_mul_f32 v110, v110, v126
    v_mfma_f32_32x32x16_bf16 v[32:47], a[12:15], v[132:135], v[32:47]
    v_mul_f32 v111, v111, v127
    v_cvt_pk_bf16_f32 v184, v96, v97
    v_cvt_pk_bf16_f32 v185, v98, v99
    v_cvt_pk_bf16_f32 v186, v100, v101
    v_cvt_pk_bf16_f32 v187, v102, v103
    v_cvt_pk_bf16_f32 v188, v104, v105
    v_cvt_pk_bf16_f32 v189, v106, v107
    v_mfma_f32_32x32x16_bf16 v[48:63], a[12:15], v[140:143], v[48:63]
    v_cvt_pk_bf16_f32 v190, v108, v109
    v_cvt_pk_bf16_f32 v191, v110, v111
    buffer_store_dwordx4 v[184:187], v210, s[24:27], s59 offen offset:0 sc1
    buffer_store_dwordx4 v[188:191], v210, s[24:27], s59 offen offset:1024 sc1
    s_add_u32 s58, s58, 2048
    s_add_u32 s59, s59, 2048
    v_mov_b32 v64, v146
    v_mov_b32 v65, v147
    v_mov_b32 v66, v148
    v_max3_f32 v216, v0, v1, v2
    v_max3_f32 v216, v216, v3, v4
    v_max3_f32 v216, v216, v5, v6
    v_max3_f32 v216, v216, v7, v8
    v_max3_f32 v216, v216, v9, v10
    v_max3_f32 v216, v216, v11, v12
    v_max3_f32 v216, v216, v13, v14
    v_max_f32 v216, v216, v15
    v_max3_f32 v217, v16, v17, v18
    v_max3_f32 v217, v217, v19, v20
    v_max3_f32 v217, v217, v21, v22
    v_max3_f32 v217, v217, v23, v24
    v_max3_f32 v217, v217, v25, v26
    v_max3_f32 v217, v217, v27, v28
    v_max3_f32 v217, v217, v29, v30
    v_max_f32 v217, v217, v31
    v_max3_f32 v216, v216, v32, v33
    v_max3_f32 v216, v216, v34, v35
    v_max3_f32 v216, v216, v36, v37
    v_max3_f32 v216, v216, v38, v39
    v_max3_f32 v216, v216, v40, v41
    v_max3_f32 v216, v216, v42, v43
    v_max3_f32 v216, v216, v44, v45
    v_max3_f32 v216, v216, v46, v47
    v_max3_f32 v217, v217, v48, v49
    v_max3_f32 v217, v217, v50, v51
    v_max3_f32 v217, v217, v52, v53
    v_max3_f32 v217, v217, v54, v55
    v_max3_f32 v217, v217, v56, v57
    v_max3_f32 v217, v217, v58, v59
    v_max3_f32 v217, v217, v60, v61
    v_max3_f32 v217, v217, v62, v63
    v_mov_b32 v218, v216
    s_nop 1
    v_permlane32_swap_b32 v216, v218
    v_max_f32 v216, v216, v218
    v_add_f32 v216, 0x42b40000, v216
    v_sub_f32 v224, 0, v216
    v_mov_b32 v225, v224
    v_mov_b32 v226, v224
    v_mov_b32 v227, v224
    v_mov_b32 v228, v224
    v_mov_b32 v229, v224
    v_mov_b32 v230, v224
    v_mov_b32 v231, v224
    v_mov_b32 v232, v224
    v_mov_b32 v233, v224
    v_mov_b32 v234, v224
    v_mov_b32 v235, v224
    v_mov_b32 v236, v224
    v_mov_b32 v237, v224
    v_mov_b32 v238, v224
    v_mov_b32 v239, v224
    v_mov_b32 v219, v217
    s_nop 1
    v_permlane32_swap_b32 v217, v219
    v_max_f32 v217, v217, v219
    v_add_f32 v217, 0x42b40000, v217
    v_sub_f32 v240, 0, v217
    v_mov_b32 v241, v240
    v_mov_b32 v242, v240
    v_mov_b32 v243, v240
    v_mov_b32 v244, v240
    v_mov_b32 v245, v240
    v_mov_b32 v246, v240
    v_mov_b32 v247, v240
    v_mov_b32 v248, v240
    v_mov_b32 v249, v240
    v_mov_b32 v250, v240
    v_mov_b32 v251, v240
    v_mov_b32 v252, v240
    v_mov_b32 v253, v240
    v_mov_b32 v254, v240
    v_mov_b32 v255, v240
    v_add_f32 v0, v0, v224
    v_add_f32 v1, v1, v224
    v_add_f32 v2, v2, v224
    v_add_f32 v3, v3, v224
    v_add_f32 v4, v4, v224
    v_add_f32 v5, v5, v224
    v_add_f32 v6, v6, v224
    v_add_f32 v7, v7, v224
    v_add_f32 v8, v8, v224
    v_add_f32 v9, v9, v224
    v_add_f32 v10, v10, v224
    v_add_f32 v11, v11, v224
    v_add_f32 v12, v12, v224
    v_add_f32 v13, v13, v224
    v_add_f32 v14, v14, v224
    v_add_f32 v15, v15, v224
    v_add_f32 v16, v16, v240
    v_add_f32 v17, v17, v240
    v_add_f32 v18, v18, v240
    v_add_f32 v19, v19, v240
    v_add_f32 v20, v20, v240
    v_add_f32 v21, v21, v240
    v_add_f32 v22, v22, v240
    v_add_f32 v23, v23, v240
    v_add_f32 v24, v24, v240
    v_add_f32 v25, v25, v240
    v_add_f32 v26, v26, v240
    v_add_f32 v27, v27, v240
    v_add_f32 v28, v28, v240
    v_add_f32 v29, v29, v240
    v_add_f32 v30, v30, v240
    v_add_f32 v31, v31, v240
    s_mov_b32 s76, 0
    s_mov_b32 s77, 110592
    s_barrier
    v_add_u32 v67, s76, v65
    v_add_u32 v69, s77, v65
    s_add_u32 s34, s76, 8192
    s_add_u32 s35, s77, 8192
    s_add_u32 s36, s76, 12288
    v_add_u32 v68, s34, v64
    v_add_u32 v70, s35, v64
    v_add_u32 v71, s36, v66
    s_mov_b32 s76, s77
    s_sub_u32 s77, s77, 36864
    s_cselect_b32 s77, 110592, s77
    v_mfma_f32_32x32x16_bf16 v[32:47], a[8:11], v[128:131], v[224:239]
    ds_read_b128 a[0:3], v67 offset:1024
    v_exp_f32 v0, v0
    v_exp_f32 v1, v1
    v_exp_f32 v2, v2
    v_exp_f32 v3, v3
    v_exp_f32 v4, v4
    v_exp_f32 v5, v5
    ds_read_b128 a[4:7], v68 offset:1024
    v_exp_f32 v6, v6
    v_exp_f32 v7, v7
    v_cvt_pk_bf16_f32 v176, v0, v1
    v_cvt_pk_bf16_f32 v177, v2, v3
    v_exp_f32 v8, v8
    v_exp_f32 v9, v9
    v_mfma_f32_32x32x16_bf16 v[48:63], a[8:11], v[136:139], v[240:255]
    ds_read_b128 a[16:19], v71 offset:0
    v_exp_f32 v10, v10
    v_exp_f32 v11, v11
    v_cvt_pk_bf16_f32 v178, v4, v5
    s_add_u32 m0, s75, s69
    s_nop 0
    buffer_load_dwordx4 v210, s[24:27], s63 offen sc1 lds
    s_add_u32 s63, s63, 4096
    v_cvt_pk_bf16_f32 v179, v6, v7
    v_exp_f32 v12, v12
    v_exp_f32 v13, v13
    ds_read_b128 a[20:23], v71 offset:608
    v_exp_f32 v14, v14
    v_exp_f32 v15, v15
    v_cvt_pk_bf16_f32 v180, v8, v9
    v_cvt_pk_bf16_f32 v181, v10, v11
    v_cvt_pk_bf16_f32 v182, v12, v13
    v_cvt_pk_bf16_f32 v183, v14, v15
    v_mfma_f32_32x32x16_bf16 v[32:47], a[12:15], v[132:135], v[32:47]
    v_exp_f32 v16, v16
    v_exp_f32 v17, v17
    v_exp_f32 v18, v18
    v_exp_f32 v19, v19
    v_exp_f32 v20, v20
    v_exp_f32 v21, v21
    v_exp_f32 v22, v22
    v_exp_f32 v23, v23
    v_cvt_pk_bf16_f32 v184, v16, v17
    v_cvt_pk_bf16_f32 v185, v18, v19
    v_exp_f32 v24, v24
    v_exp_f32 v25, v25
    v_mfma_f32_32x32x16_bf16 v[48:63], a[12:15], v[140:143], v[48:63]
    v_exp_f32 v26, v26
    v_exp_f32 v27, v27
    v_cvt_pk_bf16_f32 v186, v20, v21
    s_add_u32 m0, s75, s70
    s_nop 0
    buffer_load_dwordx4 v210, s[24:27], s64 offen sc1 lds
    s_add_u32 s64, s64, 4096
    v_cvt_pk_bf16_f32 v187, v22, v23
    v_exp_f32 v28, v28
    v_exp_f32 v29, v29
    v_exp_f32 v30, v30
    v_exp_f32 v31, v31
    v_cvt_pk_bf16_f32 v188, v24, v25
    v_cvt_pk_bf16_f32 v189, v26, v27
    v_cvt_pk_bf16_f32 v190, v28, v29
    v_cvt_pk_bf16_f32 v191, v30, v31
    s_waitcnt lgkmcnt(3)
    v_mfma_f32_32x32x16_bf16 v[0:15], a[0:3], v[128:131], v[224:239]
    ds_read_b128 a[8:11], v67 offset:1536
    v_exp_f32 v32, v32
    v_exp_f32 v33, v33
    v_exp_f32 v34, v34
    v_exp_f32 v35, v35
    v_exp_f32 v36, v36
    v_exp_f32 v37, v37
    s_waitcnt lgkmcnt(2)
    v_mfma_f32_32x32x16_bf16 v[144:159], a[16:19], v[176:179], 0
    ds_read_b128 a[12:15], v68 offset:1536
    v_exp_f32 v38, v38
    v_exp_f32 v39, v39
    v_cvt_pk_bf16_f32 v192, v32, v33
    v_cvt_pk_bf16_f32 v193, v34, v35
    v_exp_f32 v40, v40
    v_exp_f32 v41, v41
    v_mfma_f32_32x32x16_bf16 v[16:31], a[0:3], v[136:139], v[240:255]
    ds_read_b128 a[24:27], v71 offset:1216
    v_exp_f32 v42, v42
    v_exp_f32 v43, v43
    v_cvt_pk_bf16_f32 v194, v36, v37
    s_add_u32 m0, s75, s71
    s_nop 0
    buffer_load_dwordx4 v210, s[24:27], s65 offen sc1 lds
    s_add_u32 s65, s65, 4096
    v_cvt_pk_bf16_f32 v195, v38, v39
    v_exp_f32 v44, v44
    v_exp_f32 v45, v45
    v_mfma_f32_32x32x16_bf16 v[160:175], a[16:19], v[184:187], 0
    ds_read_b128 a[28:31], v71 offset:1824
    v_exp_f32 v46, v46
    v_exp_f32 v47, v47
    v_cvt_pk_bf16_f32 v196, v40, v41
    v_cvt_pk_bf16_f32 v197, v42, v43
    v_cvt_pk_bf16_f32 v198, v44, v45
    v_cvt_pk_bf16_f32 v199, v46, v47
    v_mfma_f32_32x32x16_bf16 v[0:15], a[4:7], v[132:135], v[0:15]
    v_exp_f32 v48, v48
    v_exp_f32 v49, v49
    v_exp_f32 v50, v50
    v_exp_f32 v51, v51
    v_exp_f32 v52, v52
    v_exp_f32 v53, v53
    s_waitcnt lgkmcnt(4)
    v_mfma_f32_32x32x16_bf16 v[144:159], a[20:23], v[180:183], v[144:159]
    v_exp_f32 v54, v54
    v_exp_f32 v55, v55
    v_cvt_pk_bf16_f32 v200, v48, v49
    v_cvt_pk_bf16_f32 v201, v50, v51
    v_exp_f32 v56, v56
    v_exp_f32 v57, v57
    v_mfma_f32_32x32x16_bf16 v[16:31], a[4:7], v[140:143], v[16:31]
    v_exp_f32 v58, v58
    v_exp_f32 v59, v59
    v_cvt_pk_bf16_f32 v202, v52, v53
    s_add_u32 m0, s75, s72
    s_nop 0
    buffer_load_dwordx4 v210, s[24:27], s66 offen sc1 lds
    s_add_u32 s66, s66, 9728
    v_cvt_pk_bf16_f32 v203, v54, v55
    v_exp_f32 v60, v60
    v_exp_f32 v61, v61
    v_mfma_f32_32x32x16_bf16 v[160:175], a[20:23], v[188:191], v[160:175]
    v_exp_f32 v62, v62
    v_exp_f32 v63, v63
    v_cvt_pk_bf16_f32 v204, v56, v57
    v_cvt_pk_bf16_f32 v205, v58, v59
    v_cvt_pk_bf16_f32 v206, v60, v61
    v_cvt_pk_bf16_f32 v207, v62, v63
    s_waitcnt lgkmcnt(3)
    v_mfma_f32_32x32x16_bf16 v[32:47], a[8:11], v[128:131], v[224:239]
    ds_read_b128 a[0:3], v67 offset:2048
    v_exp_f32 v0, v0
    v_exp_f32 v1, v1
    v_exp_f32 v2, v2
    v_exp_f32 v3, v3
    v_exp_f32 v4, v4
    v_exp_f32 v5, v5
    s_waitcnt lgkmcnt(2)
    v_mfma_f32_32x32x16_bf16 v[144:159], a[24:27], v[192:195], v[144:159]
    ds_read_b128 a[4:7], v68 offset:2048
    v_exp_f32 v6, v6
    v_exp_f32 v7, v7
    v_cvt_pk_bf16_f32 v176, v0, v1
    v_cvt_pk_bf16_f32 v177, v2, v3
    v_exp_f32 v8, v8
    v_exp_f32 v9, v9
    v_mfma_f32_32x32x16_bf16 v[48:63], a[8:11], v[136:139], v[240:255]
    ds_read_b128 a[16:19], v71 offset:2432
    v_exp_f32 v10, v10
    v_exp_f32 v11, v11
    v_cvt_pk_bf16_f32 v178, v4, v5
    s_add_u32 m0, s75, s73
    s_nop 0
    buffer_load_dwordx4 v210, s[24:27], s67 offen sc1 lds
    s_add_u32 s67, s67, 9728
    v_cvt_pk_bf16_f32 v179, v6, v7
    v_exp_f32 v12, v12
    v_exp_f32 v13, v13
    v_mfma_f32_32x32x16_bf16 v[160:175], a[24:27], v[200:203], v[160:175]
    ds_read_b128 a[20:23], v71 offset:3040
    v_exp_f32 v14, v14
    v_exp_f32 v15, v15
    v_cvt_pk_bf16_f32 v180, v8, v9
    v_cvt_pk_bf16_f32 v181, v10, v11
    v_cvt_pk_bf16_f32 v182, v12, v13
    v_cvt_pk_bf16_f32 v183, v14, v15
    v_mfma_f32_32x32x16_bf16 v[32:47], a[12:15], v[132:135], v[32:47]
    v_exp_f32 v16, v16
    v_exp_f32 v17, v17
    v_exp_f32 v18, v18
    v_exp_f32 v19, v19
    v_exp_f32 v20, v20
    v_exp_f32 v21, v21
    s_waitcnt lgkmcnt(4)
    v_mfma_f32_32x32x16_bf16 v[144:159], a[28:31], v[196:199], v[144:159]
    v_exp_f32 v22, v22
    v_exp_f32 v23, v23
    v_cvt_pk_bf16_f32 v184, v16, v17
    v_cvt_pk_bf16_f32 v185, v18, v19
    v_exp_f32 v24, v24
    v_exp_f32 v25, v25
    v_mfma_f32_32x32x16_bf16 v[48:63], a[12:15], v[140:143], v[48:63]
    v_exp_f32 v26, v26
    v_exp_f32 v27, v27
    v_cvt_pk_bf16_f32 v186, v20, v21
    s_add_u32 m0, s75, s74
    s_nop 0
    buffer_load_dwordx4 v210, s[24:27], s68 offen sc1 lds
    s_add_u32 s68, s68, 9728
    s_sub_u32 s75, s75, 36864
    s_cselect_b32 s75, 110592, s75
    v_cvt_pk_bf16_f32 v187, v22, v23
    v_exp_f32 v28, v28
    v_exp_f32 v29, v29
    v_mfma_f32_32x32x16_bf16 v[160:175], a[28:31], v[204:207], v[160:175]
    v_exp_f32 v30, v30
    v_exp_f32 v31, v31
    v_cvt_pk_bf16_f32 v188, v24, v25
    v_cvt_pk_bf16_f32 v189, v26, v27
    v_cvt_pk_bf16_f32 v190, v28, v29
    v_cvt_pk_bf16_f32 v191, v30, v31
    s_waitcnt lgkmcnt(3)
    v_mfma_f32_32x32x16_bf16 v[0:15], a[0:3], v[128:131], v[224:239]
    ds_read_b128 a[8:11], v67 offset:2560
    v_exp_f32 v32, v32
    v_exp_f32 v33, v33
    v_exp_f32 v34, v34
    v_exp_f32 v35, v35
    v_exp_f32 v36, v36
    v_exp_f32 v37, v37
    s_waitcnt lgkmcnt(2)
    v_mfma_f32_32x32x16_bf16 v[144:159], a[16:19], v[176:179], v[144:159]
    ds_read_b128 a[12:15], v68 offset:2560
    v_exp_f32 v38, v38
    v_exp_f32 v39, v39
    v_cvt_pk_bf16_f32 v192, v32, v33
    v_mul_u32_u24 v72, 7282, v208
    v_lshrrev_b32 v72, 16, v72
    v_mul_u32_u24 v73, 9, v72
    v_sub_u32 v73, v208, v73
    v_mul_u32_u24 v72, 1152, v72
    v_lshl_add_u32 v72, v73, 7, v72
    v_cvt_pk_bf16_f32 v193, v34, v35
    v_exp_f32 v40, v40
    v_exp_f32 v41, v41
    v_mfma_f32_32x32x16_bf16 v[16:31], a[0:3], v[136:139], v[240:255]
    ds_read_b128 a[24:27], v71 offset:3648
    v_exp_f32 v42, v42
    v_exp_f32 v43, v43
    v_cvt_pk_bf16_f32 v194, v36, v37
    v_cvt_pk_bf16_f32 v195, v38, v39
    v_exp_f32 v44, v44
    v_exp_f32 v45, v45
    v_mfma_f32_32x32x16_bf16 v[160:175], a[16:19], v[184:187], v[160:175]
    ds_read_b128 a[28:31], v71 offset:4256
    v_exp_f32 v46, v46
    v_exp_f32 v47, v47
    v_cvt_pk_bf16_f32 v196, v40, v41
    s_lshr_b32 s34, s2, 3
    s_mul_i32 s34, s34, 18
    s_mul_i32 s35, s28, 7
    s_add_u32 s34, s34, s35
    s_mul_i32 s34, s34, 1152
    s_mul_i32 s35, s30, 663552
    s_add_u32 s35, s35, s34
    v_cvt_pk_bf16_f32 v197, v42, v43
    v_cvt_pk_bf16_f32 v198, v44, v45
    v_cvt_pk_bf16_f32 v199, v46, v47
    v_mfma_f32_32x32x16_bf16 v[0:15], a[4:7], v[132:135], v[0:15]
    v_exp_f32 v48, v48
    v_exp_f32 v49, v49
    v_exp_f32 v50, v50
    v_exp_f32 v51, v51
    v_exp_f32 v52, v52
    v_exp_f32 v53, v53
    s_waitcnt lgkmcnt(4)
    v_mfma_f32_32x32x16_bf16 v[144:159], a[20:23], v[180:183], v[144:159]
    v_exp_f32 v54, v54
    v_exp_f32 v55, v55
    v_cvt_pk_bf16_f32 v200, v48, v49
    s_mov_b32 s48, s16
    s_mov_b32 s49, s17
    s_mov_b32 s50, 5308416
    s_mov_b32 s51, 0x00020000
    buffer_load_dword v74, v72, s[48:51], s35 offen
    s_mov_b32 s48, s8
    s_mov_b32 s49, s9
    s_mov_b32 s50, 663552
    buffer_load_dword v75, v72, s[48:51], s34 offen
    v_cvt_pk_bf16_f32 v201, v50, v51
    v_exp_f32 v56, v56
    v_exp_f32 v57, v57
    v_mfma_f32_32x32x16_bf16 v[16:31], a[4:7], v[140:143], v[16:31]
    v_exp_f32 v58, v58
    v_exp_f32 v59, v59
    v_cvt_pk_bf16_f32 v202, v52, v53
    v_cvt_pk_bf16_f32 v203, v54, v55
    v_exp_f32 v60, v60
    v_exp_f32 v61, v61
    v_mfma_f32_32x32x16_bf16 v[160:175], a[20:23], v[188:191], v[160:175]
    v_exp_f32 v62, v62
    v_exp_f32 v63, v63
    v_cvt_pk_bf16_f32 v204, v56, v57
    v_cvt_pk_bf16_f32 v205, v58, v59
    v_cvt_pk_bf16_f32 v206, v60, v61
    v_cvt_pk_bf16_f32 v207, v62, v63
    s_waitcnt lgkmcnt(3)
    v_mfma_f32_32x32x16_bf16 v[32:47], a[8:11], v[128:131], v[224:239]
    ds_read_b128 a[0:3], v67 offset:3072
    v_exp_f32 v0, v0
    v_exp_f32 v1, v1
    v_exp_f32 v2, v2
    v_exp_f32 v3, v3
    v_exp_f32 v4, v4
    v_exp_f32 v5, v5
    s_waitcnt lgkmcnt(2)
    v_mfma_f32_32x32x16_bf16 v[144:159], a[24:27], v[192:195], v[144:159]
    ds_read_b128 a[4:7], v68 offset:3072
    v_exp_f32 v6, v6
    v_exp_f32 v7, v7
    v_cvt_pk_bf16_f32 v176, v0, v1
    v_cvt_pk_bf16_f32 v177, v2, v3
    v_exp_f32 v8, v8
    v_exp_f32 v9, v9
    v_mfma_f32_32x32x16_bf16 v[48:63], a[8:11], v[136:139], v[240:255]
    ds_read_b128 a[16:19], v71 offset:4864
    v_exp_f32 v10, v10
    v_exp_f32 v11, v11
    v_cvt_pk_bf16_f32 v178, v4, v5
    v_cvt_pk_bf16_f32 v179, v6, v7
    v_exp_f32 v12, v12
    v_exp_f32 v13, v13
    v_mfma_f32_32x32x16_bf16 v[160:175], a[24:27], v[200:203], v[160:175]
    ds_read_b128 a[20:23], v71 offset:5472
    v_exp_f32 v14, v14
    v_exp_f32 v15, v15
    v_cvt_pk_bf16_f32 v180, v8, v9
    v_cvt_pk_bf16_f32 v181, v10, v11
    v_cvt_pk_bf16_f32 v182, v12, v13
    v_cvt_pk_bf16_f32 v183, v14, v15
    v_mfma_f32_32x32x16_bf16 v[32:47], a[12:15], v[132:135], v[32:47]
    v_exp_f32 v16, v16
    v_exp_f32 v17, v17
    v_exp_f32 v18, v18
    v_exp_f32 v19, v19
    v_exp_f32 v20, v20
    v_exp_f32 v21, v21
    s_waitcnt lgkmcnt(4)
    v_mfma_f32_32x32x16_bf16 v[144:159], a[28:31], v[196:199], v[144:159]
    v_exp_f32 v22, v22
    v_exp_f32 v23, v23
    v_cvt_pk_bf16_f32 v184, v16, v17
    v_cvt_pk_bf16_f32 v185, v18, v19
    v_exp_f32 v24, v24
    v_exp_f32 v25, v25
    v_mfma_f32_32x32x16_bf16 v[48:63], a[12:15], v[140:143], v[48:63]
    v_exp_f32 v26, v26
    v_exp_f32 v27, v27
    v_cvt_pk_bf16_f32 v186, v20, v21
    v_cvt_pk_bf16_f32 v187, v22, v23
    v_exp_f32 v28, v28
    v_exp_f32 v29, v29
    v_mfma_f32_32x32x16_bf16 v[160:175], a[28:31], v[204:207], v[160:175]
    v_exp_f32 v30, v30
    v_exp_f32 v31, v31
    v_cvt_pk_bf16_f32 v188, v24, v25
    v_cvt_pk_bf16_f32 v189, v26, v27
    v_cvt_pk_bf16_f32 v190, v28, v29
    v_cvt_pk_bf16_f32 v191, v30, v31
    s_waitcnt lgkmcnt(3)
    v_mfma_f32_32x32x16_bf16 v[0:15], a[0:3], v[128:131], v[224:239]
    ds_read_b128 a[8:11], v67 offset:3584
    v_exp_f32 v32, v32
    v_exp_f32 v33, v33
    v_exp_f32 v34, v34
    v_exp_f32 v35, v35
    v_exp_f32 v36, v36
    v_exp_f32 v37, v37
    s_waitcnt lgkmcnt(2)
    v_mfma_f32_32x32x16_bf16 v[144:159], a[16:19], v[176:179], v[144:159]
    ds_read_b128 a[12:15], v68 offset:3584
    v_exp_f32 v38, v38
    v_exp_f32 v39, v39
    v_cvt_pk_bf16_f32 v192, v32, v33
    v_cvt_pk_bf16_f32 v193, v34, v35
    v_exp_f32 v40, v40
    v_exp_f32 v41, v41
    v_mfma_f32_32x32x16_bf16 v[16:31], a[0:3], v[136:139], v[240:255]
    ds_read_b128 a[24:27], v71 offset:6080
    v_exp_f32 v42, v42
    v_exp_f32 v43, v43
    v_cvt_pk_bf16_f32 v194, v36, v37
    v_cvt_pk_bf16_f32 v195, v38, v39
    v_exp_f32 v44, v44
    v_exp_f32 v45, v45
    v_mfma_f32_32x32x16_bf16 v[160:175], a[16:19], v[184:187], v[160:175]
    ds_read_b128 a[28:31], v71 offset:6688
    v_exp_f32 v46, v46
    v_exp_f32 v47, v47
    v_cvt_pk_bf16_f32 v196, v40, v41
    v_cvt_pk_bf16_f32 v197, v42, v43
    v_cvt_pk_bf16_f32 v198, v44, v45
    v_cvt_pk_bf16_f32 v199, v46, v47
    v_mfma_f32_32x32x16_bf16 v[0:15], a[4:7], v[132:135], v[0:15]
    v_exp_f32 v48, v48
    v_exp_f32 v49, v49
    v_exp_f32 v50, v50
    v_exp_f32 v51, v51
    v_exp_f32 v52, v52
    v_exp_f32 v53, v53
    s_waitcnt lgkmcnt(4)
    v_mfma_f32_32x32x16_bf16 v[144:159], a[20:23], v[180:183], v[144:159]
    v_exp_f32 v54, v54
    v_exp_f32 v55, v55
    v_cvt_pk_bf16_f32 v200, v48, v49
    v_cvt_pk_bf16_f32 v201, v50, v51
    v_exp_f32 v56, v56
    v_exp_f32 v57, v57
    v_mfma_f32_32x32x16_bf16 v[16:31], a[4:7], v[140:143], v[16:31]
    v_exp_f32 v58, v58
    v_exp_f32 v59, v59
    v_cvt_pk_bf16_f32 v202, v52, v53
    s_waitcnt vmcnt(8)
    s_barrier
    v_mov_b32 v212, s32
    v_mov_b32 v213, s33
    s_lshl_b32 s34, s2, 7
    s_add_u32 s34, s34, 49946624
    buffer_store_dwordx2 v[212:213], v209, s[24:27], s34 offen sc1
    v_cvt_pk_bf16_f32 v203, v54, v55
    v_exp_f32 v60, v60
    v_exp_f32 v61, v61
    v_mfma_f32_32x32x16_bf16 v[160:175], a[20:23], v[188:191], v[160:175]
    v_exp_f32 v62, v62
    v_exp_f32 v63, v63
    v_cvt_pk_bf16_f32 v204, v56, v57
    v_cvt_pk_bf16_f32 v205, v58, v59
    v_cvt_pk_bf16_f32 v206, v60, v61
    v_cvt_pk_bf16_f32 v207, v62, v63
    s_waitcnt lgkmcnt(3)
    v_mfma_f32_32x32x16_bf16 v[32:47], a[8:11], v[128:131], v[224:239]
    ds_read_b128 a[0:3], v69 offset:0
    v_exp_f32 v0, v0
    v_exp_f32 v1, v1
    v_exp_f32 v2, v2
    v_exp_f32 v3, v3
    v_exp_f32 v4, v4
    v_exp_f32 v5, v5
    s_waitcnt lgkmcnt(2)
    v_mfma_f32_32x32x16_bf16 v[144:159], a[24:27], v[192:195], v[144:159]
    ds_read_b128 a[4:7], v70 offset:0
    v_exp_f32 v6, v6
    v_exp_f32 v7, v7
    v_cvt_pk_bf16_f32 v176, v0, v1
    v_cvt_pk_bf16_f32 v177, v2, v3
    v_exp_f32 v8, v8
    v_exp_f32 v9, v9
    v_mfma_f32_32x32x16_bf16 v[48:63], a[8:11], v[136:139], v[240:255]
    ds_read_b128 a[16:19], v71 offset:7296
    v_exp_f32 v10, v10
    v_exp_f32 v11, v11
    v_cvt_pk_bf16_f32 v178, v4, v5
    v_cvt_pk_bf16_f32 v179, v6, v7
    v_exp_f32 v12, v12
    v_exp_f32 v13, v13
    v_mfma_f32_32x32x16_bf16 v[160:175], a[24:27], v[200:203], v[160:175]
    ds_read_b128 a[20:23], v71 offset:7904
    v_exp_f32 v14, v14
    v_exp_f32 v15, v15
    v_cvt_pk_bf16_f32 v180, v8, v9
    v_cvt_pk_bf16_f32 v181, v10, v11
    v_cvt_pk_bf16_f32 v182, v12, v13
    v_cvt_pk_bf16_f32 v183, v14, v15
    v_mfma_f32_32x32x16_bf16 v[32:47], a[12:15], v[132:135], v[32:47]
    v_exp_f32 v16, v16
    v_exp_f32 v17, v17
    v_exp_f32 v18, v18
    v_exp_f32 v19, v19
    v_exp_f32 v20, v20
    v_exp_f32 v21, v21
    s_waitcnt lgkmcnt(4)
    v_mfma_f32_32x32x16_bf16 v[144:159], a[28:31], v[196:199], v[144:159]
    v_exp_f32 v22, v22
    v_exp_f32 v23, v23
    v_cvt_pk_bf16_f32 v184, v16, v17
    v_cvt_pk_bf16_f32 v185, v18, v19
    v_exp_f32 v24, v24
    v_exp_f32 v25, v25
    v_mfma_f32_32x32x16_bf16 v[48:63], a[12:15], v[140:143], v[48:63]
    v_exp_f32 v26, v26
    v_exp_f32 v27, v27
    v_cvt_pk_bf16_f32 v186, v20, v21
    v_cvt_pk_bf16_f32 v187, v22, v23
    v_exp_f32 v28, v28
    v_exp_f32 v29, v29
    v_mfma_f32_32x32x16_bf16 v[160:175], a[28:31], v[204:207], v[160:175]
    v_exp_f32 v30, v30
    v_exp_f32 v31, v31
    v_cvt_pk_bf16_f32 v188, v24, v25
    v_cvt_pk_bf16_f32 v189, v26, v27
    v_cvt_pk_bf16_f32 v190, v28, v29
    v_cvt_pk_bf16_f32 v191, v30, v31
    s_waitcnt lgkmcnt(3)
    v_mfma_f32_32x32x16_bf16 v[0:15], a[0:3], v[128:131], v[224:239]
    ds_read_b128 a[8:11], v69 offset:512
    v_exp_f32 v32, v32
    v_exp_f32 v33, v33
    v_exp_f32 v34, v34
    v_exp_f32 v35, v35
    v_exp_f32 v36, v36
    v_exp_f32 v37, v37
    s_waitcnt lgkmcnt(2)
    v_mfma_f32_32x32x16_bf16 v[144:159], a[16:19], v[176:179], v[144:159]
    ds_read_b128 a[12:15], v70 offset:512
    v_exp_f32 v38, v38
    v_exp_f32 v39, v39
    v_cvt_pk_bf16_f32 v192, v32, v33
    v_cvt_pk_bf16_f32 v193, v34, v35
    v_exp_f32 v40, v40
    v_exp_f32 v41, v41
    v_mfma_f32_32x32x16_bf16 v[16:31], a[0:3], v[136:139], v[240:255]
    ds_read_b128 a[24:27], v71 offset:8512
    v_exp_f32 v42, v42
    v_exp_f32 v43, v43
    v_cvt_pk_bf16_f32 v194, v36, v37
    v_cvt_pk_bf16_f32 v195, v38, v39
    v_exp_f32 v44, v44
    v_exp_f32 v45, v45
    v_mfma_f32_32x32x16_bf16 v[160:175], a[16:19], v[184:187], v[160:175]
    ds_read_b128 a[28:31], v71 offset:9120
    v_exp_f32 v46, v46
    v_exp_f32 v47, v47
    v_cvt_pk_bf16_f32 v196, v40, v41
    v_cvt_pk_bf16_f32 v197, v42, v43
    v_cvt_pk_bf16_f32 v198, v44, v45
    v_cvt_pk_bf16_f32 v199, v46, v47
    v_mfma_f32_32x32x16_bf16 v[0:15], a[4:7], v[132:135], v[0:15]
    v_exp_f32 v48, v48
    v_exp_f32 v49, v49
    v_exp_f32 v50, v50
    v_exp_f32 v51, v51
    v_exp_f32 v52, v52
    v_exp_f32 v53, v53
    s_waitcnt lgkmcnt(4)
    v_mfma_f32_32x32x16_bf16 v[144:159], a[20:23], v[180:183], v[144:159]
    v_exp_f32 v54, v54
    v_exp_f32 v55, v55
    v_cvt_pk_bf16_f32 v200, v48, v49
    v_cvt_pk_bf16_f32 v201, v50, v51
    v_exp_f32 v56, v56
    v_exp_f32 v57, v57
    v_mfma_f32_32x32x16_bf16 v[16:31], a[4:7], v[140:143], v[16:31]
    v_exp_f32 v58, v58
    v_exp_f32 v59, v59
    v_cvt_pk_bf16_f32 v202, v52, v53
    v_cvt_pk_bf16_f32 v203, v54, v55
    v_exp_f32 v60, v60
    v_exp_f32 v61, v61
    v_mfma_f32_32x32x16_bf16 v[160:175], a[20:23], v[188:191], v[160:175]
    v_exp_f32 v62, v62
    v_exp_f32 v63, v63
    v_cvt_pk_bf16_f32 v204, v56, v57
    v_cvt_pk_bf16_f32 v205, v58, v59
    v_cvt_pk_bf16_f32 v206, v60, v61
    v_cvt_pk_bf16_f32 v207, v62, v63
    s_mov_b32 s78, 3
L_att:
    v_add_u32 v67, s76, v65
    v_add_u32 v69, s77, v65
    s_add_u32 s34, s76, 8192
    s_add_u32 s35, s77, 8192
    s_add_u32 s36, s76, 12288
    v_add_u32 v68, s34, v64
    v_add_u32 v70, s35, v64
    v_add_u32 v71, s36, v66
    s_mov_b32 s76, s77
    s_sub_u32 s77, s77, 36864
    s_cselect_b32 s77, 110592, s77
    s_waitcnt lgkmcnt(3)
    v_mfma_f32_32x32x16_bf16 v[32:47], a[8:11], v[128:131], v[224:239]
    ds_read_b128 a[0:3], v67 offset:1024
    v_exp_f32 v0, v0
    v_exp_f32 v1, v1
    v_exp_f32 v2, v2
    v_exp_f32 v3, v3
    v_exp_f32 v4, v4
    v_exp_f32 v5, v5
    s_waitcnt lgkmcnt(2)
    v_mfma_f32_32x32x16_bf16 v[144:159], a[24:27], v[192:195], v[144:159]
    ds_read_b128 a[4:7], v68 offset:1024
    v_exp_f32 v6, v6
    v_exp_f32 v7, v7
    v_cvt_pk_bf16_f32 v176, v0, v1
    v_cvt_pk_bf16_f32 v177, v2, v3
    v_exp_f32 v8, v8
    v_exp_f32 v9, v9
    v_mfma_f32_32x32x16_bf16 v[48:63], a[8:11], v[136:139], v[240:255]
    ds_read_b128 a[16:19], v71 offset:0
    v_exp_f32 v10, v10
    v_exp_f32 v11, v11
    v_cvt_pk_bf16_f32 v178, v4, v5
    s_add_u32 m0, s75, s69
    s_nop 0
    buffer_load_dwordx4 v210, s[24:27], s63 offen sc1 lds
    s_add_u32 s63, s63, 4096
    v_cvt_pk_bf16_f32 v179, v6, v7
    v_exp_f32 v12, v12
    v_exp_f32 v13, v13
    v_mfma_f32_32x32x16_bf16 v[160:175], a[24:27], v[200:203], v[160:175]
    ds_read_b128 a[20:23], v71 offset:608
    v_exp_f32 v14, v14
    v_exp_f32 v15, v15
    v_cvt_pk_bf16_f32 v180, v8, v9
    v_cvt_pk_bf16_f32 v181, v10, v11
    v_cvt_pk_bf16_f32 v182, v12, v13
    v_cvt_pk_bf16_f32 v183, v14, v15
    v_mfma_f32_32x32x16_bf16 v[32:47], a[12:15], v[132:135], v[32:47]
    v_exp_f32 v16, v16
    v_exp_f32 v17, v17
    v_exp_f32 v18, v18
    v_exp_f32 v19, v19
    v_exp_f32 v20, v20
    v_exp_f32 v21, v21
    s_waitcnt lgkmcnt(4)
    v_mfma_f32_32x32x16_bf16 v[144:159], a[28:31], v[196:199], v[144:159]
    v_exp_f32 v22, v22
    v_exp_f32 v23, v23
    v_cvt_pk_bf16_f32 v184, v16, v17
    v_cvt_pk_bf16_f32 v185, v18, v19
    v_exp_f32 v24, v24
    v_exp_f32 v25, v25
    v_mfma_f32_32x32x16_bf16 v[48:63], a[12:15], v[140:143], v[48:63]
    v_exp_f32 v26, v26
    v_exp_f32 v27, v27
    v_cvt_pk_bf16_f32 v186, v20, v21
    s_add_u32 m0, s75, s70
    s_nop 0
    buffer_load_dwordx4 v210, s[24:27], s64 offen sc1 lds
    s_add_u32 s64, s64, 4096
    v_cvt_pk_bf16_f32 v187, v22, v23
    v_exp_f32 v28, v28
    v_exp_f32 v29, v29
    v_mfma_f32_32x32x16_bf16 v[160:175], a[28:31], v[204:207], v[160:175]
    v_exp_f32 v30, v30
    v_exp_f32 v31, v31
    v_cvt_pk_bf16_f32 v188, v24, v25
    v_cvt_pk_bf16_f32 v189, v26, v27
    v_cvt_pk_bf16_f32 v190, v28, v29
    v_cvt_pk_bf16_f32 v191, v30, v31
    s_waitcnt lgkmcnt(3)
    v_mfma_f32_32x32x16_bf16 v[0:15], a[0:3], v[128:131], v[224:239]
    ds_read_b128 a[8:11], v67 offset:1536
    v_exp_f32 v32, v32
    v_exp_f32 v33, v33
    v_exp_f32 v34, v34
    v_exp_f32 v35, v35
    v_exp_f32 v36, v36
    v_exp_f32 v37, v37
    s_waitcnt lgkmcnt(2)
    v_mfma_f32_32x32x16_bf16 v[144:159], a[16:19], v[176:179], v[144:159]
    ds_read_b128 a[12:15], v68 offset:1536
    v_exp_f32 v38, v38
    v_exp_f32 v39, v39
    v_cvt_pk_bf16_f32 v192, v32, v33
    v_cvt_pk_bf16_f32 v193, v34, v35
    v_exp_f32 v40, v40
    v_exp_f32 v41, v41
    v_mfma_f32_32x32x16_bf16 v[16:31], a[0:3], v[136:139], v[240:255]
    ds_read_b128 a[24:27], v71 offset:1216
    v_exp_f32 v42, v42
    v_exp_f32 v43, v43
    v_cvt_pk_bf16_f32 v194, v36, v37
    s_add_u32 m0, s75, s71
    s_nop 0
    buffer_load_dwordx4 v210, s[24:27], s65 offen sc1 lds
    s_add_u32 s65, s65, 4096
    v_cvt_pk_bf16_f32 v195, v38, v39
    v_exp_f32 v44, v44
    v_exp_f32 v45, v45
    v_mfma_f32_32x32x16_bf16 v[160:175], a[16:19], v[184:187], v[160:175]
    ds_read_b128 a[28:31], v71 offset:1824
    v_exp_f32 v46, v46
    v_exp_f32 v47, v47
    v_cvt_pk_bf16_f32 v196, v40, v41
    v_cvt_pk_bf16_f32 v197, v42, v43
    v_cvt_pk_bf16_f32 v198, v44, v45
    v_cvt_pk_bf16_f32 v199, v46, v47
    v_mfma_f32_32x32x16_bf16 v[0:15], a[4:7], v[132:135], v[0:15]
    v_exp_f32 v48, v48
    v_exp_f32 v49, v49
    v_exp_f32 v50, v50
    v_exp_f32 v51, v51
    v_exp_f32 v52, v52
    v_exp_f32 v53, v53
    s_waitcnt lgkmcnt(4)
    v_mfma_f32_32x32x16_bf16 v[144:159], a[20:23], v[180:183], v[144:159]
    v_exp_f32 v54, v54
    v_exp_f32 v55, v55
    v_cvt_pk_bf16_f32 v200, v48, v49
    v_cvt_pk_bf16_f32 v201, v50, v51
    v_exp_f32 v56, v56
    v_exp_f32 v57, v57
    v_mfma_f32_32x32x16_bf16 v[16:31], a[4:7], v[140:143], v[16:31]
    v_exp_f32 v58, v58
    v_exp_f32 v59, v59
    v_cvt_pk_bf16_f32 v202, v52, v53
    s_add_u32 m0, s75, s72
    s_nop 0
    buffer_load_dwordx4 v210, s[24:27], s66 offen sc1 lds
    s_add_u32 s66, s66, 9728
    v_cvt_pk_bf16_f32 v203, v54, v55
    v_exp_f32 v60, v60
    v_exp_f32 v61, v61
    v_mfma_f32_32x32x16_bf16 v[160:175], a[20:23], v[188:191], v[160:175]
    v_exp_f32 v62, v62
    v_exp_f32 v63, v63
    v_cvt_pk_bf16_f32 v204, v56, v57
    v_cvt_pk_bf16_f32 v205, v58, v59
    v_cvt_pk_bf16_f32 v206, v60, v61
    v_cvt_pk_bf16_f32 v207, v62, v63
    s_waitcnt lgkmcnt(3)
    v_mfma_f32_32x32x16_bf16 v[32:47], a[8:11], v[128:131], v[224:239]
    ds_read_b128 a[0:3], v67 offset:2048
    v_exp_f32 v0, v0
    v_exp_f32 v1, v1
    v_exp_f32 v2, v2
    v_exp_f32 v3, v3
    v_exp_f32 v4, v4
    v_exp_f32 v5, v5
    s_waitcnt lgkmcnt(2)
    v_mfma_f32_32x32x16_bf16 v[144:159], a[24:27], v[192:195], v[144:159]
    ds_read_b128 a[4:7], v68 offset:2048
    v_exp_f32 v6, v6
    v_exp_f32 v7, v7
    v_cvt_pk_bf16_f32 v176, v0, v1
    v_cvt_pk_bf16_f32 v177, v2, v3
    v_exp_f32 v8, v8
    v_exp_f32 v9, v9
    v_mfma_f32_32x32x16_bf16 v[48:63], a[8:11], v[136:139], v[240:255]
    ds_read_b128 a[16:19], v71 offset:2432
    v_exp_f32 v10, v10
    v_exp_f32 v11, v11
    v_cvt_pk_bf16_f32 v178, v4, v5
    s_add_u32 m0, s75, s73
    s_nop 0
    buffer_load_dwordx4 v210, s[24:27], s67 offen sc1 lds
    s_add_u32 s67, s67, 9728
    v_cvt_pk_bf16_f32 v179, v6, v7
    v_exp_f32 v12, v12
    v_exp_f32 v13, v13
    v_mfma_f32_32x32x16_bf16 v[160:175], a[24:27], v[200:203], v[160:175]
    ds_read_b128 a[20:23], v71 offset:3040
    v_exp_f32 v14, v14
    v_exp_f32 v15, v15
    v_cvt_pk_bf16_f32 v180, v8, v9
    v_cvt_pk_bf16_f32 v181, v10, v11
    v_cvt_pk_bf16_f32 v182, v12, v13
    v_cvt_pk_bf16_f32 v183, v14, v15
    v_mfma_f32_32x32x16_bf16 v[32:47], a[12:15], v[132:135], v[32:47]
    v_exp_f32 v16, v16
    v_exp_f32 v17, v17
    v_exp_f32 v18, v18
    v_exp_f32 v19, v19
    v_exp_f32 v20, v20
    v_exp_f32 v21, v21
    s_waitcnt lgkmcnt(4)
    v_mfma_f32_32x32x16_bf16 v[144:159], a[28:31], v[196:199], v[144:159]
    v_exp_f32 v22, v22
    v_exp_f32 v23, v23
    v_cvt_pk_bf16_f32 v184, v16, v17
    v_cvt_pk_bf16_f32 v185, v18, v19
    v_exp_f32 v24, v24
    v_exp_f32 v25, v25
    v_mfma_f32_32x32x16_bf16 v[48:63], a[12:15], v[140:143], v[48:63]
    v_exp_f32 v26, v26
    v_exp_f32 v27, v27
    v_cvt_pk_bf16_f32 v186, v20, v21
    s_add_u32 m0, s75, s74
    s_nop 0
    buffer_load_dwordx4 v210, s[24:27], s68 offen sc1 lds
    s_add_u32 s68, s68, 9728
    s_sub_u32 s75, s75, 36864
    s_cselect_b32 s75, 110592, s75
    v_cvt_pk_bf16_f32 v187, v22, v23
    v_exp_f32 v28, v28
    v_exp_f32 v29, v29
    v_mfma_f32_32x32x16_bf16 v[160:175], a[28:31], v[204:207], v[160:175]
    v_exp_f32 v30, v30
    v_exp_f32 v31, v31
    v_cvt_pk_bf16_f32 v188, v24, v25
    v_cvt_pk_bf16_f32 v189, v26, v27
    v_cvt_pk_bf16_f32 v190, v28, v29
    v_cvt_pk_bf16_f32 v191, v30, v31
    s_waitcnt lgkmcnt(3)
    v_mfma_f32_32x32x16_bf16 v[0:15], a[0:3], v[128:131], v[224:239]
    ds_read_b128 a[8:11], v67 offset:2560
    v_exp_f32 v32, v32
    v_exp_f32 v33, v33
    v_exp_f32 v34, v34
    v_exp_f32 v35, v35
    v_exp_f32 v36, v36
    v_exp_f32 v37, v37
    s_waitcnt lgkmcnt(2)
    v_mfma_f32_32x32x16_bf16 v[144:159], a[16:19], v[176:179], v[144:159]
    ds_read_b128 a[12:15], v68 offset:2560
    v_exp_f32 v38, v38
    v_exp_f32 v39, v39
    v_cvt_pk_bf16_f32 v192, v32, v33
    v_cvt_pk_bf16_f32 v193, v34, v35
    v_exp_f32 v40, v40
    v_exp_f32 v41, v41
    v_mfma_f32_32x32x16_bf16 v[16:31], a[0:3], v[136:139], v[240:255]
    ds_read_b128 a[24:27], v71 offset:3648
    v_exp_f32 v42, v42
    v_exp_f32 v43, v43
    v_cvt_pk_bf16_f32 v194, v36, v37
    v_cvt_pk_bf16_f32 v195, v38, v39
    v_exp_f32 v44, v44
    v_exp_f32 v45, v45
    v_mfma_f32_32x32x16_bf16 v[160:175], a[16:19], v[184:187], v[160:175]
    ds_read_b128 a[28:31], v71 offset:4256
    v_exp_f32 v46, v46
    v_exp_f32 v47, v47
    v_cvt_pk_bf16_f32 v196, v40, v41
    v_cvt_pk_bf16_f32 v197, v42, v43
    v_cvt_pk_bf16_f32 v198, v44, v45
    v_cvt_pk_bf16_f32 v199, v46, v47
    v_mfma_f32_32x32x16_bf16 v[0:15], a[4:7], v[132:135], v[0:15]
    v_exp_f32 v48, v48
    v_exp_f32 v49, v49
    v_exp_f32 v50, v50
    v_exp_f32 v51, v51
    v_exp_f32 v52, v52
    v_exp_f32 v53, v53
    s_waitcnt lgkmcnt(4)
    v_mfma_f32_32x32x16_bf16 v[144:159], a[20:23], v[180:183], v[144:159]
    v_exp_f32 v54, v54
    v_exp_f32 v55, v55
    v_cvt_pk_bf16_f32 v200, v48, v49
    v_cvt_pk_bf16_f32 v201, v50, v51
    v_exp_f32 v56, v56
    v_exp_f32 v57, v57
    v_mfma_f32_32x32x16_bf16 v[16:31], a[4:7], v[140:143], v[16:31]
    v_exp_f32 v58, v58
    v_exp_f32 v59, v59
    v_cvt_pk_bf16_f32 v202, v52, v53
    v_cvt_pk_bf16_f32 v203, v54, v55
    v_exp_f32 v60, v60
    v_exp_f32 v61, v61
    v_mfma_f32_32x32x16_bf16 v[160:175], a[20:23], v[188:191], v[160:175]
    v_exp_f32 v62, v62
    v_exp_f32 v63, v63
    v_cvt_pk_bf16_f32 v204, v56, v57
    v_cvt_pk_bf16_f32 v205, v58, v59
    v_cvt_pk_bf16_f32 v206, v60, v61
    v_cvt_pk_bf16_f32 v207, v62, v63
    s_waitcnt lgkmcnt(3)
    v_mfma_f32_32x32x16_bf16 v[32:47], a[8:11], v[128:131], v[224:239]
    ds_read_b128 a[0:3], v67 offset:3072
    v_exp_f32 v0, v0
    v_exp_f32 v1, v1
    v_exp_f32 v2, v2
    v_exp_f32 v3, v3
    v_exp_f32 v4, v4
    v_exp_f32 v5, v5
    s_waitcnt lgkmcnt(2)
    v_mfma_f32_32x32x16_bf16 v[144:159], a[24:27], v[192:195], v[144:159]
    ds_read_b128 a[4:7], v68 offset:3072
    v_exp_f32 v6, v6
    v_exp_f32 v7, v7
    v_cvt_pk_bf16_f32 v176, v0, v1
    v_cvt_pk_bf16_f32 v177, v2, v3
    v_exp_f32 v8, v8
    v_exp_f32 v9, v9
    v_mfma_f32_32x32x16_bf16 v[48:63], a[8:11], v[136:139], v[240:255]
    ds_read_b128 a[16:19], v71 offset:4864
    v_exp_f32 v10, v10
    v_exp_f32 v11, v11
    v_cvt_pk_bf16_f32 v178, v4, v5
    v_cvt_pk_bf16_f32 v179, v6, v7
    v_exp_f32 v12, v12
    v_exp_f32 v13, v13
    v_mfma_f32_32x32x16_bf16 v[160:175], a[24:27], v[200:203], v[160:175]
    ds_read_b128 a[20:23], v71 offset:5472
    v_exp_f32 v14, v14
    v_exp_f32 v15, v15
    v_cvt_pk_bf16_f32 v180, v8, v9
    v_cvt_pk_bf16_f32 v181, v10, v11
    v_cvt_pk_bf16_f32 v182, v12, v13
    v_cvt_pk_bf16_f32 v183, v14, v15
    v_mfma_f32_32x32x16_bf16 v[32:47], a[12:15], v[132:135], v[32:47]
    v_exp_f32 v16, v16
    v_exp_f32 v17, v17
    v_exp_f32 v18, v18
    v_exp_f32 v19, v19
    v_exp_f32 v20, v20
    v_exp_f32 v21, v21
    s_waitcnt lgkmcnt(4)
    v_mfma_f32_32x32x16_bf16 v[144:159], a[28:31], v[196:199], v[144:159]
    v_exp_f32 v22, v22
    v_exp_f32 v23, v23
    v_cvt_pk_bf16_f32 v184, v16, v17
    v_cvt_pk_bf16_f32 v185, v18, v19
    v_exp_f32 v24, v24
    v_exp_f32 v25, v25
    v_mfma_f32_32x32x16_bf16 v[48:63], a[12:15], v[140:143], v[48:63]
    v_exp_f32 v26, v26
    v_exp_f32 v27, v27
    v_cvt_pk_bf16_f32 v186, v20, v21
    v_cvt_pk_bf16_f32 v187, v22, v23
    v_exp_f32 v28, v28
    v_exp_f32 v29, v29
    v_mfma_f32_32x32x16_bf16 v[160:175], a[28:31], v[204:207], v[160:175]
    v_exp_f32 v30, v30
    v_exp_f32 v31, v31
    v_cvt_pk_bf16_f32 v188, v24, v25
    v_cvt_pk_bf16_f32 v189, v26, v27
    v_cvt_pk_bf16_f32 v190, v28, v29
    v_cvt_pk_bf16_f32 v191, v30, v31
    s_waitcnt lgkmcnt(3)
    v_mfma_f32_32x32x16_bf16 v[0:15], a[0:3], v[128:131], v[224:239]
    ds_read_b128 a[8:11], v67 offset:3584
    v_exp_f32 v32, v32
    v_exp_f32 v33, v33
    v_exp_f32 v34, v34
    v_exp_f32 v35, v35
    v_exp_f32 v36, v36
    v_exp_f32 v37, v37
    s_waitcnt lgkmcnt(2)
    v_mfma_f32_32x32x16_bf16 v[144:159], a[16:19], v[176:179], v[144:159]
    ds_read_b128 a[12:15], v68 offset:3584
    v_exp_f32 v38, v38
    v_exp_f32 v39, v39
    v_cvt_pk_bf16_f32 v192, v32, v33
    v_cvt_pk_bf16_f32 v193, v34, v35
    v_exp_f32 v40, v40
    v_exp_f32 v41, v41
    v_mfma_f32_32x32x16_bf16 v[16:31], a[0:3], v[136:139], v[240:255]
    ds_read_b128 a[24:27], v71 offset:6080
    v_exp_f32 v42, v42
    v_exp_f32 v43, v43
    v_cvt_pk_bf16_f32 v194, v36, v37
    v_cvt_pk_bf16_f32 v195, v38, v39
    v_exp_f32 v44, v44
    v_exp_f32 v45, v45
    v_mfma_f32_32x32x16_bf16 v[160:175], a[16:19], v[184:187], v[160:175]
    ds_read_b128 a[28:31], v71 offset:6688
    v_exp_f32 v46, v46
    v_exp_f32 v47, v47
    v_cvt_pk_bf16_f32 v196, v40, v41
    v_cvt_pk_bf16_f32 v197, v42, v43
    v_cvt_pk_bf16_f32 v198, v44, v45
    v_cvt_pk_bf16_f32 v199, v46, v47
    v_mfma_f32_32x32x16_bf16 v[0:15], a[4:7], v[132:135], v[0:15]
    v_exp_f32 v48, v48
    v_exp_f32 v49, v49
    v_exp_f32 v50, v50
    v_exp_f32 v51, v51
    v_exp_f32 v52, v52
    v_exp_f32 v53, v53
    s_waitcnt lgkmcnt(4)
    v_mfma_f32_32x32x16_bf16 v[144:159], a[20:23], v[180:183], v[144:159]
    v_exp_f32 v54, v54
    v_exp_f32 v55, v55
    v_cvt_pk_bf16_f32 v200, v48, v49
    v_cvt_pk_bf16_f32 v201, v50, v51
    v_exp_f32 v56, v56
    v_exp_f32 v57, v57
    v_mfma_f32_32x32x16_bf16 v[16:31], a[4:7], v[140:143], v[16:31]
    v_exp_f32 v58, v58
    v_exp_f32 v59, v59
    v_cvt_pk_bf16_f32 v202, v52, v53
    s_waitcnt vmcnt(6)
    s_barrier
    v_cvt_pk_bf16_f32 v203, v54, v55
    v_exp_f32 v60, v60
    v_exp_f32 v61, v61
    v_mfma_f32_32x32x16_bf16 v[160:175], a[20:23], v[188:191], v[160:175]
    v_exp_f32 v62, v62
    v_exp_f32 v63, v63
    v_cvt_pk_bf16_f32 v204, v56, v57
    v_cvt_pk_bf16_f32 v205, v58, v59
    v_cvt_pk_bf16_f32 v206, v60, v61
    v_cvt_pk_bf16_f32 v207, v62, v63
    s_waitcnt lgkmcnt(3)
    v_mfma_f32_32x32x16_bf16 v[32:47], a[8:11], v[128:131], v[224:239]
    ds_read_b128 a[0:3], v69 offset:0
    v_exp_f32 v0, v0
    v_exp_f32 v1, v1
    v_exp_f32 v2, v2
    v_exp_f32 v3, v3
    v_exp_f32 v4, v4
    v_exp_f32 v5, v5
    s_waitcnt lgkmcnt(2)
    v_mfma_f32_32x32x16_bf16 v[144:159], a[24:27], v[192:195], v[144:159]
    ds_read_b128 a[4:7], v70 offset:0
    v_exp_f32 v6, v6
    v_exp_f32 v7, v7
    v_cvt_pk_bf16_f32 v176, v0, v1
    v_cvt_pk_bf16_f32 v177, v2, v3
    v_exp_f32 v8, v8
    v_exp_f32 v9, v9
    v_mfma_f32_32x32x16_bf16 v[48:63], a[8:11], v[136:139], v[240:255]
    ds_read_b128 a[16:19], v71 offset:7296
    v_exp_f32 v10, v10
    v_exp_f32 v11, v11
    v_cvt_pk_bf16_f32 v178, v4, v5
    v_cvt_pk_bf16_f32 v179, v6, v7
    v_exp_f32 v12, v12
    v_exp_f32 v13, v13
    v_mfma_f32_32x32x16_bf16 v[160:175], a[24:27], v[200:203], v[160:175]
    ds_read_b128 a[20:23], v71 offset:7904
    v_exp_f32 v14, v14
    v_exp_f32 v15, v15
    v_cvt_pk_bf16_f32 v180, v8, v9
    v_cvt_pk_bf16_f32 v181, v10, v11
    v_cvt_pk_bf16_f32 v182, v12, v13
    v_cvt_pk_bf16_f32 v183, v14, v15
    v_mfma_f32_32x32x16_bf16 v[32:47], a[12:15], v[132:135], v[32:47]
    v_exp_f32 v16, v16
    v_exp_f32 v17, v17
    v_exp_f32 v18, v18
    v_exp_f32 v19, v19
    v_exp_f32 v20, v20
    v_exp_f32 v21, v21
    s_waitcnt lgkmcnt(4)
    v_mfma_f32_32x32x16_bf16 v[144:159], a[28:31], v[196:199], v[144:159]
    v_exp_f32 v22, v22
    v_exp_f32 v23, v23
    v_cvt_pk_bf16_f32 v184, v16, v17
    v_cvt_pk_bf16_f32 v185, v18, v19
    v_exp_f32 v24, v24
    v_exp_f32 v25, v25
    v_mfma_f32_32x32x16_bf16 v[48:63], a[12:15], v[140:143], v[48:63]
    v_exp_f32 v26, v26
    v_exp_f32 v27, v27
    v_cvt_pk_bf16_f32 v186, v20, v21
    v_cvt_pk_bf16_f32 v187, v22, v23
    v_exp_f32 v28, v28
    v_exp_f32 v29, v29
    v_mfma_f32_32x32x16_bf16 v[160:175], a[28:31], v[204:207], v[160:175]
    v_exp_f32 v30, v30
    v_exp_f32 v31, v31
    v_cvt_pk_bf16_f32 v188, v24, v25
    v_cvt_pk_bf16_f32 v189, v26, v27
    v_cvt_pk_bf16_f32 v190, v28, v29
    v_cvt_pk_bf16_f32 v191, v30, v31
    s_waitcnt lgkmcnt(3)
    v_mfma_f32_32x32x16_bf16 v[0:15], a[0:3], v[128:131], v[224:239]
    ds_read_b128 a[8:11], v69 offset:512
    v_exp_f32 v32, v32
    v_exp_f32 v33, v33
    v_exp_f32 v34, v34
    v_exp_f32 v35, v35
    v_exp_f32 v36, v36
    v_exp_f32 v37, v37
    s_waitcnt lgkmcnt(2)
    v_mfma_f32_32x32x16_bf16 v[144:159], a[16:19], v[176:179], v[144:159]
    ds_read_b128 a[12:15], v70 offset:512
    v_exp_f32 v38, v38
    v_exp_f32 v39, v39
    v_cvt_pk_bf16_f32 v192, v32, v33
    v_cvt_pk_bf16_f32 v193, v34, v35
    v_exp_f32 v40, v40
    v_exp_f32 v41, v41
    v_mfma_f32_32x32x16_bf16 v[16:31], a[0:3], v[136:139], v[240:255]
    ds_read_b128 a[24:27], v71 offset:8512
    v_exp_f32 v42, v42
    v_exp_f32 v43, v43
    v_cvt_pk_bf16_f32 v194, v36, v37
    v_cvt_pk_bf16_f32 v195, v38, v39
    v_exp_f32 v44, v44
    v_exp_f32 v45, v45
    v_mfma_f32_32x32x16_bf16 v[160:175], a[16:19], v[184:187], v[160:175]
    ds_read_b128 a[28:31], v71 offset:9120
    v_exp_f32 v46, v46
    v_exp_f32 v47, v47
    v_cvt_pk_bf16_f32 v196, v40, v41
    v_cvt_pk_bf16_f32 v197, v42, v43
    v_cvt_pk_bf16_f32 v198, v44, v45
    v_cvt_pk_bf16_f32 v199, v46, v47
    v_mfma_f32_32x32x16_bf16 v[0:15], a[4:7], v[132:135], v[0:15]
    v_exp_f32 v48, v48
    v_exp_f32 v49, v49
    v_exp_f32 v50, v50
    v_exp_f32 v51, v51
    v_exp_f32 v52, v52
    v_exp_f32 v53, v53
    s_waitcnt lgkmcnt(4)
    v_mfma_f32_32x32x16_bf16 v[144:159], a[20:23], v[180:183], v[144:159]
    v_exp_f32 v54, v54
    v_exp_f32 v55, v55
    v_cvt_pk_bf16_f32 v200, v48, v49
    v_cvt_pk_bf16_f32 v201, v50, v51
    v_exp_f32 v56, v56
    v_exp_f32 v57, v57
    v_mfma_f32_32x32x16_bf16 v[16:31], a[4:7], v[140:143], v[16:31]
    v_exp_f32 v58, v58
    v_exp_f32 v59, v59
    v_cvt_pk_bf16_f32 v202, v52, v53
    v_cvt_pk_bf16_f32 v203, v54, v55
    v_exp_f32 v60, v60
    v_exp_f32 v61, v61
    v_mfma_f32_32x32x16_bf16 v[160:175], a[20:23], v[188:191], v[160:175]
    v_exp_f32 v62, v62
    v_exp_f32 v63, v63
    v_cvt_pk_bf16_f32 v204, v56, v57
    v_cvt_pk_bf16_f32 v205, v58, v59
    v_cvt_pk_bf16_f32 v206, v60, v61
    v_cvt_pk_bf16_f32 v207, v62, v63
    s_sub_u32 s78, s78, 1
    s_cmp_lg_u32 s78, 0
    s_cbranch_scc1 L_att
    v_add_u32 v67, s76, v65
    v_add_u32 v69, s77, v65
    s_add_u32 s34, s76, 8192
    s_add_u32 s35, s77, 8192
    s_add_u32 s36, s76, 12288
    v_add_u32 v68, s34, v64
    v_add_u32 v70, s35, v64
    v_add_u32 v71, s36, v66
    s_mov_b32 s76, s77
    s_sub_u32 s77, s77, 36864
    s_cselect_b32 s77, 110592, s77
    s_waitcnt lgkmcnt(3)
    v_mfma_f32_32x32x16_bf16 v[32:47], a[8:11], v[128:131], v[224:239]
    ds_read_b128 a[0:3], v67 offset:1024
    v_exp_f32 v0, v0
    v_exp_f32 v1, v1
    v_exp_f32 v2, v2
    s_mov_b32 s48, s16
    s_mov_b32 s49, s17
    v_exp_f32 v3, v3
    v_exp_f32 v4, v4
    v_exp_f32 v5, v5
    s_waitcnt lgkmcnt(2)
    v_mfma_f32_32x32x16_bf16 v[144:159], a[24:27], v[192:195], v[144:159]
    ds_read_b128 a[4:7], v68 offset:1024
    v_exp_f32 v6, v6
    v_exp_f32 v7, v7
    v_cvt_pk_bf16_f32 v176, v0, v1
    s_mov_b32 s50, 5308416
    v_cvt_pk_bf16_f32 v177, v2, v3
    v_exp_f32 v8, v8
    v_exp_f32 v9, v9
    v_mfma_f32_32x32x16_bf16 v[48:63], a[8:11], v[136:139], v[240:255]
    ds_read_b128 a[16:19], v71 offset:0
    v_exp_f32 v10, v10
    v_exp_f32 v11, v11
    v_cvt_pk_bf16_f32 v178, v4, v5
    s_add_u32 m0, s75, s69
    s_nop 0
    buffer_load_dwordx4 v210, s[24:27], s63 offen sc1 lds
    s_add_u32 s63, s63, 4096
    s_mov_b32 s51, 0x00020000
    s_lshl_b32 s34, s29, 5
    v_cvt_pk_bf16_f32 v179, v6, v7
    v_exp_f32 v12, v12
    v_exp_f32 v13, v13
    v_mfma_f32_32x32x16_bf16 v[160:175], a[24:27], v[200:203], v[160:175]
    ds_read_b128 a[20:23], v71 offset:608
    v_exp_f32 v14, v14
    v_exp_f32 v15, v15
    v_cvt_pk_bf16_f32 v180, v8, v9
    s_add_u32 s34, s34, s30
    v_cvt_pk_bf16_f32 v181, v10, v11
    v_cvt_pk_bf16_f32 v182, v12, v13
    v_cvt_pk_bf16_f32 v183, v14, v15
    v_mfma_f32_32x32x16_bf16 v[32:47], a[12:15], v[132:135], v[32:47]
    v_exp_f32 v16, v16
    v_exp_f32 v17, v17
    v_exp_f32 v18, v18
    s_lshl_b32 s34, s34, 7
    s_add_u32 s58, s34, 49946624
    v_exp_f32 v19, v19
    v_exp_f32 v20, v20
    v_exp_f32 v21, v21
    s_waitcnt lgkmcnt(4)
    v_mfma_f32_32x32x16_bf16 v[144:159], a[28:31], v[196:199], v[144:159]
    v_exp_f32 v22, v22
    v_exp_f32 v23, v23
    v_cvt_pk_bf16_f32 v184, v16, v17
    v_and_b32 v90, 3, v208
    v_cvt_pk_bf16_f32 v185, v18, v19
    v_exp_f32 v24, v24
    v_exp_f32 v25, v25
    v_mfma_f32_32x32x16_bf16 v[48:63], a[12:15], v[140:143], v[48:63]
    v_exp_f32 v26, v26
    v_exp_f32 v27, v27
    v_cvt_pk_bf16_f32 v186, v20, v21
    s_add_u32 m0, s75, s70
    s_nop 0
    buffer_load_dwordx4 v210, s[24:27], s64 offen sc1 lds
    s_add_u32 s64, s64, 4096
    v_lshlrev_b32 v87, 10, v90
    v_cvt_pk_bf16_f32 v187, v22, v23
    v_exp_f32 v28, v28
    v_exp_f32 v29, v29
    v_mfma_f32_32x32x16_bf16 v[160:175], a[28:31], v[204:207], v[160:175]
    v_exp_f32 v30, v30
    v_exp_f32 v31, v31
    v_cvt_pk_bf16_f32 v188, v24, v25
    buffer_load_dwordx2 v[88:89], v87, s[24:27], s58 offen sc1
    s_lshr_b32 s55, s2, 4
    v_cvt_pk_bf16_f32 v189, v26, v27
    v_cvt_pk_bf16_f32 v190, v28, v29
    v_cvt_pk_bf16_f32 v191, v30, v31
    s_waitcnt lgkmcnt(3)
    v_mfma_f32_32x32x16_bf16 v[0:15], a[0:3], v[128:131], v[224:239]
    ds_read_b128 a[8:11], v67 offset:1536
    v_exp_f32 v32, v32
    v_exp_f32 v33, v33
    v_exp_f32 v34, v34
    s_bfe_u32 s56, s2, 0x10003
    v_exp_f32 v35, v35
    v_exp_f32 v36, v36
    v_exp_f32 v37, v37
    s_waitcnt lgkmcnt(2)
    v_mfma_f32_32x32x16_bf16 v[144:159], a[16:19], v[176:179], v[144:159]
    ds_read_b128 a[12:15], v68 offset:1536
    v_exp_f32 v38, v38
    v_exp_f32 v39, v39
    v_cvt_pk_bf16_f32 v192, v32, v33
    s_mul_i32 s52, s30, 663552
    s_mul_i32 s34, s56, 576
    v_cvt_pk_bf16_f32 v193, v34, v35
    v_exp_f32 v40, v40
    v_exp_f32 v41, v41
    v_mfma_f32_32x32x16_bf16 v[16:31], a[0:3], v[136:139], v[240:255]
    ds_read_b128 a[24:27], v71 offset:1216
    v_exp_f32 v42, v42
    v_exp_f32 v43, v43
    v_cvt_pk_bf16_f32 v194, v36, v37
    s_add_u32 m0, s75, s71
    s_nop 0
    buffer_load_dwordx4 v210, s[24:27], s65 offen sc1 lds
    s_add_u32 s65, s65, 4096
    s_add_u32 s52, s52, s34
    v_cvt_pk_bf16_f32 v195, v38, v39
    v_exp_f32 v44, v44
    v_exp_f32 v45, v45
    v_mfma_f32_32x32x16_bf16 v[160:175], a[16:19], v[184:187], v[160:175]
    ds_read_b128 a[28:31], v71 offset:1824
    v_exp_f32 v46, v46
    v_exp_f32 v47, v47
    v_cvt_pk_bf16_f32 v196, v40, v41
    s_mul_i32 s34, s28, 55296
    v_cvt_pk_bf16_f32 v197, v42, v43
    v_cvt_pk_bf16_f32 v198, v44, v45
    v_cvt_pk_bf16_f32 v199, v46, v47
    v_mfma_f32_32x32x16_bf16 v[0:15], a[4:7], v[132:135], v[0:15]
    v_exp_f32 v48, v48
    v_exp_f32 v49, v49
    v_exp_f32 v50, v50
    s_add_u32 s52, s52, s34
    s_mul_i32 s53, s28, 9216
    v_exp_f32 v51, v51
    v_exp_f32 v52, v52
    v_exp_f32 v53, v53
    s_waitcnt lgkmcnt(4)
    v_mfma_f32_32x32x16_bf16 v[144:159], a[20:23], v[180:183], v[144:159]
    v_exp_f32 v54, v54
    v_exp_f32 v55, v55
    v_cvt_pk_bf16_f32 v200, v48, v49
    s_lshl_b32 s34, s55, 2
    v_cvt_pk_bf16_f32 v201, v50, v51
    v_exp_f32 v56, v56
    v_exp_f32 v57, v57
    v_mfma_f32_32x32x16_bf16 v[16:31], a[4:7], v[140:143], v[16:31]
    v_exp_f32 v58, v58
    v_exp_f32 v59, v59
    v_cvt_pk_bf16_f32 v202, v52, v53
    s_add_u32 m0, s75, s72
    s_nop 0
    buffer_load_dwordx4 v210, s[24:27], s66 offen sc1 lds
    s_add_u32 s66, s66, 9728
    s_add_u32 s34, s34, s28
    s_mul_i32 s54, s34, 294912
    v_cvt_pk_bf16_f32 v203, v54, v55
    v_exp_f32 v60, v60
    v_exp_f32 v61, v61
    v_mfma_f32_32x32x16_bf16 v[160:175], a[20:23], v[188:191], v[160:175]
    v_exp_f32 v62, v62
    v_exp_f32 v63, v63
    v_cvt_pk_bf16_f32 v204, v56, v57
    s_mul_i32 s35, s30, 36864
    v_cvt_pk_bf16_f32 v205, v58, v59
    v_cvt_pk_bf16_f32 v206, v60, v61
    v_cvt_pk_bf16_f32 v207, v62, v63
    s_waitcnt lgkmcnt(3)
    v_mfma_f32_32x32x16_bf16 v[32:47], a[8:11], v[128:131], v[224:239]
    ds_read_b128 a[0:3], v67 offset:2048
    v_exp_f32 v0, v0
    v_exp_f32 v1, v1
    v_exp_f32 v2, v2
    s_add_u32 s54, s54, s35
    v_exp_f32 v3, v3
    v_exp_f32 v4, v4
    v_exp_f32 v5, v5
    s_waitcnt lgkmcnt(2)
    v_mfma_f32_32x32x16_bf16 v[144:159], a[24:27], v[192:195], v[144:159]
    ds_read_b128 a[4:7], v68 offset:2048
    v_exp_f32 v6, v6
    v_exp_f32 v7, v7
    v_cvt_pk_bf16_f32 v176, v0, v1
    s_add_u32 s54, s54, 9576448
    s_mul_i32 s57, s34, 36864
    v_cvt_pk_bf16_f32 v177, v2, v3
    v_exp_f32 v8, v8
    v_exp_f32 v9, v9
    v_mfma_f32_32x32x16_bf16 v[48:63], a[8:11], v[136:139], v[240:255]
    ds_read_b128 a[16:19], v71 offset:2432
    v_exp_f32 v10, v10
    v_exp_f32 v11, v11
    v_cvt_pk_bf16_f32 v178, v4, v5
    s_add_u32 m0, s75, s73
    s_nop 0
    buffer_load_dwordx4 v210, s[24:27], s67 offen sc1 lds
    s_add_u32 s67, s67, 9728
    s_mul_i32 s35, s30, 2359296
    v_cvt_pk_bf16_f32 v179, v6, v7
    v_exp_f32 v12, v12
    v_exp_f32 v13, v13
    v_mfma_f32_32x32x16_bf16 v[160:175], a[24:27], v[200:203], v[160:175]
    ds_read_b128 a[20:23], v71 offset:3040
    v_exp_f32 v14, v14
    v_exp_f32 v15, v15
    v_cvt_pk_bf16_f32 v180, v8, v9
    s_add_u32 s57, s57, s35
    s_mul_i32 s35, s56, 9216
    v_cvt_pk_bf16_f32 v181, v10, v11
    v_cvt_pk_bf16_f32 v182, v12, v13
    v_cvt_pk_bf16_f32 v183, v14, v15
    v_mfma_f32_32x32x16_bf16 v[32:47], a[12:15], v[132:135], v[32:47]
    v_exp_f32 v16, v16
    v_exp_f32 v17, v17
    v_exp_f32 v18, v18
    s_add_u32 s57, s57, s35
    v_exp_f32 v19, v19
    v_exp_f32 v20, v20
    v_exp_f32 v21, v21
    s_waitcnt lgkmcnt(4)
    v_mfma_f32_32x32x16_bf16 v[144:159], a[28:31], v[196:199], v[144:159]
    v_exp_f32 v22, v22
    v_exp_f32 v23, v23
    v_cvt_pk_bf16_f32 v184, v16, v17
    s_add_u32 s57, s57, 30810112
    v_cvt_pk_bf16_f32 v185, v18, v19
    v_exp_f32 v24, v24
    v_exp_f32 v25, v25
    v_mfma_f32_32x32x16_bf16 v[48:63], a[12:15], v[140:143], v[48:63]
    v_exp_f32 v26, v26
    v_exp_f32 v27, v27
    v_cvt_pk_bf16_f32 v186, v20, v21
    s_add_u32 m0, s75, s74
    s_nop 0
    buffer_load_dwordx4 v210, s[24:27], s68 offen sc1 lds
    s_add_u32 s68, s68, 9728
    s_sub_u32 s75, s75, 36864
    s_cselect_b32 s75, 110592, s75
    v_add_u32 v90, 0, v208
    v_mul_u32_u24 v91, 5462, v90
    v_cvt_pk_bf16_f32 v187, v22, v23
    v_exp_f32 v28, v28
    v_exp_f32 v29, v29
    v_mfma_f32_32x32x16_bf16 v[160:175], a[28:31], v[204:207], v[160:175]
    v_exp_f32 v30, v30
    v_exp_f32 v31, v31
    v_cvt_pk_bf16_f32 v188, v24, v25
    v_lshrrev_b32 v91, 16, v91
    v_cvt_pk_bf16_f32 v189, v26, v27
    v_cvt_pk_bf16_f32 v190, v28, v29
    v_cvt_pk_bf16_f32 v191, v30, v31
    s_waitcnt lgkmcnt(3)
    v_mfma_f32_32x32x16_bf16 v[0:15], a[0:3], v[128:131], v[224:239]
    ds_read_b128 a[8:11], v67 offset:2560
    v_exp_f32 v32, v32
    v_exp_f32 v33, v33
    v_exp_f32 v34, v34
    v_mul_u32_u24 v92, 12, v91
    v_exp_f32 v35, v35
    v_exp_f32 v36, v36
    v_exp_f32 v37, v37
    s_waitcnt lgkmcnt(2)
    v_mfma_f32_32x32x16_bf16 v[144:159], a[16:19], v[176:179], v[144:159]
    ds_read_b128 a[12:15], v68 offset:2560
    v_exp_f32 v38, v38
    v_exp_f32 v39, v39
    v_cvt_pk_bf16_f32 v192, v32, v33
    v_sub_u32 v92, v90, v92
    v_mul_u32_u24 v91, 1152, v91
    v_cvt_pk_bf16_f32 v193, v34, v35
    v_exp_f32 v40, v40
    v_exp_f32 v41, v41
    v_mfma_f32_32x32x16_bf16 v[16:31], a[0:3], v[136:139], v[240:255]
    ds_read_b128 a[24:27], v71 offset:3648
    v_exp_f32 v42, v42
    v_exp_f32 v43, v43
    v_cvt_pk_bf16_f32 v194, v36, v37
    v_lshl_add_u32 v72, v92, 4, v91
    v_cvt_pk_bf16_f32 v195, v38, v39
    v_exp_f32 v44, v44
    v_exp_f32 v45, v45
    v_mfma_f32_32x32x16_bf16 v[160:175], a[16:19], v[184:187], v[160:175]
    ds_read_b128 a[28:31], v71 offset:4256
    v_exp_f32 v46, v46
    v_exp_f32 v47, v47
    v_cvt_pk_bf16_f32 v196, v40, v41
    v_add_u32 v75, 18432, v72
    v_cvt_pk_bf16_f32 v197, v42, v43
    v_cvt_pk_bf16_f32 v198, v44, v45
    v_cvt_pk_bf16_f32 v199, v46, v47
    v_mfma_f32_32x32x16_bf16 v[0:15], a[4:7], v[132:135], v[0:15]
    v_exp_f32 v48, v48
    v_exp_f32 v49, v49
    v_exp_f32 v50, v50
    v_add_u32 v78, 36864, v72
    v_add_u32 v90, 64, v208
    v_exp_f32 v51, v51
    v_exp_f32 v52, v52
    v_exp_f32 v53, v53
    s_waitcnt lgkmcnt(4)
    v_mfma_f32_32x32x16_bf16 v[144:159], a[20:23], v[180:183], v[144:159]
    v_exp_f32 v54, v54
    v_exp_f32 v55, v55
    v_cvt_pk_bf16_f32 v200, v48, v49
    v_mul_u32_u24 v91, 5462, v90
    v_cvt_pk_bf16_f32 v201, v50, v51
    v_exp_f32 v56, v56
    v_exp_f32 v57, v57
    v_mfma_f32_32x32x16_bf16 v[16:31], a[4:7], v[140:143], v[16:31]
    v_exp_f32 v58, v58
    v_exp_f32 v59, v59
    v_cvt_pk_bf16_f32 v202, v52, v53
    v_lshrrev_b32 v91, 16, v91
    v_cvt_pk_bf16_f32 v203, v54, v55
    v_exp_f32 v60, v60
    v_exp_f32 v61, v61
    v_mfma_f32_32x32x16_bf16 v[160:175], a[20:23], v[188:191], v[160:175]
    v_exp_f32 v62, v62
    v_exp_f32 v63, v63
    v_cvt_pk_bf16_f32 v204, v56, v57
    v_mul_u32_u24 v92, 12, v91
    v_sub_u32 v92, v90, v92
    v_cvt_pk_bf16_f32 v205, v58, v59
    v_cvt_pk_bf16_f32 v206, v60, v61
    v_cvt_pk_bf16_f32 v207, v62, v63
    s_waitcnt lgkmcnt(3)
    v_mfma_f32_32x32x16_bf16 v[32:47], a[8:11], v[128:131], v[224:239]
    ds_read_b128 a[0:3], v67 offset:3072
    v_exp_f32 v0, v0
    v_exp_f32 v1, v1
    v_exp_f32 v2, v2
    v_mul_u32_u24 v91, 1152, v91
    v_exp_f32 v3, v3
    v_exp_f32 v4, v4
    v_exp_f32 v5, v5
    s_waitcnt lgkmcnt(2)
    v_mfma_f32_32x32x16_bf16 v[144:159], a[24:27], v[192:195], v[144:159]
    ds_read_b128 a[4:7], v68 offset:3072
    v_exp_f32 v6, v6
    v_exp_f32 v7, v7
    v_cvt_pk_bf16_f32 v176, v0, v1
    v_lshl_add_u32 v73, v92, 4, v91
    v_cvt_pk_bf16_f32 v177, v2, v3
    v_exp_f32 v8, v8
    v_exp_f32 v9, v9
    v_mfma_f32_32x32x16_bf16 v[48:63], a[8:11], v[136:139], v[240:255]
    ds_read_b128 a[16:19], v71 offset:4864
    v_exp_f32 v10, v10
    v_exp_f32 v11, v11
    v_cvt_pk_bf16_f32 v178, v4, v5
    v_add_u32 v76, 18432, v73
    v_cvt_pk_bf16_f32 v179, v6, v7
    v_exp_f32 v12, v12
    v_exp_f32 v13, v13
    v_mfma_f32_32x32x16_bf16 v[160:175], a[24:27], v[200:203], v[160:175]
    ds_read_b128 a[20:23], v71 offset:5472
    v_exp_f32 v14, v14
    v_exp_f32 v15, v15
    v_cvt_pk_bf16_f32 v180, v8, v9
    v_add_u32 v79, 36864, v73
    v_add_u32 v90, 128, v208
    v_cvt_pk_bf16_f32 v181, v10, v11
    v_cvt_pk_bf16_f32 v182, v12, v13
    v_cvt_pk_bf16_f32 v183, v14, v15
    v_mfma_f32_32x32x16_bf16 v[32:47], a[12:15], v[132:135], v[32:47]
    v_exp_f32 v16, v16
    v_exp_f32 v17, v17
    v_exp_f32 v18, v18
    v_mul_u32_u24 v91, 5462, v90
    v_exp_f32 v19, v19
    v_exp_f32 v20, v20
    v_exp_f32 v21, v21
    s_waitcnt lgkmcnt(4)
    v_mfma_f32_32x32x16_bf16 v[144:159], a[28:31], v[196:199], v[144:159]
    v_exp_f32 v22, v22
    v_exp_f32 v23, v23
    v_cvt_pk_bf16_f32 v184, v16, v17
    v_lshrrev_b32 v91, 16, v91
    v_cvt_pk_bf16_f32 v185, v18, v19
    v_exp_f32 v24, v24
    v_exp_f32 v25, v25
    v_mfma_f32_32x32x16_bf16 v[48:63], a[12:15], v[140:143], v[48:63]
    v_exp_f32 v26, v26
    v_exp_f32 v27, v27
    v_cvt_pk_bf16_f32 v186, v20, v21
    v_mul_u32_u24 v92, 12, v91
    v_sub_u32 v92, v90, v92
    v_cvt_pk_bf16_f32 v187, v22, v23
    v_exp_f32 v28, v28
    v_exp_f32 v29, v29
    v_mfma_f32_32x32x16_bf16 v[160:175], a[28:31], v[204:207], v[160:175]
    v_exp_f32 v30, v30
    v_exp_f32 v31, v31
    v_cvt_pk_bf16_f32 v188, v24, v25
    v_mul_u32_u24 v91, 1152, v91
    v_cvt_pk_bf16_f32 v189, v26, v27
    v_cvt_pk_bf16_f32 v190, v28, v29
    v_cvt_pk_bf16_f32 v191, v30, v31
    s_waitcnt lgkmcnt(3)
    v_mfma_f32_32x32x16_bf16 v[0:15], a[0:3], v[128:131], v[224:239]
    ds_read_b128 a[8:11], v67 offset:3584
    v_exp_f32 v32, v32
    v_exp_f32 v33, v33
    v_exp_f32 v34, v34
    v_lshl_add_u32 v74, v92, 4, v91
    s_waitcnt vmcnt(4)
    v_cmp_ne_u64 vcc, s[32:33], v[88:89]
    s_cbranch_vccz L_f2ok
    s_mov_b32 s36, 0
L_poll_5:
    buffer_load_dwordx2 v[88:89], v87, s[24:27], s58 offen sc1
    s_waitcnt vmcnt(0)
    v_cmp_ne_u64 vcc, s[32:33], v[88:89]
    s_add_u32 s36, s36, 1
    s_cbranch_vccz L_polld_6
    s_cmp_lt_u32 s36, 0x20000
    s_cbranch_scc1 L_poll_5
L_polld_6:
L_f2ok:
    v_exp_f32 v35, v35
    v_exp_f32 v36, v36
    v_exp_f32 v37, v37
    s_waitcnt lgkmcnt(2)
    v_mfma_f32_32x32x16_bf16 v[144:159], a[16:19], v[176:179], v[144:159]
    ds_read_b128 a[12:15], v68 offset:3584
    v_exp_f32 v38, v38
    v_exp_f32 v39, v39
    v_cvt_pk_bf16_f32 v192, v32, v33
    v_add_u32 v77, 18432, v74
    v_add_u32 v80, 36864, v74
    v_cvt_pk_bf16_f32 v193, v34, v35
    v_exp_f32 v40, v40
    v_exp_f32 v41, v41
    v_mfma_f32_32x32x16_bf16 v[16:31], a[0:3], v[136:139], v[240:255]
    ds_read_b128 a[24:27], v71 offset:6080
    v_exp_f32 v42, v42
    v_exp_f32 v43, v43
    v_cvt_pk_bf16_f32 v194, v36, v37
    v_mov_b32 v96, -1
    v_cvt_pk_bf16_f32 v195, v38, v39
    v_exp_f32 v44, v44
    v_exp_f32 v45, v45
    v_mfma_f32_32x32x16_bf16 v[160:175], a[16:19], v[184:187], v[160:175]
    ds_read_b128 a[28:31], v71 offset:6688
    v_exp_f32 v46, v46
    v_exp_f32 v47, v47
    v_cvt_pk_bf16_f32 v196, v40, v41
    v_mov_b32 v97, -1
    v_cvt_pk_bf16_f32 v197, v42, v43
    v_cvt_pk_bf16_f32 v198, v44, v45
    v_cvt_pk_bf16_f32 v199, v46, v47
    v_mfma_f32_32x32x16_bf16 v[0:15], a[4:7], v[132:135], v[0:15]
    v_exp_f32 v48, v48
    v_exp_f32 v49, v49
    v_exp_f32 v50, v50
    v_mov_b32 v98, -1
    v_mov_b32 v99, -1
    v_exp_f32 v51, v51
    v_exp_f32 v52, v52
    v_exp_f32 v53, v53
    s_waitcnt lgkmcnt(4)
    v_mfma_f32_32x32x16_bf16 v[144:159], a[20:23], v[180:183], v[144:159]
    v_exp_f32 v54, v54
    v_exp_f32 v55, v55
    v_cvt_pk_bf16_f32 v200, v48, v49
    v_lshrrev_b32 v90, 5, v208
    v_cvt_pk_bf16_f32 v201, v50, v51
    v_exp_f32 v56, v56
    v_exp_f32 v57, v57
    v_mfma_f32_32x32x16_bf16 v[16:31], a[4:7], v[140:143], v[16:31]
    v_exp_f32 v58, v58
    v_exp_f32 v59, v59
    v_cvt_pk_bf16_f32 v202, v52, v53
    s_barrier
    v_bfe_u32 v91, v208, 2, 2
    buffer_load_dwordx4 a[32:35], v210, s[24:27], s54 offen offset:0 sc1
    v_cvt_pk_bf16_f32 v203, v54, v55
    v_exp_f32 v60, v60
    v_exp_f32 v61, v61
    v_mfma_f32_32x32x16_bf16 v[160:175], a[20:23], v[188:191], v[160:175]
    v_exp_f32 v62, v62
    v_exp_f32 v63, v63
    v_cvt_pk_bf16_f32 v204, v56, v57
    v_lshl_add_u32 v92, v90, 2, v91
    v_cvt_pk_bf16_f32 v205, v58, v59
    v_cvt_pk_bf16_f32 v206, v60, v61
    v_cvt_pk_bf16_f32 v207, v62, v63
    s_waitcnt lgkmcnt(3)
    v_mfma_f32_32x32x16_bf16 v[32:47], a[8:11], v[128:131], v[224:239]
    ds_read_b128 a[0:3], v69 offset:0
    v_exp_f32 v0, v0
    v_exp_f32 v1, v1
    v_exp_f32 v2, v2
    v_mul_u32_u24 v92, 192, v92
    v_bfe_u32 v93, v208, 4, 1
    v_exp_f32 v3, v3
    v_exp_f32 v4, v4
    v_exp_f32 v5, v5
    s_waitcnt lgkmcnt(2)
    v_mfma_f32_32x32x16_bf16 v[144:159], a[24:27], v[192:195], v[144:159]
    ds_read_b128 a[4:7], v70 offset:0
    v_exp_f32 v6, v6
    v_exp_f32 v7, v7
    v_cvt_pk_bf16_f32 v176, v0, v1
    v_lshl_add_u32 v92, v93, 5, v92
    buffer_load_dwordx4 a[36:39], v210, s[24:27], s54 offen offset:1024 sc1
    v_cvt_pk_bf16_f32 v177, v2, v3
    v_exp_f32 v8, v8
    v_exp_f32 v9, v9
    v_mfma_f32_32x32x16_bf16 v[48:63], a[8:11], v[136:139], v[240:255]
    ds_read_b128 a[16:19], v71 offset:7296
    v_exp_f32 v10, v10
    v_exp_f32 v11, v11
    v_cvt_pk_bf16_f32 v178, v4, v5
    v_and_b32 v94, 3, v208
    v_cvt_pk_bf16_f32 v179, v6, v7
    v_exp_f32 v12, v12
    v_exp_f32 v13, v13
    v_mfma_f32_32x32x16_bf16 v[160:175], a[24:27], v[200:203], v[160:175]
    ds_read_b128 a[20:23], v71 offset:7904
    v_exp_f32 v14, v14
    v_exp_f32 v15, v15
    v_cvt_pk_bf16_f32 v180, v8, v9
    v_lshl_add_u32 v81, v94, 3, v92
    v_add_u32 v82, 0, v81
    v_cvt_pk_bf16_f32 v181, v10, v11
    v_cvt_pk_bf16_f32 v182, v12, v13
    v_cvt_pk_bf16_f32 v183, v14, v15
    v_mfma_f32_32x32x16_bf16 v[32:47], a[12:15], v[132:135], v[32:47]
    v_exp_f32 v16, v16
    v_exp_f32 v17, v17
    v_exp_f32 v18, v18
    v_add_u32 v83, 110592, v81
    buffer_load_dwordx4 a[40:43], v210, s[24:27], s54 offen offset:2048 sc1
    v_exp_f32 v19, v19
    v_exp_f32 v20, v20
    v_exp_f32 v21, v21
    s_waitcnt lgkmcnt(4)
    v_mfma_f32_32x32x16_bf16 v[144:159], a[28:31], v[196:199], v[144:159]
    v_exp_f32 v22, v22
    v_exp_f32 v23, v23
    v_cvt_pk_bf16_f32 v184, v16, v17
    v_add_u32 v84, 73728, v81
    v_cvt_pk_bf16_f32 v185, v18, v19
    v_exp_f32 v24, v24
    v_exp_f32 v25, v25
    v_mfma_f32_32x32x16_bf16 v[48:63], a[12:15], v[140:143], v[48:63]
    v_exp_f32 v26, v26
    v_exp_f32 v27, v27
    v_cvt_pk_bf16_f32 v186, v20, v21
    v_add_u32 v85, 36864, v81
    v_mul_u32_u24 v93, 18432, v93
    v_cvt_pk_bf16_f32 v187, v22, v23
    v_exp_f32 v28, v28
    v_exp_f32 v29, v29
    v_mfma_f32_32x32x16_bf16 v[160:175], a[28:31], v[204:207], v[160:175]
    v_exp_f32 v30, v30
    v_exp_f32 v31, v31
    v_cvt_pk_bf16_f32 v188, v24, v25
    v_and_b32 v94, 15, v208
    buffer_load_dwordx4 a[44:47], v210, s[24:27], s54 offen offset:3072 sc1
    s_add_u32 s54, s54, 4096
    v_cvt_pk_bf16_f32 v189, v26, v27
    v_cvt_pk_bf16_f32 v190, v28, v29
    v_cvt_pk_bf16_f32 v191, v30, v31
    s_waitcnt lgkmcnt(3)
    v_mfma_f32_32x32x16_bf16 v[0:15], a[0:3], v[128:131], v[224:239]
    ds_read_b128 a[8:11], v69 offset:512
    v_exp_f32 v32, v32
    v_exp_f32 v33, v33
    v_exp_f32 v34, v34
    v_lshl_add_u32 v93, v94, 4, v93
    v_exp_f32 v35, v35
    v_exp_f32 v36, v36
    v_exp_f32 v37, v37
    s_waitcnt lgkmcnt(2)
    v_mfma_f32_32x32x16_bf16 v[144:159], a[16:19], v[176:179], v[144:159]
    ds_read_b128 a[12:15], v70 offset:512
    v_exp_f32 v38, v38
    v_exp_f32 v39, v39
    v_cvt_pk_bf16_f32 v192, v32, v33
    v_lshl_add_u32 v86, v90, 8, v93
    v_cvt_pk_bf16_f32 v193, v34, v35
    v_exp_f32 v40, v40
    v_exp_f32 v41, v41
    v_mfma_f32_32x32x16_bf16 v[16:31], a[0:3], v[136:139], v[240:255]
    ds_read_b128 a[24:27], v71 offset:8512
    v_exp_f32 v42, v42
    v_exp_f32 v43, v43
    v_cvt_pk_bf16_f32 v194, v36, v37
    buffer_load_dwordx4 a[48:51], v210, s[24:27], s54 offen offset:0 sc1
    v_cvt_pk_bf16_f32 v195, v38, v39
    v_exp_f32 v44, v44
    v_exp_f32 v45, v45
    v_mfma_f32_32x32x16_bf16 v[160:175], a[16:19], v[184:187], v[160:175]
    ds_read_b128 a[28:31], v71 offset:9120
    v_exp_f32 v46, v46
    v_exp_f32 v47, v47
    v_cvt_pk_bf16_f32 v196, v40, v41
    v_cvt_pk_bf16_f32 v197, v42, v43
    v_cvt_pk_bf16_f32 v198, v44, v45
    v_cvt_pk_bf16_f32 v199, v46, v47
    v_mfma_f32_32x32x16_bf16 v[0:15], a[4:7], v[132:135], v[0:15]
    v_exp_f32 v48, v48
    v_exp_f32 v49, v49
    v_exp_f32 v50, v50
    v_exp_f32 v51, v51
    v_exp_f32 v52, v52
    v_exp_f32 v53, v53
    s_waitcnt lgkmcnt(4)
    v_mfma_f32_32x32x16_bf16 v[144:159], a[20:23], v[180:183], v[144:159]
    v_exp_f32 v54, v54
    v_exp_f32 v55, v55
    v_cvt_pk_bf16_f32 v200, v48, v49
    buffer_load_dwordx4 a[52:55], v210, s[24:27], s54 offen offset:1024 sc1
    v_cvt_pk_bf16_f32 v201, v50, v51
    v_exp_f32 v56, v56
    v_exp_f32 v57, v57
    v_mfma_f32_32x32x16_bf16 v[16:31], a[4:7], v[140:143], v[16:31]
    v_exp_f32 v58, v58
    v_exp_f32 v59, v59
    v_cvt_pk_bf16_f32 v202, v52, v53
    v_cvt_pk_bf16_f32 v203, v54, v55
    v_exp_f32 v60, v60
    v_exp_f32 v61, v61
    v_mfma_f32_32x32x16_bf16 v[160:175], a[20:23], v[188:191], v[160:175]
    v_exp_f32 v62, v62
    v_exp_f32 v63, v63
    v_cvt_pk_bf16_f32 v204, v56, v57
    v_cvt_pk_bf16_f32 v205, v58, v59
    v_cvt_pk_bf16_f32 v206, v60, v61
    v_cvt_pk_bf16_f32 v207, v62, v63
    v_add_u32 v67, s76, v65
    v_add_u32 v69, s77, v65
    s_add_u32 s34, s76, 8192
    s_add_u32 s35, s77, 8192
    s_add_u32 s36, s76, 12288
    v_add_u32 v68, s34, v64
    v_add_u32 v70, s35, v64
    v_add_u32 v71, s36, v66
    s_mov_b32 s76, s77
    s_sub_u32 s77, s77, 36864
    s_cselect_b32 s77, 110592, s77
    s_waitcnt lgkmcnt(3)
    v_mfma_f32_32x32x16_bf16 v[32:47], a[8:11], v[128:131], v[224:239]
    ds_read_b128 a[0:3], v67 offset:1024
    v_exp_f32 v0, v0
    v_exp_f32 v1, v1
    v_exp_f32 v2, v2
    v_exp_f32 v3, v3
    v_exp_f32 v4, v4
    v_exp_f32 v5, v5
    s_waitcnt lgkmcnt(2)
    v_mfma_f32_32x32x16_bf16 v[144:159], a[24:27], v[192:195], v[144:159]
    ds_read_b128 a[4:7], v68 offset:1024
    v_exp_f32 v6, v6
    v_exp_f32 v7, v7
    v_cvt_pk_bf16_f32 v176, v0, v1
    v_cvt_pk_bf16_f32 v177, v2, v3
    v_exp_f32 v8, v8
    v_exp_f32 v9, v9
    v_mfma_f32_32x32x16_bf16 v[48:63], a[8:11], v[136:139], v[240:255]
    ds_read_b128 a[16:19], v71 offset:0
    v_exp_f32 v10, v10
    v_exp_f32 v11, v11
    v_cvt_pk_bf16_f32 v178, v4, v5
    s_add_u32 m0, s75, s69
    s_nop 0
    buffer_load_dwordx4 v210, s[24:27], s63 offen sc1 lds
    s_add_u32 s63, s63, 4096
    v_cvt_pk_bf16_f32 v179, v6, v7
    v_exp_f32 v12, v12
    v_exp_f32 v13, v13
    v_mfma_f32_32x32x16_bf16 v[160:175], a[24:27], v[200:203], v[160:175]
    ds_read_b128 a[20:23], v71 offset:608
    v_exp_f32 v14, v14
    v_exp_f32 v15, v15
    v_cvt_pk_bf16_f32 v180, v8, v9
    v_cvt_pk_bf16_f32 v181, v10, v11
    v_cvt_pk_bf16_f32 v182, v12, v13
    v_cvt_pk_bf16_f32 v183, v14, v15
    v_mfma_f32_32x32x16_bf16 v[32:47], a[12:15], v[132:135], v[32:47]
    v_exp_f32 v16, v16
    v_exp_f32 v17, v17
    v_exp_f32 v18, v18
    v_exp_f32 v19, v19
    v_exp_f32 v20, v20
    v_exp_f32 v21, v21
    s_waitcnt lgkmcnt(4)
    v_mfma_f32_32x32x16_bf16 v[144:159], a[28:31], v[196:199], v[144:159]
    v_exp_f32 v22, v22
    v_exp_f32 v23, v23
    v_cvt_pk_bf16_f32 v184, v16, v17
    v_cvt_pk_bf16_f32 v185, v18, v19
    v_exp_f32 v24, v24
    v_exp_f32 v25, v25
    v_mfma_f32_32x32x16_bf16 v[48:63], a[12:15], v[140:143], v[48:63]
    v_exp_f32 v26, v26
    v_exp_f32 v27, v27
    v_cvt_pk_bf16_f32 v186, v20, v21
    s_add_u32 m0, s75, s70
    s_nop 0
    buffer_load_dwordx4 v210, s[24:27], s64 offen sc1 lds
    s_add_u32 s64, s64, 4096
    v_cvt_pk_bf16_f32 v187, v22, v23
    v_exp_f32 v28, v28
    v_exp_f32 v29, v29
    v_mfma_f32_32x32x16_bf16 v[160:175], a[28:31], v[204:207], v[160:175]
    v_exp_f32 v30, v30
    v_exp_f32 v31, v31
    v_cvt_pk_bf16_f32 v188, v24, v25
    v_cvt_pk_bf16_f32 v189, v26, v27
    v_cvt_pk_bf16_f32 v190, v28, v29
    v_cvt_pk_bf16_f32 v191, v30, v31
    s_waitcnt lgkmcnt(3)
    v_mfma_f32_32x32x16_bf16 v[0:15], a[0:3], v[128:131], v[224:239]
    ds_read_b128 a[8:11], v67 offset:1536
    v_exp_f32 v32, v32
    v_exp_f32 v33, v33
    v_exp_f32 v34, v34
    v_exp_f32 v35, v35
    v_exp_f32 v36, v36
    v_exp_f32 v37, v37
    s_waitcnt lgkmcnt(2)
    v_mfma_f32_32x32x16_bf16 v[144:159], a[16:19], v[176:179], v[144:159]
    ds_read_b128 a[12:15], v68 offset:1536
    v_exp_f32 v38, v38
    v_exp_f32 v39, v39
    v_cvt_pk_bf16_f32 v192, v32, v33
    v_cvt_pk_bf16_f32 v193, v34, v35
    v_exp_f32 v40, v40
    v_exp_f32 v41, v41
    v_mfma_f32_32x32x16_bf16 v[16:31], a[0:3], v[136:139], v[240:255]
    ds_read_b128 a[24:27], v71 offset:1216
    v_exp_f32 v42, v42
    v_exp_f32 v43, v43
    v_cvt_pk_bf16_f32 v194, v36, v37
    s_add_u32 m0, s75, s71
    s_nop 0
    buffer_load_dwordx4 v210, s[24:27], s65 offen sc1 lds
    s_add_u32 s65, s65, 4096
    v_cvt_pk_bf16_f32 v195, v38, v39
    v_exp_f32 v44, v44
    v_exp_f32 v45, v45
    v_mfma_f32_32x32x16_bf16 v[160:175], a[16:19], v[184:187], v[160:175]
    ds_read_b128 a[28:31], v71 offset:1824
    v_exp_f32 v46, v46
    v_exp_f32 v47, v47
    v_cvt_pk_bf16_f32 v196, v40, v41
    v_cvt_pk_bf16_f32 v197, v42, v43
    v_cvt_pk_bf16_f32 v198, v44, v45
    v_cvt_pk_bf16_f32 v199, v46, v47
    v_mfma_f32_32x32x16_bf16 v[0:15], a[4:7], v[132:135], v[0:15]
    v_exp_f32 v48, v48
    v_exp_f32 v49, v49
    v_exp_f32 v50, v50
    v_exp_f32 v51, v51
    v_exp_f32 v52, v52
    v_exp_f32 v53, v53
    s_waitcnt lgkmcnt(4)
    v_mfma_f32_32x32x16_bf16 v[144:159], a[20:23], v[180:183], v[144:159]
    v_exp_f32 v54, v54
    v_exp_f32 v55, v55
    v_cvt_pk_bf16_f32 v200, v48, v49
    v_cvt_pk_bf16_f32 v201, v50, v51
    v_exp_f32 v56, v56
    v_exp_f32 v57, v57
    v_mfma_f32_32x32x16_bf16 v[16:31], a[4:7], v[140:143], v[16:31]
    v_exp_f32 v58, v58
    v_exp_f32 v59, v59
    v_cvt_pk_bf16_f32 v202, v52, v53
    s_add_u32 m0, s75, s72
    s_nop 0
    buffer_load_dwordx4 v210, s[24:27], s66 offen sc1 lds
    s_add_u32 s66, s66, 9728
    v_cvt_pk_bf16_f32 v203, v54, v55
    v_exp_f32 v60, v60
    v_exp_f32 v61, v61
    v_mfma_f32_32x32x16_bf16 v[160:175], a[20:23], v[188:191], v[160:175]
    v_exp_f32 v62, v62
    v_exp_f32 v63, v63
    v_cvt_pk_bf16_f32 v204, v56, v57
    v_cvt_pk_bf16_f32 v205, v58, v59
    v_cvt_pk_bf16_f32 v206, v60, v61
    v_cvt_pk_bf16_f32 v207, v62, v63
    s_waitcnt lgkmcnt(3)
    v_mfma_f32_32x32x16_bf16 v[32:47], a[8:11], v[128:131], v[224:239]
    ds_read_b128 a[0:3], v67 offset:2048
    v_exp_f32 v0, v0
    v_exp_f32 v1, v1
    v_exp_f32 v2, v2
    v_exp_f32 v3, v3
    v_exp_f32 v4, v4
    v_exp_f32 v5, v5
    s_waitcnt lgkmcnt(2)
    v_mfma_f32_32x32x16_bf16 v[144:159], a[24:27], v[192:195], v[144:159]
    ds_read_b128 a[4:7], v68 offset:2048
    v_exp_f32 v6, v6
    v_exp_f32 v7, v7
    v_cvt_pk_bf16_f32 v176, v0, v1
    v_cvt_pk_bf16_f32 v177, v2, v3
    v_exp_f32 v8, v8
    v_exp_f32 v9, v9
    v_mfma_f32_32x32x16_bf16 v[48:63], a[8:11], v[136:139], v[240:255]
    ds_read_b128 a[16:19], v71 offset:2432
    v_exp_f32 v10, v10
    v_exp_f32 v11, v11
    v_cvt_pk_bf16_f32 v178, v4, v5
    s_add_u32 m0, s75, s73
    s_nop 0
    buffer_load_dwordx4 v210, s[24:27], s67 offen sc1 lds
    s_add_u32 s67, s67, 9728
    v_cvt_pk_bf16_f32 v179, v6, v7
    v_exp_f32 v12, v12
    v_exp_f32 v13, v13
    v_mfma_f32_32x32x16_bf16 v[160:175], a[24:27], v[200:203], v[160:175]
    ds_read_b128 a[20:23], v71 offset:3040
    v_exp_f32 v14, v14
    v_exp_f32 v15, v15
    v_cvt_pk_bf16_f32 v180, v8, v9
    v_cvt_pk_bf16_f32 v181, v10, v11
    v_cvt_pk_bf16_f32 v182, v12, v13
    v_cvt_pk_bf16_f32 v183, v14, v15
    v_mfma_f32_32x32x16_bf16 v[32:47], a[12:15], v[132:135], v[32:47]
    v_exp_f32 v16, v16
    v_exp_f32 v17, v17
    v_exp_f32 v18, v18
    v_exp_f32 v19, v19
    v_exp_f32 v20, v20
    v_exp_f32 v21, v21
    s_waitcnt lgkmcnt(4)
    v_mfma_f32_32x32x16_bf16 v[144:159], a[28:31], v[196:199], v[144:159]
    v_exp_f32 v22, v22
    v_exp_f32 v23, v23
    v_cvt_pk_bf16_f32 v184, v16, v17
    v_cvt_pk_bf16_f32 v185, v18, v19
    v_exp_f32 v24, v24
    v_exp_f32 v25, v25
    v_mfma_f32_32x32x16_bf16 v[48:63], a[12:15], v[140:143], v[48:63]
    v_exp_f32 v26, v26
    v_exp_f32 v27, v27
    v_cvt_pk_bf16_f32 v186, v20, v21
    s_add_u32 m0, s75, s74
    s_nop 0
    buffer_load_dwordx4 v210, s[24:27], s68 offen sc1 lds
    s_add_u32 s68, s68, 9728
    s_sub_u32 s75, s75, 36864
    s_cselect_b32 s75, 110592, s75
    v_cvt_pk_bf16_f32 v187, v22, v23
    v_exp_f32 v28, v28
    v_exp_f32 v29, v29
    v_mfma_f32_32x32x16_bf16 v[160:175], a[28:31], v[204:207], v[160:175]
    v_exp_f32 v30, v30
    v_exp_f32 v31, v31
    v_cvt_pk_bf16_f32 v188, v24, v25
    v_cvt_pk_bf16_f32 v189, v26, v27
    v_cvt_pk_bf16_f32 v190, v28, v29
    v_cvt_pk_bf16_f32 v191, v30, v31
    s_waitcnt lgkmcnt(3)
    v_mfma_f32_32x32x16_bf16 v[0:15], a[0:3], v[128:131], v[224:239]
    ds_read_b128 a[8:11], v67 offset:2560
    v_exp_f32 v32, v32
    v_exp_f32 v33, v33
    v_exp_f32 v34, v34
    buffer_load_dwordx4 a[56:59], v210, s[24:27], s54 offen offset:2048 sc1
    v_exp_f32 v35, v35
    v_exp_f32 v36, v36
    v_exp_f32 v37, v37
    s_waitcnt lgkmcnt(2)
    v_mfma_f32_32x32x16_bf16 v[144:159], a[16:19], v[176:179], v[144:159]
    ds_read_b128 a[12:15], v68 offset:2560
    v_exp_f32 v38, v38
    v_exp_f32 v39, v39
    v_cvt_pk_bf16_f32 v192, v32, v33
    v_cvt_pk_bf16_f32 v193, v34, v35
    v_exp_f32 v40, v40
    v_exp_f32 v41, v41
    v_mfma_f32_32x32x16_bf16 v[16:31], a[0:3], v[136:139], v[240:255]
    ds_read_b128 a[24:27], v71 offset:3648
    v_exp_f32 v42, v42
    v_exp_f32 v43, v43
    v_cvt_pk_bf16_f32 v194, v36, v37
    s_add_u32 s34, s57, 0
    buffer_store_dwordx4 v[96:99], v86, s[24:27], s34 offen offset:0 sc1
    v_cvt_pk_bf16_f32 v195, v38, v39
    v_exp_f32 v44, v44
    v_exp_f32 v45, v45
    v_mfma_f32_32x32x16_bf16 v[160:175], a[16:19], v[184:187], v[160:175]
    ds_read_b128 a[28:31], v71 offset:4256
    v_exp_f32 v46, v46
    v_exp_f32 v47, v47
    v_cvt_pk_bf16_f32 v196, v40, v41
    v_cvt_pk_bf16_f32 v197, v42, v43
    v_cvt_pk_bf16_f32 v198, v44, v45
    v_cvt_pk_bf16_f32 v199, v46, v47
    v_mfma_f32_32x32x16_bf16 v[0:15], a[4:7], v[132:135], v[0:15]
    v_exp_f32 v48, v48
    v_exp_f32 v49, v49
    v_exp_f32 v50, v50
    buffer_load_dwordx4 a[60:63], v210, s[24:27], s54 offen offset:3072 sc1
    s_add_u32 s54, s54, 4096
    v_exp_f32 v51, v51
    v_exp_f32 v52, v52
    v_exp_f32 v53, v53
    s_waitcnt lgkmcnt(4)
    v_mfma_f32_32x32x16_bf16 v[144:159], a[20:23], v[180:183], v[144:159]
    v_exp_f32 v54, v54
    v_exp_f32 v55, v55
    v_cvt_pk_bf16_f32 v200, v48, v49
    v_cvt_pk_bf16_f32 v201, v50, v51
    v_exp_f32 v56, v56
    v_exp_f32 v57, v57
    v_mfma_f32_32x32x16_bf16 v[16:31], a[4:7], v[140:143], v[16:31]
    v_exp_f32 v58, v58
    v_exp_f32 v59, v59
    v_cvt_pk_bf16_f32 v202, v52, v53
    v_cvt_pk_bf16_f32 v203, v54, v55
    v_exp_f32 v60, v60
    v_exp_f32 v61, v61
    v_mfma_f32_32x32x16_bf16 v[160:175], a[20:23], v[188:191], v[160:175]
    v_exp_f32 v62, v62
    v_exp_f32 v63, v63
    v_cvt_pk_bf16_f32 v204, v56, v57
    v_cvt_pk_bf16_f32 v205, v58, v59
    v_cvt_pk_bf16_f32 v206, v60, v61
    v_cvt_pk_bf16_f32 v207, v62, v63
    s_waitcnt lgkmcnt(3)
    v_mfma_f32_32x32x16_bf16 v[32:47], a[8:11], v[128:131], v[224:239]
    ds_read_b128 a[0:3], v67 offset:3072
    v_exp_f32 v0, v0
    v_exp_f32 v1, v1
    v_exp_f32 v2, v2
    buffer_load_dwordx4 a[64:67], v210, s[24:27], s54 offen offset:0 sc1
    buffer_store_dwordx4 v[96:99], v86, s[24:27], s34 offen offset:512 sc1
    v_exp_f32 v3, v3
    v_exp_f32 v4, v4
    v_exp_f32 v5, v5
    s_waitcnt lgkmcnt(2)
    v_mfma_f32_32x32x16_bf16 v[144:159], a[24:27], v[192:195], v[144:159]
    ds_read_b128 a[4:7], v68 offset:3072
    v_exp_f32 v6, v6
    v_exp_f32 v7, v7
    v_cvt_pk_bf16_f32 v176, v0, v1
    v_cvt_pk_bf16_f32 v177, v2, v3
    v_exp_f32 v8, v8
    v_exp_f32 v9, v9
    v_mfma_f32_32x32x16_bf16 v[48:63], a[8:11], v[136:139], v[240:255]
    ds_read_b128 a[16:19], v71 offset:4864
    v_exp_f32 v10, v10
    v_exp_f32 v11, v11
    v_cvt_pk_bf16_f32 v178, v4, v5
    v_cvt_pk_bf16_f32 v179, v6, v7
    v_exp_f32 v12, v12
    v_exp_f32 v13, v13
    v_mfma_f32_32x32x16_bf16 v[160:175], a[24:27], v[200:203], v[160:175]
    ds_read_b128 a[20:23], v71 offset:5472
    v_exp_f32 v14, v14
    v_exp_f32 v15, v15
    v_cvt_pk_bf16_f32 v180, v8, v9
    v_cvt_pk_bf16_f32 v181, v10, v11
    v_cvt_pk_bf16_f32 v182, v12, v13
    v_cvt_pk_bf16_f32 v183, v14, v15
    v_mfma_f32_32x32x16_bf16 v[32:47], a[12:15], v[132:135], v[32:47]
    v_exp_f32 v16, v16
    v_exp_f32 v17, v17
    v_exp_f32 v18, v18
    buffer_load_dwordx4 a[68:71], v210, s[24:27], s54 offen offset:1024 sc1
    v_exp_f32 v19, v19
    v_exp_f32 v20, v20
    v_exp_f32 v21, v21
    s_waitcnt lgkmcnt(4)
    v_mfma_f32_32x32x16_bf16 v[144:159], a[28:31], v[196:199], v[144:159]
    v_exp_f32 v22, v22
    v_exp_f32 v23, v23
    v_cvt_pk_bf16_f32 v184, v16, v17
    v_cvt_pk_bf16_f32 v185, v18, v19
    v_exp_f32 v24, v24
    v_exp_f32 v25, v25
    v_mfma_f32_32x32x16_bf16 v[48:63], a[12:15], v[140:143], v[48:63]
    v_exp_f32 v26, v26
    v_exp_f32 v27, v27
    v_cvt_pk_bf16_f32 v186, v20, v21
    s_add_u32 s34, s57, 1024
    buffer_store_dwordx4 v[96:99], v86, s[24:27], s34 offen offset:0 sc1
    v_cvt_pk_bf16_f32 v187, v22, v23
    v_exp_f32 v28, v28
    v_exp_f32 v29, v29
    v_mfma_f32_32x32x16_bf16 v[160:175], a[28:31], v[204:207], v[160:175]
    v_exp_f32 v30, v30
    v_exp_f32 v31, v31
    v_cvt_pk_bf16_f32 v188, v24, v25
    v_cvt_pk_bf16_f32 v189, v26, v27
    v_cvt_pk_bf16_f32 v190, v28, v29
    v_cvt_pk_bf16_f32 v191, v30, v31
    s_waitcnt lgkmcnt(3)
    v_mfma_f32_32x32x16_bf16 v[0:15], a[0:3], v[128:131], v[224:239]
    ds_read_b128 a[8:11], v67 offset:3584
    v_exp_f32 v32, v32
    v_exp_f32 v33, v33
    v_exp_f32 v34, v34
    buffer_load_dwordx4 a[72:75], v210, s[24:27], s54 offen offset:2048 sc1
    v_exp_f32 v35, v35
    v_exp_f32 v36, v36
    v_exp_f32 v37, v37
    s_waitcnt lgkmcnt(2)
    v_mfma_f32_32x32x16_bf16 v[144:159], a[16:19], v[176:179], v[144:159]
    ds_read_b128 a[12:15], v68 offset:3584
    v_exp_f32 v38, v38
    v_exp_f32 v39, v39
    v_cvt_pk_bf16_f32 v192, v32, v33
    v_cvt_pk_bf16_f32 v193, v34, v35
    v_exp_f32 v40, v40
    v_exp_f32 v41, v41
    v_mfma_f32_32x32x16_bf16 v[16:31], a[0:3], v[136:139], v[240:255]
    ds_read_b128 a[24:27], v71 offset:6080
    v_exp_f32 v42, v42
    v_exp_f32 v43, v43
    v_cvt_pk_bf16_f32 v194, v36, v37
    v_cvt_pk_bf16_f32 v195, v38, v39
    v_exp_f32 v44, v44
    v_exp_f32 v45, v45
    v_mfma_f32_32x32x16_bf16 v[160:175], a[16:19], v[184:187], v[160:175]
    ds_read_b128 a[28:31], v71 offset:6688
    v_exp_f32 v46, v46
    v_exp_f32 v47, v47
    v_cvt_pk_bf16_f32 v196, v40, v41
    v_cvt_pk_bf16_f32 v197, v42, v43
    v_cvt_pk_bf16_f32 v198, v44, v45
    v_cvt_pk_bf16_f32 v199, v46, v47
    v_mfma_f32_32x32x16_bf16 v[0:15], a[4:7], v[132:135], v[0:15]
    v_exp_f32 v48, v48
    v_exp_f32 v49, v49
    v_exp_f32 v50, v50
    buffer_load_dwordx4 a[76:79], v210, s[24:27], s54 offen offset:3072 sc1
    s_add_u32 s54, s54, 4096
    buffer_store_dwordx4 v[96:99], v86, s[24:27], s34 offen offset:512 sc1
    v_exp_f32 v51, v51
    v_exp_f32 v52, v52
    v_exp_f32 v53, v53
    s_waitcnt lgkmcnt(4)
    v_mfma_f32_32x32x16_bf16 v[144:159], a[20:23], v[180:183], v[144:159]
    v_exp_f32 v54, v54
    v_exp_f32 v55, v55
    v_cvt_pk_bf16_f32 v200, v48, v49
    v_cvt_pk_bf16_f32 v201, v50, v51
    v_exp_f32 v56, v56
    v_exp_f32 v57, v57
    v_mfma_f32_32x32x16_bf16 v[16:31], a[4:7], v[140:143], v[16:31]
    v_exp_f32 v58, v58
    v_exp_f32 v59, v59
    v_cvt_pk_bf16_f32 v202, v52, v53
    s_waitcnt vmcnt(22)
    s_barrier
    v_cvt_pk_bf16_f32 v203, v54, v55
    v_exp_f32 v60, v60
    v_exp_f32 v61, v61
    v_mfma_f32_32x32x16_bf16 v[160:175], a[20:23], v[188:191], v[160:175]
    v_exp_f32 v62, v62
    v_exp_f32 v63, v63
    v_cvt_pk_bf16_f32 v204, v56, v57
    v_cvt_pk_bf16_f32 v205, v58, v59
    v_cvt_pk_bf16_f32 v206, v60, v61
    v_cvt_pk_bf16_f32 v207, v62, v63
    s_waitcnt lgkmcnt(3)
    v_mfma_f32_32x32x16_bf16 v[32:47], a[8:11], v[128:131], v[224:239]
    ds_read_b128 a[0:3], v69 offset:0
    v_exp_f32 v0, v0
    v_exp_f32 v1, v1
    v_exp_f32 v2, v2
    buffer_load_dwordx4 a[80:83], v210, s[24:27], s54 offen offset:0 sc1
    v_exp_f32 v3, v3
    v_exp_f32 v4, v4
    v_exp_f32 v5, v5
    s_waitcnt lgkmcnt(2)
    v_mfma_f32_32x32x16_bf16 v[144:159], a[24:27], v[192:195], v[144:159]
    ds_read_b128 a[4:7], v70 offset:0
    v_exp_f32 v6, v6
    v_exp_f32 v7, v7
    v_cvt_pk_bf16_f32 v176, v0, v1
    v_cvt_pk_bf16_f32 v177, v2, v3
    v_exp_f32 v8, v8
    v_exp_f32 v9, v9
    v_mfma_f32_32x32x16_bf16 v[48:63], a[8:11], v[136:139], v[240:255]
    ds_read_b128 a[16:19], v71 offset:7296
    v_exp_f32 v10, v10
    v_exp_f32 v11, v11
    v_cvt_pk_bf16_f32 v178, v4, v5
    s_add_u32 s34, s57, 2048
    buffer_store_dwordx4 v[96:99], v86, s[24:27], s34 offen offset:0 sc1
    v_cvt_pk_bf16_f32 v179, v6, v7
    v_exp_f32 v12, v12
    v_exp_f32 v13, v13
    v_mfma_f32_32x32x16_bf16 v[160:175], a[24:27], v[200:203], v[160:175]
    ds_read_b128 a[20:23], v71 offset:7904
    v_exp_f32 v14, v14
    v_exp_f32 v15, v15
    v_cvt_pk_bf16_f32 v180, v8, v9
    v_cvt_pk_bf16_f32 v181, v10, v11
    v_cvt_pk_bf16_f32 v182, v12, v13
    v_cvt_pk_bf16_f32 v183, v14, v15
    v_mfma_f32_32x32x16_bf16 v[32:47], a[12:15], v[132:135], v[32:47]
    v_exp_f32 v16, v16
    v_exp_f32 v17, v17
    v_exp_f32 v18, v18
    buffer_load_dwordx4 a[84:87], v210, s[24:27], s54 offen offset:1024 sc1
    v_exp_f32 v19, v19
    v_exp_f32 v20, v20
    v_exp_f32 v21, v21
    s_waitcnt lgkmcnt(4)
    v_mfma_f32_32x32x16_bf16 v[144:159], a[28:31], v[196:199], v[144:159]
    v_exp_f32 v22, v22
    v_exp_f32 v23, v23
    v_cvt_pk_bf16_f32 v184, v16, v17
    v_cvt_pk_bf16_f32 v185, v18, v19
    v_exp_f32 v24, v24
    v_exp_f32 v25, v25
    v_mfma_f32_32x32x16_bf16 v[48:63], a[12:15], v[140:143], v[48:63]
    v_exp_f32 v26, v26
    v_exp_f32 v27, v27
    v_cvt_pk_bf16_f32 v186, v20, v21
    v_cvt_pk_bf16_f32 v187, v22, v23
    v_exp_f32 v28, v28
    v_exp_f32 v29, v29
    v_mfma_f32_32x32x16_bf16 v[160:175], a[28:31], v[204:207], v[160:175]
    v_exp_f32 v30, v30
    v_exp_f32 v31, v31
    v_cvt_pk_bf16_f32 v188, v24, v25
    v_cvt_pk_bf16_f32 v189, v26, v27
    v_cvt_pk_bf16_f32 v190, v28, v29
    v_cvt_pk_bf16_f32 v191, v30, v31
    s_waitcnt lgkmcnt(3)
    v_mfma_f32_32x32x16_bf16 v[0:15], a[0:3], v[128:131], v[224:239]
    ds_read_b128 a[8:11], v69 offset:512
    v_exp_f32 v32, v32
    v_exp_f32 v33, v33
    v_exp_f32 v34, v34
    buffer_load_dwordx4 a[88:91], v210, s[24:27], s54 offen offset:2048 sc1
    buffer_store_dwordx4 v[96:99], v86, s[24:27], s34 offen offset:512 sc1
    v_exp_f32 v35, v35
    v_exp_f32 v36, v36
    v_exp_f32 v37, v37
    s_waitcnt lgkmcnt(2)
    v_mfma_f32_32x32x16_bf16 v[144:159], a[16:19], v[176:179], v[144:159]
    ds_read_b128 a[12:15], v70 offset:512
    v_exp_f32 v38, v38
    v_exp_f32 v39, v39
    v_cvt_pk_bf16_f32 v192, v32, v33
    v_cvt_pk_bf16_f32 v193, v34, v35
    v_exp_f32 v40, v40
    v_exp_f32 v41, v41
    v_mfma_f32_32x32x16_bf16 v[16:31], a[0:3], v[136:139], v[240:255]
    ds_read_b128 a[24:27], v71 offset:8512
    v_exp_f32 v42, v42
    v_exp_f32 v43, v43
    v_cvt_pk_bf16_f32 v194, v36, v37
    v_cvt_pk_bf16_f32 v195, v38, v39
    v_exp_f32 v44, v44
    v_exp_f32 v45, v45
    v_mfma_f32_32x32x16_bf16 v[160:175], a[16:19], v[184:187], v[160:175]
    ds_read_b128 a[28:31], v71 offset:9120
    v_exp_f32 v46, v46
    v_exp_f32 v47, v47
    v_cvt_pk_bf16_f32 v196, v40, v41
    v_cvt_pk_bf16_f32 v197, v42, v43
    v_cvt_pk_bf16_f32 v198, v44, v45
    v_cvt_pk_bf16_f32 v199, v46, v47
    v_mfma_f32_32x32x16_bf16 v[0:15], a[4:7], v[132:135], v[0:15]
    v_exp_f32 v48, v48
    v_exp_f32 v49, v49
    v_exp_f32 v50, v50
    buffer_load_dwordx4 a[92:95], v210, s[24:27], s54 offen offset:3072 sc1
    s_add_u32 s54, s54, 4096
    v_exp_f32 v51, v51
    v_exp_f32 v52, v52
    v_exp_f32 v53, v53
    s_waitcnt lgkmcnt(4)
    v_mfma_f32_32x32x16_bf16 v[144:159], a[20:23], v[180:183], v[144:159]
    v_exp_f32 v54, v54
    v_exp_f32 v55, v55
    v_cvt_pk_bf16_f32 v200, v48, v49
    v_cvt_pk_bf16_f32 v201, v50, v51
    v_exp_f32 v56, v56
    v_exp_f32 v57, v57
    v_mfma_f32_32x32x16_bf16 v[16:31], a[4:7], v[140:143], v[16:31]
    v_exp_f32 v58, v58
    v_exp_f32 v59, v59
    v_cvt_pk_bf16_f32 v202, v52, v53
    v_cvt_pk_bf16_f32 v203, v54, v55
    v_exp_f32 v60, v60
    v_exp_f32 v61, v61
    v_mfma_f32_32x32x16_bf16 v[160:175], a[20:23], v[188:191], v[160:175]
    v_exp_f32 v62, v62
    v_exp_f32 v63, v63
    v_cvt_pk_bf16_f32 v204, v56, v57
    v_cvt_pk_bf16_f32 v205, v58, v59
    v_cvt_pk_bf16_f32 v206, v60, v61
    v_cvt_pk_bf16_f32 v207, v62, v63
    v_add_u32 v67, s76, v65
    v_add_u32 v69, s77, v65
    s_add_u32 s34, s76, 8192
    s_add_u32 s35, s77, 8192
    s_add_u32 s36, s76, 12288
    v_add_u32 v68, s34, v64
    v_add_u32 v70, s35, v64
    v_add_u32 v71, s36, v66
    s_mov_b32 s76, s77
    s_sub_u32 s77, s77, 36864
    s_cselect_b32 s77, 110592, s77
    s_waitcnt lgkmcnt(3)
    v_mfma_f32_32x32x16_bf16 v[32:47], a[8:11], v[128:131], v[224:239]
    ds_read_b128 a[0:3], v67 offset:1024
    v_exp_f32 v0, v0
    v_exp_f32 v1, v1
    v_exp_f32 v2, v2
    v_exp_f32 v3, v3
    v_exp_f32 v4, v4
    v_exp_f32 v5, v5
    s_waitcnt lgkmcnt(2)
    v_mfma_f32_32x32x16_bf16 v[144:159], a[24:27], v[192:195], v[144:159]
    ds_read_b128 a[4:7], v68 offset:1024
    v_exp_f32 v6, v6
    v_exp_f32 v7, v7
    v_cvt_pk_bf16_f32 v176, v0, v1
    s_add_u32 m0, s53, 0
    s_nop 0
    buffer_load_dwordx4 v72, s[48:51], s52 offen lds
    v_cvt_pk_bf16_f32 v177, v2, v3
    v_exp_f32 v8, v8
    v_exp_f32 v9, v9
    v_mfma_f32_32x32x16_bf16 v[48:63], a[8:11], v[136:139], v[240:255]
    ds_read_b128 a[16:19], v71 offset:0
    v_exp_f32 v10, v10
    v_exp_f32 v11, v11
    v_cvt_pk_bf16_f32 v178, v4, v5
    v_cvt_pk_bf16_f32 v179, v6, v7
    v_exp_f32 v12, v12
    v_exp_f32 v13, v13
    v_mfma_f32_32x32x16_bf16 v[160:175], a[24:27], v[200:203], v[160:175]
    ds_read_b128 a[20:23], v71 offset:608
    v_exp_f32 v14, v14
    v_exp_f32 v15, v15
    v_cvt_pk_bf16_f32 v180, v8, v9
    v_cvt_pk_bf16_f32 v181, v10, v11
    v_cvt_pk_bf16_f32 v182, v12, v13
    v_cvt_pk_bf16_f32 v183, v14, v15
    v_mfma_f32_32x32x16_bf16 v[32:47], a[12:15], v[132:135], v[32:47]
    v_exp_f32 v16, v16
    v_exp_f32 v17, v17
    v_exp_f32 v18, v18
    buffer_load_dwordx4 a[96:99], v210, s[24:27], s54 offen offset:0 sc1
    v_exp_f32 v19, v19
    v_exp_f32 v20, v20
    v_exp_f32 v21, v21
    s_waitcnt lgkmcnt(4)
    v_mfma_f32_32x32x16_bf16 v[144:159], a[28:31], v[196:199], v[144:159]
    v_exp_f32 v22, v22
    v_exp_f32 v23, v23
    v_cvt_pk_bf16_f32 v184, v16, v17
    s_add_u32 m0, s53, 1024
    s_nop 0
    buffer_load_dwordx4 v73, s[48:51], s52 offen lds
    v_cvt_pk_bf16_f32 v185, v18, v19
    v_exp_f32 v24, v24
    v_exp_f32 v25, v25
    v_mfma_f32_32x32x16_bf16 v[48:63], a[12:15], v[140:143], v[48:63]
    v_exp_f32 v26, v26
    v_exp_f32 v27, v27
    v_cvt_pk_bf16_f32 v186, v20, v21
    v_cvt_pk_bf16_f32 v187, v22, v23
    v_exp_f32 v28, v28
    v_exp_f32 v29, v29
    v_mfma_f32_32x32x16_bf16 v[160:175], a[28:31], v[204:207], v[160:175]
    v_exp_f32 v30, v30
    v_exp_f32 v31, v31
    v_cvt_pk_bf16_f32 v188, v24, v25
    v_cvt_pk_bf16_f32 v189, v26, v27
    v_cvt_pk_bf16_f32 v190, v28, v29
    v_cvt_pk_bf16_f32 v191, v30, v31
    s_waitcnt lgkmcnt(3)
    v_mfma_f32_32x32x16_bf16 v[0:15], a[0:3], v[128:131], v[224:239]
    ds_read_b128 a[8:11], v67 offset:1536
    v_exp_f32 v32, v32
    v_exp_f32 v33, v33
    v_exp_f32 v34, v34
    v_exp_f32 v35, v35
    v_exp_f32 v36, v36
    v_exp_f32 v37, v37
    s_waitcnt lgkmcnt(2)
    v_mfma_f32_32x32x16_bf16 v[144:159], a[16:19], v[176:179], v[144:159]
    ds_read_b128 a[12:15], v68 offset:1536
    v_exp_f32 v38, v38
    v_exp_f32 v39, v39
    v_cvt_pk_bf16_f32 v192, v32, v33
    s_add_u32 m0, s53, 2048
    s_nop 0
    buffer_load_dwordx4 v74, s[48:51], s52 offen lds
    buffer_load_dwordx4 a[100:103], v210, s[24:27], s54 offen offset:1024 sc1
    v_cvt_pk_bf16_f32 v193, v34, v35
    v_exp_f32 v40, v40
    v_exp_f32 v41, v41
    v_mfma_f32_32x32x16_bf16 v[16:31], a[0:3], v[136:139], v[240:255]
    ds_read_b128 a[24:27], v71 offset:1216
    v_exp_f32 v42, v42
    v_exp_f32 v43, v43
    v_cvt_pk_bf16_f32 v194, v36, v37
    s_add_u32 s34, s57, 3072
    buffer_store_dwordx4 v[96:99], v86, s[24:27], s34 offen offset:0 sc1
    v_cvt_pk_bf16_f32 v195, v38, v39
    v_exp_f32 v44, v44
    v_exp_f32 v45, v45
    v_mfma_f32_32x32x16_bf16 v[160:175], a[16:19], v[184:187], v[160:175]
    ds_read_b128 a[28:31], v71 offset:1824
    v_exp_f32 v46, v46
    v_exp_f32 v47, v47
    v_cvt_pk_bf16_f32 v196, v40, v41
    v_cvt_pk_bf16_f32 v197, v42, v43
    v_cvt_pk_bf16_f32 v198, v44, v45
    v_cvt_pk_bf16_f32 v199, v46, v47
    v_mfma_f32_32x32x16_bf16 v[0:15], a[4:7], v[132:135], v[0:15]
    v_exp_f32 v48, v48
    v_exp_f32 v49, v49
    v_exp_f32 v50, v50
    v_exp_f32 v51, v51
    v_exp_f32 v52, v52
    v_exp_f32 v53, v53
    s_waitcnt lgkmcnt(4)
    v_mfma_f32_32x32x16_bf16 v[144:159], a[20:23], v[180:183], v[144:159]
    v_exp_f32 v54, v54
    v_exp_f32 v55, v55
    v_cvt_pk_bf16_f32 v200, v48, v49
    v_cvt_pk_bf16_f32 v201, v50, v51
    v_exp_f32 v56, v56
    v_exp_f32 v57, v57
    v_mfma_f32_32x32x16_bf16 v[16:31], a[4:7], v[140:143], v[16:31]
    v_exp_f32 v58, v58
    v_exp_f32 v59, v59
    v_cvt_pk_bf16_f32 v202, v52, v53
    s_add_u32 m0, s53, 3072
    s_nop 0
    buffer_load_dwordx4 v75, s[48:51], s52 offen lds
    v_cvt_pk_bf16_f32 v203, v54, v55
    v_exp_f32 v60, v60
    v_exp_f32 v61, v61
    v_mfma_f32_32x32x16_bf16 v[160:175], a[20:23], v[188:191], v[160:175]
    v_exp_f32 v62, v62
    v_exp_f32 v63, v63
    v_cvt_pk_bf16_f32 v204, v56, v57
    buffer_load_dwordx4 a[104:107], v210, s[24:27], s54 offen offset:2048 sc1
    v_cvt_pk_bf16_f32 v205, v58, v59
    v_cvt_pk_bf16_f32 v206, v60, v61
    v_cvt_pk_bf16_f32 v207, v62, v63
    s_waitcnt lgkmcnt(3)
    v_mfma_f32_32x32x16_bf16 v[32:47], a[8:11], v[128:131], v[224:239]
    ds_read_b128 a[0:3], v67 offset:2048
    v_exp_f32 v0, v0
    v_exp_f32 v1, v1
    v_exp_f32 v2, v2
    v_exp_f32 v3, v3
    v_exp_f32 v4, v4
    v_exp_f32 v5, v5
    s_waitcnt lgkmcnt(2)
    v_mfma_f32_32x32x16_bf16 v[144:159], a[24:27], v[192:195], v[144:159]
    ds_read_b128 a[4:7], v68 offset:2048
    v_exp_f32 v6, v6
    v_exp_f32 v7, v7
    v_cvt_pk_bf16_f32 v176, v0, v1
    v_cvt_pk_bf16_f32 v177, v2, v3
    v_exp_f32 v8, v8
    v_exp_f32 v9, v9
    v_mfma_f32_32x32x16_bf16 v[48:63], a[8:11], v[136:139], v[240:255]
    ds_read_b128 a[16:19], v71 offset:2432
    v_exp_f32 v10, v10
    v_exp_f32 v11, v11
    v_cvt_pk_bf16_f32 v178, v4, v5
    s_add_u32 m0, s53, 4096
    s_nop 0
    buffer_load_dwordx4 v76, s[48:51], s52 offen lds
    buffer_store_dwordx4 v[96:99], v86, s[24:27], s34 offen offset:512 sc1
    v_cvt_pk_bf16_f32 v179, v6, v7
    v_exp_f32 v12, v12
    v_exp_f32 v13, v13
    v_mfma_f32_32x32x16_bf16 v[160:175], a[24:27], v[200:203], v[160:175]
    ds_read_b128 a[20:23], v71 offset:3040
    v_exp_f32 v14, v14
    v_exp_f32 v15, v15
    v_cvt_pk_bf16_f32 v180, v8, v9
    v_cvt_pk_bf16_f32 v181, v10, v11
    v_cvt_pk_bf16_f32 v182, v12, v13
    v_cvt_pk_bf16_f32 v183, v14, v15
    v_mfma_f32_32x32x16_bf16 v[32:47], a[12:15], v[132:135], v[32:47]
    v_exp_f32 v16, v16
    v_exp_f32 v17, v17
    v_exp_f32 v18, v18
    v_exp_f32 v19, v19
    v_exp_f32 v20, v20
    v_exp_f32 v21, v21
    s_waitcnt lgkmcnt(4)
    v_mfma_f32_32x32x16_bf16 v[144:159], a[28:31], v[196:199], v[144:159]
    v_exp_f32 v22, v22
    v_exp_f32 v23, v23
    v_cvt_pk_bf16_f32 v184, v16, v17
    buffer_load_dwordx4 a[108:111], v210, s[24:27], s54 offen offset:3072 sc1
    s_add_u32 s54, s54, 4096
    v_cvt_pk_bf16_f32 v185, v18, v19
    v_exp_f32 v24, v24
    v_exp_f32 v25, v25
    v_mfma_f32_32x32x16_bf16 v[48:63], a[12:15], v[140:143], v[48:63]
    v_exp_f32 v26, v26
    v_exp_f32 v27, v27
    v_cvt_pk_bf16_f32 v186, v20, v21
    s_add_u32 m0, s53, 5120
    s_nop 0
    buffer_load_dwordx4 v77, s[48:51], s52 offen lds
    v_cvt_pk_bf16_f32 v187, v22, v23
    v_exp_f32 v28, v28
    v_exp_f32 v29, v29
    v_mfma_f32_32x32x16_bf16 v[160:175], a[28:31], v[204:207], v[160:175]
    v_exp_f32 v30, v30
    v_exp_f32 v31, v31
    v_cvt_pk_bf16_f32 v188, v24, v25
    v_cvt_pk_bf16_f32 v189, v26, v27
    v_cvt_pk_bf16_f32 v190, v28, v29
    v_cvt_pk_bf16_f32 v191, v30, v31
    s_waitcnt lgkmcnt(3)
    v_mfma_f32_32x32x16_bf16 v[0:15], a[0:3], v[128:131], v[224:239]
    ds_read_b128 a[8:11], v67 offset:2560
    v_exp_f32 v32, v32
    v_exp_f32 v33, v33
    v_exp_f32 v34, v34
    v_exp_f32 v35, v35
    v_exp_f32 v36, v36
    v_exp_f32 v37, v37
    s_waitcnt lgkmcnt(2)
    v_mfma_f32_32x32x16_bf16 v[144:159], a[16:19], v[176:179], v[144:159]
    ds_read_b128 a[12:15], v68 offset:2560
    v_exp_f32 v38, v38
    v_exp_f32 v39, v39
    v_cvt_pk_bf16_f32 v192, v32, v33
    v_cvt_pk_bf16_f32 v193, v34, v35
    v_exp_f32 v40, v40
    v_exp_f32 v41, v41
    v_mfma_f32_32x32x16_bf16 v[16:31], a[0:3], v[136:139], v[240:255]
    ds_read_b128 a[24:27], v71 offset:3648
    v_exp_f32 v42, v42
    v_exp_f32 v43, v43
    v_cvt_pk_bf16_f32 v194, v36, v37
    s_add_u32 s34, s57, 4096
    buffer_store_dwordx4 v[96:99], v86, s[24:27], s34 offen offset:0 sc1
    v_cvt_pk_bf16_f32 v195, v38, v39
    v_exp_f32 v44, v44
    v_exp_f32 v45, v45
    v_mfma_f32_32x32x16_bf16 v[160:175], a[16:19], v[184:187], v[160:175]
    ds_read_b128 a[28:31], v71 offset:4256
    v_exp_f32 v46, v46
    v_exp_f32 v47, v47
    v_cvt_pk_bf16_f32 v196, v40, v41
    s_add_u32 m0, s53, 6144
    s_nop 0
    buffer_load_dwordx4 v78, s[48:51], s52 offen lds
    buffer_load_dwordx4 a[112:115], v210, s[24:27], s54 offen offset:0 sc1
    v_cvt_pk_bf16_f32 v197, v42, v43
    v_cvt_pk_bf16_f32 v198, v44, v45
    v_cvt_pk_bf16_f32 v199, v46, v47
    v_mfma_f32_32x32x16_bf16 v[0:15], a[4:7], v[132:135], v[0:15]
    v_exp_f32 v48, v48
    v_exp_f32 v49, v49
    v_exp_f32 v50, v50
    v_exp_f32 v51, v51
    v_exp_f32 v52, v52
    v_exp_f32 v53, v53
    s_waitcnt lgkmcnt(4)
    v_mfma_f32_32x32x16_bf16 v[144:159], a[20:23], v[180:183], v[144:159]
    v_exp_f32 v54, v54
    v_exp_f32 v55, v55
    v_cvt_pk_bf16_f32 v200, v48, v49
    v_cvt_pk_bf16_f32 v201, v50, v51
    v_exp_f32 v56, v56
    v_exp_f32 v57, v57
    v_mfma_f32_32x32x16_bf16 v[16:31], a[4:7], v[140:143], v[16:31]
    v_exp_f32 v58, v58
    v_exp_f32 v59, v59
    v_cvt_pk_bf16_f32 v202, v52, v53
    v_cvt_pk_bf16_f32 v203, v54, v55
    v_exp_f32 v60, v60
    v_exp_f32 v61, v61
    v_mfma_f32_32x32x16_bf16 v[160:175], a[20:23], v[188:191], v[160:175]
    v_exp_f32 v62, v62
    v_exp_f32 v63, v63
    v_cvt_pk_bf16_f32 v204, v56, v57
    s_add_u32 m0, s53, 7168
    s_nop 0
    buffer_load_dwordx4 v79, s[48:51], s52 offen lds
    v_cvt_pk_bf16_f32 v205, v58, v59
    v_cvt_pk_bf16_f32 v206, v60, v61
    v_cvt_pk_bf16_f32 v207, v62, v63
    s_waitcnt lgkmcnt(3)
    v_mfma_f32_32x32x16_bf16 v[32:47], a[8:11], v[128:131], v[224:239]
    ds_read_b128 a[0:3], v67 offset:3072
    v_exp_f32 v0, v0
    v_exp_f32 v1, v1
    v_exp_f32 v2, v2
    v_exp_f32 v3, v3
    v_exp_f32 v4, v4
    v_exp_f32 v5, v5
    s_waitcnt lgkmcnt(2)
    v_mfma_f32_32x32x16_bf16 v[144:159], a[24:27], v[192:195], v[144:159]
    ds_read_b128 a[4:7], v68 offset:3072
    v_exp_f32 v6, v6
    v_exp_f32 v7, v7
    v_cvt_pk_bf16_f32 v176, v0, v1
    buffer_load_dwordx4 a[116:119], v210, s[24:27], s54 offen offset:1024 sc1
    v_cvt_pk_bf16_f32 v177, v2, v3
    v_exp_f32 v8, v8
    v_exp_f32 v9, v9
    v_mfma_f32_32x32x16_bf16 v[48:63], a[8:11], v[136:139], v[240:255]
    ds_read_b128 a[16:19], v71 offset:4864
    v_exp_f32 v10, v10
    v_exp_f32 v11, v11
    v_cvt_pk_bf16_f32 v178, v4, v5
    v_cvt_pk_bf16_f32 v179, v6, v7
    v_exp_f32 v12, v12
    v_exp_f32 v13, v13
    v_mfma_f32_32x32x16_bf16 v[160:175], a[24:27], v[200:203], v[160:175]
    ds_read_b128 a[20:23], v71 offset:5472
    v_exp_f32 v14, v14
    v_exp_f32 v15, v15
    v_cvt_pk_bf16_f32 v180, v8, v9
    s_add_u32 m0, s53, 8192
    s_nop 0
    buffer_load_dwordx4 v80, s[48:51], s52 offen lds
    s_add_u32 s52, s52, 221184
    buffer_store_dwordx4 v[96:99], v86, s[24:27], s34 offen offset:512 sc1
    v_cvt_pk_bf16_f32 v181, v10, v11
    v_cvt_pk_bf16_f32 v182, v12, v13
    v_cvt_pk_bf16_f32 v183, v14, v15
    v_mfma_f32_32x32x16_bf16 v[32:47], a[12:15], v[132:135], v[32:47]
    v_exp_f32 v16, v16
    v_exp_f32 v17, v17
    v_exp_f32 v18, v18
    v_exp_f32 v19, v19
    v_exp_f32 v20, v20
    v_exp_f32 v21, v21
    s_waitcnt lgkmcnt(4)
    v_mfma_f32_32x32x16_bf16 v[144:159], a[28:31], v[196:199], v[144:159]
    v_exp_f32 v22, v22
    v_exp_f32 v23, v23
    v_cvt_pk_bf16_f32 v184, v16, v17
    v_cvt_pk_bf16_f32 v185, v18, v19
    v_exp_f32 v24, v24
    v_exp_f32 v25, v25
    v_mfma_f32_32x32x16_bf16 v[48:63], a[12:15], v[140:143], v[48:63]
    v_exp_f32 v26, v26
    v_exp_f32 v27, v27
    v_cvt_pk_bf16_f32 v186, v20, v21
    buffer_load_dwordx4 a[120:123], v210, s[24:27], s54 offen offset:2048 sc1
    v_cvt_pk_bf16_f32 v187, v22, v23
    v_exp_f32 v28, v28
    v_exp_f32 v29, v29
    v_mfma_f32_32x32x16_bf16 v[160:175], a[28:31], v[204:207], v[160:175]
    v_exp_f32 v30, v30
    v_exp_f32 v31, v31
    v_cvt_pk_bf16_f32 v188, v24, v25
    v_cvt_pk_bf16_f32 v189, v26, v27
    v_cvt_pk_bf16_f32 v190, v28, v29
    v_cvt_pk_bf16_f32 v191, v30, v31
    s_waitcnt lgkmcnt(3)
    v_mfma_f32_32x32x16_bf16 v[0:15], a[0:3], v[128:131], v[224:239]
    ds_read_b128 a[8:11], v67 offset:3584
    v_exp_f32 v32, v32
    v_exp_f32 v33, v33
    v_exp_f32 v34, v34
    v_exp_f32 v35, v35
    v_exp_f32 v36, v36
    v_exp_f32 v37, v37
    s_waitcnt lgkmcnt(2)
    v_mfma_f32_32x32x16_bf16 v[144:159], a[16:19], v[176:179], v[144:159]
    ds_read_b128 a[12:15], v68 offset:3584
    v_exp_f32 v38, v38
    v_exp_f32 v39, v39
    v_cvt_pk_bf16_f32 v192, v32, v33
    v_cvt_pk_bf16_f32 v193, v34, v35
    v_exp_f32 v40, v40
    v_exp_f32 v41, v41
    v_mfma_f32_32x32x16_bf16 v[16:31], a[0:3], v[136:139], v[240:255]
    ds_read_b128 a[24:27], v71 offset:6080
    v_exp_f32 v42, v42
    v_exp_f32 v43, v43
    v_cvt_pk_bf16_f32 v194, v36, v37
    v_cvt_pk_bf16_f32 v195, v38, v39
    v_exp_f32 v44, v44
    v_exp_f32 v45, v45
    v_mfma_f32_32x32x16_bf16 v[160:175], a[16:19], v[184:187], v[160:175]
    ds_read_b128 a[28:31], v71 offset:6688
    v_exp_f32 v46, v46
    v_exp_f32 v47, v47
    v_cvt_pk_bf16_f32 v196, v40, v41
    s_add_u32 s34, s57, 5120
    buffer_store_dwordx4 v[96:99], v86, s[24:27], s34 offen offset:0 sc1
    v_cvt_pk_bf16_f32 v197, v42, v43
    v_cvt_pk_bf16_f32 v198, v44, v45
    v_cvt_pk_bf16_f32 v199, v46, v47
    v_mfma_f32_32x32x16_bf16 v[0:15], a[4:7], v[132:135], v[0:15]
    v_exp_f32 v48, v48
    v_exp_f32 v49, v49
    v_exp_f32 v50, v50
    buffer_load_dwordx4 a[124:127], v210, s[24:27], s54 offen offset:3072 sc1
    s_add_u32 s54, s54, 4096
    v_exp_f32 v51, v51
    v_exp_f32 v52, v52
    v_exp_f32 v53, v53
    s_waitcnt lgkmcnt(4)
    v_mfma_f32_32x32x16_bf16 v[144:159], a[20:23], v[180:183], v[144:159]
    v_exp_f32 v54, v54
    v_exp_f32 v55, v55
    v_cvt_pk_bf16_f32 v200, v48, v49
    v_cvt_pk_bf16_f32 v201, v50, v51
    v_exp_f32 v56, v56
    v_exp_f32 v57, v57
    v_mfma_f32_32x32x16_bf16 v[16:31], a[4:7], v[140:143], v[16:31]
    v_exp_f32 v58, v58
    v_exp_f32 v59, v59
    v_cvt_pk_bf16_f32 v202, v52, v53
    s_waitcnt vmcnt(38)
    s_barrier
    v_cvt_pk_bf16_f32 v203, v54, v55
    v_exp_f32 v60, v60
    v_exp_f32 v61, v61
    v_mfma_f32_32x32x16_bf16 v[160:175], a[20:23], v[188:191], v[160:175]
    v_exp_f32 v62, v62
    v_exp_f32 v63, v63
    v_cvt_pk_bf16_f32 v204, v56, v57
    v_cvt_pk_bf16_f32 v205, v58, v59
    v_cvt_pk_bf16_f32 v206, v60, v61
    v_cvt_pk_bf16_f32 v207, v62, v63
    s_waitcnt lgkmcnt(3)
    v_mfma_f32_32x32x16_bf16 v[32:47], a[8:11], v[128:131], v[224:239]
    ds_read_b128 a[0:3], v69 offset:0
    v_exp_f32 v0, v0
    v_exp_f32 v1, v1
    v_exp_f32 v2, v2
    v_exp_f32 v3, v3
    v_exp_f32 v4, v4
    v_exp_f32 v5, v5
    s_waitcnt lgkmcnt(2)
    v_mfma_f32_32x32x16_bf16 v[144:159], a[24:27], v[192:195], v[144:159]
    ds_read_b128 a[4:7], v70 offset:0
    v_exp_f32 v6, v6
    v_exp_f32 v7, v7
    v_cvt_pk_bf16_f32 v176, v0, v1
    v_cvt_pk_bf16_f32 v177, v2, v3
    v_exp_f32 v8, v8
    v_exp_f32 v9, v9
    v_mfma_f32_32x32x16_bf16 v[48:63], a[8:11], v[136:139], v[240:255]
    ds_read_b128 a[16:19], v71 offset:7296
    v_exp_f32 v10, v10
    v_exp_f32 v11, v11
    v_cvt_pk_bf16_f32 v178, v4, v5
    buffer_load_dwordx4 a[128:131], v210, s[24:27], s54 offen offset:0 sc1
    v_cvt_pk_bf16_f32 v179, v6, v7
    v_exp_f32 v12, v12
    v_exp_f32 v13, v13
    v_mfma_f32_32x32x16_bf16 v[160:175], a[24:27], v[200:203], v[160:175]
    ds_read_b128 a[20:23], v71 offset:7904
    v_exp_f32 v14, v14
    v_exp_f32 v15, v15
    v_cvt_pk_bf16_f32 v180, v8, v9
    buffer_store_dwordx4 v[96:99], v86, s[24:27], s34 offen offset:512 sc1
    v_cvt_pk_bf16_f32 v181, v10, v11
    v_cvt_pk_bf16_f32 v182, v12, v13
    v_cvt_pk_bf16_f32 v183, v14, v15
    v_mfma_f32_32x32x16_bf16 v[32:47], a[12:15], v[132:135], v[32:47]
    v_exp_f32 v16, v16
    v_exp_f32 v17, v17
    v_exp_f32 v18, v18
    v_exp_f32 v19, v19
    v_exp_f32 v20, v20
    v_exp_f32 v21, v21
    s_waitcnt lgkmcnt(4)
    v_mfma_f32_32x32x16_bf16 v[144:159], a[28:31], v[196:199], v[144:159]
    v_exp_f32 v22, v22
    v_exp_f32 v23, v23
    v_cvt_pk_bf16_f32 v184, v16, v17
    v_cvt_pk_bf16_f32 v185, v18, v19
    v_exp_f32 v24, v24
    v_exp_f32 v25, v25
    v_mfma_f32_32x32x16_bf16 v[48:63], a[12:15], v[140:143], v[48:63]
    v_exp_f32 v26, v26
    v_exp_f32 v27, v27
    v_cvt_pk_bf16_f32 v186, v20, v21
    v_cvt_pk_bf16_f32 v187, v22, v23
    v_exp_f32 v28, v28
    v_exp_f32 v29, v29
    v_mfma_f32_32x32x16_bf16 v[160:175], a[28:31], v[204:207], v[160:175]
    v_exp_f32 v30, v30
    v_exp_f32 v31, v31
    v_cvt_pk_bf16_f32 v188, v24, v25
    v_cvt_pk_bf16_f32 v189, v26, v27
    v_cvt_pk_bf16_f32 v190, v28, v29
    v_cvt_pk_bf16_f32 v191, v30, v31
    s_waitcnt lgkmcnt(3)
    v_mfma_f32_32x32x16_bf16 v[0:15], a[0:3], v[128:131], v[224:239]
    ds_read_b128 a[8:11], v69 offset:512
    v_exp_f32 v32, v32
    v_exp_f32 v33, v33
    v_exp_f32 v34, v34
    buffer_load_dwordx4 a[132:135], v210, s[24:27], s54 offen offset:1024 sc1
    v_exp_f32 v35, v35
    v_exp_f32 v36, v36
    v_exp_f32 v37, v37
    s_waitcnt lgkmcnt(2)
    v_mfma_f32_32x32x16_bf16 v[144:159], a[16:19], v[176:179], v[144:159]
    ds_read_b128 a[12:15], v70 offset:512
    v_exp_f32 v38, v38
    v_exp_f32 v39, v39
    v_cvt_pk_bf16_f32 v192, v32, v33
    v_cvt_pk_bf16_f32 v193, v34, v35
    v_exp_f32 v40, v40
    v_exp_f32 v41, v41
    v_mfma_f32_32x32x16_bf16 v[16:31], a[0:3], v[136:139], v[240:255]
    ds_read_b128 a[24:27], v71 offset:8512
    v_exp_f32 v42, v42
    v_exp_f32 v43, v43
    v_cvt_pk_bf16_f32 v194, v36, v37
    v_cvt_pk_bf16_f32 v195, v38, v39
    v_exp_f32 v44, v44
    v_exp_f32 v45, v45
    v_mfma_f32_32x32x16_bf16 v[160:175], a[16:19], v[184:187], v[160:175]
    ds_read_b128 a[28:31], v71 offset:9120
    v_exp_f32 v46, v46
    v_exp_f32 v47, v47
    v_cvt_pk_bf16_f32 v196, v40, v41
    v_cvt_pk_bf16_f32 v197, v42, v43
    v_cvt_pk_bf16_f32 v198, v44, v45
    v_cvt_pk_bf16_f32 v199, v46, v47
    v_mfma_f32_32x32x16_bf16 v[0:15], a[4:7], v[132:135], v[0:15]
    v_exp_f32 v48, v48
    v_exp_f32 v49, v49
    v_exp_f32 v50, v50
    v_exp_f32 v51, v51
    v_exp_f32 v52, v52
    v_exp_f32 v53, v53
    s_waitcnt lgkmcnt(4)
    v_mfma_f32_32x32x16_bf16 v[144:159], a[20:23], v[180:183], v[144:159]
    v_exp_f32 v54, v54
    v_exp_f32 v55, v55
    v_cvt_pk_bf16_f32 v200, v48, v49
    v_cvt_pk_bf16_f32 v201, v50, v51
    v_exp_f32 v56, v56
    v_exp_f32 v57, v57
    v_mfma_f32_32x32x16_bf16 v[16:31], a[4:7], v[140:143], v[16:31]
    v_exp_f32 v58, v58
    v_exp_f32 v59, v59
    v_cvt_pk_bf16_f32 v202, v52, v53
    v_cvt_pk_bf16_f32 v203, v54, v55
    v_exp_f32 v60, v60
    v_exp_f32 v61, v61
    v_mfma_f32_32x32x16_bf16 v[160:175], a[20:23], v[188:191], v[160:175]
    v_exp_f32 v62, v62
    v_exp_f32 v63, v63
    v_cvt_pk_bf16_f32 v204, v56, v57
    v_cvt_pk_bf16_f32 v205, v58, v59
    v_cvt_pk_bf16_f32 v206, v60, v61
    v_cvt_pk_bf16_f32 v207, v62, v63
    v_add_u32 v67, s76, v65
    v_add_u32 v69, s77, v65
    s_add_u32 s34, s76, 8192
    s_add_u32 s35, s77, 8192
    s_add_u32 s36, s76, 12288
    v_add_u32 v68, s34, v64
    v_add_u32 v70, s35, v64
    v_add_u32 v71, s36, v66
    s_mov_b32 s76, s77
    s_sub_u32 s77, s77, 36864
    s_cselect_b32 s77, 110592, s77
    s_waitcnt lgkmcnt(3)
    v_mfma_f32_32x32x16_bf16 v[32:47], a[8:11], v[128:131], v[224:239]
    ds_read_b128 a[0:3], v67 offset:1024
    v_exp_f32 v0, v0
    v_exp_f32 v1, v1
    v_exp_f32 v2, v2
    buffer_load_dwordx4 a[136:139], v210, s[24:27], s54 offen offset:2048 sc1
    v_exp_f32 v3, v3
    v_exp_f32 v4, v4
    v_exp_f32 v5, v5
    s_waitcnt lgkmcnt(2)
    v_mfma_f32_32x32x16_bf16 v[144:159], a[24:27], v[192:195], v[144:159]
    ds_read_b128 a[4:7], v68 offset:1024
    v_exp_f32 v6, v6
    v_exp_f32 v7, v7
    v_cvt_pk_bf16_f32 v176, v0, v1
    v_cvt_pk_bf16_f32 v177, v2, v3
    v_exp_f32 v8, v8
    v_exp_f32 v9, v9
    v_mfma_f32_32x32x16_bf16 v[48:63], a[8:11], v[136:139], v[240:255]
    ds_read_b128 a[16:19], v71 offset:0
    v_exp_f32 v10, v10
    v_exp_f32 v11, v11
    v_cvt_pk_bf16_f32 v178, v4, v5
    s_add_u32 m0, s53, 110592
    s_nop 0
    buffer_load_dwordx4 v72, s[48:51], s52 offen lds
    v_cvt_pk_bf16_f32 v179, v6, v7
    v_exp_f32 v12, v12
    v_exp_f32 v13, v13
    v_mfma_f32_32x32x16_bf16 v[160:175], a[24:27], v[200:203], v[160:175]
    ds_read_b128 a[20:23], v71 offset:608
    v_exp_f32 v14, v14
    v_exp_f32 v15, v15
    v_cvt_pk_bf16_f32 v180, v8, v9
    v_cvt_pk_bf16_f32 v181, v10, v11
    v_cvt_pk_bf16_f32 v182, v12, v13
    v_cvt_pk_bf16_f32 v183, v14, v15
    v_mfma_f32_32x32x16_bf16 v[32:47], a[12:15], v[132:135], v[32:47]
    v_exp_f32 v16, v16
    v_exp_f32 v17, v17
    v_exp_f32 v18, v18
    buffer_load_dwordx4 a[140:143], v210, s[24:27], s54 offen offset:3072 sc1
    s_add_u32 s54, s54, 4096
    v_exp_f32 v19, v19
    v_exp_f32 v20, v20
    v_exp_f32 v21, v21
    s_waitcnt lgkmcnt(4)
    v_mfma_f32_32x32x16_bf16 v[144:159], a[28:31], v[196:199], v[144:159]
    v_exp_f32 v22, v22
    v_exp_f32 v23, v23
    v_cvt_pk_bf16_f32 v184, v16, v17
    v_cvt_pk_bf16_f32 v185, v18, v19
    v_exp_f32 v24, v24
    v_exp_f32 v25, v25
    v_mfma_f32_32x32x16_bf16 v[48:63], a[12:15], v[140:143], v[48:63]
    v_exp_f32 v26, v26
    v_exp_f32 v27, v27
    v_cvt_pk_bf16_f32 v186, v20, v21
    s_add_u32 m0, s53, 111616
    s_nop 0
    buffer_load_dwordx4 v73, s[48:51], s52 offen lds
    s_add_u32 s34, s57, 6144
    buffer_store_dwordx4 v[96:99], v86, s[24:27], s34 offen offset:0 sc1
    v_cvt_pk_bf16_f32 v187, v22, v23
    v_exp_f32 v28, v28
    v_exp_f32 v29, v29
    v_mfma_f32_32x32x16_bf16 v[160:175], a[28:31], v[204:207], v[160:175]
    v_exp_f32 v30, v30
    v_exp_f32 v31, v31
    v_cvt_pk_bf16_f32 v188, v24, v25
    v_cvt_pk_bf16_f32 v189, v26, v27
    v_cvt_pk_bf16_f32 v190, v28, v29
    v_cvt_pk_bf16_f32 v191, v30, v31
    s_waitcnt lgkmcnt(3)
    v_mfma_f32_32x32x16_bf16 v[0:15], a[0:3], v[128:131], v[224:239]
    ds_read_b128 a[8:11], v67 offset:1536
    v_exp_f32 v32, v32
    v_exp_f32 v33, v33
    v_exp_f32 v34, v34
    buffer_load_dwordx4 a[144:147], v210, s[24:27], s54 offen offset:0 sc1
    v_exp_f32 v35, v35
    v_exp_f32 v36, v36
    v_exp_f32 v37, v37
    s_waitcnt lgkmcnt(2)
    v_mfma_f32_32x32x16_bf16 v[144:159], a[16:19], v[176:179], v[144:159]
    ds_read_b128 a[12:15], v68 offset:1536
    v_exp_f32 v38, v38
    v_exp_f32 v39, v39
    v_cvt_pk_bf16_f32 v192, v32, v33
    v_cvt_pk_bf16_f32 v193, v34, v35
    v_exp_f32 v40, v40
    v_exp_f32 v41, v41
    v_mfma_f32_32x32x16_bf16 v[16:31], a[0:3], v[136:139], v[240:255]
    ds_read_b128 a[24:27], v71 offset:1216
    v_exp_f32 v42, v42
    v_exp_f32 v43, v43
    v_cvt_pk_bf16_f32 v194, v36, v37
    s_add_u32 m0, s53, 112640
    s_nop 0
    buffer_load_dwordx4 v74, s[48:51], s52 offen lds
    v_cvt_pk_bf16_f32 v195, v38, v39
    v_exp_f32 v44, v44
    v_exp_f32 v45, v45
    v_mfma_f32_32x32x16_bf16 v[160:175], a[16:19], v[184:187], v[160:175]
    ds_read_b128 a[28:31], v71 offset:1824
    v_exp_f32 v46, v46
    v_exp_f32 v47, v47
    v_cvt_pk_bf16_f32 v196, v40, v41
    v_cvt_pk_bf16_f32 v197, v42, v43
    v_cvt_pk_bf16_f32 v198, v44, v45
    v_cvt_pk_bf16_f32 v199, v46, v47
    v_mfma_f32_32x32x16_bf16 v[0:15], a[4:7], v[132:135], v[0:15]
    v_exp_f32 v48, v48
    v_exp_f32 v49, v49
    v_exp_f32 v50, v50
    buffer_store_dwordx4 v[96:99], v86, s[24:27], s34 offen offset:512 sc1
    v_exp_f32 v51, v51
    v_exp_f32 v52, v52
    v_exp_f32 v53, v53
    s_waitcnt lgkmcnt(4)
    v_mfma_f32_32x32x16_bf16 v[144:159], a[20:23], v[180:183], v[144:159]
    v_exp_f32 v54, v54
    v_exp_f32 v55, v55
    v_cvt_pk_bf16_f32 v200, v48, v49
    buffer_load_dwordx4 a[148:151], v210, s[24:27], s54 offen offset:1024 sc1
    v_cvt_pk_bf16_f32 v201, v50, v51
    v_exp_f32 v56, v56
    v_exp_f32 v57, v57
    v_mfma_f32_32x32x16_bf16 v[16:31], a[4:7], v[140:143], v[16:31]
    v_exp_f32 v58, v58
    v_exp_f32 v59, v59
    v_cvt_pk_bf16_f32 v202, v52, v53
    v_cvt_pk_bf16_f32 v203, v54, v55
    v_exp_f32 v60, v60
    v_exp_f32 v61, v61
    v_mfma_f32_32x32x16_bf16 v[160:175], a[20:23], v[188:191], v[160:175]
    v_exp_f32 v62, v62
    v_exp_f32 v63, v63
    v_cvt_pk_bf16_f32 v204, v56, v57
    s_add_u32 m0, s53, 113664
    s_nop 0
    buffer_load_dwordx4 v75, s[48:51], s52 offen lds
    v_cvt_pk_bf16_f32 v205, v58, v59
    v_cvt_pk_bf16_f32 v206, v60, v61
    v_cvt_pk_bf16_f32 v207, v62, v63
    s_waitcnt lgkmcnt(3)
    v_mfma_f32_32x32x16_bf16 v[32:47], a[8:11], v[128:131], v[224:239]
    ds_read_b128 a[0:3], v67 offset:2048
    v_exp_f32 v0, v0
    v_exp_f32 v1, v1
    v_exp_f32 v2, v2
    v_exp_f32 v3, v3
    v_exp_f32 v4, v4
    v_exp_f32 v5, v5
    s_waitcnt lgkmcnt(2)
    v_mfma_f32_32x32x16_bf16 v[144:159], a[24:27], v[192:195], v[144:159]
    ds_read_b128 a[4:7], v68 offset:2048
    v_exp_f32 v6, v6
    v_exp_f32 v7, v7
    v_cvt_pk_bf16_f32 v176, v0, v1
    buffer_load_dwordx4 a[152:155], v210, s[24:27], s54 offen offset:2048 sc1
    v_cvt_pk_bf16_f32 v177, v2, v3
    v_exp_f32 v8, v8
    v_exp_f32 v9, v9
    v_mfma_f32_32x32x16_bf16 v[48:63], a[8:11], v[136:139], v[240:255]
    ds_read_b128 a[16:19], v71 offset:2432
    v_exp_f32 v10, v10
    v_exp_f32 v11, v11
    v_cvt_pk_bf16_f32 v178, v4, v5
    v_cvt_pk_bf16_f32 v179, v6, v7
    v_exp_f32 v12, v12
    v_exp_f32 v13, v13
    v_mfma_f32_32x32x16_bf16 v[160:175], a[24:27], v[200:203], v[160:175]
    ds_read_b128 a[20:23], v71 offset:3040
    v_exp_f32 v14, v14
    v_exp_f32 v15, v15
    v_cvt_pk_bf16_f32 v180, v8, v9
    s_add_u32 m0, s53, 114688
    s_nop 0
    buffer_load_dwordx4 v76, s[48:51], s52 offen lds
    s_add_u32 s34, s57, 7168
    buffer_store_dwordx4 v[96:99], v86, s[24:27], s34 offen offset:0 sc1
    v_cvt_pk_bf16_f32 v181, v10, v11
    v_cvt_pk_bf16_f32 v182, v12, v13
    v_cvt_pk_bf16_f32 v183, v14, v15
    v_mfma_f32_32x32x16_bf16 v[32:47], a[12:15], v[132:135], v[32:47]
    v_exp_f32 v16, v16
    v_exp_f32 v17, v17
    v_exp_f32 v18, v18
    v_exp_f32 v19, v19
    v_exp_f32 v20, v20
    v_exp_f32 v21, v21
    s_waitcnt lgkmcnt(4)
    v_mfma_f32_32x32x16_bf16 v[144:159], a[28:31], v[196:199], v[144:159]
    v_exp_f32 v22, v22
    v_exp_f32 v23, v23
    v_cvt_pk_bf16_f32 v184, v16, v17
    v_cvt_pk_bf16_f32 v185, v18, v19
    v_exp_f32 v24, v24
    v_exp_f32 v25, v25
    v_mfma_f32_32x32x16_bf16 v[48:63], a[12:15], v[140:143], v[48:63]
    v_exp_f32 v26, v26
    v_exp_f32 v27, v27
    v_cvt_pk_bf16_f32 v186, v20, v21
    buffer_load_dwordx4 a[156:159], v210, s[24:27], s54 offen offset:3072 sc1
    s_add_u32 s54, s54, 4096
    v_cvt_pk_bf16_f32 v187, v22, v23
    v_exp_f32 v28, v28
    v_exp_f32 v29, v29
    v_mfma_f32_32x32x16_bf16 v[160:175], a[28:31], v[204:207], v[160:175]
    v_exp_f32 v30, v30
    v_exp_f32 v31, v31
    v_cvt_pk_bf16_f32 v188, v24, v25
    v_cvt_pk_bf16_f32 v189, v26, v27
    v_cvt_pk_bf16_f32 v190, v28, v29
    v_cvt_pk_bf16_f32 v191, v30, v31
    s_waitcnt lgkmcnt(3)
    v_mfma_f32_32x32x16_bf16 v[0:15], a[0:3], v[128:131], v[224:239]
    ds_read_b128 a[8:11], v67 offset:2560
    v_exp_f32 v32, v32
    v_exp_f32 v33, v33
    v_exp_f32 v34, v34
    s_add_u32 m0, s53, 115712
    s_nop 0
    buffer_load_dwordx4 v77, s[48:51], s52 offen lds
    v_exp_f32 v35, v35
    v_exp_f32 v36, v36
    v_exp_f32 v37, v37
    s_waitcnt lgkmcnt(2)
    v_mfma_f32_32x32x16_bf16 v[144:159], a[16:19], v[176:179], v[144:159]
    ds_read_b128 a[12:15], v68 offset:2560
    v_exp_f32 v38, v38
    v_exp_f32 v39, v39
    v_cvt_pk_bf16_f32 v192, v32, v33
    buffer_store_dwordx4 v[96:99], v86, s[24:27], s34 offen offset:512 sc1
    v_cvt_pk_bf16_f32 v193, v34, v35
    v_exp_f32 v40, v40
    v_exp_f32 v41, v41
    v_mfma_f32_32x32x16_bf16 v[16:31], a[0:3], v[136:139], v[240:255]
    ds_read_b128 a[24:27], v71 offset:3648
    v_exp_f32 v42, v42
    v_exp_f32 v43, v43
    v_cvt_pk_bf16_f32 v194, v36, v37
    buffer_load_dwordx4 a[160:163], v210, s[24:27], s54 offen offset:0 sc1
    v_cvt_pk_bf16_f32 v195, v38, v39
    v_exp_f32 v44, v44
    v_exp_f32 v45, v45
    v_mfma_f32_32x32x16_bf16 v[160:175], a[16:19], v[184:187], v[160:175]
    ds_read_b128 a[28:31], v71 offset:4256
    v_exp_f32 v46, v46
    v_exp_f32 v47, v47
    v_cvt_pk_bf16_f32 v196, v40, v41
    v_cvt_pk_bf16_f32 v197, v42, v43
    v_cvt_pk_bf16_f32 v198, v44, v45
    v_cvt_pk_bf16_f32 v199, v46, v47
    v_mfma_f32_32x32x16_bf16 v[0:15], a[4:7], v[132:135], v[0:15]
    v_exp_f32 v48, v48
    v_exp_f32 v49, v49
    v_exp_f32 v50, v50
    s_add_u32 m0, s53, 116736
    s_nop 0
    buffer_load_dwordx4 v78, s[48:51], s52 offen lds
    v_exp_f32 v51, v51
    v_exp_f32 v52, v52
    v_exp_f32 v53, v53
    s_waitcnt lgkmcnt(4)
    v_mfma_f32_32x32x16_bf16 v[144:159], a[20:23], v[180:183], v[144:159]
    v_exp_f32 v54, v54
    v_exp_f32 v55, v55
    v_cvt_pk_bf16_f32 v200, v48, v49
    v_cvt_pk_bf16_f32 v201, v50, v51
    v_exp_f32 v56, v56
    v_exp_f32 v57, v57
    v_mfma_f32_32x32x16_bf16 v[16:31], a[4:7], v[140:143], v[16:31]
    v_exp_f32 v58, v58
    v_exp_f32 v59, v59
    v_cvt_pk_bf16_f32 v202, v52, v53
    buffer_load_dwordx4 a[164:167], v210, s[24:27], s54 offen offset:1024 sc1
    v_cvt_pk_bf16_f32 v203, v54, v55
    v_exp_f32 v60, v60
    v_exp_f32 v61, v61
    v_mfma_f32_32x32x16_bf16 v[160:175], a[20:23], v[188:191], v[160:175]
    v_exp_f32 v62, v62
    v_exp_f32 v63, v63
    v_cvt_pk_bf16_f32 v204, v56, v57
    v_cvt_pk_bf16_f32 v205, v58, v59
    v_cvt_pk_bf16_f32 v206, v60, v61
    v_cvt_pk_bf16_f32 v207, v62, v63
    s_waitcnt lgkmcnt(3)
    v_mfma_f32_32x32x16_bf16 v[32:47], a[8:11], v[128:131], v[224:239]
    ds_read_b128 a[0:3], v67 offset:3072
    v_exp_f32 v0, v0
    v_exp_f32 v1, v1
    v_exp_f32 v2, v2
    s_add_u32 s34, s57, 8192
    buffer_store_dwordx4 v[96:99], v86, s[24:27], s34 offen offset:0 sc1
    v_exp_f32 v3, v3
    v_exp_f32 v4, v4
    v_exp_f32 v5, v5
    s_waitcnt lgkmcnt(2)
    v_mfma_f32_32x32x16_bf16 v[144:159], a[24:27], v[192:195], v[144:159]
    ds_read_b128 a[4:7], v68 offset:3072
    v_exp_f32 v6, v6
    v_exp_f32 v7, v7
    v_cvt_pk_bf16_f32 v176, v0, v1
    s_add_u32 m0, s53, 117760
    s_nop 0
    buffer_load_dwordx4 v79, s[48:51], s52 offen lds
    v_cvt_pk_bf16_f32 v177, v2, v3
    v_exp_f32 v8, v8
    v_exp_f32 v9, v9
    v_mfma_f32_32x32x16_bf16 v[48:63], a[8:11], v[136:139], v[240:255]
    ds_read_b128 a[16:19], v71 offset:4864
    v_exp_f32 v10, v10
    v_exp_f32 v11, v11
    v_cvt_pk_bf16_f32 v178, v4, v5
    v_cvt_pk_bf16_f32 v179, v6, v7
    v_exp_f32 v12, v12
    v_exp_f32 v13, v13
    v_mfma_f32_32x32x16_bf16 v[160:175], a[24:27], v[200:203], v[160:175]
    ds_read_b128 a[20:23], v71 offset:5472
    v_exp_f32 v14, v14
    v_exp_f32 v15, v15
    v_cvt_pk_bf16_f32 v180, v8, v9
    buffer_load_dwordx4 a[168:171], v210, s[24:27], s54 offen offset:2048 sc1
    v_cvt_pk_bf16_f32 v181, v10, v11
    v_cvt_pk_bf16_f32 v182, v12, v13
    v_cvt_pk_bf16_f32 v183, v14, v15
    v_mfma_f32_32x32x16_bf16 v[32:47], a[12:15], v[132:135], v[32:47]
    v_exp_f32 v16, v16
    v_exp_f32 v17, v17
    v_exp_f32 v18, v18
    v_exp_f32 v19, v19
    v_exp_f32 v20, v20
    v_exp_f32 v21, v21
    s_waitcnt lgkmcnt(4)
    v_mfma_f32_32x32x16_bf16 v[144:159], a[28:31], v[196:199], v[144:159]
    v_exp_f32 v22, v22
    v_exp_f32 v23, v23
    v_cvt_pk_bf16_f32 v184, v16, v17
    s_add_u32 m0, s53, 118784
    s_nop 0
    buffer_load_dwordx4 v80, s[48:51], s52 offen lds
    s_add_u32 s52, s52, 221184
    v_cvt_pk_bf16_f32 v185, v18, v19
    v_exp_f32 v24, v24
    v_exp_f32 v25, v25
    v_mfma_f32_32x32x16_bf16 v[48:63], a[12:15], v[140:143], v[48:63]
    v_exp_f32 v26, v26
    v_exp_f32 v27, v27
    v_cvt_pk_bf16_f32 v186, v20, v21
    buffer_store_dwordx4 v[96:99], v86, s[24:27], s34 offen offset:512 sc1
    v_cvt_pk_bf16_f32 v187, v22, v23
    v_exp_f32 v28, v28
    v_exp_f32 v29, v29
    v_mfma_f32_32x32x16_bf16 v[160:175], a[28:31], v[204:207], v[160:175]
    v_exp_f32 v30, v30
    v_exp_f32 v31, v31
    v_cvt_pk_bf16_f32 v188, v24, v25
    buffer_load_dwordx4 a[172:175], v210, s[24:27], s54 offen offset:3072 sc1
    s_add_u32 s54, s54, 4096
    v_cvt_pk_bf16_f32 v189, v26, v27
    v_cvt_pk_bf16_f32 v190, v28, v29
    v_cvt_pk_bf16_f32 v191, v30, v31
    s_waitcnt lgkmcnt(3)
    v_mfma_f32_32x32x16_bf16 v[0:15], a[0:3], v[128:131], v[224:239]
    ds_read_b128 a[8:11], v67 offset:3584
    v_exp_f32 v32, v32
    v_exp_f32 v33, v33
    v_exp_f32 v34, v34
    v_exp_f32 v35, v35
    v_exp_f32 v36, v36
    v_exp_f32 v37, v37
    s_waitcnt lgkmcnt(2)
    v_mfma_f32_32x32x16_bf16 v[144:159], a[16:19], v[176:179], v[144:159]
    ds_read_b128 a[12:15], v68 offset:3584
    v_exp_f32 v38, v38
    v_exp_f32 v39, v39
    v_cvt_pk_bf16_f32 v192, v32, v33
    v_cvt_pk_bf16_f32 v193, v34, v35
    v_exp_f32 v40, v40
    v_exp_f32 v41, v41
    v_mfma_f32_32x32x16_bf16 v[16:31], a[0:3], v[136:139], v[240:255]
    ds_read_b128 a[24:27], v71 offset:6080
    v_exp_f32 v42, v42
    v_exp_f32 v43, v43
    v_cvt_pk_bf16_f32 v194, v36, v37
    v_cvt_pk_bf16_f32 v195, v38, v39
    v_exp_f32 v44, v44
    v_exp_f32 v45, v45
    v_mfma_f32_32x32x16_bf16 v[160:175], a[16:19], v[184:187], v[160:175]
    ds_read_b128 a[28:31], v71 offset:6688
    v_exp_f32 v46, v46
    v_exp_f32 v47, v47
    v_cvt_pk_bf16_f32 v196, v40, v41
    v_cvt_pk_bf16_f32 v197, v42, v43
    v_cvt_pk_bf16_f32 v198, v44, v45
    v_cvt_pk_bf16_f32 v199, v46, v47
    v_mfma_f32_32x32x16_bf16 v[0:15], a[4:7], v[132:135], v[0:15]
    v_exp_f32 v48, v48
    v_exp_f32 v49, v49
    v_exp_f32 v50, v50
    v_exp_f32 v51, v51
    v_exp_f32 v52, v52
    v_exp_f32 v53, v53
    s_waitcnt lgkmcnt(4)
    v_mfma_f32_32x32x16_bf16 v[144:159], a[20:23], v[180:183], v[144:159]
    v_exp_f32 v54, v54
    v_exp_f32 v55, v55
    v_cvt_pk_bf16_f32 v200, v48, v49
    v_cvt_pk_bf16_f32 v201, v50, v51
    v_exp_f32 v56, v56
    v_exp_f32 v57, v57
    v_mfma_f32_32x32x16_bf16 v[16:31], a[4:7], v[140:143], v[16:31]
    v_exp_f32 v58, v58
    v_exp_f32 v59, v59
    v_cvt_pk_bf16_f32 v202, v52, v53
    s_barrier
    v_cvt_pk_bf16_f32 v203, v54, v55
    v_exp_f32 v60, v60
    v_exp_f32 v61, v61
    v_mfma_f32_32x32x16_bf16 v[160:175], a[20:23], v[188:191], v[160:175]
    v_exp_f32 v62, v62
    v_exp_f32 v63, v63
    v_cvt_pk_bf16_f32 v204, v56, v57
    s_add_u32 m0, s53, 73728
    s_nop 0
    buffer_load_dwordx4 v72, s[48:51], s52 offen lds
    v_cvt_pk_bf16_f32 v205, v58, v59
    v_cvt_pk_bf16_f32 v206, v60, v61
    v_cvt_pk_bf16_f32 v207, v62, v63
    s_waitcnt lgkmcnt(3)
    v_mfma_f32_32x32x16_bf16 v[32:47], a[8:11], v[128:131], v[224:239]
    ds_read_b128 a[0:3], v69 offset:0
    v_exp_f32 v0, v0
    v_exp_f32 v1, v1
    v_exp_f32 v2, v2
    s_add_u32 m0, s53, 74752
    s_nop 0
    buffer_load_dwordx4 v73, s[48:51], s52 offen lds
    v_exp_f32 v3, v3
    v_exp_f32 v4, v4
    v_exp_f32 v5, v5
    s_waitcnt lgkmcnt(2)
    v_mfma_f32_32x32x16_bf16 v[144:159], a[24:27], v[192:195], v[144:159]
    ds_read_b128 a[4:7], v70 offset:0
    v_exp_f32 v6, v6
    v_exp_f32 v7, v7
    v_cvt_pk_bf16_f32 v176, v0, v1
    v_cvt_pk_bf16_f32 v177, v2, v3
    v_exp_f32 v8, v8
    v_exp_f32 v9, v9
    v_mfma_f32_32x32x16_bf16 v[48:63], a[8:11], v[136:139], v[240:255]
    ds_read_b128 a[16:19], v71 offset:7296
    v_exp_f32 v10, v10
    v_exp_f32 v11, v11
    v_cvt_pk_bf16_f32 v178, v4, v5
    s_add_u32 m0, s53, 75776
    s_nop 0
    buffer_load_dwordx4 v74, s[48:51], s52 offen lds
    v_cvt_pk_bf16_f32 v179, v6, v7
    v_exp_f32 v12, v12
    v_exp_f32 v13, v13
    v_mfma_f32_32x32x16_bf16 v[160:175], a[24:27], v[200:203], v[160:175]
    ds_read_b128 a[20:23], v71 offset:7904
    v_exp_f32 v14, v14
    v_exp_f32 v15, v15
    v_cvt_pk_bf16_f32 v180, v8, v9
    v_cvt_pk_bf16_f32 v181, v10, v11
    v_cvt_pk_bf16_f32 v182, v12, v13
    v_cvt_pk_bf16_f32 v183, v14, v15
    v_mfma_f32_32x32x16_bf16 v[32:47], a[12:15], v[132:135], v[32:47]
    v_exp_f32 v16, v16
    v_exp_f32 v17, v17
    v_exp_f32 v18, v18
    s_add_u32 m0, s53, 76800
    s_nop 0
    buffer_load_dwordx4 v75, s[48:51], s52 offen lds
    v_exp_f32 v19, v19
    v_exp_f32 v20, v20
    v_exp_f32 v21, v21
    s_waitcnt lgkmcnt(4)
    v_mfma_f32_32x32x16_bf16 v[144:159], a[28:31], v[196:199], v[144:159]
    v_exp_f32 v22, v22
    v_exp_f32 v23, v23
    v_cvt_pk_bf16_f32 v184, v16, v17
    v_cvt_pk_bf16_f32 v185, v18, v19
    v_exp_f32 v24, v24
    v_exp_f32 v25, v25
    v_mfma_f32_32x32x16_bf16 v[48:63], a[12:15], v[140:143], v[48:63]
    v_exp_f32 v26, v26
    v_exp_f32 v27, v27
    v_cvt_pk_bf16_f32 v186, v20, v21
    s_add_u32 m0, s53, 77824
    s_nop 0
    buffer_load_dwordx4 v76, s[48:51], s52 offen lds
    v_cvt_pk_bf16_f32 v187, v22, v23
    v_exp_f32 v28, v28
    v_exp_f32 v29, v29
    v_mfma_f32_32x32x16_bf16 v[160:175], a[28:31], v[204:207], v[160:175]
    v_exp_f32 v30, v30
    v_exp_f32 v31, v31
    v_cvt_pk_bf16_f32 v188, v24, v25
    v_cvt_pk_bf16_f32 v189, v26, v27
    v_cvt_pk_bf16_f32 v190, v28, v29
    v_cvt_pk_bf16_f32 v191, v30, v31
    v_exp_f32 v32, v32
    v_exp_f32 v33, v33
    v_exp_f32 v34, v34
    s_add_u32 m0, s53, 78848
    s_nop 0
    buffer_load_dwordx4 v77, s[48:51], s52 offen lds
    v_exp_f32 v35, v35
    v_exp_f32 v36, v36
    v_exp_f32 v37, v37
    s_waitcnt lgkmcnt(1)
    v_mfma_f32_32x32x16_bf16 v[144:159], a[16:19], v[176:179], v[144:159]
    v_exp_f32 v38, v38
    v_exp_f32 v39, v39
    v_cvt_pk_bf16_f32 v192, v32, v33
    v_cvt_pk_bf16_f32 v193, v34, v35
    v_exp_f32 v40, v40
    v_exp_f32 v41, v41
    ds_read_b128 a[24:27], v71 offset:8512
    v_exp_f32 v42, v42
    v_exp_f32 v43, v43
    v_cvt_pk_bf16_f32 v194, v36, v37
    s_add_u32 m0, s53, 79872
    s_nop 0
    buffer_load_dwordx4 v78, s[48:51], s52 offen lds
    v_cvt_pk_bf16_f32 v195, v38, v39
    v_exp_f32 v44, v44
    v_exp_f32 v45, v45
    v_mfma_f32_32x32x16_bf16 v[160:175], a[16:19], v[184:187], v[160:175]
    ds_read_b128 a[28:31], v71 offset:9120
    v_exp_f32 v46, v46
    v_exp_f32 v47, v47
    v_cvt_pk_bf16_f32 v196, v40, v41
    v_cvt_pk_bf16_f32 v197, v42, v43
    v_cvt_pk_bf16_f32 v198, v44, v45
    v_cvt_pk_bf16_f32 v199, v46, v47
    v_exp_f32 v48, v48
    v_exp_f32 v49, v49
    v_exp_f32 v50, v50
    s_add_u32 m0, s53, 80896
    s_nop 0
    buffer_load_dwordx4 v79, s[48:51], s52 offen lds
    v_exp_f32 v51, v51
    v_exp_f32 v52, v52
    v_exp_f32 v53, v53
    s_waitcnt lgkmcnt(2)
    v_mfma_f32_32x32x16_bf16 v[144:159], a[20:23], v[180:183], v[144:159]
    v_exp_f32 v54, v54
    v_exp_f32 v55, v55
    v_cvt_pk_bf16_f32 v200, v48, v49
    v_cvt_pk_bf16_f32 v201, v50, v51
    v_exp_f32 v56, v56
    v_exp_f32 v57, v57
    v_exp_f32 v58, v58
    v_exp_f32 v59, v59
    v_cvt_pk_bf16_f32 v202, v52, v53
    s_add_u32 m0, s53, 81920
    s_nop 0
    buffer_load_dwordx4 v80, s[48:51], s52 offen lds
    s_sub_u32 s52, s52, 442176
    v_cvt_pk_bf16_f32 v203, v54, v55
    v_exp_f32 v60, v60
    v_exp_f32 v61, v61
    v_mfma_f32_32x32x16_bf16 v[160:175], a[20:23], v[188:191], v[160:175]
    v_exp_f32 v62, v62
    v_exp_f32 v63, v63
    v_cvt_pk_bf16_f32 v204, v56, v57
    v_cvt_pk_bf16_f32 v205, v58, v59
    v_cvt_pk_bf16_f32 v206, v60, v61
    v_cvt_pk_bf16_f32 v207, v62, v63
    s_waitcnt lgkmcnt(1)
    v_mfma_f32_32x32x16_bf16 v[144:159], a[24:27], v[192:195], v[144:159]
    s_waitcnt lgkmcnt(0)
    v_mfma_f32_32x32x16_bf16 v[144:159], a[28:31], v[196:199], v[144:159]
    v_mfma_f32_32x32x16_bf16 v[160:175], a[24:27], v[200:203], v[160:175]
    v_mfma_f32_32x32x16_bf16 v[160:175], a[28:31], v[204:207], v[160:175]
    s_nop 9
    v_add_f32 v0, |v144|, |v145|
    v_add_f32 v0, v0, |v146|
    v_add_f32 v0, v0, |v147|
    v_add_f32 v0, v0, |v148|
    v_add_f32 v0, v0, |v149|
    v_add_f32 v0, v0, |v150|
    v_add_f32 v0, v0, |v151|
    v_add_f32 v0, v0, |v152|
    v_add_f32 v0, v0, |v153|
    v_add_f32 v0, v0, |v154|
    v_add_f32 v1, |v160|, |v161|
    v_add_f32 v1, v1, |v162|
    v_add_f32 v1, v1, |v163|
    v_add_f32 v1, v1, |v164|
    v_add_f32 v1, v1, |v165|
    v_add_f32 v1, v1, |v166|
    v_add_f32 v1, v1, |v167|
    v_add_f32 v1, v1, |v168|
    v_add_f32 v1, v1, |v169|
    v_add_f32 v1, v1, |v170|
    v_add_f32 v1, v1, v0
    s_mov_b32 s34, 0x7b800000
    v_cmp_nlt_f32 vcc, v1, s34
    s_cbranch_vccz L_att_out
    v_mov_b32 v216, 0xff7fffff
    v_mov_b32 v217, 0xff7fffff
    s_mov_b32 s78, 64
    s_mov_b32 s34, s43
L_fb1:
    s_add_u32 s35, s34, 65536
    buffer_load_dwordx4 a[0:3], v215, s[24:27], s34 offen sc1
    buffer_load_dwordx4 a[4:7], v64, s[24:27], s35 offen sc1
    s_waitcnt vmcnt(1)
    v_mfma_f32_32x32x16_bf16 v[0:15], a[0:3], v[128:131], 0
    s_waitcnt vmcnt(0)
    v_mfma_f32_32x32x16_bf16 v[0:15], a[4:7], v[132:135], v[0:15]
    v_mfma_f32_32x32x16_bf16 v[16:31], a[0:3], v[136:139], 0
    v_mfma_f32_32x32x16_bf16 v[16:31], a[4:7], v[140:143], v[16:31]
    s_nop 9
    v_max3_f32 v216, v216, v0, v1
    v_max3_f32 v216, v216, v2, v3
    v_max3_f32 v216, v216, v4, v5
    v_max3_f32 v216, v216, v6, v7
    v_max3_f32 v216, v216, v8, v9
    v_max3_f32 v216, v216, v10, v11
    v_max3_f32 v216, v216, v12, v13
    v_max3_f32 v216, v216, v14, v15
    v_max3_f32 v217, v217, v16, v17
    v_max3_f32 v217, v217, v18, v19
    v_max3_f32 v217, v217, v20, v21
    v_max3_f32 v217, v217, v22, v23
    v_max3_f32 v217, v217, v24, v25
    v_max3_f32 v217, v217, v26, v27
    v_max3_f32 v217, v217, v28, v29
    v_max3_f32 v217, v217, v30, v31
    s_add_u32 s34, s34, 512
    s_sub_u32 s78, s78, 1
    s_cmp_lg_u32 s78, 0
    s_cbranch_scc1 L_fb1
    v_mov_b32 v218, v216
    s_nop 1
    v_permlane32_swap_b32 v216, v218
    v_max_f32 v216, v216, v218
    v_sub_f32 v224, 0, v216
    v_mov_b32 v225, v224
    v_mov_b32 v226, v224
    v_mov_b32 v227, v224
    v_mov_b32 v228, v224
    v_mov_b32 v229, v224
    v_mov_b32 v230, v224
    v_mov_b32 v231, v224
    v_mov_b32 v232, v224
    v_mov_b32 v233, v224
    v_mov_b32 v234, v224
    v_mov_b32 v235, v224
    v_mov_b32 v236, v224
    v_mov_b32 v237, v224
    v_mov_b32 v238, v224
    v_mov_b32 v239, v224
    v_mov_b32 v219, v217
    s_nop 1
    v_permlane32_swap_b32 v217, v219
    v_max_f32 v217, v217, v219
    v_sub_f32 v240, 0, v217
    v_mov_b32 v241, v240
    v_mov_b32 v242, v240
    v_mov_b32 v243, v240
    v_mov_b32 v244, v240
    v_mov_b32 v245, v240
    v_mov_b32 v246, v240
    v_mov_b32 v247, v240
    v_mov_b32 v248, v240
    v_mov_b32 v249, v240
    v_mov_b32 v250, v240
    v_mov_b32 v251, v240
    v_mov_b32 v252, v240
    v_mov_b32 v253, v240
    v_mov_b32 v254, v240
    v_mov_b32 v255, v240
    v_mov_b32 v144, 0
    v_mov_b32 v145, 0
    v_mov_b32 v146, 0
    v_mov_b32 v147, 0
    v_mov_b32 v148, 0
    v_mov_b32 v149, 0
    v_mov_b32 v150, 0
    v_mov_b32 v151, 0
    v_mov_b32 v152, 0
    v_mov_b32 v153, 0
    v_mov_b32 v154, 0
    v_mov_b32 v155, 0
    v_mov_b32 v156, 0
    v_mov_b32 v157, 0
    v_mov_b32 v158, 0
    v_mov_b32 v159, 0
    v_mov_b32 v160, 0
    v_mov_b32 v161, 0
    v_mov_b32 v162, 0
    v_mov_b32 v163, 0
    v_mov_b32 v164, 0
    v_mov_b32 v165, 0
    v_mov_b32 v166, 0
    v_mov_b32 v167, 0
    v_mov_b32 v168, 0
    v_mov_b32 v169, 0
    v_mov_b32 v170, 0
    v_mov_b32 v171, 0
    v_mov_b32 v172, 0
    v_mov_b32 v173, 0
    v_mov_b32 v174, 0
    v_mov_b32 v175, 0
    s_mov_b32 s78, 64
    s_mov_b32 s34, s43
    s_mov_b32 s36, s44
L_fb2:
    s_add_u32 s35, s34, 65536
    buffer_load_dwordx4 a[0:3], v215, s[24:27], s34 offen sc1
    buffer_load_dwordx4 a[4:7], v64, s[24:27], s35 offen sc1
    buffer_load_dwordx4 a[16:19], v66, s[24:27], s36 offen sc1
    buffer_load_dwordx4 a[20:23], v66, s[24:27], s36 offen offset:608 sc1
    s_waitcnt vmcnt(3)
    v_mfma_f32_32x32x16_bf16 v[0:15], a[0:3], v[128:131], v[224:239]
    s_waitcnt vmcnt(2)
    v_mfma_f32_32x32x16_bf16 v[0:15], a[4:7], v[132:135], v[0:15]
    v_mfma_f32_32x32x16_bf16 v[16:31], a[0:3], v[136:139], v[240:255]
    v_mfma_f32_32x32x16_bf16 v[16:31], a[4:7], v[140:143], v[16:31]
    s_nop 9
    v_exp_f32 v0, v0
    v_exp_f32 v1, v1
    v_exp_f32 v2, v2
    v_exp_f32 v3, v3
    v_exp_f32 v4, v4
    v_exp_f32 v5, v5
    v_exp_f32 v6, v6
    v_exp_f32 v7, v7
    v_cvt_pk_bf16_f32 v176, v0, v1
    v_cvt_pk_bf16_f32 v177, v2, v3
    v_exp_f32 v8, v8
    v_exp_f32 v9, v9
    v_exp_f32 v10, v10
    v_exp_f32 v11, v11
    v_cvt_pk_bf16_f32 v178, v4, v5
    v_cvt_pk_bf16_f32 v179, v6, v7
    v_exp_f32 v12, v12
    v_exp_f32 v13, v13
    v_exp_f32 v14, v14
    v_exp_f32 v15, v15
    v_cvt_pk_bf16_f32 v180, v8, v9
    v_cvt_pk_bf16_f32 v181, v10, v11
    v_cvt_pk_bf16_f32 v182, v12, v13
    v_cvt_pk_bf16_f32 v183, v14, v15
    v_exp_f32 v16, v16
    v_exp_f32 v17, v17
    v_exp_f32 v18, v18
    v_exp_f32 v19, v19
    v_exp_f32 v20, v20
    v_exp_f32 v21, v21
    v_exp_f32 v22, v22
    v_exp_f32 v23, v23
    v_cvt_pk_bf16_f32 v184, v16, v17
    v_cvt_pk_bf16_f32 v185, v18, v19
    v_exp_f32 v24, v24
    v_exp_f32 v25, v25
    v_exp_f32 v26, v26
    v_exp_f32 v27, v27
    v_cvt_pk_bf16_f32 v186, v20, v21
    v_cvt_pk_bf16_f32 v187, v22, v23
    v_exp_f32 v28, v28
    v_exp_f32 v29, v29
    v_exp_f32 v30, v30
    v_exp_f32 v31, v31
    v_cvt_pk_bf16_f32 v188, v24, v25
    v_cvt_pk_bf16_f32 v189, v26, v27
    v_cvt_pk_bf16_f32 v190, v28, v29
    v_cvt_pk_bf16_f32 v191, v30, v31
    s_waitcnt vmcnt(1)
    v_mfma_f32_32x32x16_bf16 v[144:159], a[16:19], v[176:179], v[144:159]
    s_waitcnt vmcnt(0)
    v_mfma_f32_32x32x16_bf16 v[144:159], a[20:23], v[180:183], v[144:159]
    v_mfma_f32_32x32x16_bf16 v[160:175], a[16:19], v[184:187], v[160:175]
    v_mfma_f32_32x32x16_bf16 v[160:175], a[20:23], v[188:191], v[160:175]
    s_add_u32 s34, s34, 512
    s_add_u32 s36, s36, 1216
    s_sub_u32 s78, s78, 1
    s_cmp_lg_u32 s78, 0
    s_cbranch_scc1 L_fb2
L_att_out:
    s_lshl_b32 s34, s61, 4
    s_lshl_b32 s35, s28, 2
    s_add_u32 s34, s34, s35
    s_mul_i32 s34, s34, 18432
    s_add_u32 s34, s34, 28450816
    s_lshr_b32 s35, s60, 1
    s_lshl_b32 s35, s35, 10
    s_add_u32 s45, s34, s35
    s_and_b32 s35, s60, 1
    s_lshl_b32 s35, s35, 9
    s_add_u32 s45, s45, s35
    s_lshr_b32 s35, s60, 4
    s_add_u32 s35, s35, 16
    s_lshl_b32 s35, s35, 10
    s_add_u32 s46, s34, s35
    s_bfe_u32 s35, s60, 0x20002
    s_lshl_b32 s35, s35, 8
    s_add_u32 s46, s46, s35
    s_and_b32 s35, s60, 3
    s_lshl_b32 s35, s35, 2
    s_add_u32 s46, s46, s35
    v_bfe_u32 v2, v208, 4, 1
    v_mul_u32_u24 v2, 18432, v2
    v_and_b32 v3, 15, v208
    v_lshlrev_b32 v3, 4, v3
    v_add_u32 v2, v2, v3
    v_lshrrev_b32 v3, 5, v208
    v_lshlrev_b32 v3, 8, v3
    v_add_u32 v3, v2, v3
    v_mov_b32 v4, 0x80000000
    v_cndmask_b32 v2, v4, v2, s[80:81]
    v_mov_b32 v4, v154
    v_mov_b32 v6, v154
    s_nop 1
    v_permlane32_swap_b32 v4, v6
    v_rcp_f32 v4, v4
    s_nop 0
    v_mul_f32 v144, v144, v4
    v_mul_f32 v145, v145, v4
    v_mul_f32 v146, v146, v4
    v_mul_f32 v147, v147, v4
    v_mul_f32 v148, v148, v4
    v_mul_f32 v149, v149, v4
    v_mul_f32 v150, v150, v4
    v_mul_f32 v151, v151, v4
    v_mul_f32 v152, v152, v4
    v_mul_f32 v153, v153, v4
    v_cvt_pk_bf16_f32 v8, v144, v145
    v_cvt_pk_bf16_f32 v9, v146, v147
    v_cvt_pk_bf16_f32 v10, v148, v149
    v_cvt_pk_bf16_f32 v11, v150, v151
    v_cvt_pk_bf16_f32 v12, v152, v153
    buffer_store_dwordx4 v[8:11], v3, s[24:27], s45 offen sc1
    buffer_store_dword v12, v2, s[24:27], s46 offen sc1
    s_add_u32 s45, s45, 36864
    s_add_u32 s46, s46, 36864
    v_mov_b32 v5, v170
    v_mov_b32 v6, v170
    s_nop 1
    v_permlane32_swap_b32 v5, v6
    v_rcp_f32 v5, v5
    s_nop 0
    v_mul_f32 v160, v160, v5
    v_mul_f32 v161, v161, v5
    v_mul_f32 v162, v162, v5
    v_mul_f32 v163, v163, v5
    v_mul_f32 v164, v164, v5
    v_mul_f32 v165, v165, v5
    v_mul_f32 v166, v166, v5
    v_mul_f32 v167, v167, v5
    v_mul_f32 v168, v168, v5
    v_mul_f32 v169, v169, v5
    v_cvt_pk_bf16_f32 v16, v160, v161
    v_cvt_pk_bf16_f32 v17, v162, v163
    v_cvt_pk_bf16_f32 v18, v164, v165
    v_cvt_pk_bf16_f32 v19, v166, v167
    v_cvt_pk_bf16_f32 v20, v168, v169
    buffer_store_dwordx4 v[16:19], v3, s[24:27], s45 offen sc1
    buffer_store_dword v20, v2, s[24:27], s46 offen sc1
    s_waitcnt vmcnt(45)
    s_barrier
    ds_read_b64_tr_b16 a[176:177], v82 offset:0
    ds_read_b64_tr_b16 a[178:179], v82 offset:1536
    ds_read_b64_tr_b16 a[180:181], v82 offset:64
    ds_read_b64_tr_b16 a[182:183], v82 offset:1600
    ds_read_b64_tr_b16 a[184:185], v82 offset:128
    ds_read_b64_tr_b16 a[186:187], v82 offset:1664
    ds_read_b64_tr_b16 a[188:189], v82 offset:3072
    ds_read_b64_tr_b16 a[190:191], v82 offset:4608
    ds_read_b64_tr_b16 a[192:193], v82 offset:3136
    ds_read_b64_tr_b16 a[194:195], v82 offset:4672
    ds_read_b64_tr_b16 a[196:197], v82 offset:3200
    ds_read_b64_tr_b16 a[198:199], v82 offset:4736
    s_waitcnt lgkmcnt(10)
    v_mfma_f32_32x32x16_bf16 v[0:15], a[176:179], a[32:35], 0
    s_waitcnt vmcnt(15)
    s_barrier
    ds_read_b64_tr_b16 a[200:201], v82 offset:6144
    ds_read_b64_tr_b16 a[202:203], v82 offset:7680
    s_waitcnt lgkmcnt(10)
    v_mfma_f32_32x32x16_bf16 v[16:31], a[180:183], a[32:35], 0
    ds_read_b64_tr_b16 a[204:205], v82 offset:6208
    ds_read_b64_tr_b16 a[206:207], v82 offset:7744
    s_add_u32 m0, s53, 36864
    s_waitcnt lgkmcnt(10)
    v_mfma_f32_32x32x16_bf16 v[32:47], a[184:187], a[32:35], 0
    ds_read_b64_tr_b16 a[176:177], v82 offset:6272
    ds_read_b64_tr_b16 a[178:179], v82 offset:7808
    buffer_load_dwordx4 v72, s[48:51], s52 offen lds
    s_waitcnt lgkmcnt(10)
    v_mfma_f32_32x32x16_bf16 v[0:15], a[188:191], a[36:39], v[0:15]
    ds_read_b64_tr_b16 a[180:181], v82 offset:9216
    ds_read_b64_tr_b16 a[182:183], v82 offset:10752
    s_waitcnt lgkmcnt(10)
    v_mfma_f32_32x32x16_bf16 v[16:31], a[192:195], a[36:39], v[16:31]
    ds_read_b64_tr_b16 a[184:185], v82 offset:9280
    ds_read_b64_tr_b16 a[186:187], v82 offset:10816
    s_add_u32 m0, s53, 37888
    s_waitcnt lgkmcnt(10)
    v_mfma_f32_32x32x16_bf16 v[32:47], a[196:199], a[36:39], v[32:47]
    ds_read_b64_tr_b16 a[188:189], v82 offset:9344
    ds_read_b64_tr_b16 a[190:191], v82 offset:10880
    buffer_load_dwordx4 v73, s[48:51], s52 offen lds
    s_waitcnt lgkmcnt(10)
    v_mfma_f32_32x32x16_bf16 v[0:15], a[200:203], a[40:43], v[0:15]
    ds_read_b64_tr_b16 a[192:193], v82 offset:12288
    ds_read_b64_tr_b16 a[194:195], v82 offset:13824
    s_waitcnt lgkmcnt(10)
    v_mfma_f32_32x32x16_bf16 v[16:31], a[204:207], a[40:43], v[16:31]
    ds_read_b64_tr_b16 a[196:197], v82 offset:12352
    ds_read_b64_tr_b16 a[198:199], v82 offset:13888
    s_waitcnt lgkmcnt(10)
    v_mfma_f32_32x32x16_bf16 v[32:47], a[176:179], a[40:43], v[32:47]
    ds_read_b64_tr_b16 a[200:201], v82 offset:12416
    ds_read_b64_tr_b16 a[202:203], v82 offset:13952
    s_add_u32 m0, s53, 38912
    s_waitcnt lgkmcnt(10)
    v_mfma_f32_32x32x16_bf16 v[0:15], a[180:183], a[44:47], v[0:15]
    ds_read_b64_tr_b16 a[204:205], v82 offset:15360
    ds_read_b64_tr_b16 a[206:207], v82 offset:16896
    buffer_load_dwordx4 v74, s[48:51], s52 offen lds
    s_waitcnt lgkmcnt(10)
    v_mfma_f32_32x32x16_bf16 v[16:31], a[184:187], a[44:47], v[16:31]
    ds_read_b64_tr_b16 a[176:177], v82 offset:15424
    ds_read_b64_tr_b16 a[178:179], v82 offset:16960
    s_waitcnt lgkmcnt(10)
    v_mfma_f32_32x32x16_bf16 v[32:47], a[188:191], a[44:47], v[32:47]
    ds_read_b64_tr_b16 a[180:181], v82 offset:15488
    ds_read_b64_tr_b16 a[182:183], v82 offset:17024
    s_waitcnt lgkmcnt(10)
    v_mfma_f32_32x32x16_bf16 v[0:15], a[192:195], a[48:51], v[0:15]
    ds_read_b64_tr_b16 a[184:185], v82 offset:18432
    ds_read_b64_tr_b16 a[186:187], v82 offset:19968
    s_add_u32 m0, s53, 39936
    s_waitcnt lgkmcnt(10)
    v_mfma_f32_32x32x16_bf16 v[16:31], a[196:199], a[48:51], v[16:31]
    ds_read_b64_tr_b16 a[188:189], v82 offset:18496
    ds_read_b64_tr_b16 a[190:191], v82 offset:20032
    buffer_load_dwordx4 v75, s[48:51], s52 offen lds
    s_waitcnt lgkmcnt(10)
    v_mfma_f32_32x32x16_bf16 v[32:47], a[200:203], a[48:51], v[32:47]
    ds_read_b64_tr_b16 a[192:193], v82 offset:18560
    ds_read_b64_tr_b16 a[194:195], v82 offset:20096
    s_waitcnt lgkmcnt(10)
    v_mfma_f32_32x32x16_bf16 v[0:15], a[204:207], a[52:55], v[0:15]
    ds_read_b64_tr_b16 a[196:197], v82 offset:21504
    ds_read_b64_tr_b16 a[198:199], v82 offset:23040
    s_add_u32 m0, s53, 40960
    s_waitcnt lgkmcnt(10)
    v_mfma_f32_32x32x16_bf16 v[16:31], a[176:179], a[52:55], v[16:31]
    ds_read_b64_tr_b16 a[200:201], v82 offset:21568
    ds_read_b64_tr_b16 a[202:203], v82 offset:23104
    buffer_load_dwordx4 v76, s[48:51], s52 offen lds
    s_waitcnt lgkmcnt(10)
    v_mfma_f32_32x32x16_bf16 v[32:47], a[180:183], a[52:55], v[32:47]
    ds_read_b64_tr_b16 a[204:205], v82 offset:21632
    ds_read_b64_tr_b16 a[206:207], v82 offset:23168
    s_waitcnt lgkmcnt(10)
    v_mfma_f32_32x32x16_bf16 v[0:15], a[184:187], a[56:59], v[0:15]
    ds_read_b64_tr_b16 a[176:177], v82 offset:24576
    ds_read_b64_tr_b16 a[178:179], v82 offset:26112
    s_waitcnt lgkmcnt(10)
    v_mfma_f32_32x32x16_bf16 v[16:31], a[188:191], a[56:59], v[16:31]
    ds_read_b64_tr_b16 a[180:181], v82 offset:24640
    ds_read_b64_tr_b16 a[182:183], v82 offset:26176
    s_add_u32 m0, s53, 41984
    s_waitcnt lgkmcnt(10)
    v_mfma_f32_32x32x16_bf16 v[32:47], a[192:195], a[56:59], v[32:47]
    ds_read_b64_tr_b16 a[184:185], v82 offset:24704
    ds_read_b64_tr_b16 a[186:187], v82 offset:26240
    buffer_load_dwordx4 v77, s[48:51], s52 offen lds
    s_waitcnt lgkmcnt(10)
    v_mfma_f32_32x32x16_bf16 v[0:15], a[196:199], a[60:63], v[0:15]
    ds_read_b64_tr_b16 a[188:189], v82 offset:27648
    ds_read_b64_tr_b16 a[190:191], v82 offset:29184
    s_waitcnt lgkmcnt(10)
    v_mfma_f32_32x32x16_bf16 v[16:31], a[200:203], a[60:63], v[16:31]
    ds_read_b64_tr_b16 a[192:193], v82 offset:27712
    ds_read_b64_tr_b16 a[194:195], v82 offset:29248
    s_waitcnt lgkmcnt(10)
    v_mfma_f32_32x32x16_bf16 v[32:47], a[204:207], a[60:63], v[32:47]
    ds_read_b64_tr_b16 a[196:197], v82 offset:27776
    ds_read_b64_tr_b16 a[198:199], v82 offset:29312
    s_add_u32 m0, s53, 43008
    s_waitcnt lgkmcnt(10)
    v_mfma_f32_32x32x16_bf16 v[0:15], a[176:179], a[64:67], v[0:15]
    ds_read_b64_tr_b16 a[200:201], v82 offset:30720
    ds_read_b64_tr_b16 a[202:203], v82 offset:32256
    buffer_load_dwordx4 v78, s[48:51], s52 offen lds
    s_waitcnt lgkmcnt(10)
    v_mfma_f32_32x32x16_bf16 v[16:31], a[180:183], a[64:67], v[16:31]
    ds_read_b64_tr_b16 a[204:205], v82 offset:30784
    ds_read_b64_tr_b16 a[206:207], v82 offset:32320
    s_waitcnt lgkmcnt(10)
    v_mfma_f32_32x32x16_bf16 v[32:47], a[184:187], a[64:67], v[32:47]
    ds_read_b64_tr_b16 a[176:177], v82 offset:30848
    ds_read_b64_tr_b16 a[178:179], v82 offset:32384
    s_add_u32 m0, s53, 44032
    s_waitcnt lgkmcnt(10)
    v_mfma_f32_32x32x16_bf16 v[0:15], a[188:191], a[68:71], v[0:15]
    ds_read_b64_tr_b16 a[180:181], v82 offset:33792
    ds_read_b64_tr_b16 a[182:183], v82 offset:35328
    buffer_load_dwordx4 v79, s[48:51], s52 offen lds
    s_waitcnt lgkmcnt(10)
    v_mfma_f32_32x32x16_bf16 v[16:31], a[192:195], a[68:71], v[16:31]
    ds_read_b64_tr_b16 a[184:185], v82 offset:33856
    ds_read_b64_tr_b16 a[186:187], v82 offset:35392
    s_waitcnt lgkmcnt(10)
    v_mfma_f32_32x32x16_bf16 v[32:47], a[196:199], a[68:71], v[32:47]
    ds_read_b64_tr_b16 a[188:189], v82 offset:33920
    ds_read_b64_tr_b16 a[190:191], v82 offset:35456
    s_waitcnt lgkmcnt(10)
    v_mfma_f32_32x32x16_bf16 v[0:15], a[200:203], a[72:75], v[0:15]
    ds_read_b64_tr_b16 a[192:193], v83 offset:0
    ds_read_b64_tr_b16 a[194:195], v83 offset:1536
    s_add_u32 m0, s53, 45056
    s_waitcnt lgkmcnt(10)
    v_mfma_f32_32x32x16_bf16 v[16:31], a[204:207], a[72:75], v[16:31]
    ds_read_b64_tr_b16 a[196:197], v83 offset:64
    ds_read_b64_tr_b16 a[198:199], v83 offset:1600
    buffer_load_dwordx4 v80, s[48:51], s52 offen lds
    s_add_u32 s52, s52, 221184
    s_waitcnt lgkmcnt(10)
    v_mfma_f32_32x32x16_bf16 v[32:47], a[176:179], a[72:75], v[32:47]
    ds_read_b64_tr_b16 a[200:201], v83 offset:128
    ds_read_b64_tr_b16 a[202:203], v83 offset:1664
    s_waitcnt lgkmcnt(10)
    v_mfma_f32_32x32x16_bf16 v[0:15], a[180:183], a[76:79], v[0:15]
    ds_read_b64_tr_b16 a[204:205], v83 offset:3072
    ds_read_b64_tr_b16 a[206:207], v83 offset:4608
    s_waitcnt lgkmcnt(10)
    v_mfma_f32_32x32x16_bf16 v[16:31], a[184:187], a[76:79], v[16:31]
    ds_read_b64_tr_b16 a[176:177], v83 offset:3136
    ds_read_b64_tr_b16 a[178:179], v83 offset:4672
    s_waitcnt lgkmcnt(10)
    v_mfma_f32_32x32x16_bf16 v[32:47], a[188:191], a[76:79], v[32:47]
    ds_read_b64_tr_b16 a[180:181], v83 offset:3200
    ds_read_b64_tr_b16 a[182:183], v83 offset:4736
    s_waitcnt lgkmcnt(10)
    v_mfma_f32_32x32x16_bf16 v[0:15], a[192:195], a[80:83], v[0:15]
    s_waitcnt vmcnt(9)
    s_barrier
    v_mov_b32 v88, s32
    v_mov_b32 v89, s33
    s_lshl_b32 s34, s2, 7
    s_add_u32 s34, s34, 50077696
    buffer_store_dwordx2 v[88:89], v209, s[24:27], s34 offen sc1
    ds_read_b64_tr_b16 a[184:185], v83 offset:6144
    ds_read_b64_tr_b16 a[186:187], v83 offset:7680
    s_waitcnt lgkmcnt(10)
    v_mfma_f32_32x32x16_bf16 v[16:31], a[196:199], a[80:83], v[16:31]
    ds_read_b64_tr_b16 a[188:189], v83 offset:6208
    ds_read_b64_tr_b16 a[190:191], v83 offset:7744
    s_add_u32 m0, s53, 0
    s_waitcnt lgkmcnt(10)
    v_mfma_f32_32x32x16_bf16 v[32:47], a[200:203], a[80:83], v[32:47]
    ds_read_b64_tr_b16 a[192:193], v83 offset:6272
    ds_read_b64_tr_b16 a[194:195], v83 offset:7808
    buffer_load_dwordx4 v72, s[48:51], s52 offen lds
    v_and_b32 v91, 31, v208
    v_lshlrev_b32 v123, 7, v91
    s_waitcnt lgkmcnt(10)
    v_mfma_f32_32x32x16_bf16 v[0:15], a[204:207], a[84:87], v[0:15]
    ds_read_b64_tr_b16 a[196:197], v83 offset:9216
    ds_read_b64_tr_b16 a[198:199], v83 offset:10752
    s_mov_b32 s60, s8
    s_mov_b32 s61, s9
    s_waitcnt lgkmcnt(10)
    v_mfma_f32_32x32x16_bf16 v[16:31], a[176:179], a[84:87], v[16:31]
    ds_read_b64_tr_b16 a[200:201], v83 offset:9280
    ds_read_b64_tr_b16 a[202:203], v83 offset:10816
    s_add_u32 m0, s53, 1024
    s_mov_b32 s62, 663552
    s_mov_b32 s63, 0x00020000
    s_waitcnt lgkmcnt(10)
    v_mfma_f32_32x32x16_bf16 v[32:47], a[180:183], a[84:87], v[32:47]
    ds_read_b64_tr_b16 a[204:205], v83 offset:9344
    ds_read_b64_tr_b16 a[206:207], v83 offset:10880
    buffer_load_dwordx4 v73, s[48:51], s52 offen lds
    s_mov_b32 s64, s4
    s_mov_b32 s65, s5
    s_waitcnt lgkmcnt(10)
    v_mfma_f32_32x32x16_bf16 v[0:15], a[184:187], a[88:91], v[0:15]
    ds_read_b64_tr_b16 a[176:177], v83 offset:12288
    ds_read_b64_tr_b16 a[178:179], v83 offset:13824
    s_mov_b32 s66, 2359296
    s_mov_b32 s67, 0x00020000
    s_waitcnt lgkmcnt(10)
    v_mfma_f32_32x32x16_bf16 v[16:31], a[188:191], a[88:91], v[16:31]
    ds_read_b64_tr_b16 a[180:181], v83 offset:12352
    ds_read_b64_tr_b16 a[182:183], v83 offset:13888
    s_mov_b32 s68, s18
    s_mov_b32 s69, s19
    s_waitcnt lgkmcnt(10)
    v_mfma_f32_32x32x16_bf16 v[32:47], a[192:195], a[88:91], v[32:47]
    ds_read_b64_tr_b16 a[184:185], v83 offset:12416
    ds_read_b64_tr_b16 a[186:187], v83 offset:13952
    s_add_u32 m0, s53, 2048
    s_mov_b32 s70, 2359296
    s_waitcnt lgkmcnt(10)
    v_mfma_f32_32x32x16_bf16 v[0:15], a[196:199], a[92:95], v[0:15]
    ds_read_b64_tr_b16 a[188:189], v83 offset:15360
    ds_read_b64_tr_b16 a[190:191], v83 offset:16896
    buffer_load_dwordx4 v74, s[48:51], s52 offen lds
    s_mov_b32 s71, 0x00020000
    s_mov_b32 s34, s31
    s_waitcnt lgkmcnt(10)
    v_mfma_f32_32x32x16_bf16 v[16:31], a[200:203], a[92:95], v[16:31]
    ds_read_b64_tr_b16 a[192:193], v83 offset:15424
    ds_read_b64_tr_b16 a[194:195], v83 offset:16960
    s_and_b32 s45, s34, 1
    s_add_u32 s35, s34, 6
    s_waitcnt lgkmcnt(10)
    v_mfma_f32_32x32x16_bf16 v[32:47], a[204:207], a[92:95], v[32:47]
    ds_read_b64_tr_b16 a[196:197], v83 offset:15488
    ds_read_b64_tr_b16 a[198:199], v83 offset:17024
    s_cmp_eq_u32 s34, 3
    s_cselect_b32 s35, 5, s35
    s_lshl_b32 s46, s34, 6
    s_waitcnt lgkmcnt(10)
    v_mfma_f32_32x32x16_bf16 v[0:15], a[176:179], a[96:99], v[0:15]
    ds_read_b64_tr_b16 a[200:201], v83 offset:18432
    ds_read_b64_tr_b16 a[202:203], v83 offset:19968
    s_add_u32 m0, s53, 3072
    s_lshl_b32 s47, s35, 6
    s_lshl_b32 s59, s45, 5
    s_waitcnt lgkmcnt(10)
    v_mfma_f32_32x32x16_bf16 v[16:31], a[180:183], a[96:99], v[16:31]
    ds_read_b64_tr_b16 a[204:205], v83 offset:18496
    ds_read_b64_tr_b16 a[206:207], v83 offset:20032
    buffer_load_dwordx4 v75, s[48:51], s52 offen lds
    s_add_u32 s59, s59, 256
    s_lshl_b32 s75, s34, 10
    s_waitcnt lgkmcnt(10)
    v_mfma_f32_32x32x16_bf16 v[32:47], a[184:187], a[96:99], v[32:47]
    ds_read_b64_tr_b16 a[176:177], v83 offset:18560
    ds_read_b64_tr_b16 a[178:179], v83 offset:20096
    s_lshl_b32 s80, s35, 10
    s_waitcnt lgkmcnt(10)
    v_mfma_f32_32x32x16_bf16 v[0:15], a[188:191], a[100:103], v[0:15]
    ds_read_b64_tr_b16 a[180:181], v83 offset:21504
    ds_read_b64_tr_b16 a[182:183], v83 offset:23040
    s_add_u32 m0, s53, 4096
    s_and_b32 s36, s30, 1
    s_mul_i32 s72, s36, 576
    s_waitcnt lgkmcnt(10)
    v_mfma_f32_32x32x16_bf16 v[16:31], a[192:195], a[100:103], v[16:31]
    ds_read_b64_tr_b16 a[184:185], v83 offset:21568
    ds_read_b64_tr_b16 a[186:187], v83 offset:23104
    buffer_load_dwordx4 v76, s[48:51], s52 offen lds
    s_mul_i32 s36, s36, 9216
    s_lshl_b32 s34, s29, 2
    s_waitcnt lgkmcnt(10)
    v_mfma_f32_32x32x16_bf16 v[32:47], a[196:199], a[100:103], v[32:47]
    ds_read_b64_tr_b16 a[188:189], v83 offset:21632
    ds_read_b64_tr_b16 a[190:191], v83 offset:23168
    s_lshr_b32 s35, s30, 1
    s_add_u32 s34, s34, s35
    s_waitcnt lgkmcnt(10)
    v_mfma_f32_32x32x16_bf16 v[0:15], a[200:203], a[104:107], v[0:15]
    ds_read_b64_tr_b16 a[192:193], v83 offset:24576
    ds_read_b64_tr_b16 a[194:195], v83 offset:26112
    s_lshl_b32 s34, s34, 2
    s_add_u32 s34, s34, s28
    s_waitcnt lgkmcnt(10)
    v_mfma_f32_32x32x16_bf16 v[16:31], a[204:207], a[104:107], v[16:31]
    ds_read_b64_tr_b16 a[196:197], v83 offset:24640
    ds_read_b64_tr_b16 a[198:199], v83 offset:26176
    s_add_u32 m0, s53, 5120
    s_mul_i32 s35, s34, 18432
    s_add_u32 s73, s35, 28450816
    s_waitcnt lgkmcnt(10)
    v_mfma_f32_32x32x16_bf16 v[32:47], a[176:179], a[104:107], v[32:47]
    ds_read_b64_tr_b16 a[200:201], v83 offset:24704
    ds_read_b64_tr_b16 a[202:203], v83 offset:26240
    buffer_load_dwordx4 v77, s[48:51], s52 offen lds
    s_add_u32 s36, s36, s35
    s_waitcnt lgkmcnt(10)
    v_mfma_f32_32x32x16_bf16 v[0:15], a[180:183], a[108:111], v[0:15]
    ds_read_b64_tr_b16 a[204:205], v83 offset:27648
    ds_read_b64_tr_b16 a[206:207], v83 offset:29184
    s_add_u32 s36, s36, 30810112
    s_add_u32 s75, s75, s36
    s_waitcnt lgkmcnt(10)
    v_mfma_f32_32x32x16_bf16 v[16:31], a[184:187], a[108:111], v[16:31]
    ds_read_b64_tr_b16 a[176:177], v83 offset:27712
    ds_read_b64_tr_b16 a[178:179], v83 offset:29248
    s_add_u32 s80, s80, s36
    s_add_u32 s81, s36, 4096
    s_waitcnt lgkmcnt(10)
    v_mfma_f32_32x32x16_bf16 v[32:47], a[188:191], a[108:111], v[32:47]
    ds_read_b64_tr_b16 a[180:181], v83 offset:27776
    ds_read_b64_tr_b16 a[182:183], v83 offset:29312
    s_add_u32 m0, s53, 6144
    s_mul_i32 s74, s34, 18432
    s_add_u32 s74, s74, s72
    s_waitcnt lgkmcnt(10)
    v_mfma_f32_32x32x16_bf16 v[0:15], a[192:195], a[112:115], v[0:15]
    ds_read_b64_tr_b16 a[184:185], v83 offset:30720
    ds_read_b64_tr_b16 a[186:187], v83 offset:32256
    buffer_load_dwordx4 v78, s[48:51], s52 offen lds
    s_add_u32 s34, s28, 12
    s_mul_i32 s76, s34, 41472
    s_waitcnt lgkmcnt(10)
    v_mfma_f32_32x32x16_bf16 v[16:31], a[196:199], a[112:115], v[16:31]
    ds_read_b64_tr_b16 a[188:189], v83 offset:30784
    ds_read_b64_tr_b16 a[190:191], v83 offset:32320
    s_add_u32 s76, s76, s72
    s_mul_i32 s77, s34, 5120
    s_waitcnt lgkmcnt(10)
    v_mfma_f32_32x32x16_bf16 v[32:47], a[200:203], a[112:115], v[32:47]
    ds_read_b64_tr_b16 a[192:193], v83 offset:30848
    ds_read_b64_tr_b16 a[194:195], v83 offset:32384
    s_add_u32 m0, s53, 7168
    s_add_u32 s77, s77, 55296
    s_waitcnt lgkmcnt(10)
    v_mfma_f32_32x32x16_bf16 v[0:15], a[204:207], a[116:119], v[0:15]
    ds_read_b64_tr_b16 a[196:197], v83 offset:33792
    ds_read_b64_tr_b16 a[198:199], v83 offset:35328
    buffer_load_dwordx4 v79, s[48:51], s52 offen lds
    s_and_b32 s34, s28, 1
    s_mul_i32 s78, s34, 331776
    s_waitcnt lgkmcnt(10)
    v_mfma_f32_32x32x16_bf16 v[16:31], a[176:179], a[116:119], v[16:31]
    ds_read_b64_tr_b16 a[200:201], v83 offset:33856
    ds_read_b64_tr_b16 a[202:203], v83 offset:35392
    s_add_u32 s78, s78, s72
    s_add_u32 s34, s34, 16
    s_waitcnt lgkmcnt(10)
    v_mfma_f32_32x32x16_bf16 v[32:47], a[180:183], a[116:119], v[32:47]
    ds_read_b64_tr_b16 a[204:205], v83 offset:33920
    ds_read_b64_tr_b16 a[206:207], v83 offset:35456
    s_mul_i32 s79, s34, 5120
    s_add_u32 s79, s79, 55296
    s_waitcnt lgkmcnt(10)
    v_mfma_f32_32x32x16_bf16 v[0:15], a[184:187], a[120:123], v[0:15]
    ds_read_b64_tr_b16 a[176:177], v84 offset:0
    ds_read_b64_tr_b16 a[178:179], v84 offset:1536
    s_add_u32 m0, s53, 8192
    s_lshl_b32 s34, s29, 12
    s_add_u32 s43, s34, 50077696
    s_waitcnt lgkmcnt(10)
    v_mfma_f32_32x32x16_bf16 v[16:31], a[188:191], a[120:123], v[16:31]
    ds_read_b64_tr_b16 a[180:181], v84 offset:64
    ds_read_b64_tr_b16 a[182:183], v84 offset:1600
    buffer_load_dwordx4 v80, s[48:51], s52 offen lds
    s_add_u32 s52, s52, 221184
    s_lshr_b32 s34, s2, 3
    s_lshl_b32 s34, s34, 10
    s_waitcnt lgkmcnt(10)
    v_mfma_f32_32x32x16_bf16 v[32:47], a[192:195], a[120:123], v[32:47]
    ds_read_b64_tr_b16 a[184:185], v84 offset:128
    ds_read_b64_tr_b16 a[186:187], v84 offset:1664
    s_add_u32 s44, s34, 50208768
    s_waitcnt lgkmcnt(10)
    v_mfma_f32_32x32x16_bf16 v[0:15], a[196:199], a[124:127], v[0:15]
    ds_read_b64_tr_b16 a[188:189], v84 offset:3072
    ds_read_b64_tr_b16 a[190:191], v84 offset:4608
    s_waitcnt lgkmcnt(10)
    v_mfma_f32_32x32x16_bf16 v[16:31], a[200:203], a[124:127], v[16:31]
    ds_read_b64_tr_b16 a[192:193], v84 offset:3136
    ds_read_b64_tr_b16 a[194:195], v84 offset:4672
    s_waitcnt lgkmcnt(10)
    v_mfma_f32_32x32x16_bf16 v[32:47], a[204:207], a[124:127], v[32:47]
    ds_read_b64_tr_b16 a[196:197], v84 offset:3200
    ds_read_b64_tr_b16 a[198:199], v84 offset:4736
    s_waitcnt lgkmcnt(10)
    v_mfma_f32_32x32x16_bf16 v[0:15], a[176:179], a[128:131], v[0:15]
    s_waitcnt vmcnt(10)
    s_barrier
    ds_read_b64_tr_b16 a[200:201], v84 offset:6144
    ds_read_b64_tr_b16 a[202:203], v84 offset:7680
    s_waitcnt lgkmcnt(10)
    v_mfma_f32_32x32x16_bf16 v[16:31], a[180:183], a[128:131], v[16:31]
    ds_read_b64_tr_b16 a[204:205], v84 offset:6208
    ds_read_b64_tr_b16 a[206:207], v84 offset:7744
    s_add_u32 m0, s53, 110592
    v_add_u32 v90, 0, v208
    v_mul_u32_u24 v91, 6554, v90
    v_lshrrev_b32 v91, 16, v91
    s_waitcnt lgkmcnt(10)
    v_mfma_f32_32x32x16_bf16 v[32:47], a[184:187], a[128:131], v[32:47]
    ds_read_b64_tr_b16 a[176:177], v84 offset:6272
    ds_read_b64_tr_b16 a[178:179], v84 offset:7808
    buffer_load_dwordx4 v72, s[48:51], s52 offen lds
    v_mul_u32_u24 v92, 10, v91
    v_sub_u32 v92, v90, v92
    s_waitcnt lgkmcnt(10)
    v_mfma_f32_32x32x16_bf16 v[0:15], a[188:191], a[132:135], v[0:15]
    ds_read_b64_tr_b16 a[180:181], v84 offset:9216
    ds_read_b64_tr_b16 a[182:183], v84 offset:10752
    v_bfe_u32 v93, v91, 3, 1
    v_mul_u32_u24 v93, 18, v93
    v_lshrrev_b32 v94, 4, v91
    s_waitcnt lgkmcnt(10)
    v_mfma_f32_32x32x16_bf16 v[16:31], a[192:195], a[132:135], v[16:31]
    ds_read_b64_tr_b16 a[184:185], v84 offset:9280
    ds_read_b64_tr_b16 a[186:187], v84 offset:10816
    s_add_u32 m0, s53, 111616
    v_lshl_add_u32 v93, v94, 3, v93
    v_bfe_u32 v94, v91, 2, 1
    s_waitcnt lgkmcnt(10)
    v_mfma_f32_32x32x16_bf16 v[32:47], a[196:199], a[132:135], v[32:47]
    ds_read_b64_tr_b16 a[188:189], v84 offset:9344
    ds_read_b64_tr_b16 a[190:191], v84 offset:10880
    buffer_load_dwordx4 v73, s[48:51], s52 offen lds
    v_lshl_add_u32 v93, v94, 2, v93
    v_and_b32 v94, 3, v91
    v_add_u32 v93, v93, v94
    s_waitcnt lgkmcnt(10)
    v_mfma_f32_32x32x16_bf16 v[0:15], a[200:203], a[136:139], v[0:15]
    ds_read_b64_tr_b16 a[192:193], v84 offset:12288
    ds_read_b64_tr_b16 a[194:195], v84 offset:13824
    v_mul_u32_u24 v93, 1152, v93
    v_mov_b32 v94, s46
    v_mov_b32 v91, s47
    v_cmp_lt_u32 vcc, 3, v92
    s_nop 1
    v_cndmask_b32 v94, v94, v91, vcc
    s_waitcnt lgkmcnt(10)
    v_mfma_f32_32x32x16_bf16 v[16:31], a[204:207], a[136:139], v[16:31]
    ds_read_b64_tr_b16 a[196:197], v84 offset:12352
    ds_read_b64_tr_b16 a[198:199], v84 offset:13888
    v_mov_b32 v91, s59
    v_cmp_lt_u32 vcc, 7, v92
    s_nop 1
    v_cndmask_b32 v94, v94, v91, vcc
    v_and_b32 v92, 3, v92
    v_add_u32 v93, v93, v94
    s_waitcnt lgkmcnt(10)
    v_mfma_f32_32x32x16_bf16 v[32:47], a[176:179], a[136:139], v[32:47]
    ds_read_b64_tr_b16 a[200:201], v84 offset:12416
    ds_read_b64_tr_b16 a[202:203], v84 offset:13952
    s_add_u32 m0, s53, 112640
    v_lshl_add_u32 v112, v92, 4, v93
    v_add_u32 v90, 64, v208
    s_waitcnt lgkmcnt(10)
    v_mfma_f32_32x32x16_bf16 v[0:15], a[180:183], a[140:143], v[0:15]
    ds_read_b64_tr_b16 a[204:205], v84 offset:15360
    ds_read_b64_tr_b16 a[206:207], v84 offset:16896
    buffer_load_dwordx4 v74, s[48:51], s52 offen lds
    v_mul_u32_u24 v91, 6554, v90
    v_lshrrev_b32 v91, 16, v91
    v_mul_u32_u24 v92, 10, v91
    s_waitcnt lgkmcnt(10)
    v_mfma_f32_32x32x16_bf16 v[16:31], a[184:187], a[140:143], v[16:31]
    ds_read_b64_tr_b16 a[176:177], v84 offset:15424
    ds_read_b64_tr_b16 a[178:179], v84 offset:16960
    v_sub_u32 v92, v90, v92
    v_bfe_u32 v93, v91, 3, 1
    s_waitcnt lgkmcnt(10)
    v_mfma_f32_32x32x16_bf16 v[32:47], a[188:191], a[140:143], v[32:47]
    ds_read_b64_tr_b16 a[180:181], v84 offset:15488
    ds_read_b64_tr_b16 a[182:183], v84 offset:17024
    v_mul_u32_u24 v93, 18, v93
    v_lshrrev_b32 v94, 4, v91
    v_lshl_add_u32 v93, v94, 3, v93
    s_waitcnt lgkmcnt(10)
    v_mfma_f32_32x32x16_bf16 v[0:15], a[192:195], a[144:147], v[0:15]
    ds_read_b64_tr_b16 a[184:185], v84 offset:18432
    ds_read_b64_tr_b16 a[186:187], v84 offset:19968
    s_add_u32 m0, s53, 113664
    v_bfe_u32 v94, v91, 2, 1
    v_lshl_add_u32 v93, v94, 2, v93
    s_waitcnt lgkmcnt(10)
    v_mfma_f32_32x32x16_bf16 v[16:31], a[196:199], a[144:147], v[16:31]
    ds_read_b64_tr_b16 a[188:189], v84 offset:18496
    ds_read_b64_tr_b16 a[190:191], v84 offset:20032
    buffer_load_dwordx4 v75, s[48:51], s52 offen lds
    v_and_b32 v94, 3, v91
    v_add_u32 v93, v93, v94
    v_mul_u32_u24 v93, 1152, v93
    s_waitcnt lgkmcnt(10)
    v_mfma_f32_32x32x16_bf16 v[32:47], a[200:203], a[144:147], v[32:47]
    ds_read_b64_tr_b16 a[192:193], v84 offset:18560
    ds_read_b64_tr_b16 a[194:195], v84 offset:20096
    v_mov_b32 v94, s46
    v_mov_b32 v91, s47
    v_cmp_lt_u32 vcc, 3, v92
    s_nop 1
    v_cndmask_b32 v94, v94, v91, vcc
    v_mov_b32 v91, s59
    v_cmp_lt_u32 vcc, 7, v92
    s_nop 1
    v_cndmask_b32 v94, v94, v91, vcc
    s_waitcnt lgkmcnt(10)
    v_mfma_f32_32x32x16_bf16 v[0:15], a[204:207], a[148:151], v[0:15]
    ds_read_b64_tr_b16 a[196:197], v84 offset:21504
    ds_read_b64_tr_b16 a[198:199], v84 offset:23040
    s_add_u32 m0, s53, 114688
    v_and_b32 v92, 3, v92
    v_add_u32 v93, v93, v94
    v_lshl_add_u32 v113, v92, 4, v93
    s_waitcnt lgkmcnt(10)
    v_mfma_f32_32x32x16_bf16 v[16:31], a[176:179], a[148:151], v[16:31]
    ds_read_b64_tr_b16 a[200:201], v84 offset:21568
    ds_read_b64_tr_b16 a[202:203], v84 offset:23104
    buffer_load_dwordx4 v76, s[48:51], s52 offen lds
    v_add_u32 v90, 128, v208
    v_mul_u32_u24 v91, 6554, v90
    s_waitcnt lgkmcnt(10)
    v_mfma_f32_32x32x16_bf16 v[32:47], a[180:183], a[148:151], v[32:47]
    ds_read_b64_tr_b16 a[204:205], v84 offset:21632
    ds_read_b64_tr_b16 a[206:207], v84 offset:23168
    v_lshrrev_b32 v91, 16, v91
    v_mul_u32_u24 v92, 10, v91
    v_sub_u32 v92, v90, v92
    s_waitcnt lgkmcnt(10)
    v_mfma_f32_32x32x16_bf16 v[0:15], a[184:187], a[152:155], v[0:15]
    ds_read_b64_tr_b16 a[176:177], v84 offset:24576
    ds_read_b64_tr_b16 a[178:179], v84 offset:26112
    v_bfe_u32 v93, v91, 3, 1
    v_mul_u32_u24 v93, 18, v93
    s_waitcnt lgkmcnt(10)
    v_mfma_f32_32x32x16_bf16 v[16:31], a[188:191], a[152:155], v[16:31]
    ds_read_b64_tr_b16 a[180:181], v84 offset:24640
    ds_read_b64_tr_b16 a[182:183], v84 offset:26176
    s_add_u32 m0, s53, 115712
    v_lshrrev_b32 v94, 4, v91
    v_lshl_add_u32 v93, v94, 3, v93
    v_bfe_u32 v94, v91, 2, 1
    s_waitcnt lgkmcnt(10)
    v_mfma_f32_32x32x16_bf16 v[32:47], a[192:195], a[152:155], v[32:47]
    ds_read_b64_tr_b16 a[184:185], v84 offset:24704
    ds_read_b64_tr_b16 a[186:187], v84 offset:26240
    buffer_load_dwordx4 v77, s[48:51], s52 offen lds
    v_lshl_add_u32 v93, v94, 2, v93
    v_and_b32 v94, 3, v91
    s_waitcnt lgkmcnt(10)
    v_mfma_f32_32x32x16_bf16 v[0:15], a[196:199], a[156:159], v[0:15]
    ds_read_b64_tr_b16 a[188:189], v84 offset:27648
    ds_read_b64_tr_b16 a[190:191], v84 offset:29184
    v_add_u32 v93, v93, v94
    v_mul_u32_u24 v93, 1152, v93
    v_mov_b32 v94, s46
    v_mov_b32 v91, s47
    v_cmp_lt_u32 vcc, 3, v92
    s_nop 1
    v_cndmask_b32 v94, v94, v91, vcc
    s_waitcnt lgkmcnt(10)
    v_mfma_f32_32x32x16_bf16 v[16:31], a[200:203], a[156:159], v[16:31]
    ds_read_b64_tr_b16 a[192:193], v84 offset:27712
    ds_read_b64_tr_b16 a[194:195], v84 offset:29248
    v_mov_b32 v91, s59
    v_cmp_lt_u32 vcc, 7, v92
    s_nop 1
    v_cndmask_b32 v94, v94, v91, vcc
    v_and_b32 v92, 3, v92
    s_waitcnt lgkmcnt(10)
    v_mfma_f32_32x32x16_bf16 v[32:47], a[204:207], a[156:159], v[32:47]
    ds_read_b64_tr_b16 a[196:197], v84 offset:27776
    ds_read_b64_tr_b16 a[198:199], v84 offset:29312
    s_add_u32 m0, s53, 116736
    v_add_u32 v93, v93, v94
    v_lshl_add_u32 v114, v92, 4, v93
    v_add_u32 v90, 192, v208
    s_waitcnt lgkmcnt(10)
    v_mfma_f32_32x32x16_bf16 v[0:15], a[176:179], a[160:163], v[0:15]
    ds_read_b64_tr_b16 a[200:201], v84 offset:30720
    ds_read_b64_tr_b16 a[202:203], v84 offset:32256
    buffer_load_dwordx4 v78, s[48:51], s52 offen lds
    v_mul_u32_u24 v91, 6554, v90
    v_lshrrev_b32 v91, 16, v91
    s_waitcnt lgkmcnt(10)
    v_mfma_f32_32x32x16_bf16 v[16:31], a[180:183], a[160:163], v[16:31]
    ds_read_b64_tr_b16 a[204:205], v84 offset:30784
    ds_read_b64_tr_b16 a[206:207], v84 offset:32320
    v_mul_u32_u24 v92, 10, v91
    v_sub_u32 v92, v90, v92
    v_bfe_u32 v93, v91, 3, 1
    s_waitcnt lgkmcnt(10)
    v_mfma_f32_32x32x16_bf16 v[32:47], a[184:187], a[160:163], v[32:47]
    ds_read_b64_tr_b16 a[176:177], v84 offset:30848
    ds_read_b64_tr_b16 a[178:179], v84 offset:32384
    s_add_u32 m0, s53, 117760
    v_mul_u32_u24 v93, 18, v93
    v_lshrrev_b32 v94, 4, v91
    s_waitcnt lgkmcnt(10)
    v_mfma_f32_32x32x16_bf16 v[0:15], a[188:191], a[164:167], v[0:15]
    ds_read_b64_tr_b16 a[180:181], v84 offset:33792
    ds_read_b64_tr_b16 a[182:183], v84 offset:35328
    buffer_load_dwordx4 v79, s[48:51], s52 offen lds
    v_lshl_add_u32 v93, v94, 3, v93
    v_bfe_u32 v94, v91, 2, 1
    v_lshl_add_u32 v93, v94, 2, v93
    s_waitcnt lgkmcnt(10)
    v_mfma_f32_32x32x16_bf16 v[16:31], a[192:195], a[164:167], v[16:31]
    ds_read_b64_tr_b16 a[184:185], v84 offset:33856
    ds_read_b64_tr_b16 a[186:187], v84 offset:35392
    v_and_b32 v94, 3, v91
    v_add_u32 v93, v93, v94
    s_waitcnt lgkmcnt(10)
    v_mfma_f32_32x32x16_bf16 v[32:47], a[196:199], a[164:167], v[32:47]
    ds_read_b64_tr_b16 a[188:189], v84 offset:33920
    ds_read_b64_tr_b16 a[190:191], v84 offset:35456
    v_mul_u32_u24 v93, 1152, v93
    v_mov_b32 v94, s46
    v_mov_b32 v91, s47
    v_cmp_lt_u32 vcc, 3, v92
    s_nop 1
    v_cndmask_b32 v94, v94, v91, vcc
    v_mov_b32 v91, s59
    v_cmp_lt_u32 vcc, 7, v92
    s_nop 1
    v_cndmask_b32 v94, v94, v91, vcc
    s_waitcnt lgkmcnt(10)
    v_mfma_f32_32x32x16_bf16 v[0:15], a[200:203], a[168:171], v[0:15]
    ds_read_b64_tr_b16 a[192:193], v85 offset:0
    ds_read_b64_tr_b16 a[194:195], v85 offset:1536
    s_add_u32 m0, s53, 118784
    v_and_b32 v92, 3, v92
    v_add_u32 v93, v93, v94
    buffer_load_dwordx2 v[124:125], v123, s[24:27], s43 offen sc1
    s_waitcnt lgkmcnt(10)
    v_mfma_f32_32x32x16_bf16 v[16:31], a[204:207], a[168:171], v[16:31]
    ds_read_b64_tr_b16 a[196:197], v85 offset:64
    ds_read_b64_tr_b16 a[198:199], v85 offset:1600
    buffer_load_dwordx4 v80, s[48:51], s52 offen lds
    s_sub_u32 s52, s52, 442176
    v_lshl_add_u32 v115, v92, 4, v93
    v_add_u32 v90, 256, v208
    v_mul_u32_u24 v91, 6554, v90
    s_waitcnt lgkmcnt(10)
    v_mfma_f32_32x32x16_bf16 v[32:47], a[176:179], a[168:171], v[32:47]
    ds_read_b64_tr_b16 a[200:201], v85 offset:128
    ds_read_b64_tr_b16 a[202:203], v85 offset:1664
    v_lshrrev_b32 v91, 16, v91
    v_mul_u32_u24 v92, 10, v91
    s_waitcnt lgkmcnt(10)
    v_mfma_f32_32x32x16_bf16 v[0:15], a[180:183], a[172:175], v[0:15]
    ds_read_b64_tr_b16 a[204:205], v85 offset:3072
    ds_read_b64_tr_b16 a[206:207], v85 offset:4608
    v_sub_u32 v92, v90, v92
    v_bfe_u32 v93, v91, 3, 1
    v_mul_u32_u24 v93, 18, v93
    s_waitcnt lgkmcnt(10)
    v_mfma_f32_32x32x16_bf16 v[16:31], a[184:187], a[172:175], v[16:31]
    ds_read_b64_tr_b16 a[176:177], v85 offset:3136
    ds_read_b64_tr_b16 a[178:179], v85 offset:4672
    v_lshrrev_b32 v94, 4, v91
    v_lshl_add_u32 v93, v94, 3, v93
    s_waitcnt lgkmcnt(10)
    v_mfma_f32_32x32x16_bf16 v[32:47], a[188:191], a[172:175], v[32:47]
    ds_read_b64_tr_b16 a[180:181], v85 offset:3200
    ds_read_b64_tr_b16 a[182:183], v85 offset:4736
    v_bfe_u32 v94, v91, 2, 1
    v_lshl_add_u32 v93, v94, 2, v93
    s_waitcnt vmcnt(1)
    v_cmp_ne_u64 vcc, s[32:33], v[124:125]
    s_cbranch_vccz L_f3ok
    s_mov_b32 s36, 0
L_poll_7:
    buffer_load_dwordx2 v[124:125], v123, s[24:27], s43 offen sc1
    s_waitcnt vmcnt(0)
    v_cmp_ne_u64 vcc, s[32:33], v[124:125]
    s_add_u32 s36, s36, 1
    s_cbranch_vccz L_polld_8
    s_cmp_lt_u32 s36, 0x20000
    s_cbranch_scc1 L_poll_7
L_polld_8:
L_f3ok:
    s_waitcnt lgkmcnt(10)
    v_mfma_f32_32x32x16_bf16 v[48:63], a[192:195], a[32:35], 0
    s_barrier
    ds_read_b64_tr_b16 a[184:185], v85 offset:6144
    ds_read_b64_tr_b16 a[186:187], v85 offset:7680
    s_waitcnt lgkmcnt(10)
    v_mfma_f32_32x32x16_bf16 v[128:143], a[196:199], a[32:35], 0
    ds_read_b64_tr_b16 a[188:189], v85 offset:6208
    ds_read_b64_tr_b16 a[190:191], v85 offset:7744
    s_add_u32 m0, s53, 73728
    v_and_b32 v94, 3, v91
    v_add_u32 v93, v93, v94
    v_mul_u32_u24 v93, 1152, v93
    v_mov_b32 v94, s46
    v_mov_b32 v91, s47
    v_cmp_lt_u32 vcc, 3, v92
    s_nop 1
    v_cndmask_b32 v94, v94, v91, vcc
    s_waitcnt lgkmcnt(10)
    v_mfma_f32_32x32x16_bf16 v[144:159], a[200:203], a[32:35], 0
    ds_read_b64_tr_b16 a[192:193], v85 offset:6272
    ds_read_b64_tr_b16 a[194:195], v85 offset:7808
    buffer_load_dwordx4 v72, s[48:51], s52 offen lds
    v_mov_b32 v91, s59
    v_cmp_lt_u32 vcc, 7, v92
    s_nop 1
    v_cndmask_b32 v94, v94, v91, vcc
    v_and_b32 v92, 3, v92
    v_add_u32 v93, v93, v94
    s_waitcnt lgkmcnt(10)
    v_mfma_f32_32x32x16_bf16 v[48:63], a[204:207], a[36:39], v[48:63]
    ds_read_b64_tr_b16 a[196:197], v85 offset:9216
    ds_read_b64_tr_b16 a[198:199], v85 offset:10752
    v_lshl_add_u32 v116, v92, 4, v93
    s_cmp_lt_u32 s28, 2
    s_cselect_b32 s34, 0, 3
    s_lshl_b32 s35, s34, 10
    s_add_u32 s40, s79, s35
    s_lshl_b32 s34, s34, 6
    v_add_u32 v90, s34, v208
    v_mul_u32_u24 v91, 6554, v90
    s_add_u32 s35, s73, 12288
    buffer_load_dwordx4 a[224:227], v210, s[24:27], s35 offen offset:0 sc1
    s_waitcnt lgkmcnt(10)
    v_mfma_f32_32x32x16_bf16 v[128:143], a[176:179], a[36:39], v[128:143]
    ds_read_b64_tr_b16 a[200:201], v85 offset:9280
    ds_read_b64_tr_b16 a[202:203], v85 offset:10816
    s_add_u32 m0, s53, 74752
    v_cvt_pk_bf16_f32 v96, v0, v1
    v_cvt_pk_bf16_f32 v97, v2, v3
    v_lshrrev_b32 v91, 16, v91
    v_mul_u32_u24 v92, 10, v91
    v_sub_u32 v92, v90, v92
    s_waitcnt lgkmcnt(10)
    v_mfma_f32_32x32x16_bf16 v[144:159], a[180:183], a[36:39], v[144:159]
    ds_read_b64_tr_b16 a[204:205], v85 offset:9344
    ds_read_b64_tr_b16 a[206:207], v85 offset:10880
    buffer_load_dwordx4 v73, s[48:51], s52 offen lds
    v_cvt_pk_bf16_f32 v98, v8, v9
    v_bfe_u32 v93, v91, 2, 2
    v_mul_u32_u24 v93, 72, v93
    v_lshrrev_b32 v94, 4, v91
    s_waitcnt lgkmcnt(10)
    v_mfma_f32_32x32x16_bf16 v[48:63], a[184:187], a[40:43], v[48:63]
    ds_read_b64_tr_b16 a[176:177], v85 offset:12288
    ds_read_b64_tr_b16 a[178:179], v85 offset:13824
    v_cvt_pk_bf16_f32 v99, v10, v11
    v_mul_u32_u24 v94, 36, v94
    v_add_u32 v93, v93, v94
    v_bfe_u32 v94, v91, 1, 1
    s_waitcnt lgkmcnt(10)
    v_mfma_f32_32x32x16_bf16 v[128:143], a[188:191], a[40:43], v[128:143]
    ds_read_b64_tr_b16 a[180:181], v85 offset:12352
    ds_read_b64_tr_b16 a[182:183], v85 offset:13888
    buffer_store_dwordx4 v[96:99], v86, s[24:27], s57 offen offset:0 sc1
    v_mul_u32_u24 v94, 18, v94
    v_add_u32 v93, v93, v94
    v_and_b32 v94, 1, v91
    s_waitcnt lgkmcnt(10)
    v_mfma_f32_32x32x16_bf16 v[144:159], a[192:195], a[40:43], v[144:159]
    ds_read_b64_tr_b16 a[184:185], v85 offset:12416
    ds_read_b64_tr_b16 a[186:187], v85 offset:13952
    s_add_u32 m0, s53, 75776
    v_cvt_pk_bf16_f32 v100, v4, v5
    v_add_u32 v93, v93, v94
    v_add_u32 v93, 16, v93
    v_mul_u32_u24 v93, 1152, v93
    s_add_u32 s35, s73, 12288
    buffer_load_dwordx4 a[228:231], v210, s[24:27], s35 offen offset:1024 sc1
    s_waitcnt lgkmcnt(10)
    v_mfma_f32_32x32x16_bf16 v[48:63], a[196:199], a[44:47], v[48:63]
    ds_read_b64_tr_b16 a[188:189], v85 offset:15360
    ds_read_b64_tr_b16 a[190:191], v85 offset:16896
    buffer_load_dwordx4 v74, s[48:51], s52 offen lds
    v_cvt_pk_bf16_f32 v101, v6, v7
    v_mov_b32 v94, s46
    v_mov_b32 v91, s47
    v_cmp_lt_u32 vcc, 3, v92
    s_nop 1
    v_cndmask_b32 v94, v94, v91, vcc
    v_mov_b32 v91, s59
    v_cmp_lt_u32 vcc, 7, v92
    s_nop 1
    v_cndmask_b32 v94, v94, v91, vcc
    v_and_b32 v92, 3, v92
    s_waitcnt lgkmcnt(10)
    v_mfma_f32_32x32x16_bf16 v[128:143], a[200:203], a[44:47], v[128:143]
    ds_read_b64_tr_b16 a[192:193], v85 offset:15424
    ds_read_b64_tr_b16 a[194:195], v85 offset:16960
    v_cvt_pk_bf16_f32 v102, v12, v13
    v_add_u32 v93, v93, v94
    v_lshl_add_u32 v117, v92, 4, v93
    s_cmp_lt_u32 s28, 2
    s_cselect_b32 s34, 1, 4
    s_lshl_b32 s35, s34, 10
    s_add_u32 s41, s79, s35
    s_lshl_b32 s34, s34, 6
    v_add_u32 v90, s34, v208
    s_waitcnt lgkmcnt(10)
    v_mfma_f32_32x32x16_bf16 v[144:159], a[204:207], a[44:47], v[144:159]
    ds_read_b64_tr_b16 a[196:197], v85 offset:15488
    ds_read_b64_tr_b16 a[198:199], v85 offset:17024
    v_cvt_pk_bf16_f32 v103, v14, v15
    v_mul_u32_u24 v91, 6554, v90
    v_lshrrev_b32 v91, 16, v91
    v_mul_u32_u24 v92, 10, v91
    s_waitcnt lgkmcnt(10)
    v_mfma_f32_32x32x16_bf16 v[48:63], a[176:179], a[48:51], v[48:63]
    ds_read_b64_tr_b16 a[200:201], v85 offset:18432
    ds_read_b64_tr_b16 a[202:203], v85 offset:19968
    s_add_u32 m0, s53, 76800
    buffer_store_dwordx4 v[100:103], v86, s[24:27], s57 offen offset:512 sc1
    v_sub_u32 v92, v90, v92
    v_bfe_u32 v93, v91, 2, 2
    v_mul_u32_u24 v93, 72, v93
    s_waitcnt lgkmcnt(10)
    v_mfma_f32_32x32x16_bf16 v[128:143], a[180:183], a[48:51], v[128:143]
    ds_read_b64_tr_b16 a[204:205], v85 offset:18496
    ds_read_b64_tr_b16 a[206:207], v85 offset:20032
    buffer_load_dwordx4 v75, s[48:51], s52 offen lds
    s_add_u32 s57, s57, 1024
    v_lshrrev_b32 v94, 4, v91
    v_mul_u32_u24 v94, 36, v94
    v_add_u32 v93, v93, v94
    s_add_u32 s35, s73, 12288
    buffer_load_dwordx4 a[232:235], v210, s[24:27], s35 offen offset:2048 sc1
    s_waitcnt lgkmcnt(10)
    v_mfma_f32_32x32x16_bf16 v[144:159], a[184:187], a[48:51], v[144:159]
    ds_read_b64_tr_b16 a[176:177], v85 offset:18560
    ds_read_b64_tr_b16 a[178:179], v85 offset:20096
    v_cvt_pk_bf16_f32 v104, v16, v17
    v_cvt_pk_bf16_f32 v105, v18, v19
    v_bfe_u32 v94, v91, 1, 1
    v_mul_u32_u24 v94, 18, v94
    v_add_u32 v93, v93, v94
    s_waitcnt lgkmcnt(10)
    v_mfma_f32_32x32x16_bf16 v[48:63], a[188:191], a[52:55], v[48:63]
    ds_read_b64_tr_b16 a[180:181], v85 offset:21504
    ds_read_b64_tr_b16 a[182:183], v85 offset:23040
    s_add_u32 m0, s53, 77824
    v_cvt_pk_bf16_f32 v106, v24, v25
    v_and_b32 v94, 1, v91
    v_add_u32 v93, v93, v94
    v_add_u32 v93, 16, v93
    s_waitcnt lgkmcnt(10)
    v_mfma_f32_32x32x16_bf16 v[128:143], a[192:195], a[52:55], v[128:143]
    ds_read_b64_tr_b16 a[184:185], v85 offset:21568
    ds_read_b64_tr_b16 a[186:187], v85 offset:23104
    buffer_load_dwordx4 v76, s[48:51], s52 offen lds
    v_cvt_pk_bf16_f32 v107, v26, v27
    v_mul_u32_u24 v93, 1152, v93
    v_mov_b32 v94, s46
    v_mov_b32 v91, s47
    v_cmp_lt_u32 vcc, 3, v92
    s_nop 1
    v_cndmask_b32 v94, v94, v91, vcc
    v_mov_b32 v91, s59
    v_cmp_lt_u32 vcc, 7, v92
    s_nop 1
    v_cndmask_b32 v94, v94, v91, vcc
    s_waitcnt lgkmcnt(10)
    v_mfma_f32_32x32x16_bf16 v[144:159], a[196:199], a[52:55], v[144:159]
    ds_read_b64_tr_b16 a[188:189], v85 offset:21632
    ds_read_b64_tr_b16 a[190:191], v85 offset:23168
    buffer_store_dwordx4 v[104:107], v86, s[24:27], s57 offen offset:0 sc1
    v_and_b32 v92, 3, v92
    v_add_u32 v93, v93, v94
    v_lshl_add_u32 v118, v92, 4, v93
    s_waitcnt lgkmcnt(10)
    v_mfma_f32_32x32x16_bf16 v[48:63], a[200:203], a[56:59], v[48:63]
    ds_read_b64_tr_b16 a[192:193], v85 offset:24576
    ds_read_b64_tr_b16 a[194:195], v85 offset:26112
    v_cvt_pk_bf16_f32 v108, v20, v21
    s_cmp_lt_u32 s28, 2
    s_cselect_b32 s34, 2, 4
    s_lshl_b32 s35, s34, 10
    s_add_u32 s42, s79, s35
    s_lshl_b32 s34, s34, 6
    v_add_u32 v90, s34, v208
    v_mul_u32_u24 v91, 6554, v90
    v_lshrrev_b32 v91, 16, v91
    s_add_u32 s35, s73, 12288
    buffer_load_dwordx4 a[236:239], v210, s[24:27], s35 offen offset:3072 sc1
    s_waitcnt lgkmcnt(10)
    v_mfma_f32_32x32x16_bf16 v[128:143], a[204:207], a[56:59], v[128:143]
    ds_read_b64_tr_b16 a[196:197], v85 offset:24640
    ds_read_b64_tr_b16 a[198:199], v85 offset:26176
    s_add_u32 m0, s53, 78848
    v_cvt_pk_bf16_f32 v109, v22, v23
    v_mul_u32_u24 v92, 10, v91
    v_sub_u32 v92, v90, v92
    v_bfe_u32 v93, v91, 2, 2
    s_waitcnt lgkmcnt(10)
    v_mfma_f32_32x32x16_bf16 v[144:159], a[176:179], a[56:59], v[144:159]
    ds_read_b64_tr_b16 a[200:201], v85 offset:24704
    ds_read_b64_tr_b16 a[202:203], v85 offset:26240
    buffer_load_dwordx4 v77, s[48:51], s52 offen lds
    v_cvt_pk_bf16_f32 v110, v28, v29
    v_mul_u32_u24 v93, 72, v93
    v_lshrrev_b32 v94, 4, v91
    v_mul_u32_u24 v94, 36, v94
    s_waitcnt lgkmcnt(10)
    v_mfma_f32_32x32x16_bf16 v[48:63], a[180:183], a[60:63], v[48:63]
    ds_read_b64_tr_b16 a[204:205], v85 offset:27648
    ds_read_b64_tr_b16 a[206:207], v85 offset:29184
    v_cvt_pk_bf16_f32 v111, v30, v31
    v_add_u32 v93, v93, v94
    v_bfe_u32 v94, v91, 1, 1
    v_mul_u32_u24 v94, 18, v94
    s_waitcnt lgkmcnt(10)
    v_mfma_f32_32x32x16_bf16 v[128:143], a[184:187], a[60:63], v[128:143]
    ds_read_b64_tr_b16 a[176:177], v85 offset:27712
    ds_read_b64_tr_b16 a[178:179], v85 offset:29248
    buffer_store_dwordx4 v[108:111], v86, s[24:27], s57 offen offset:512 sc1
    v_add_u32 v93, v93, v94
    v_and_b32 v94, 1, v91
    v_add_u32 v93, v93, v94
    s_waitcnt lgkmcnt(10)
    v_mfma_f32_32x32x16_bf16 v[144:159], a[188:191], a[60:63], v[144:159]
    ds_read_b64_tr_b16 a[180:181], v85 offset:27776
    ds_read_b64_tr_b16 a[182:183], v85 offset:29312
    s_add_u32 m0, s53, 79872
    s_add_u32 s57, s57, 1024
    v_add_u32 v93, 16, v93
    v_mul_u32_u24 v93, 1152, v93
    v_mov_b32 v94, s46
    v_mov_b32 v91, s47
    v_cmp_lt_u32 vcc, 3, v92
    s_nop 1
    v_cndmask_b32 v94, v94, v91, vcc
    s_add_u32 s35, s73, 16384
    buffer_load_dwordx4 a[240:243], v210, s[24:27], s35 offen offset:0 sc1
    s_waitcnt lgkmcnt(10)
    v_mfma_f32_32x32x16_bf16 v[48:63], a[192:195], a[64:67], v[48:63]
    ds_read_b64_tr_b16 a[184:185], v85 offset:30720
    ds_read_b64_tr_b16 a[186:187], v85 offset:32256
    buffer_load_dwordx4 v78, s[48:51], s52 offen lds
    v_cvt_pk_bf16_f32 v96, v32, v33
    v_cvt_pk_bf16_f32 v97, v34, v35
    v_mov_b32 v91, s59
    v_cmp_lt_u32 vcc, 7, v92
    s_nop 1
    v_cndmask_b32 v94, v94, v91, vcc
    v_and_b32 v92, 3, v92
    v_add_u32 v93, v93, v94
    s_waitcnt lgkmcnt(10)
    v_mfma_f32_32x32x16_bf16 v[128:143], a[196:199], a[64:67], v[128:143]
    ds_read_b64_tr_b16 a[188:189], v85 offset:30784
    ds_read_b64_tr_b16 a[190:191], v85 offset:32320
    v_cvt_pk_bf16_f32 v98, v40, v41
    v_lshl_add_u32 v119, v92, 4, v93
    v_lshrrev_b32 v90, 4, v208
    v_bfe_u32 v91, v208, 2, 2
    s_waitcnt lgkmcnt(10)
    v_mfma_f32_32x32x16_bf16 v[144:159], a[200:203], a[64:67], v[144:159]
    ds_read_b64_tr_b16 a[192:193], v85 offset:30848
    ds_read_b64_tr_b16 a[194:195], v85 offset:32384
    s_add_u32 m0, s53, 80896
    v_cvt_pk_bf16_f32 v99, v42, v43
    v_lshl_add_u32 v92, v90, 2, v91
    v_mul_u32_u24 v92, 160, v92
    v_and_b32 v91, 3, v208
    s_waitcnt lgkmcnt(10)
    v_mfma_f32_32x32x16_bf16 v[48:63], a[204:207], a[68:71], v[48:63]
    ds_read_b64_tr_b16 a[196:197], v85 offset:33792
    ds_read_b64_tr_b16 a[198:199], v85 offset:35328
    buffer_load_dwordx4 v79, s[48:51], s52 offen lds
    buffer_store_dwordx4 v[96:99], v86, s[24:27], s57 offen offset:0 sc1
    v_lshl_add_u32 v92, v91, 3, v92
    v_add_u32 v120, 55296, v92
    v_and_b32 v91, 15, v208
    s_waitcnt lgkmcnt(10)
    v_mfma_f32_32x32x16_bf16 v[128:143], a[176:179], a[68:71], v[128:143]
    ds_read_b64_tr_b16 a[200:201], v85 offset:33856
    ds_read_b64_tr_b16 a[202:203], v85 offset:35392
    v_cvt_pk_bf16_f32 v100, v36, v37
    v_mul_u32_u24 v91, 1152, v91
    v_lshl_add_u32 v122, v90, 3, v91
    v_and_b32 v92, 1, v90
    s_add_u32 s35, s73, 16384
    buffer_load_dwordx4 a[244:247], v210, s[24:27], s35 offen offset:1024 sc1
    s_waitcnt lgkmcnt(10)
    v_mfma_f32_32x32x16_bf16 v[144:159], a[180:183], a[68:71], v[144:159]
    ds_read_b64_tr_b16 a[204:205], v85 offset:33920
    ds_read_b64_tr_b16 a[206:207], v85 offset:35456
    v_cvt_pk_bf16_f32 v101, v38, v39
    v_lshl_add_u32 v91, v92, 5, v91
    v_lshrrev_b32 v92, 1, v90
    v_lshl_add_u32 v121, v92, 4, v91
    s_waitcnt lgkmcnt(10)
    v_mfma_f32_32x32x16_bf16 v[48:63], a[184:187], a[72:75], v[48:63]
    ds_read_b64_tr_b16 a[176:177], v82 offset:0
    ds_read_b64_tr_b16 a[178:179], v82 offset:1536
    s_add_u32 m0, s53, 81920
    v_cvt_pk_bf16_f32 v102, v44, v45
    s_waitcnt lgkmcnt(10)
    v_mfma_f32_32x32x16_bf16 v[128:143], a[188:191], a[72:75], v[128:143]
    ds_read_b64_tr_b16 a[180:181], v82 offset:64
    ds_read_b64_tr_b16 a[182:183], v82 offset:1600
    buffer_load_dwordx4 v80, s[48:51], s52 offen lds
    s_add_u32 s52, s52, 221184
    v_cvt_pk_bf16_f32 v103, v46, v47
    s_waitcnt lgkmcnt(10)
    v_mfma_f32_32x32x16_bf16 v[144:159], a[192:195], a[72:75], v[144:159]
    ds_read_b64_tr_b16 a[184:185], v82 offset:128
    ds_read_b64_tr_b16 a[186:187], v82 offset:1664
    buffer_store_dwordx4 v[100:103], v86, s[24:27], s57 offen offset:512 sc1
    s_waitcnt lgkmcnt(10)
    v_mfma_f32_32x32x16_bf16 v[48:63], a[196:199], a[76:79], v[48:63]
    ds_read_b64_tr_b16 a[188:189], v82 offset:3072
    ds_read_b64_tr_b16 a[190:191], v82 offset:4608
    s_add_u32 s57, s57, 1024
    s_add_u32 s46, s46, s74
    s_add_u32 s47, s47, s74
    s_waitcnt lgkmcnt(10)
    v_mfma_f32_32x32x16_bf16 v[128:143], a[200:203], a[76:79], v[128:143]
    ds_read_b64_tr_b16 a[192:193], v82 offset:3136
    ds_read_b64_tr_b16 a[194:195], v82 offset:4672
    s_add_u32 s59, s59, s74
    s_waitcnt lgkmcnt(10)
    v_mfma_f32_32x32x16_bf16 v[144:159], a[204:207], a[76:79], v[144:159]
    ds_read_b64_tr_b16 a[196:197], v82 offset:3200
    ds_read_b64_tr_b16 a[198:199], v82 offset:4736
    s_waitcnt lgkmcnt(10)
    v_mfma_f32_32x32x16_bf16 v[48:63], a[176:179], a[80:83], v[48:63]
    s_waitcnt vmcnt(21)
    s_barrier
    ds_read_b64_tr_b16 a[200:201], v82 offset:6144
    ds_read_b64_tr_b16 a[202:203], v82 offset:7680
    s_waitcnt lgkmcnt(10)
    v_mfma_f32_32x32x16_bf16 v[128:143], a[180:183], a[80:83], v[128:143]
    ds_read_b64_tr_b16 a[204:205], v82 offset:6208
    ds_read_b64_tr_b16 a[206:207], v82 offset:7744
    s_add_u32 m0, s53, 36864
    s_waitcnt lgkmcnt(10)
    v_mfma_f32_32x32x16_bf16 v[144:159], a[184:187], a[80:83], v[144:159]
    ds_read_b64_tr_b16 a[176:177], v82 offset:6272
    ds_read_b64_tr_b16 a[178:179], v82 offset:7808
    buffer_load_dwordx4 v72, s[48:51], s52 offen lds
    s_waitcnt lgkmcnt(10)
    v_mfma_f32_32x32x16_bf16 v[48:63], a[188:191], a[84:87], v[48:63]
    ds_read_b64_tr_b16 a[180:181], v82 offset:9216
    ds_read_b64_tr_b16 a[182:183], v82 offset:10752
    s_add_u32 s35, s73, 4096
    buffer_load_dwordx4 a[16:19], v210, s[24:27], s35 offen offset:0 sc1
    s_waitcnt lgkmcnt(10)
    v_mfma_f32_32x32x16_bf16 v[128:143], a[192:195], a[84:87], v[128:143]
    ds_read_b64_tr_b16 a[184:185], v82 offset:9280
    ds_read_b64_tr_b16 a[186:187], v82 offset:10816
    s_add_u32 m0, s53, 37888
    s_waitcnt lgkmcnt(10)
    v_mfma_f32_32x32x16_bf16 v[144:159], a[196:199], a[84:87], v[144:159]
    ds_read_b64_tr_b16 a[188:189], v82 offset:9344
    ds_read_b64_tr_b16 a[190:191], v82 offset:10880
    buffer_load_dwordx4 v73, s[48:51], s52 offen lds
    s_waitcnt lgkmcnt(10)
    v_mfma_f32_32x32x16_bf16 v[48:63], a[200:203], a[88:91], v[48:63]
    ds_read_b64_tr_b16 a[192:193], v82 offset:12288
    ds_read_b64_tr_b16 a[194:195], v82 offset:13824
    s_waitcnt lgkmcnt(10)
    v_mfma_f32_32x32x16_bf16 v[128:143], a[204:207], a[88:91], v[128:143]
    ds_read_b64_tr_b16 a[196:197], v82 offset:12352
    ds_read_b64_tr_b16 a[198:199], v82 offset:13888
    s_waitcnt lgkmcnt(10)
    v_mfma_f32_32x32x16_bf16 v[144:159], a[176:179], a[88:91], v[144:159]
    ds_read_b64_tr_b16 a[200:201], v82 offset:12416
    ds_read_b64_tr_b16 a[202:203], v82 offset:13952
    s_add_u32 m0, s53, 38912
    s_add_u32 s35, s73, 4096
    buffer_load_dwordx4 a[20:23], v210, s[24:27], s35 offen offset:1024 sc1
    s_waitcnt lgkmcnt(10)
    v_mfma_f32_32x32x16_bf16 v[48:63], a[180:183], a[92:95], v[48:63]
    ds_read_b64_tr_b16 a[204:205], v82 offset:15360
    ds_read_b64_tr_b16 a[206:207], v82 offset:16896
    buffer_load_dwordx4 v74, s[48:51], s52 offen lds
    s_waitcnt lgkmcnt(10)
    v_mfma_f32_32x32x16_bf16 v[128:143], a[184:187], a[92:95], v[128:143]
    ds_read_b64_tr_b16 a[176:177], v82 offset:15424
    ds_read_b64_tr_b16 a[178:179], v82 offset:16960
    s_waitcnt lgkmcnt(10)
    v_mfma_f32_32x32x16_bf16 v[144:159], a[188:191], a[92:95], v[144:159]
    ds_read_b64_tr_b16 a[180:181], v82 offset:15488
    ds_read_b64_tr_b16 a[182:183], v82 offset:17024
    s_waitcnt lgkmcnt(10)
    v_mfma_f32_32x32x16_bf16 v[48:63], a[192:195], a[96:99], v[48:63]
    ds_read_b64_tr_b16 a[184:185], v82 offset:18432
    ds_read_b64_tr_b16 a[186:187], v82 offset:19968
    s_add_u32 m0, s53, 39936
    s_waitcnt lgkmcnt(10)
    v_mfma_f32_32x32x16_bf16 v[128:143], a[196:199], a[96:99], v[128:143]
    ds_read_b64_tr_b16 a[188:189], v82 offset:18496
    ds_read_b64_tr_b16 a[190:191], v82 offset:20032
    buffer_load_dwordx4 v75, s[48:51], s52 offen lds
    s_add_u32 s35, s73, 4096
    buffer_load_dwordx4 a[24:27], v210, s[24:27], s35 offen offset:2048 sc1
    s_waitcnt lgkmcnt(10)
    v_mfma_f32_32x32x16_bf16 v[144:159], a[200:203], a[96:99], v[144:159]
    ds_read_b64_tr_b16 a[192:193], v82 offset:18560
    ds_read_b64_tr_b16 a[194:195], v82 offset:20096
    s_waitcnt lgkmcnt(10)
    v_mfma_f32_32x32x16_bf16 v[48:63], a[204:207], a[100:103], v[48:63]
    ds_read_b64_tr_b16 a[196:197], v82 offset:21504
    ds_read_b64_tr_b16 a[198:199], v82 offset:23040
    s_add_u32 m0, s53, 40960
    s_waitcnt lgkmcnt(10)
    v_mfma_f32_32x32x16_bf16 v[128:143], a[176:179], a[100:103], v[128:143]
    ds_read_b64_tr_b16 a[200:201], v82 offset:21568
    ds_read_b64_tr_b16 a[202:203], v82 offset:23104
    buffer_load_dwordx4 v76, s[48:51], s52 offen lds
    s_waitcnt lgkmcnt(10)
    v_mfma_f32_32x32x16_bf16 v[144:159], a[180:183], a[100:103], v[144:159]
    ds_read_b64_tr_b16 a[204:205], v82 offset:21632
    ds_read_b64_tr_b16 a[206:207], v82 offset:23168
    s_waitcnt lgkmcnt(10)
    v_mfma_f32_32x32x16_bf16 v[48:63], a[184:187], a[104:107], v[48:63]
    ds_read_b64_tr_b16 a[176:177], v82 offset:24576
    ds_read_b64_tr_b16 a[178:179], v82 offset:26112
    s_add_u32 s35, s73, 4096
    buffer_load_dwordx4 a[28:31], v210, s[24:27], s35 offen offset:3072 sc1
    s_waitcnt lgkmcnt(10)
    v_mfma_f32_32x32x16_bf16 v[128:143], a[188:191], a[104:107], v[128:143]
    ds_read_b64_tr_b16 a[180:181], v82 offset:24640
    ds_read_b64_tr_b16 a[182:183], v82 offset:26176
    s_add_u32 m0, s53, 41984
    s_waitcnt lgkmcnt(10)
    v_mfma_f32_32x32x16_bf16 v[144:159], a[192:195], a[104:107], v[144:159]
    ds_read_b64_tr_b16 a[184:185], v82 offset:24704
    ds_read_b64_tr_b16 a[186:187], v82 offset:26240
    buffer_load_dwordx4 v77, s[48:51], s52 offen lds
    s_waitcnt lgkmcnt(10)
    v_mfma_f32_32x32x16_bf16 v[48:63], a[196:199], a[108:111], v[48:63]
    ds_read_b64_tr_b16 a[188:189], v82 offset:27648
    ds_read_b64_tr_b16 a[190:191], v82 offset:29184
    s_waitcnt lgkmcnt(10)
    v_mfma_f32_32x32x16_bf16 v[128:143], a[200:203], a[108:111], v[128:143]
    ds_read_b64_tr_b16 a[192:193], v82 offset:27712
    ds_read_b64_tr_b16 a[194:195], v82 offset:29248
    s_waitcnt lgkmcnt(10)
    v_mfma_f32_32x32x16_bf16 v[144:159], a[204:207], a[108:111], v[144:159]
    ds_read_b64_tr_b16 a[196:197], v82 offset:27776
    ds_read_b64_tr_b16 a[198:199], v82 offset:29312
    s_add_u32 m0, s53, 43008
    s_add_u32 s35, s73, 8192
    buffer_load_dwordx4 a[208:211], v210, s[24:27], s35 offen offset:0 sc1
    s_waitcnt lgkmcnt(10)
    v_mfma_f32_32x32x16_bf16 v[48:63], a[176:179], a[112:115], v[48:63]
    ds_read_b64_tr_b16 a[200:201], v82 offset:30720
    ds_read_b64_tr_b16 a[202:203], v82 offset:32256
    buffer_load_dwordx4 v78, s[48:51], s52 offen lds
    s_waitcnt lgkmcnt(10)
    v_mfma_f32_32x32x16_bf16 v[128:143], a[180:183], a[112:115], v[128:143]
    ds_read_b64_tr_b16 a[204:205], v82 offset:30784
    ds_read_b64_tr_b16 a[206:207], v82 offset:32320
    s_waitcnt lgkmcnt(10)
    v_mfma_f32_32x32x16_bf16 v[144:159], a[184:187], a[112:115], v[144:159]
    ds_read_b64_tr_b16 a[176:177], v82 offset:30848
    ds_read_b64_tr_b16 a[178:179], v82 offset:32384
    s_add_u32 m0, s53, 44032
    s_waitcnt lgkmcnt(10)
    v_mfma_f32_32x32x16_bf16 v[48:63], a[188:191], a[116:119], v[48:63]
    ds_read_b64_tr_b16 a[180:181], v82 offset:33792
    ds_read_b64_tr_b16 a[182:183], v82 offset:35328
    buffer_load_dwordx4 v79, s[48:51], s52 offen lds
    s_waitcnt lgkmcnt(10)
    v_mfma_f32_32x32x16_bf16 v[128:143], a[192:195], a[116:119], v[128:143]
    ds_read_b64_tr_b16 a[184:185], v82 offset:33856
    ds_read_b64_tr_b16 a[186:187], v82 offset:35392
    s_add_u32 s35, s73, 8192
    buffer_load_dwordx4 a[212:215], v210, s[24:27], s35 offen offset:1024 sc1
    s_waitcnt lgkmcnt(10)
    v_mfma_f32_32x32x16_bf16 v[144:159], a[196:199], a[116:119], v[144:159]
    ds_read_b64_tr_b16 a[188:189], v82 offset:33920
    ds_read_b64_tr_b16 a[190:191], v82 offset:35456
    s_waitcnt lgkmcnt(10)
    v_mfma_f32_32x32x16_bf16 v[48:63], a[200:203], a[120:123], v[48:63]
    ds_read_b64_tr_b16 a[192:193], v83 offset:0
    ds_read_b64_tr_b16 a[194:195], v83 offset:1536
    s_add_u32 m0, s53, 45056
    s_waitcnt lgkmcnt(10)
    v_mfma_f32_32x32x16_bf16 v[128:143], a[204:207], a[120:123], v[128:143]
    ds_read_b64_tr_b16 a[196:197], v83 offset:64
    ds_read_b64_tr_b16 a[198:199], v83 offset:1600
    buffer_load_dwordx4 v80, s[48:51], s52 offen lds
    s_add_u32 s52, s52, 221184
    s_waitcnt lgkmcnt(10)
    v_mfma_f32_32x32x16_bf16 v[144:159], a[176:179], a[120:123], v[144:159]
    ds_read_b64_tr_b16 a[200:201], v83 offset:128
    ds_read_b64_tr_b16 a[202:203], v83 offset:1664
    s_waitcnt lgkmcnt(10)
    v_mfma_f32_32x32x16_bf16 v[48:63], a[180:183], a[124:127], v[48:63]
    ds_read_b64_tr_b16 a[204:205], v83 offset:3072
    ds_read_b64_tr_b16 a[206:207], v83 offset:4608
    buffer_load_dwordx4 v[64:67], v121, s[64:67], s46 offen
    buffer_load_dwordx4 v[68:71], v121, s[64:67], s47 offen
    s_waitcnt lgkmcnt(10)
    v_mfma_f32_32x32x16_bf16 v[128:143], a[184:187], a[124:127], v[128:143]
    ds_read_b64_tr_b16 a[176:177], v83 offset:3136
    ds_read_b64_tr_b16 a[178:179], v83 offset:4672
    buffer_load_dwordx2 v[126:127], v122, s[64:67], s59 offen
    s_waitcnt lgkmcnt(10)
    v_mfma_f32_32x32x16_bf16 v[144:159], a[188:191], a[124:127], v[144:159]
    ds_read_b64_tr_b16 a[180:181], v83 offset:3200
    ds_read_b64_tr_b16 a[182:183], v83 offset:4736
    s_waitcnt lgkmcnt(10)
    v_mfma_f32_32x32x16_bf16 v[48:63], a[192:195], a[128:131], v[48:63]
    s_waitcnt vmcnt(19)
    s_barrier
    ds_read_b64_tr_b16 a[184:185], v83 offset:6144
    ds_read_b64_tr_b16 a[186:187], v83 offset:7680
    s_waitcnt lgkmcnt(10)
    v_mfma_f32_32x32x16_bf16 v[128:143], a[196:199], a[128:131], v[128:143]
    ds_read_b64_tr_b16 a[188:189], v83 offset:6208
    ds_read_b64_tr_b16 a[190:191], v83 offset:7744
    s_add_u32 m0, s53, 0
    s_waitcnt lgkmcnt(10)
    v_mfma_f32_32x32x16_bf16 v[144:159], a[200:203], a[128:131], v[144:159]
    ds_read_b64_tr_b16 a[192:193], v83 offset:6272
    ds_read_b64_tr_b16 a[194:195], v83 offset:7808
    buffer_load_dwordx4 v72, s[48:51], s52 offen lds
    s_waitcnt lgkmcnt(10)
    v_mfma_f32_32x32x16_bf16 v[48:63], a[204:207], a[132:135], v[48:63]
    ds_read_b64_tr_b16 a[196:197], v83 offset:9216
    ds_read_b64_tr_b16 a[198:199], v83 offset:10752
    s_add_u32 s35, s73, 8192
    buffer_load_dwordx4 a[216:219], v210, s[24:27], s35 offen offset:2048 sc1
    s_add_u32 s34, s75, 0
    buffer_load_dwordx4 v[0:3], v210, s[24:27], s34 offen sc1
    s_waitcnt lgkmcnt(10)
    v_mfma_f32_32x32x16_bf16 v[128:143], a[176:179], a[132:135], v[128:143]
    ds_read_b64_tr_b16 a[200:201], v83 offset:9280
    ds_read_b64_tr_b16 a[202:203], v83 offset:10816
    s_add_u32 m0, s53, 1024
    s_waitcnt lgkmcnt(10)
    v_mfma_f32_32x32x16_bf16 v[144:159], a[180:183], a[132:135], v[144:159]
    ds_read_b64_tr_b16 a[204:205], v83 offset:9344
    ds_read_b64_tr_b16 a[206:207], v83 offset:10880
    buffer_load_dwordx4 v73, s[48:51], s52 offen lds
    s_waitcnt lgkmcnt(10)
    v_mfma_f32_32x32x16_bf16 v[48:63], a[184:187], a[136:139], v[48:63]
    ds_read_b64_tr_b16 a[176:177], v83 offset:12288
    ds_read_b64_tr_b16 a[178:179], v83 offset:13824
    s_waitcnt lgkmcnt(10)
    v_mfma_f32_32x32x16_bf16 v[128:143], a[188:191], a[136:139], v[128:143]
    ds_read_b64_tr_b16 a[180:181], v83 offset:12352
    ds_read_b64_tr_b16 a[182:183], v83 offset:13888
    s_add_u32 s34, s75, 2359296
    buffer_load_dwordx4 v[4:7], v210, s[24:27], s34 offen sc1
    s_waitcnt lgkmcnt(10)
    v_mfma_f32_32x32x16_bf16 v[144:159], a[192:195], a[136:139], v[144:159]
    ds_read_b64_tr_b16 a[184:185], v83 offset:12416
    ds_read_b64_tr_b16 a[186:187], v83 offset:13952
    s_add_u32 m0, s53, 2048
    s_add_u32 s35, s73, 8192
    buffer_load_dwordx4 a[220:223], v210, s[24:27], s35 offen offset:3072 sc1
    s_waitcnt lgkmcnt(10)
    v_mfma_f32_32x32x16_bf16 v[48:63], a[196:199], a[140:143], v[48:63]
    ds_read_b64_tr_b16 a[188:189], v83 offset:15360
    ds_read_b64_tr_b16 a[190:191], v83 offset:16896
    buffer_load_dwordx4 v74, s[48:51], s52 offen lds
    s_waitcnt lgkmcnt(10)
    v_mfma_f32_32x32x16_bf16 v[128:143], a[200:203], a[140:143], v[128:143]
    ds_read_b64_tr_b16 a[192:193], v83 offset:15424
    ds_read_b64_tr_b16 a[194:195], v83 offset:16960
    s_waitcnt lgkmcnt(10)
    v_mfma_f32_32x32x16_bf16 v[144:159], a[204:207], a[140:143], v[144:159]
    ds_read_b64_tr_b16 a[196:197], v83 offset:15488
    ds_read_b64_tr_b16 a[198:199], v83 offset:17024
    s_add_u32 s34, s75, 4718592
    buffer_load_dwordx4 v[8:11], v210, s[24:27], s34 offen sc1
    s_waitcnt lgkmcnt(10)
    v_mfma_f32_32x32x16_bf16 v[48:63], a[176:179], a[144:147], v[48:63]
    ds_read_b64_tr_b16 a[200:201], v83 offset:18432
    ds_read_b64_tr_b16 a[202:203], v83 offset:19968
    s_add_u32 m0, s53, 3072
    s_waitcnt lgkmcnt(10)
    v_mfma_f32_32x32x16_bf16 v[128:143], a[180:183], a[144:147], v[128:143]
    ds_read_b64_tr_b16 a[204:205], v83 offset:18496
    ds_read_b64_tr_b16 a[206:207], v83 offset:20032
    buffer_load_dwordx4 v75, s[48:51], s52 offen lds
    s_add_u32 s35, s73, 0
    buffer_load_dwordx4 a[0:3], v210, s[24:27], s35 offen offset:0 sc1
    s_waitcnt lgkmcnt(10)
    v_mfma_f32_32x32x16_bf16 v[144:159], a[184:187], a[144:147], v[144:159]
    ds_read_b64_tr_b16 a[176:177], v83 offset:18560
    ds_read_b64_tr_b16 a[178:179], v83 offset:20096
    s_waitcnt lgkmcnt(10)
    v_mfma_f32_32x32x16_bf16 v[48:63], a[188:191], a[148:151], v[48:63]
    ds_read_b64_tr_b16 a[180:181], v83 offset:21504
    ds_read_b64_tr_b16 a[182:183], v83 offset:23040
    s_add_u32 m0, s53, 4096
    s_add_u32 s34, s75, 7077888
    buffer_load_dwordx4 v[12:15], v210, s[24:27], s34 offen sc1
    s_waitcnt lgkmcnt(10)
    v_mfma_f32_32x32x16_bf16 v[128:143], a[192:195], a[148:151], v[128:143]
    ds_read_b64_tr_b16 a[184:185], v83 offset:21568
    ds_read_b64_tr_b16 a[186:187], v83 offset:23104
    buffer_load_dwordx4 v76, s[48:51], s52 offen lds
    s_waitcnt lgkmcnt(10)
    v_mfma_f32_32x32x16_bf16 v[144:159], a[196:199], a[148:151], v[144:159]
    ds_read_b64_tr_b16 a[188:189], v83 offset:21632
    ds_read_b64_tr_b16 a[190:191], v83 offset:23168
    s_waitcnt lgkmcnt(10)
    v_mfma_f32_32x32x16_bf16 v[48:63], a[200:203], a[152:155], v[48:63]
    ds_read_b64_tr_b16 a[192:193], v83 offset:24576
    ds_read_b64_tr_b16 a[194:195], v83 offset:26112
    s_add_u32 s35, s73, 0
    buffer_load_dwordx4 a[4:7], v210, s[24:27], s35 offen offset:1024 sc1
    s_waitcnt lgkmcnt(10)
    v_mfma_f32_32x32x16_bf16 v[128:143], a[204:207], a[152:155], v[128:143]
    ds_read_b64_tr_b16 a[196:197], v83 offset:24640
    ds_read_b64_tr_b16 a[198:199], v83 offset:26176
    s_add_u32 m0, s53, 5120
    s_add_u32 s34, s75, 9437184
    buffer_load_dwordx4 v[16:19], v210, s[24:27], s34 offen sc1
    s_waitcnt lgkmcnt(10)
    v_mfma_f32_32x32x16_bf16 v[144:159], a[176:179], a[152:155], v[144:159]
    ds_read_b64_tr_b16 a[200:201], v83 offset:24704
    ds_read_b64_tr_b16 a[202:203], v83 offset:26240
    buffer_load_dwordx4 v77, s[48:51], s52 offen lds
    s_waitcnt lgkmcnt(10)
    v_mfma_f32_32x32x16_bf16 v[48:63], a[180:183], a[156:159], v[48:63]
    ds_read_b64_tr_b16 a[204:205], v83 offset:27648
    ds_read_b64_tr_b16 a[206:207], v83 offset:29184
    s_waitcnt lgkmcnt(10)
    v_mfma_f32_32x32x16_bf16 v[128:143], a[184:187], a[156:159], v[128:143]
    ds_read_b64_tr_b16 a[176:177], v83 offset:27712
    ds_read_b64_tr_b16 a[178:179], v83 offset:29248
    s_waitcnt lgkmcnt(10)
    v_mfma_f32_32x32x16_bf16 v[144:159], a[188:191], a[156:159], v[144:159]
    ds_read_b64_tr_b16 a[180:181], v83 offset:27776
    ds_read_b64_tr_b16 a[182:183], v83 offset:29312
    s_add_u32 m0, s53, 6144
    s_add_u32 s35, s73, 0
    buffer_load_dwordx4 a[8:11], v210, s[24:27], s35 offen offset:2048 sc1
    s_add_u32 s34, s75, 11796480
    buffer_load_dwordx4 v[20:23], v210, s[24:27], s34 offen sc1
    s_waitcnt lgkmcnt(10)
    v_mfma_f32_32x32x16_bf16 v[48:63], a[192:195], a[160:163], v[48:63]
    ds_read_b64_tr_b16 a[184:185], v83 offset:30720
    ds_read_b64_tr_b16 a[186:187], v83 offset:32256
    buffer_load_dwordx4 v78, s[48:51], s52 offen lds
    s_waitcnt lgkmcnt(10)
    v_mfma_f32_32x32x16_bf16 v[128:143], a[196:199], a[160:163], v[128:143]
    ds_read_b64_tr_b16 a[188:189], v83 offset:30784
    ds_read_b64_tr_b16 a[190:191], v83 offset:32320
    s_waitcnt lgkmcnt(10)
    v_mfma_f32_32x32x16_bf16 v[144:159], a[200:203], a[160:163], v[144:159]
    ds_read_b64_tr_b16 a[192:193], v83 offset:30848
    ds_read_b64_tr_b16 a[194:195], v83 offset:32384
    s_add_u32 m0, s53, 7168
    s_waitcnt lgkmcnt(10)
    v_mfma_f32_32x32x16_bf16 v[48:63], a[204:207], a[164:167], v[48:63]
    ds_read_b64_tr_b16 a[196:197], v83 offset:33792
    ds_read_b64_tr_b16 a[198:199], v83 offset:35328
    buffer_load_dwordx4 v79, s[48:51], s52 offen lds
    s_add_u32 s34, s75, 14155776
    buffer_load_dwordx4 v[24:27], v210, s[24:27], s34 offen sc1
    s_waitcnt lgkmcnt(10)
    v_mfma_f32_32x32x16_bf16 v[128:143], a[176:179], a[164:167], v[128:143]
    ds_read_b64_tr_b16 a[200:201], v83 offset:33856
    ds_read_b64_tr_b16 a[202:203], v83 offset:35392
    s_add_u32 s35, s73, 0
    buffer_load_dwordx4 a[12:15], v210, s[24:27], s35 offen offset:3072 sc1
    s_waitcnt lgkmcnt(10)
    v_mfma_f32_32x32x16_bf16 v[144:159], a[180:183], a[164:167], v[144:159]
    ds_read_b64_tr_b16 a[204:205], v83 offset:33920
    ds_read_b64_tr_b16 a[206:207], v83 offset:35456
    s_waitcnt lgkmcnt(10)
    v_mfma_f32_32x32x16_bf16 v[48:63], a[184:187], a[168:171], v[48:63]
    ds_read_b64_tr_b16 a[176:177], v84 offset:0
    ds_read_b64_tr_b16 a[178:179], v84 offset:1536
    s_add_u32 m0, s53, 8192
    s_waitcnt lgkmcnt(10)
    v_mfma_f32_32x32x16_bf16 v[128:143], a[188:191], a[168:171], v[128:143]
    ds_read_b64_tr_b16 a[180:181], v84 offset:64
    ds_read_b64_tr_b16 a[182:183], v84 offset:1600
    buffer_load_dwordx4 v80, s[48:51], s52 offen lds
    s_sub_u32 s52, s52, 442176
    s_add_u32 s34, s75, 16515072
    buffer_load_dwordx4 v[28:31], v210, s[24:27], s34 offen sc1
    s_waitcnt lgkmcnt(10)
    v_mfma_f32_32x32x16_bf16 v[144:159], a[192:195], a[168:171], v[144:159]
    ds_read_b64_tr_b16 a[184:185], v84 offset:128
    ds_read_b64_tr_b16 a[186:187], v84 offset:1664
    s_waitcnt lgkmcnt(10)
    v_mfma_f32_32x32x16_bf16 v[48:63], a[196:199], a[172:175], v[48:63]
    ds_read_b64_tr_b16 a[188:189], v84 offset:3072
    ds_read_b64_tr_b16 a[190:191], v84 offset:4608
    s_waitcnt lgkmcnt(10)
    v_mfma_f32_32x32x16_bf16 v[128:143], a[200:203], a[172:175], v[128:143]
    ds_read_b64_tr_b16 a[192:193], v84 offset:3136
    ds_read_b64_tr_b16 a[194:195], v84 offset:4672
    s_waitcnt lgkmcnt(10)
    v_mfma_f32_32x32x16_bf16 v[144:159], a[204:207], a[172:175], v[144:159]
    ds_read_b64_tr_b16 a[196:197], v84 offset:3200
    ds_read_b64_tr_b16 a[198:199], v84 offset:4736
    s_waitcnt lgkmcnt(10)
    v_mfma_f32_32x32x16_bf16 v[160:175], a[176:179], a[32:35], 0
    s_waitcnt vmcnt(26)
    s_barrier
    ds_read_b64_tr_b16 a[200:201], v84 offset:6144
    ds_read_b64_tr_b16 a[202:203], v84 offset:7680
    s_waitcnt lgkmcnt(10)
    v_mfma_f32_32x32x16_bf16 v[176:191], a[180:183], a[32:35], 0
    ds_read_b64_tr_b16 a[204:205], v84 offset:6208
    ds_read_b64_tr_b16 a[206:207], v84 offset:7744
    s_add_u32 m0, s77, 0
    s_waitcnt lgkmcnt(10)
    v_mfma_f32_32x32x16_bf16 v[192:207], a[184:187], a[32:35], 0
    ds_read_b64_tr_b16 a[176:177], v84 offset:6272
    ds_read_b64_tr_b16 a[178:179], v84 offset:7808
    buffer_load_dwordx4 v112, s[60:63], s76 offen lds
    s_waitcnt lgkmcnt(10)
    v_mfma_f32_32x32x16_bf16 v[160:175], a[188:191], a[36:39], v[160:175]
    ds_read_b64_tr_b16 a[180:181], v84 offset:9216
    ds_read_b64_tr_b16 a[182:183], v84 offset:10752
    s_waitcnt lgkmcnt(10)
    v_mfma_f32_32x32x16_bf16 v[176:191], a[192:195], a[36:39], v[176:191]
    ds_read_b64_tr_b16 a[184:185], v84 offset:9280
    ds_read_b64_tr_b16 a[186:187], v84 offset:10816
    v_cvt_pk_bf16_f32 v104, v48, v49
    v_cvt_pk_bf16_f32 v105, v50, v51
    s_waitcnt lgkmcnt(10)
    v_mfma_f32_32x32x16_bf16 v[192:207], a[196:199], a[36:39], v[192:207]
    ds_read_b64_tr_b16 a[188:189], v84 offset:9344
    ds_read_b64_tr_b16 a[190:191], v84 offset:10880
    s_add_u32 m0, s77, 1024
    v_cvt_pk_bf16_f32 v106, v56, v57
    s_waitcnt lgkmcnt(10)
    v_mfma_f32_32x32x16_bf16 v[160:175], a[200:203], a[40:43], v[160:175]
    ds_read_b64_tr_b16 a[192:193], v84 offset:12288
    ds_read_b64_tr_b16 a[194:195], v84 offset:13824
    buffer_load_dwordx4 v113, s[60:63], s76 offen lds
    v_cvt_pk_bf16_f32 v107, v58, v59
    s_waitcnt lgkmcnt(10)
    v_mfma_f32_32x32x16_bf16 v[176:191], a[204:207], a[40:43], v[176:191]
    ds_read_b64_tr_b16 a[196:197], v84 offset:12352
    ds_read_b64_tr_b16 a[198:199], v84 offset:13888
    buffer_store_dwordx4 v[104:107], v86, s[24:27], s57 offen offset:0 sc1
    s_waitcnt lgkmcnt(10)
    v_mfma_f32_32x32x16_bf16 v[192:207], a[176:179], a[40:43], v[192:207]
    ds_read_b64_tr_b16 a[200:201], v84 offset:12416
    ds_read_b64_tr_b16 a[202:203], v84 offset:13952
    v_cvt_pk_bf16_f32 v108, v52, v53
    s_waitcnt lgkmcnt(10)
    v_mfma_f32_32x32x16_bf16 v[160:175], a[180:183], a[44:47], v[160:175]
    ds_read_b64_tr_b16 a[204:205], v84 offset:15360
    ds_read_b64_tr_b16 a[206:207], v84 offset:16896
    s_add_u32 m0, s77, 2048
    v_cvt_pk_bf16_f32 v109, v54, v55
    s_waitcnt lgkmcnt(10)
    v_mfma_f32_32x32x16_bf16 v[176:191], a[184:187], a[44:47], v[176:191]
    ds_read_b64_tr_b16 a[176:177], v84 offset:15424
    ds_read_b64_tr_b16 a[178:179], v84 offset:16960
    buffer_load_dwordx4 v114, s[60:63], s76 offen lds
    v_cvt_pk_bf16_f32 v110, v60, v61
    s_waitcnt lgkmcnt(10)
    v_mfma_f32_32x32x16_bf16 v[192:207], a[188:191], a[44:47], v[192:207]
    ds_read_b64_tr_b16 a[180:181], v84 offset:15488
    ds_read_b64_tr_b16 a[182:183], v84 offset:17024
    v_cvt_pk_bf16_f32 v111, v62, v63
    s_waitcnt lgkmcnt(10)
    v_mfma_f32_32x32x16_bf16 v[160:175], a[192:195], a[48:51], v[160:175]
    ds_read_b64_tr_b16 a[184:185], v84 offset:18432
    ds_read_b64_tr_b16 a[186:187], v84 offset:19968
    buffer_store_dwordx4 v[108:111], v86, s[24:27], s57 offen offset:512 sc1
    s_waitcnt lgkmcnt(10)
    v_mfma_f32_32x32x16_bf16 v[176:191], a[196:199], a[48:51], v[176:191]
    ds_read_b64_tr_b16 a[188:189], v84 offset:18496
    ds_read_b64_tr_b16 a[190:191], v84 offset:20032
    s_add_u32 m0, s77, 3072
    s_add_u32 s57, s57, 1024
    s_waitcnt lgkmcnt(10)
    v_mfma_f32_32x32x16_bf16 v[192:207], a[200:203], a[48:51], v[192:207]
    ds_read_b64_tr_b16 a[192:193], v84 offset:18560
    ds_read_b64_tr_b16 a[194:195], v84 offset:20096
    buffer_load_dwordx4 v115, s[60:63], s76 offen lds
    v_cvt_pk_bf16_f32 v96, v128, v129
    v_cvt_pk_bf16_f32 v97, v130, v131
    s_waitcnt lgkmcnt(10)
    v_mfma_f32_32x32x16_bf16 v[160:175], a[204:207], a[52:55], v[160:175]
    ds_read_b64_tr_b16 a[196:197], v84 offset:21504
    ds_read_b64_tr_b16 a[198:199], v84 offset:23040
    v_cvt_pk_bf16_f32 v98, v136, v137
    s_waitcnt lgkmcnt(10)
    v_mfma_f32_32x32x16_bf16 v[176:191], a[176:179], a[52:55], v[176:191]
    ds_read_b64_tr_b16 a[200:201], v84 offset:21568
    ds_read_b64_tr_b16 a[202:203], v84 offset:23104
    v_cvt_pk_bf16_f32 v99, v138, v139
    s_waitcnt lgkmcnt(10)
    v_mfma_f32_32x32x16_bf16 v[192:207], a[180:183], a[52:55], v[192:207]
    ds_read_b64_tr_b16 a[204:205], v84 offset:21632
    ds_read_b64_tr_b16 a[206:207], v84 offset:23168
    s_add_u32 m0, s77, 4096
    buffer_store_dwordx4 v[96:99], v86, s[24:27], s57 offen offset:0 sc1
    s_waitcnt lgkmcnt(10)
    v_mfma_f32_32x32x16_bf16 v[160:175], a[184:187], a[56:59], v[160:175]
    ds_read_b64_tr_b16 a[176:177], v84 offset:24576
    ds_read_b64_tr_b16 a[178:179], v84 offset:26112
    buffer_load_dwordx4 v116, s[60:63], s76 offen lds
    s_sub_u32 s77, s77, 20480
    s_sub_u32 s76, s76, 165888
    v_cvt_pk_bf16_f32 v100, v132, v133
    s_waitcnt lgkmcnt(10)
    v_mfma_f32_32x32x16_bf16 v[176:191], a[188:191], a[56:59], v[176:191]
    ds_read_b64_tr_b16 a[180:181], v84 offset:24640
    ds_read_b64_tr_b16 a[182:183], v84 offset:26176
    v_cvt_pk_bf16_f32 v101, v134, v135
    s_waitcnt lgkmcnt(10)
    v_mfma_f32_32x32x16_bf16 v[192:207], a[192:195], a[56:59], v[192:207]
    ds_read_b64_tr_b16 a[184:185], v84 offset:24704
    ds_read_b64_tr_b16 a[186:187], v84 offset:26240
    v_cvt_pk_bf16_f32 v102, v140, v141
    s_waitcnt lgkmcnt(10)
    v_mfma_f32_32x32x16_bf16 v[160:175], a[196:199], a[60:63], v[160:175]
    ds_read_b64_tr_b16 a[188:189], v84 offset:27648
    ds_read_b64_tr_b16 a[190:191], v84 offset:29184
    s_mov_b32 m0, s40
    v_cvt_pk_bf16_f32 v103, v142, v143
    s_waitcnt lgkmcnt(10)
    v_mfma_f32_32x32x16_bf16 v[176:191], a[200:203], a[60:63], v[176:191]
    ds_read_b64_tr_b16 a[192:193], v84 offset:27712
    ds_read_b64_tr_b16 a[194:195], v84 offset:29248
    buffer_load_dwordx4 v117, s[60:63], s78 offen lds
    buffer_store_dwordx4 v[100:103], v86, s[24:27], s57 offen offset:512 sc1
    s_waitcnt lgkmcnt(10)
    v_mfma_f32_32x32x16_bf16 v[192:207], a[204:207], a[60:63], v[192:207]
    ds_read_b64_tr_b16 a[196:197], v84 offset:27776
    ds_read_b64_tr_b16 a[198:199], v84 offset:29312
    s_add_u32 s57, s57, 1024
    s_waitcnt lgkmcnt(10)
    v_mfma_f32_32x32x16_bf16 v[160:175], a[176:179], a[64:67], v[160:175]
    ds_read_b64_tr_b16 a[200:201], v84 offset:30720
    ds_read_b64_tr_b16 a[202:203], v84 offset:32256
    v_cvt_pk_bf16_f32 v104, v144, v145
    v_cvt_pk_bf16_f32 v105, v146, v147
    s_waitcnt lgkmcnt(10)
    v_mfma_f32_32x32x16_bf16 v[176:191], a[180:183], a[64:67], v[176:191]
    ds_read_b64_tr_b16 a[204:205], v84 offset:30784
    ds_read_b64_tr_b16 a[206:207], v84 offset:32320
    s_mov_b32 m0, s41
    v_cvt_pk_bf16_f32 v106, v152, v153
    s_waitcnt lgkmcnt(10)
    v_mfma_f32_32x32x16_bf16 v[192:207], a[184:187], a[64:67], v[192:207]
    ds_read_b64_tr_b16 a[176:177], v84 offset:30848
    ds_read_b64_tr_b16 a[178:179], v84 offset:32384
    buffer_load_dwordx4 v118, s[60:63], s78 offen lds
    v_cvt_pk_bf16_f32 v107, v154, v155
    s_waitcnt lgkmcnt(10)
    v_mfma_f32_32x32x16_bf16 v[160:175], a[188:191], a[68:71], v[160:175]
    ds_read_b64_tr_b16 a[180:181], v84 offset:33792
    ds_read_b64_tr_b16 a[182:183], v84 offset:35328
    buffer_store_dwordx4 v[104:107], v86, s[24:27], s57 offen offset:0 sc1
    s_waitcnt lgkmcnt(10)
    v_mfma_f32_32x32x16_bf16 v[176:191], a[192:195], a[68:71], v[176:191]
    ds_read_b64_tr_b16 a[184:185], v84 offset:33856
    ds_read_b64_tr_b16 a[186:187], v84 offset:35392
    v_cvt_pk_bf16_f32 v108, v148, v149
    s_waitcnt lgkmcnt(10)
    v_mfma_f32_32x32x16_bf16 v[192:207], a[196:199], a[68:71], v[192:207]
    ds_read_b64_tr_b16 a[188:189], v84 offset:33920
    ds_read_b64_tr_b16 a[190:191], v84 offset:35456
    s_mov_b32 m0, s42
    v_cvt_pk_bf16_f32 v109, v150, v151
    s_waitcnt lgkmcnt(10)
    v_mfma_f32_32x32x16_bf16 v[160:175], a[200:203], a[72:75], v[160:175]
    ds_read_b64_tr_b16 a[192:193], v85 offset:0
    ds_read_b64_tr_b16 a[194:195], v85 offset:1536
    buffer_load_dwordx4 v119, s[60:63], s78 offen lds
    v_cvt_pk_bf16_f32 v110, v156, v157
    s_waitcnt lgkmcnt(10)
    v_mfma_f32_32x32x16_bf16 v[176:191], a[204:207], a[72:75], v[176:191]
    ds_read_b64_tr_b16 a[196:197], v85 offset:64
    ds_read_b64_tr_b16 a[198:199], v85 offset:1600
    v_cvt_pk_bf16_f32 v111, v158, v159
    s_waitcnt lgkmcnt(10)
    v_mfma_f32_32x32x16_bf16 v[192:207], a[176:179], a[72:75], v[192:207]
    ds_read_b64_tr_b16 a[200:201], v85 offset:128
    ds_read_b64_tr_b16 a[202:203], v85 offset:1664
    buffer_store_dwordx4 v[108:111], v86, s[24:27], s57 offen offset:512 sc1
    s_waitcnt lgkmcnt(10)
    v_mfma_f32_32x32x16_bf16 v[160:175], a[180:183], a[76:79], v[160:175]
    ds_read_b64_tr_b16 a[204:205], v85 offset:3072
    ds_read_b64_tr_b16 a[206:207], v85 offset:4608
    s_add_u32 s57, s57, 1024
    s_waitcnt lgkmcnt(10)
    v_mfma_f32_32x32x16_bf16 v[176:191], a[184:187], a[76:79], v[176:191]
    ds_read_b64_tr_b16 a[176:177], v85 offset:3136
    ds_read_b64_tr_b16 a[178:179], v85 offset:4672
    s_waitcnt lgkmcnt(10)
    v_mfma_f32_32x32x16_bf16 v[192:207], a[188:191], a[76:79], v[192:207]
    ds_read_b64_tr_b16 a[180:181], v85 offset:3200
    ds_read_b64_tr_b16 a[182:183], v85 offset:4736
    s_waitcnt lgkmcnt(10)
    v_mfma_f32_32x32x16_bf16 v[160:175], a[192:195], a[80:83], v[160:175]
    s_waitcnt vmcnt(15)
    s_barrier
    ds_read_b64_tr_b16 a[184:185], v85 offset:6144
    ds_read_b64_tr_b16 a[186:187], v85 offset:7680
    s_waitcnt lgkmcnt(10)
    v_mfma_f32_32x32x16_bf16 v[176:191], a[196:199], a[80:83], v[176:191]
    ds_read_b64_tr_b16 a[188:189], v85 offset:6208
    ds_read_b64_tr_b16 a[190:191], v85 offset:7744
    s_add_u32 m0, s77, 0
    s_waitcnt lgkmcnt(10)
    v_mfma_f32_32x32x16_bf16 v[192:207], a[200:203], a[80:83], v[192:207]
    ds_read_b64_tr_b16 a[192:193], v85 offset:6272
    ds_read_b64_tr_b16 a[194:195], v85 offset:7808
    buffer_load_dwordx4 v112, s[60:63], s76 offen lds
    s_waitcnt lgkmcnt(10)
    v_mfma_f32_32x32x16_bf16 v[160:175], a[204:207], a[84:87], v[160:175]
    ds_read_b64_tr_b16 a[196:197], v85 offset:9216
    ds_read_b64_tr_b16 a[198:199], v85 offset:10752
    s_waitcnt lgkmcnt(10)
    v_mfma_f32_32x32x16_bf16 v[176:191], a[176:179], a[84:87], v[176:191]
    ds_read_b64_tr_b16 a[200:201], v85 offset:9280
    ds_read_b64_tr_b16 a[202:203], v85 offset:10816
    s_add_u32 m0, s77, 1024
    s_waitcnt lgkmcnt(10)
    v_mfma_f32_32x32x16_bf16 v[192:207], a[180:183], a[84:87], v[192:207]
    ds_read_b64_tr_b16 a[204:205], v85 offset:9344
    ds_read_b64_tr_b16 a[206:207], v85 offset:10880
    buffer_load_dwordx4 v113, s[60:63], s76 offen lds
    s_waitcnt lgkmcnt(10)
    v_mfma_f32_32x32x16_bf16 v[160:175], a[184:187], a[88:91], v[160:175]
    ds_read_b64_tr_b16 a[176:177], v85 offset:12288
    ds_read_b64_tr_b16 a[178:179], v85 offset:13824
    s_waitcnt lgkmcnt(10)
    v_mfma_f32_32x32x16_bf16 v[176:191], a[188:191], a[88:91], v[176:191]
    ds_read_b64_tr_b16 a[180:181], v85 offset:12352
    ds_read_b64_tr_b16 a[182:183], v85 offset:13888
    s_add_u32 m0, s77, 2048
    s_waitcnt lgkmcnt(10)
    v_mfma_f32_32x32x16_bf16 v[192:207], a[192:195], a[88:91], v[192:207]
    ds_read_b64_tr_b16 a[184:185], v85 offset:12416
    ds_read_b64_tr_b16 a[186:187], v85 offset:13952
    buffer_load_dwordx4 v114, s[60:63], s76 offen lds
    s_waitcnt lgkmcnt(10)
    v_mfma_f32_32x32x16_bf16 v[160:175], a[196:199], a[92:95], v[160:175]
    ds_read_b64_tr_b16 a[188:189], v85 offset:15360
    ds_read_b64_tr_b16 a[190:191], v85 offset:16896
    s_waitcnt lgkmcnt(10)
    v_mfma_f32_32x32x16_bf16 v[176:191], a[200:203], a[92:95], v[176:191]
    ds_read_b64_tr_b16 a[192:193], v85 offset:15424
    ds_read_b64_tr_b16 a[194:195], v85 offset:16960
    s_add_u32 m0, s77, 3072
    s_waitcnt lgkmcnt(10)
    v_mfma_f32_32x32x16_bf16 v[192:207], a[204:207], a[92:95], v[192:207]
    ds_read_b64_tr_b16 a[196:197], v85 offset:15488
    ds_read_b64_tr_b16 a[198:199], v85 offset:17024
    buffer_load_dwordx4 v115, s[60:63], s76 offen lds
    s_waitcnt lgkmcnt(10)
    v_mfma_f32_32x32x16_bf16 v[160:175], a[176:179], a[96:99], v[160:175]
    ds_read_b64_tr_b16 a[200:201], v85 offset:18432
    ds_read_b64_tr_b16 a[202:203], v85 offset:19968
    s_waitcnt lgkmcnt(10)
    v_mfma_f32_32x32x16_bf16 v[176:191], a[180:183], a[96:99], v[176:191]
    ds_read_b64_tr_b16 a[204:205], v85 offset:18496
    ds_read_b64_tr_b16 a[206:207], v85 offset:20032
    s_waitcnt lgkmcnt(10)
    v_mfma_f32_32x32x16_bf16 v[192:207], a[184:187], a[96:99], v[192:207]
    ds_read_b64_tr_b16 a[176:177], v85 offset:18560
    ds_read_b64_tr_b16 a[178:179], v85 offset:20096
    s_add_u32 m0, s77, 4096
    s_waitcnt lgkmcnt(10)
    v_mfma_f32_32x32x16_bf16 v[160:175], a[188:191], a[100:103], v[160:175]
    ds_read_b64_tr_b16 a[180:181], v85 offset:21504
    ds_read_b64_tr_b16 a[182:183], v85 offset:23040
    buffer_load_dwordx4 v116, s[60:63], s76 offen lds
    s_sub_u32 s77, s77, 20480
    s_sub_u32 s76, s76, 165888
    s_waitcnt lgkmcnt(10)
    v_mfma_f32_32x32x16_bf16 v[176:191], a[192:195], a[100:103], v[176:191]
    ds_read_b64_tr_b16 a[184:185], v85 offset:21568
    ds_read_b64_tr_b16 a[186:187], v85 offset:23104
    s_waitcnt lgkmcnt(10)
    v_mfma_f32_32x32x16_bf16 v[192:207], a[196:199], a[100:103], v[192:207]
    ds_read_b64_tr_b16 a[188:189], v85 offset:21632
    ds_read_b64_tr_b16 a[190:191], v85 offset:23168
    s_add_u32 m0, s77, 0
    s_waitcnt lgkmcnt(10)
    v_mfma_f32_32x32x16_bf16 v[160:175], a[200:203], a[104:107], v[160:175]
    ds_read_b64_tr_b16 a[192:193], v85 offset:24576
    ds_read_b64_tr_b16 a[194:195], v85 offset:26112
    buffer_load_dwordx4 v112, s[60:63], s76 offen lds
    s_waitcnt lgkmcnt(10)
    v_mfma_f32_32x32x16_bf16 v[176:191], a[204:207], a[104:107], v[176:191]
    ds_read_b64_tr_b16 a[196:197], v85 offset:24640
    ds_read_b64_tr_b16 a[198:199], v85 offset:26176
    s_waitcnt lgkmcnt(10)
    v_mfma_f32_32x32x16_bf16 v[192:207], a[176:179], a[104:107], v[192:207]
    ds_read_b64_tr_b16 a[200:201], v85 offset:24704
    ds_read_b64_tr_b16 a[202:203], v85 offset:26240
    s_add_u32 m0, s77, 1024
    s_waitcnt lgkmcnt(10)
    v_mfma_f32_32x32x16_bf16 v[160:175], a[180:183], a[108:111], v[160:175]
    ds_read_b64_tr_b16 a[204:205], v85 offset:27648
    ds_read_b64_tr_b16 a[206:207], v85 offset:29184
    buffer_load_dwordx4 v113, s[60:63], s76 offen lds
    s_waitcnt lgkmcnt(10)
    v_mfma_f32_32x32x16_bf16 v[176:191], a[184:187], a[108:111], v[176:191]
    ds_read_b64_tr_b16 a[176:177], v85 offset:27712
    ds_read_b64_tr_b16 a[178:179], v85 offset:29248
    s_waitcnt lgkmcnt(10)
    v_mfma_f32_32x32x16_bf16 v[192:207], a[188:191], a[108:111], v[192:207]
    ds_read_b64_tr_b16 a[180:181], v85 offset:27776
    ds_read_b64_tr_b16 a[182:183], v85 offset:29312
    s_waitcnt lgkmcnt(10)
    v_mfma_f32_32x32x16_bf16 v[160:175], a[192:195], a[112:115], v[160:175]
    ds_read_b64_tr_b16 a[184:185], v85 offset:30720
    ds_read_b64_tr_b16 a[186:187], v85 offset:32256
    s_add_u32 m0, s77, 2048
    s_waitcnt lgkmcnt(10)
    v_mfma_f32_32x32x16_bf16 v[176:191], a[196:199], a[112:115], v[176:191]
    ds_read_b64_tr_b16 a[188:189], v85 offset:30784
    ds_read_b64_tr_b16 a[190:191], v85 offset:32320
    buffer_load_dwordx4 v114, s[60:63], s76 offen lds
    s_waitcnt lgkmcnt(10)
    v_mfma_f32_32x32x16_bf16 v[192:207], a[200:203], a[112:115], v[192:207]
    ds_read_b64_tr_b16 a[192:193], v85 offset:30848
    ds_read_b64_tr_b16 a[194:195], v85 offset:32384
    s_waitcnt lgkmcnt(10)
    v_mfma_f32_32x32x16_bf16 v[160:175], a[204:207], a[116:119], v[160:175]
    ds_read_b64_tr_b16 a[196:197], v85 offset:33792
    ds_read_b64_tr_b16 a[198:199], v85 offset:35328
    s_add_u32 m0, s77, 3072
    s_waitcnt lgkmcnt(10)
    v_mfma_f32_32x32x16_bf16 v[176:191], a[176:179], a[116:119], v[176:191]
    ds_read_b64_tr_b16 a[200:201], v85 offset:33856
    ds_read_b64_tr_b16 a[202:203], v85 offset:35392
    buffer_load_dwordx4 v115, s[60:63], s76 offen lds
    s_waitcnt lgkmcnt(10)
    v_mfma_f32_32x32x16_bf16 v[192:207], a[180:183], a[116:119], v[192:207]
    ds_read_b64_tr_b16 a[204:205], v85 offset:33920
    ds_read_b64_tr_b16 a[206:207], v85 offset:35456
    s_waitcnt lgkmcnt(10)
    v_mfma_f32_32x32x16_bf16 v[160:175], a[184:187], a[120:123], v[160:175]
    ds_read_b64_tr_b16 a[176:177], v82 offset:0
    ds_read_b64_tr_b16 a[178:179], v82 offset:1536
    s_add_u32 m0, s77, 4096
    s_waitcnt lgkmcnt(10)
    v_mfma_f32_32x32x16_bf16 v[176:191], a[188:191], a[120:123], v[176:191]
    ds_read_b64_tr_b16 a[180:181], v82 offset:64
    ds_read_b64_tr_b16 a[182:183], v82 offset:1600
    buffer_load_dwordx4 v116, s[60:63], s76 offen lds
    s_sub_u32 s77, s77, 20480
    s_sub_u32 s76, s76, 165888
    s_waitcnt lgkmcnt(10)
    v_mfma_f32_32x32x16_bf16 v[192:207], a[192:195], a[120:123], v[192:207]
    ds_read_b64_tr_b16 a[184:185], v82 offset:128
    ds_read_b64_tr_b16 a[186:187], v82 offset:1664
    s_waitcnt lgkmcnt(10)
    v_mfma_f32_32x32x16_bf16 v[160:175], a[196:199], a[124:127], v[160:175]
    ds_read_b64_tr_b16 a[188:189], v82 offset:3072
    ds_read_b64_tr_b16 a[190:191], v82 offset:4608
    s_waitcnt lgkmcnt(10)
    v_mfma_f32_32x32x16_bf16 v[176:191], a[200:203], a[124:127], v[176:191]
    ds_read_b64_tr_b16 a[192:193], v82 offset:3136
    ds_read_b64_tr_b16 a[194:195], v82 offset:4672
    s_waitcnt lgkmcnt(10)
    v_mfma_f32_32x32x16_bf16 v[192:207], a[204:207], a[124:127], v[192:207]
    ds_read_b64_tr_b16 a[196:197], v82 offset:3200
    ds_read_b64_tr_b16 a[198:199], v82 offset:4736
    s_waitcnt lgkmcnt(10)
    v_mfma_f32_32x32x16_bf16 v[160:175], a[176:179], a[128:131], v[160:175]
    s_barrier
    ds_read_b64_tr_b16 a[200:201], v82 offset:6144
    ds_read_b64_tr_b16 a[202:203], v82 offset:7680
    s_waitcnt lgkmcnt(10)
    v_mfma_f32_32x32x16_bf16 v[176:191], a[180:183], a[128:131], v[176:191]
    ds_read_b64_tr_b16 a[204:205], v82 offset:6208
    ds_read_b64_tr_b16 a[206:207], v82 offset:7744
    s_add_u32 m0, s77, 0
    s_nop 0
    buffer_load_dwordx4 v112, s[60:63], s76 offen lds
    s_waitcnt lgkmcnt(10)
    v_mfma_f32_32x32x16_bf16 v[192:207], a[184:187], a[128:131], v[192:207]
    ds_read_b64_tr_b16 a[176:177], v82 offset:6272
    ds_read_b64_tr_b16 a[178:179], v82 offset:7808
    s_waitcnt lgkmcnt(10)
    v_mfma_f32_32x32x16_bf16 v[160:175], a[188:191], a[132:135], v[160:175]
    ds_read_b64_tr_b16 a[180:181], v82 offset:9216
    ds_read_b64_tr_b16 a[182:183], v82 offset:10752
    s_add_u32 m0, s77, 1024
    s_nop 0
    buffer_load_dwordx4 v113, s[60:63], s76 offen lds
    s_waitcnt lgkmcnt(10)
    v_mfma_f32_32x32x16_bf16 v[176:191], a[192:195], a[132:135], v[176:191]
    ds_read_b64_tr_b16 a[184:185], v82 offset:9280
    ds_read_b64_tr_b16 a[186:187], v82 offset:10816
    s_waitcnt lgkmcnt(10)
    v_mfma_f32_32x32x16_bf16 v[192:207], a[196:199], a[132:135], v[192:207]
    ds_read_b64_tr_b16 a[188:189], v82 offset:9344
    ds_read_b64_tr_b16 a[190:191], v82 offset:10880
    s_waitcnt lgkmcnt(10)
    v_mfma_f32_32x32x16_bf16 v[160:175], a[200:203], a[136:139], v[160:175]
    ds_read_b64_tr_b16 a[192:193], v82 offset:12288
    ds_read_b64_tr_b16 a[194:195], v82 offset:13824
    s_add_u32 m0, s77, 2048
    s_nop 0
    buffer_load_dwordx4 v114, s[60:63], s76 offen lds
    s_waitcnt lgkmcnt(10)
    v_mfma_f32_32x32x16_bf16 v[176:191], a[204:207], a[136:139], v[176:191]
    ds_read_b64_tr_b16 a[196:197], v82 offset:12352
    ds_read_b64_tr_b16 a[198:199], v82 offset:13888
    s_waitcnt lgkmcnt(10)
    v_mfma_f32_32x32x16_bf16 v[192:207], a[176:179], a[136:139], v[192:207]
    ds_read_b64_tr_b16 a[200:201], v82 offset:12416
    ds_read_b64_tr_b16 a[202:203], v82 offset:13952
    s_waitcnt lgkmcnt(10)
    v_mfma_f32_32x32x16_bf16 v[160:175], a[180:183], a[140:143], v[160:175]
    ds_read_b64_tr_b16 a[204:205], v82 offset:15360
    ds_read_b64_tr_b16 a[206:207], v82 offset:16896
    s_add_u32 m0, s77, 3072
    s_nop 0
    buffer_load_dwordx4 v115, s[60:63], s76 offen lds
    s_waitcnt lgkmcnt(10)
    v_mfma_f32_32x32x16_bf16 v[176:191], a[184:187], a[140:143], v[176:191]
    ds_read_b64_tr_b16 a[176:177], v82 offset:15424
    ds_read_b64_tr_b16 a[178:179], v82 offset:16960
    s_waitcnt lgkmcnt(10)
    v_mfma_f32_32x32x16_bf16 v[192:207], a[188:191], a[140:143], v[192:207]
    ds_read_b64_tr_b16 a[180:181], v82 offset:15488
    ds_read_b64_tr_b16 a[182:183], v82 offset:17024
    s_waitcnt lgkmcnt(10)
    v_mfma_f32_32x32x16_bf16 v[160:175], a[192:195], a[144:147], v[160:175]
    ds_read_b64_tr_b16 a[184:185], v82 offset:18432
    ds_read_b64_tr_b16 a[186:187], v82 offset:19968
    s_add_u32 m0, s77, 4096
    s_nop 0
    buffer_load_dwordx4 v116, s[60:63], s76 offen lds
    s_sub_u32 s77, s77, 20480
    s_sub_u32 s76, s76, 165888
    s_waitcnt lgkmcnt(10)
    v_mfma_f32_32x32x16_bf16 v[176:191], a[196:199], a[144:147], v[176:191]
    ds_read_b64_tr_b16 a[188:189], v82 offset:18496
    ds_read_b64_tr_b16 a[190:191], v82 offset:20032
    s_waitcnt lgkmcnt(10)
    v_mfma_f32_32x32x16_bf16 v[192:207], a[200:203], a[144:147], v[192:207]
    ds_read_b64_tr_b16 a[192:193], v82 offset:18560
    ds_read_b64_tr_b16 a[194:195], v82 offset:20096
    s_waitcnt lgkmcnt(10)
    v_mfma_f32_32x32x16_bf16 v[160:175], a[204:207], a[148:151], v[160:175]
    ds_read_b64_tr_b16 a[196:197], v82 offset:21504
    ds_read_b64_tr_b16 a[198:199], v82 offset:23040
    s_waitcnt lgkmcnt(10)
    v_mfma_f32_32x32x16_bf16 v[176:191], a[176:179], a[148:151], v[176:191]
    ds_read_b64_tr_b16 a[200:201], v82 offset:21568
    ds_read_b64_tr_b16 a[202:203], v82 offset:23104
    s_waitcnt lgkmcnt(10)
    v_mfma_f32_32x32x16_bf16 v[192:207], a[180:183], a[148:151], v[192:207]
    ds_read_b64_tr_b16 a[204:205], v82 offset:21632
    ds_read_b64_tr_b16 a[206:207], v82 offset:23168
    s_waitcnt lgkmcnt(10)
    v_mfma_f32_32x32x16_bf16 v[160:175], a[184:187], a[152:155], v[160:175]
    ds_read_b64_tr_b16 a[176:177], v82 offset:24576
    ds_read_b64_tr_b16 a[178:179], v82 offset:26112
    s_waitcnt lgkmcnt(10)
    v_mfma_f32_32x32x16_bf16 v[176:191], a[188:191], a[152:155], v[176:191]
    ds_read_b64_tr_b16 a[180:181], v82 offset:24640
    ds_read_b64_tr_b16 a[182:183], v82 offset:26176
    s_waitcnt lgkmcnt(10)
    v_mfma_f32_32x32x16_bf16 v[192:207], a[192:195], a[152:155], v[192:207]
    ds_read_b64_tr_b16 a[184:185], v82 offset:24704
    ds_read_b64_tr_b16 a[186:187], v82 offset:26240
    s_waitcnt lgkmcnt(10)
    v_mfma_f32_32x32x16_bf16 v[160:175], a[196:199], a[156:159], v[160:175]
    ds_read_b64_tr_b16 a[188:189], v82 offset:27648
    ds_read_b64_tr_b16 a[190:191], v82 offset:29184
    s_waitcnt lgkmcnt(10)
    v_mfma_f32_32x32x16_bf16 v[176:191], a[200:203], a[156:159], v[176:191]
    ds_read_b64_tr_b16 a[192:193], v82 offset:27712
    ds_read_b64_tr_b16 a[194:195], v82 offset:29248
    s_waitcnt lgkmcnt(10)
    v_mfma_f32_32x32x16_bf16 v[192:207], a[204:207], a[156:159], v[192:207]
    ds_read_b64_tr_b16 a[196:197], v82 offset:27776
    ds_read_b64_tr_b16 a[198:199], v82 offset:29312
    s_waitcnt lgkmcnt(10)
    v_mfma_f32_32x32x16_bf16 v[160:175], a[176:179], a[160:163], v[160:175]
    ds_read_b64_tr_b16 a[200:201], v82 offset:30720
    ds_read_b64_tr_b16 a[202:203], v82 offset:32256
    s_waitcnt lgkmcnt(10)
    v_mfma_f32_32x32x16_bf16 v[176:191], a[180:183], a[160:163], v[176:191]
    ds_read_b64_tr_b16 a[204:205], v82 offset:30784
    ds_read_b64_tr_b16 a[206:207], v82 offset:32320
    s_waitcnt lgkmcnt(10)
    v_mfma_f32_32x32x16_bf16 v[192:207], a[184:187], a[160:163], v[192:207]
    ds_read_b64_tr_b16 a[176:177], v82 offset:30848
    ds_read_b64_tr_b16 a[178:179], v82 offset:32384
    s_waitcnt lgkmcnt(10)
    v_mfma_f32_32x32x16_bf16 v[160:175], a[188:191], a[164:167], v[160:175]
    ds_read_b64_tr_b16 a[180:181], v82 offset:33792
    ds_read_b64_tr_b16 a[182:183], v82 offset:35328
    s_waitcnt lgkmcnt(10)
    v_mfma_f32_32x32x16_bf16 v[176:191], a[192:195], a[164:167], v[176:191]
    ds_read_b64_tr_b16 a[184:185], v82 offset:33856
    ds_read_b64_tr_b16 a[186:187], v82 offset:35392
    s_waitcnt lgkmcnt(10)
    v_mfma_f32_32x32x16_bf16 v[192:207], a[196:199], a[164:167], v[192:207]
    ds_read_b64_tr_b16 a[188:189], v82 offset:33920
    ds_read_b64_tr_b16 a[190:191], v82 offset:35456
    s_waitcnt lgkmcnt(10)
    v_mfma_f32_32x32x16_bf16 v[160:175], a[200:203], a[168:171], v[160:175]
    s_waitcnt lgkmcnt(8)
    v_mfma_f32_32x32x16_bf16 v[176:191], a[204:207], a[168:171], v[176:191]
    s_waitcnt lgkmcnt(6)
    v_mfma_f32_32x32x16_bf16 v[192:207], a[176:179], a[168:171], v[192:207]
    s_waitcnt lgkmcnt(4)
    v_mfma_f32_32x32x16_bf16 v[160:175], a[180:183], a[172:175], v[160:175]
    s_waitcnt lgkmcnt(2)
    v_mfma_f32_32x32x16_bf16 v[176:191], a[184:187], a[172:175], v[176:191]
    s_waitcnt lgkmcnt(0)
    v_mfma_f32_32x32x16_bf16 v[192:207], a[188:191], a[172:175], v[192:207]
    s_nop 7
    v_cvt_pk_bf16_f32 v96, v160, v161
    v_cvt_pk_bf16_f32 v97, v162, v163
    v_cvt_pk_bf16_f32 v98, v168, v169
    v_cvt_pk_bf16_f32 v99, v170, v171
    buffer_store_dwordx4 v[96:99], v86, s[24:27], s57 offen offset:0 sc1
    v_cvt_pk_bf16_f32 v100, v164, v165
    v_cvt_pk_bf16_f32 v101, v166, v167
    v_cvt_pk_bf16_f32 v102, v172, v173
    v_cvt_pk_bf16_f32 v103, v174, v175
    buffer_store_dwordx4 v[100:103], v86, s[24:27], s57 offen offset:512 sc1
    s_add_u32 s57, s57, 1024
    v_cvt_pk_bf16_f32 v104, v176, v177
    v_cvt_pk_bf16_f32 v105, v178, v179
    v_cvt_pk_bf16_f32 v106, v184, v185
    v_cvt_pk_bf16_f32 v107, v186, v187
    buffer_store_dwordx4 v[104:107], v86, s[24:27], s57 offen offset:0 sc1
    v_cvt_pk_bf16_f32 v108, v180, v181
    v_cvt_pk_bf16_f32 v109, v182, v183
    v_cvt_pk_bf16_f32 v110, v188, v189
    v_cvt_pk_bf16_f32 v111, v190, v191
    buffer_store_dwordx4 v[108:111], v86, s[24:27], s57 offen offset:512 sc1
    s_add_u32 s57, s57, 1024
    v_cvt_pk_bf16_f32 v96, v192, v193
    v_cvt_pk_bf16_f32 v97, v194, v195
    v_cvt_pk_bf16_f32 v98, v200, v201
    v_cvt_pk_bf16_f32 v99, v202, v203
    buffer_store_dwordx4 v[96:99], v86, s[24:27], s57 offen offset:0 sc1
    v_cvt_pk_bf16_f32 v100, v196, v197
    v_cvt_pk_bf16_f32 v101, v198, v199
    v_cvt_pk_bf16_f32 v102, v204, v205
    v_cvt_pk_bf16_f32 v103, v206, v207
    buffer_store_dwordx4 v[100:103], v86, s[24:27], s57 offen offset:512 sc1
    s_add_u32 s57, s57, 1024
    s_waitcnt vmcnt(11)
    s_barrier
    v_add_u32 v112, 46080, v120
    ds_read_b64_tr_b16 a[176:177], v120 offset:61440
    ds_read_b64_tr_b16 a[178:179], v120 offset:64000
    ds_read_b64_tr_b16 a[180:181], v120 offset:61472
    ds_read_b64_tr_b16 a[182:183], v120 offset:64032
    ds_read_b64_tr_b16 a[184:185], v120 offset:61504
    ds_read_b64_tr_b16 a[186:187], v120 offset:64064
    ds_read_b64_tr_b16 a[188:189], v120 offset:61536
    ds_read_b64_tr_b16 a[190:191], v120 offset:64096
    ds_read_b64_tr_b16 a[192:193], v120 offset:61568
    ds_read_b64_tr_b16 a[194:195], v120 offset:64128
    ds_read_b64_tr_b16 a[196:197], v112 offset:20480
    ds_read_b64_tr_b16 a[198:199], v112 offset:23040
    s_waitcnt lgkmcnt(10)
    v_mfma_f32_16x16x32_bf16 v[224:227], a[176:179], a[224:227], 0
    ds_read_b64_tr_b16 a[200:201], v112 offset:20512
    ds_read_b64_tr_b16 a[202:203], v112 offset:23072
    s_waitcnt lgkmcnt(10)
    v_mfma_f32_16x16x32_bf16 v[228:231], a[180:183], a[224:227], 0
    ds_read_b64_tr_b16 a[204:205], v112 offset:20544
    ds_read_b64_tr_b16 a[206:207], v112 offset:23104
    s_waitcnt lgkmcnt(10)
    v_mfma_f32_16x16x32_bf16 v[232:235], a[184:187], a[224:227], 0
    ds_read_b64_tr_b16 a[176:177], v112 offset:20576
    ds_read_b64_tr_b16 a[178:179], v112 offset:23136
    s_waitcnt lgkmcnt(10)
    v_mfma_f32_16x16x32_bf16 v[236:239], a[188:191], a[224:227], 0
    ds_read_b64_tr_b16 a[180:181], v112 offset:20608
    ds_read_b64_tr_b16 a[182:183], v112 offset:23168
    s_waitcnt lgkmcnt(10)
    v_mfma_f32_16x16x32_bf16 v[240:243], a[192:195], a[224:227], 0
    ds_read_b64_tr_b16 a[184:185], v112 offset:25600
    ds_read_b64_tr_b16 a[186:187], v112 offset:28160
    s_add_u32 s34, s81, 0
    buffer_load_dwordx4 v[32:35], v210, s[24:27], s34 offen sc1
    s_waitcnt lgkmcnt(10)
    v_mfma_f32_16x16x32_bf16 v[224:227], a[196:199], a[228:231], v[224:227]
    ds_read_b64_tr_b16 a[188:189], v112 offset:25632
    ds_read_b64_tr_b16 a[190:191], v112 offset:28192
    s_waitcnt lgkmcnt(10)
    v_mfma_f32_16x16x32_bf16 v[228:231], a[200:203], a[228:231], v[228:231]
    ds_read_b64_tr_b16 a[192:193], v112 offset:25664
    ds_read_b64_tr_b16 a[194:195], v112 offset:28224
    v_lshrrev_b32 v108, 4, v208
    v_bfe_u32 v109, v208, 2, 2
    v_cmp_eq_u32 vcc, v108, v109
    v_and_b32 v110, 1, v208
    v_lshlrev_b32 v110, 4, v110
    v_mov_b32 v111, 0x3f80
    v_lshlrev_b32 v111, v110, v111
    v_cndmask_b32 v111, 0, v111, vcc
    v_bfe_u32 v110, v208, 1, 1
    v_cmp_eq_u32 vcc, 0, v110
    s_nop 1
    v_cndmask_b32 v96, 0, v111, vcc
    v_cndmask_b32 v97, v111, 0, vcc
    v_mov_b32 v98, 0
    v_mov_b32 v99, 0
    v_mov_b32 v100, 0
    v_mov_b32 v101, 0
    v_mov_b32 v102, v96
    v_mov_b32 v103, v97
    s_waitcnt lgkmcnt(10)
    v_mfma_f32_16x16x32_bf16 v[232:235], a[204:207], a[228:231], v[232:235]
    ds_read_b64_tr_b16 a[196:197], v112 offset:25696
    ds_read_b64_tr_b16 a[198:199], v112 offset:28256
    s_waitcnt lgkmcnt(10)
    v_mfma_f32_16x16x32_bf16 v[236:239], a[176:179], a[228:231], v[236:239]
    ds_read_b64_tr_b16 a[200:201], v112 offset:25728
    ds_read_b64_tr_b16 a[202:203], v112 offset:28288
    s_waitcnt lgkmcnt(10)
    v_mfma_f32_16x16x32_bf16 v[240:243], a[180:183], a[228:231], v[240:243]
    ds_read_b64_tr_b16 a[204:205], v112 offset:30720
    ds_read_b64_tr_b16 a[206:207], v112 offset:33280
    s_cmp_eq_u32 s45, 0
    s_cselect_b64 vcc, -1, 0
    v_cndmask_b32 v104, v100, v96, vcc
    v_cndmask_b32 v105, v101, v97, vcc
    v_cndmask_b32 v106, v102, v98, vcc
    v_cndmask_b32 v107, v103, v99, vcc
    s_waitcnt lgkmcnt(10)
    v_mfma_f32_16x16x32_bf16 v[224:227], a[184:187], a[232:235], v[224:227]
    ds_read_b64_tr_b16 a[176:177], v112 offset:30752
    ds_read_b64_tr_b16 a[178:179], v112 offset:33312
    s_waitcnt lgkmcnt(10)
    v_mfma_f32_16x16x32_bf16 v[228:231], a[188:191], a[232:235], v[228:231]
    ds_read_b64_tr_b16 a[180:181], v112 offset:30784
    ds_read_b64_tr_b16 a[182:183], v112 offset:33344
    s_waitcnt lgkmcnt(10)
    v_mfma_f32_16x16x32_bf16 v[232:235], a[192:195], a[232:235], v[232:235]
    ds_read_b64_tr_b16 a[184:185], v112 offset:30816
    ds_read_b64_tr_b16 a[186:187], v112 offset:33376
    s_add_u32 s34, s81, 2359296
    buffer_load_dwordx4 v[36:39], v210, s[24:27], s34 offen sc1
    s_waitcnt lgkmcnt(10)
    v_mfma_f32_16x16x32_bf16 v[236:239], a[196:199], a[232:235], v[236:239]
    ds_read_b64_tr_b16 a[188:189], v112 offset:30848
    ds_read_b64_tr_b16 a[190:191], v112 offset:33408
    s_waitcnt lgkmcnt(10)
    v_mfma_f32_16x16x32_bf16 v[240:243], a[200:203], a[232:235], v[240:243]
    ds_read_b64_tr_b16 a[192:193], v112 offset:35840
    ds_read_b64_tr_b16 a[194:195], v112 offset:38400
    s_waitcnt lgkmcnt(10)
    v_mfma_f32_16x16x32_bf16 v[224:227], a[204:207], a[236:239], v[224:227]
    ds_read_b64_tr_b16 a[196:197], v112 offset:35872
    ds_read_b64_tr_b16 a[198:199], v112 offset:38432
    s_waitcnt lgkmcnt(10)
    v_mfma_f32_16x16x32_bf16 v[228:231], a[176:179], a[236:239], v[228:231]
    ds_read_b64_tr_b16 a[200:201], v112 offset:35904
    ds_read_b64_tr_b16 a[202:203], v112 offset:38464
    s_waitcnt lgkmcnt(10)
    v_mfma_f32_16x16x32_bf16 v[232:235], a[180:183], a[236:239], v[232:235]
    ds_read_b64_tr_b16 a[204:205], v112 offset:35936
    ds_read_b64_tr_b16 a[206:207], v112 offset:38496
    s_waitcnt lgkmcnt(10)
    v_mfma_f32_16x16x32_bf16 v[236:239], a[184:187], a[236:239], v[236:239]
    ds_read_b64_tr_b16 a[176:177], v112 offset:35968
    ds_read_b64_tr_b16 a[178:179], v112 offset:38528
    s_waitcnt lgkmcnt(10)
    v_mfma_f32_16x16x32_bf16 v[240:243], a[188:191], a[236:239], v[240:243]
    ds_read_b64_tr_b16 a[180:181], v112 offset:40960
    ds_read_b64_tr_b16 a[182:183], v112 offset:43520
    s_waitcnt lgkmcnt(10)
    v_mfma_f32_16x16x32_bf16 v[224:227], a[192:195], a[240:243], v[224:227]
    ds_read_b64_tr_b16 a[184:185], v112 offset:40992
    ds_read_b64_tr_b16 a[186:187], v112 offset:43552
    s_add_u32 s34, s81, 4718592
    buffer_load_dwordx4 v[40:43], v210, s[24:27], s34 offen sc1
    s_waitcnt lgkmcnt(10)
    v_mfma_f32_16x16x32_bf16 v[228:231], a[196:199], a[240:243], v[228:231]
    ds_read_b64_tr_b16 a[188:189], v112 offset:41024
    ds_read_b64_tr_b16 a[190:191], v112 offset:43584
    s_waitcnt lgkmcnt(10)
    v_mfma_f32_16x16x32_bf16 v[232:235], a[200:203], a[240:243], v[232:235]
    ds_read_b64_tr_b16 a[192:193], v112 offset:41056
    ds_read_b64_tr_b16 a[194:195], v112 offset:43616
    s_waitcnt lgkmcnt(10)
    v_mfma_f32_16x16x32_bf16 v[236:239], a[204:207], a[240:243], v[236:239]
    ds_read_b64_tr_b16 a[196:197], v112 offset:41088
    ds_read_b64_tr_b16 a[198:199], v112 offset:43648
    s_waitcnt lgkmcnt(10)
    v_mfma_f32_16x16x32_bf16 v[240:243], a[176:179], a[240:243], v[240:243]
    ds_read_b64_tr_b16 a[200:201], v120 offset:20480
    ds_read_b64_tr_b16 a[202:203], v120 offset:23040
    s_waitcnt lgkmcnt(10)
    v_mfma_f32_16x16x32_bf16 v[224:227], a[180:183], a[244:247], v[224:227]
    ds_read_b64_tr_b16 a[204:205], v120 offset:20512
    ds_read_b64_tr_b16 a[206:207], v120 offset:23072
    s_waitcnt lgkmcnt(10)
    v_mfma_f32_16x16x32_bf16 v[228:231], a[184:187], a[244:247], v[228:231]
    ds_read_b64_tr_b16 a[176:177], v120 offset:20544
    ds_read_b64_tr_b16 a[178:179], v120 offset:23104
    s_waitcnt lgkmcnt(10)
    v_mfma_f32_16x16x32_bf16 v[232:235], a[188:191], a[244:247], v[232:235]
    ds_read_b64_tr_b16 a[180:181], v120 offset:20576
    ds_read_b64_tr_b16 a[182:183], v120 offset:23136
    s_waitcnt lgkmcnt(10)
    v_mfma_f32_16x16x32_bf16 v[236:239], a[192:195], a[244:247], v[236:239]
    ds_read_b64_tr_b16 a[184:185], v120 offset:20608
    ds_read_b64_tr_b16 a[186:187], v120 offset:23168
    s_add_u32 s34, s81, 7077888
    buffer_load_dwordx4 v[44:47], v210, s[24:27], s34 offen sc1
    s_waitcnt lgkmcnt(10)
    v_mfma_f32_16x16x32_bf16 v[240:243], a[196:199], a[244:247], v[240:243]
    ds_read_b64_tr_b16 a[188:189], v120 offset:25600
    ds_read_b64_tr_b16 a[190:191], v120 offset:28160
    s_waitcnt lgkmcnt(10)
    v_mfma_f32_16x16x32_bf16 v[224:227], a[200:203], a[16:19], v[224:227]
    ds_read_b64_tr_b16 a[192:193], v120 offset:25632
    ds_read_b64_tr_b16 a[194:195], v120 offset:28192
    s_waitcnt lgkmcnt(10)
    v_mfma_f32_16x16x32_bf16 v[228:231], a[204:207], a[16:19], v[228:231]
    ds_read_b64_tr_b16 a[196:197], v120 offset:25664
    ds_read_b64_tr_b16 a[198:199], v120 offset:28224
    s_waitcnt lgkmcnt(10)
    v_mfma_f32_16x16x32_bf16 v[232:235], a[176:179], a[16:19], v[232:235]
    ds_read_b64_tr_b16 a[200:201], v120 offset:25696
    ds_read_b64_tr_b16 a[202:203], v120 offset:28256
    s_waitcnt lgkmcnt(10)
    v_mfma_f32_16x16x32_bf16 v[236:239], a[180:183], a[16:19], v[236:239]
    ds_read_b64_tr_b16 a[204:205], v120 offset:25728
    ds_read_b64_tr_b16 a[206:207], v120 offset:28288
    s_waitcnt lgkmcnt(10)
    v_mfma_f32_16x16x32_bf16 v[240:243], a[184:187], a[16:19], v[240:243]
    ds_read_b64_tr_b16 a[176:177], v120 offset:30720
    ds_read_b64_tr_b16 a[178:179], v120 offset:33280
    s_waitcnt lgkmcnt(10)
    v_mfma_f32_16x16x32_bf16 v[224:227], a[188:191], a[20:23], v[224:227]
    ds_read_b64_tr_b16 a[180:181], v120 offset:30752
    ds_read_b64_tr_b16 a[182:183], v120 offset:33312
    s_waitcnt lgkmcnt(10)
    v_mfma_f32_16x16x32_bf16 v[228:231], a[192:195], a[20:23], v[228:231]
    ds_read_b64_tr_b16 a[184:185], v120 offset:30784
    ds_read_b64_tr_b16 a[186:187], v120 offset:33344
    s_add_u32 s34, s81, 9437184
    buffer_load_dwordx4 v[48:51], v210, s[24:27], s34 offen sc1
    s_waitcnt lgkmcnt(10)
    v_mfma_f32_16x16x32_bf16 v[232:235], a[196:199], a[20:23], v[232:235]
    ds_read_b64_tr_b16 a[188:189], v120 offset:30816
    ds_read_b64_tr_b16 a[190:191], v120 offset:33376
    s_waitcnt lgkmcnt(10)
    v_mfma_f32_16x16x32_bf16 v[236:239], a[200:203], a[20:23], v[236:239]
    ds_read_b64_tr_b16 a[192:193], v120 offset:30848
    ds_read_b64_tr_b16 a[194:195], v120 offset:33408
    s_waitcnt lgkmcnt(10)
    v_mfma_f32_16x16x32_bf16 v[240:243], a[204:207], a[20:23], v[240:243]
    ds_read_b64_tr_b16 a[196:197], v120 offset:35840
    ds_read_b64_tr_b16 a[198:199], v120 offset:38400
    s_waitcnt lgkmcnt(10)
    v_mfma_f32_16x16x32_bf16 v[224:227], a[176:179], a[24:27], v[224:227]
    ds_read_b64_tr_b16 a[200:201], v120 offset:35872
    ds_read_b64_tr_b16 a[202:203], v120 offset:38432
    s_waitcnt lgkmcnt(10)
    v_mfma_f32_16x16x32_bf16 v[228:231], a[180:183], a[24:27], v[228:231]
    ds_read_b64_tr_b16 a[204:205], v120 offset:35904
    ds_read_b64_tr_b16 a[206:207], v120 offset:38464
    s_waitcnt lgkmcnt(10)
    v_mfma_f32_16x16x32_bf16 v[232:235], a[184:187], a[24:27], v[232:235]
    ds_read_b64_tr_b16 a[176:177], v120 offset:35936
    ds_read_b64_tr_b16 a[178:179], v120 offset:38496
    s_waitcnt lgkmcnt(10)
    v_mfma_f32_16x16x32_bf16 v[236:239], a[188:191], a[24:27], v[236:239]
    ds_read_b64_tr_b16 a[180:181], v120 offset:35968
    ds_read_b64_tr_b16 a[182:183], v120 offset:38528
    s_waitcnt lgkmcnt(10)
    v_mfma_f32_16x16x32_bf16 v[240:243], a[192:195], a[24:27], v[240:243]
    ds_read_b64_tr_b16 a[184:185], v120 offset:40960
    ds_read_b64_tr_b16 a[186:187], v120 offset:43520
    s_add_u32 s34, s81, 11796480
    buffer_load_dwordx4 v[52:55], v210, s[24:27], s34 offen sc1
    s_waitcnt lgkmcnt(10)
    v_mfma_f32_16x16x32_bf16 v[224:227], a[196:199], a[28:31], v[224:227]
    ds_read_b64_tr_b16 a[188:189], v120 offset:40992
    ds_read_b64_tr_b16 a[190:191], v120 offset:43552
    s_waitcnt lgkmcnt(10)
    v_mfma_f32_16x16x32_bf16 v[228:231], a[200:203], a[28:31], v[228:231]
    ds_read_b64_tr_b16 a[192:193], v120 offset:41024
    ds_read_b64_tr_b16 a[194:195], v120 offset:43584
    s_waitcnt lgkmcnt(10)
    v_mfma_f32_16x16x32_bf16 v[232:235], a[204:207], a[28:31], v[232:235]
    ds_read_b64_tr_b16 a[196:197], v120 offset:41056
    ds_read_b64_tr_b16 a[198:199], v120 offset:43616
    s_waitcnt lgkmcnt(10)
    v_mfma_f32_16x16x32_bf16 v[236:239], a[176:179], a[28:31], v[236:239]
    ds_read_b64_tr_b16 a[200:201], v120 offset:41088
    ds_read_b64_tr_b16 a[202:203], v120 offset:43648
    s_waitcnt lgkmcnt(10)
    v_mfma_f32_16x16x32_bf16 v[240:243], a[180:183], a[28:31], v[240:243]
    ds_read_b64_tr_b16 a[204:205], v120 offset:46080
    ds_read_b64_tr_b16 a[206:207], v120 offset:48640
    s_waitcnt lgkmcnt(10)
    v_mfma_f32_16x16x32_bf16 v[224:227], a[184:187], a[208:211], v[224:227]
    ds_read_b64_tr_b16 a[176:177], v120 offset:46112
    ds_read_b64_tr_b16 a[178:179], v120 offset:48672
    s_waitcnt lgkmcnt(10)
    v_mfma_f32_16x16x32_bf16 v[228:231], a[188:191], a[208:211], v[228:231]
    ds_read_b64_tr_b16 a[180:181], v120 offset:46144
    ds_read_b64_tr_b16 a[182:183], v120 offset:48704
    s_waitcnt lgkmcnt(10)
    v_mfma_f32_16x16x32_bf16 v[232:235], a[192:195], a[208:211], v[232:235]
    ds_read_b64_tr_b16 a[184:185], v120 offset:46176
    ds_read_b64_tr_b16 a[186:187], v120 offset:48736
    s_add_u32 s34, s81, 14155776
    buffer_load_dwordx4 v[56:59], v210, s[24:27], s34 offen sc1
    s_waitcnt lgkmcnt(10)
    v_mfma_f32_16x16x32_bf16 v[236:239], a[196:199], a[208:211], v[236:239]
    ds_read_b64_tr_b16 a[188:189], v120 offset:46208
    ds_read_b64_tr_b16 a[190:191], v120 offset:48768
    s_waitcnt lgkmcnt(10)
    v_mfma_f32_16x16x32_bf16 v[240:243], a[200:203], a[208:211], v[240:243]
    ds_read_b64_tr_b16 a[192:193], v120 offset:51200
    ds_read_b64_tr_b16 a[194:195], v120 offset:53760
    s_waitcnt lgkmcnt(10)
    v_mfma_f32_16x16x32_bf16 v[224:227], a[204:207], a[212:215], v[224:227]
    ds_read_b64_tr_b16 a[196:197], v120 offset:51232
    ds_read_b64_tr_b16 a[198:199], v120 offset:53792
    s_waitcnt lgkmcnt(10)
    v_mfma_f32_16x16x32_bf16 v[228:231], a[176:179], a[212:215], v[228:231]
    ds_read_b64_tr_b16 a[200:201], v120 offset:51264
    ds_read_b64_tr_b16 a[202:203], v120 offset:53824
    s_waitcnt lgkmcnt(10)
    v_mfma_f32_16x16x32_bf16 v[232:235], a[180:183], a[212:215], v[232:235]
    ds_read_b64_tr_b16 a[204:205], v120 offset:51296
    ds_read_b64_tr_b16 a[206:207], v120 offset:53856
    s_waitcnt lgkmcnt(10)
    v_mfma_f32_16x16x32_bf16 v[236:239], a[184:187], a[212:215], v[236:239]
    ds_read_b64_tr_b16 a[176:177], v120 offset:51328
    ds_read_b64_tr_b16 a[178:179], v120 offset:53888
    s_waitcnt lgkmcnt(10)
    v_mfma_f32_16x16x32_bf16 v[240:243], a[188:191], a[212:215], v[240:243]
    ds_read_b64_tr_b16 a[180:181], v120 offset:56320
    ds_read_b64_tr_b16 a[182:183], v120 offset:58880
    s_waitcnt lgkmcnt(10)
    v_mfma_f32_16x16x32_bf16 v[224:227], a[192:195], a[216:219], v[224:227]
    ds_read_b64_tr_b16 a[184:185], v120 offset:56352
    ds_read_b64_tr_b16 a[186:187], v120 offset:58912
    s_add_u32 s34, s81, 16515072
    buffer_load_dwordx4 v[60:63], v210, s[24:27], s34 offen sc1
    s_waitcnt lgkmcnt(10)
    v_mfma_f32_16x16x32_bf16 v[228:231], a[196:199], a[216:219], v[228:231]
    ds_read_b64_tr_b16 a[188:189], v120 offset:56384
    ds_read_b64_tr_b16 a[190:191], v120 offset:58944
    s_waitcnt lgkmcnt(10)
    v_mfma_f32_16x16x32_bf16 v[232:235], a[200:203], a[216:219], v[232:235]
    ds_read_b64_tr_b16 a[192:193], v120 offset:56416
    ds_read_b64_tr_b16 a[194:195], v120 offset:58976
    s_waitcnt lgkmcnt(10)
    v_mfma_f32_16x16x32_bf16 v[236:239], a[204:207], a[216:219], v[236:239]
    ds_read_b64_tr_b16 a[196:197], v120 offset:56448
    ds_read_b64_tr_b16 a[198:199], v120 offset:59008
    s_waitcnt lgkmcnt(10)
    v_mfma_f32_16x16x32_bf16 v[240:243], a[176:179], a[216:219], v[240:243]
    s_waitcnt vmcnt(14)
    s_barrier
    ds_read_b64_tr_b16 a[200:201], v120 offset:0
    ds_read_b64_tr_b16 a[202:203], v120 offset:2560
    s_add_u32 s34, s80, 0
    buffer_load_dwordx4 v[128:131], v210, s[24:27], s34 offen sc1
    s_waitcnt lgkmcnt(10)
    v_mfma_f32_16x16x32_bf16 v[224:227], a[180:183], a[220:223], v[224:227]
    ds_read_b64_tr_b16 a[204:205], v120 offset:32
    ds_read_b64_tr_b16 a[206:207], v120 offset:2592
    s_waitcnt lgkmcnt(10)
    v_mfma_f32_16x16x32_bf16 v[228:231], a[184:187], a[220:223], v[228:231]
    ds_read_b64_tr_b16 a[176:177], v120 offset:64
    ds_read_b64_tr_b16 a[178:179], v120 offset:2624
    s_waitcnt lgkmcnt(10)
    v_mfma_f32_16x16x32_bf16 v[232:235], a[188:191], a[220:223], v[232:235]
    ds_read_b64_tr_b16 a[180:181], v120 offset:96
    ds_read_b64_tr_b16 a[182:183], v120 offset:2656
    s_add_u32 s34, s80, 2359296
    buffer_load_dwordx4 v[132:135], v210, s[24:27], s34 offen sc1
    s_waitcnt lgkmcnt(10)
    v_mfma_f32_16x16x32_bf16 v[236:239], a[192:195], a[220:223], v[236:239]
    ds_read_b64_tr_b16 a[184:185], v120 offset:128
    ds_read_b64_tr_b16 a[186:187], v120 offset:2688
    s_waitcnt lgkmcnt(10)
    v_mfma_f32_16x16x32_bf16 v[240:243], a[196:199], a[220:223], v[240:243]
    ds_read_b64_tr_b16 a[188:189], v120 offset:5120
    ds_read_b64_tr_b16 a[190:191], v120 offset:7680
    s_waitcnt lgkmcnt(10)
    v_mfma_f32_16x16x32_bf16 v[224:227], a[200:203], a[0:3], v[224:227]
    ds_read_b64_tr_b16 a[192:193], v120 offset:5152
    ds_read_b64_tr_b16 a[194:195], v120 offset:7712
    s_add_u32 s34, s80, 4718592
    buffer_load_dwordx4 v[136:139], v210, s[24:27], s34 offen sc1
    s_waitcnt lgkmcnt(10)
    v_mfma_f32_16x16x32_bf16 v[228:231], a[204:207], a[0:3], v[228:231]
    ds_read_b64_tr_b16 a[196:197], v120 offset:5184
    ds_read_b64_tr_b16 a[198:199], v120 offset:7744
    s_waitcnt lgkmcnt(10)
    v_mfma_f32_16x16x32_bf16 v[232:235], a[176:179], a[0:3], v[232:235]
    ds_read_b64_tr_b16 a[200:201], v120 offset:5216
    ds_read_b64_tr_b16 a[202:203], v120 offset:7776
    s_waitcnt lgkmcnt(10)
    v_mfma_f32_16x16x32_bf16 v[236:239], a[180:183], a[0:3], v[236:239]
    ds_read_b64_tr_b16 a[204:205], v120 offset:5248
    ds_read_b64_tr_b16 a[206:207], v120 offset:7808
    s_add_u32 s34, s80, 7077888
    buffer_load_dwordx4 v[140:143], v210, s[24:27], s34 offen sc1
    s_waitcnt lgkmcnt(10)
    v_mfma_f32_16x16x32_bf16 v[240:243], a[184:187], a[0:3], v[240:243]
    ds_read_b64_tr_b16 a[176:177], v120 offset:10240
    ds_read_b64_tr_b16 a[178:179], v120 offset:12800
    s_waitcnt lgkmcnt(10)
    v_mfma_f32_16x16x32_bf16 v[224:227], a[188:191], a[4:7], v[224:227]
    ds_read_b64_tr_b16 a[180:181], v120 offset:10272
    ds_read_b64_tr_b16 a[182:183], v120 offset:12832
    s_waitcnt lgkmcnt(10)
    v_mfma_f32_16x16x32_bf16 v[228:231], a[192:195], a[4:7], v[228:231]
    ds_read_b64_tr_b16 a[184:185], v120 offset:10304
    ds_read_b64_tr_b16 a[186:187], v120 offset:12864
    s_add_u32 s34, s80, 9437184
    buffer_load_dwordx4 v[144:147], v210, s[24:27], s34 offen sc1
    s_waitcnt lgkmcnt(10)
    v_mfma_f32_16x16x32_bf16 v[232:235], a[196:199], a[4:7], v[232:235]
    ds_read_b64_tr_b16 a[188:189], v120 offset:10336
    ds_read_b64_tr_b16 a[190:191], v120 offset:12896
    s_waitcnt lgkmcnt(10)
    v_mfma_f32_16x16x32_bf16 v[236:239], a[200:203], a[4:7], v[236:239]
    ds_read_b64_tr_b16 a[192:193], v120 offset:10368
    ds_read_b64_tr_b16 a[194:195], v120 offset:12928
    s_waitcnt lgkmcnt(10)
    v_mfma_f32_16x16x32_bf16 v[240:243], a[204:207], a[4:7], v[240:243]
    ds_read_b64_tr_b16 a[196:197], v120 offset:15360
    ds_read_b64_tr_b16 a[198:199], v120 offset:17920
    s_add_u32 s34, s80, 11796480
    buffer_load_dwordx4 v[148:151], v210, s[24:27], s34 offen sc1
    s_waitcnt lgkmcnt(10)
    v_mfma_f32_16x16x32_bf16 v[224:227], a[176:179], a[8:11], v[224:227]
    ds_read_b64_tr_b16 a[200:201], v120 offset:15392
    ds_read_b64_tr_b16 a[202:203], v120 offset:17952
    s_waitcnt lgkmcnt(10)
    v_mfma_f32_16x16x32_bf16 v[228:231], a[180:183], a[8:11], v[228:231]
    ds_read_b64_tr_b16 a[204:205], v120 offset:15424
    ds_read_b64_tr_b16 a[206:207], v120 offset:17984
    s_waitcnt lgkmcnt(10)
    v_mfma_f32_16x16x32_bf16 v[232:235], a[184:187], a[8:11], v[232:235]
    ds_read_b64_tr_b16 a[176:177], v120 offset:15456
    ds_read_b64_tr_b16 a[178:179], v120 offset:18016
    s_add_u32 s34, s80, 14155776
    buffer_load_dwordx4 v[152:155], v210, s[24:27], s34 offen sc1
    s_waitcnt lgkmcnt(10)
    v_mfma_f32_16x16x32_bf16 v[236:239], a[188:191], a[8:11], v[236:239]
    ds_read_b64_tr_b16 a[180:181], v120 offset:15488
    ds_read_b64_tr_b16 a[182:183], v120 offset:18048
    s_waitcnt lgkmcnt(10)
    v_mfma_f32_16x16x32_bf16 v[240:243], a[192:195], a[8:11], v[240:243]
    s_waitcnt lgkmcnt(8)
    v_mfma_f32_16x16x32_bf16 v[224:227], a[196:199], a[12:15], v[224:227]
    s_add_u32 s34, s80, 16515072
    buffer_load_dwordx4 v[156:159], v210, s[24:27], s34 offen sc1
    s_waitcnt lgkmcnt(6)
    v_mfma_f32_16x16x32_bf16 v[228:231], a[200:203], a[12:15], v[228:231]
    s_waitcnt lgkmcnt(4)
    v_mfma_f32_16x16x32_bf16 v[232:235], a[204:207], a[12:15], v[232:235]
    s_waitcnt lgkmcnt(2)
    v_mfma_f32_16x16x32_bf16 v[236:239], a[176:179], a[12:15], v[236:239]
    s_waitcnt lgkmcnt(0)
    v_mfma_f32_16x16x32_bf16 v[240:243], a[180:183], a[12:15], v[240:243]
    v_permlane16_swap_b32 v64, v66
    v_permlane16_swap_b32 v65, v67
    v_permlane16_swap_b32 v68, v70
    v_permlane16_swap_b32 v69, v71
    s_mov_b32 s36, 0
L_e0chk:
    v_max3_u32 v180, v0, v1, v2
    v_max3_u32 v181, v3, v4, v5
    v_max3_u32 v180, v180, v6, v7
    v_max3_u32 v181, v181, v8, v9
    v_max3_u32 v180, v180, v10, v11
    v_max3_u32 v181, v181, v12, v13
    v_max3_u32 v180, v180, v14, v15
    v_max3_u32 v181, v181, v16, v17
    v_max3_u32 v180, v180, v18, v19
    v_max3_u32 v181, v181, v20, v21
    v_max3_u32 v180, v180, v22, v23
    v_max3_u32 v181, v181, v24, v25
    v_max3_u32 v180, v180, v26, v27
    v_max3_u32 v181, v181, v28, v29
    v_max3_u32 v180, v180, v30, v31
    v_max_u32 v180, v180, v181
    v_cmp_eq_u32 vcc, -1, v180
    s_cbranch_vccz L_e0ok
    v_max3_u32 v180, v0, v1, v2
    v_max_u32 v180, v180, v3
    v_cmp_eq_u32 vcc, -1, v180
    s_cbranch_vccz L_e0s0
    s_add_u32 s34, s75, 0
    buffer_load_dwordx4 v[0:3], v210, s[24:27], s34 offen sc1
L_e0s0:
    v_max3_u32 v180, v4, v5, v6
    v_max_u32 v180, v180, v7
    v_cmp_eq_u32 vcc, -1, v180
    s_cbranch_vccz L_e0s1
    s_add_u32 s34, s75, 2359296
    buffer_load_dwordx4 v[4:7], v210, s[24:27], s34 offen sc1
L_e0s1:
    v_max3_u32 v180, v8, v9, v10
    v_max_u32 v180, v180, v11
    v_cmp_eq_u32 vcc, -1, v180
    s_cbranch_vccz L_e0s2
    s_add_u32 s34, s75, 4718592
    buffer_load_dwordx4 v[8:11], v210, s[24:27], s34 offen sc1
L_e0s2:
    v_max3_u32 v180, v12, v13, v14
    v_max_u32 v180, v180, v15
    v_cmp_eq_u32 vcc, -1, v180
    s_cbranch_vccz L_e0s3
    s_add_u32 s34, s75, 7077888
    buffer_load_dwordx4 v[12:15], v210, s[24:27], s34 offen sc1
L_e0s3:
    v_max3_u32 v180, v16, v17, v18
    v_max_u32 v180, v180, v19
    v_cmp_eq_u32 vcc, -1, v180
    s_cbranch_vccz L_e0s4
    s_add_u32 s34, s75, 9437184
    buffer_load_dwordx4 v[16:19], v210, s[24:27], s34 offen sc1
L_e0s4:
    v_max3_u32 v180, v20, v21, v22
    v_max_u32 v180, v180, v23
    v_cmp_eq_u32 vcc, -1, v180
    s_cbranch_vccz L_e0s5
    s_add_u32 s34, s75, 11796480
    buffer_load_dwordx4 v[20:23], v210, s[24:27], s34 offen sc1
L_e0s5:
    v_max3_u32 v180, v24, v25, v26
    v_max_u32 v180, v180, v27
    v_cmp_eq_u32 vcc, -1, v180
    s_cbranch_vccz L_e0s6
    s_add_u32 s34, s75, 14155776
    buffer_load_dwordx4 v[24:27], v210, s[24:27], s34 offen sc1
L_e0s6:
    v_max3_u32 v180, v28, v29, v30
    v_max_u32 v180, v180, v31
    v_cmp_eq_u32 vcc, -1, v180
    s_cbranch_vccz L_e0s7
    s_add_u32 s34, s75, 16515072
    buffer_load_dwordx4 v[28:31], v210, s[24:27], s34 offen sc1
L_e0s7:
    s_waitcnt vmcnt(0)
    s_add_u32 s36, s36, 1
    s_cmp_lt_u32 s36, 0x8000
    s_cbranch_scc1 L_e0chk
L_e0ok:
    v_mfma_f32_16x16x32_bf16 v[160:163], v[96:99], v[0:3], 0
    v_mfma_f32_16x16x32_bf16 v[164:167], v[100:103], v[0:3], 0
    v_mfma_f32_16x16x32_bf16 v[160:163], v[96:99], v[4:7], v[160:163]
    v_mfma_f32_16x16x32_bf16 v[164:167], v[100:103], v[4:7], v[164:167]
    v_mfma_f32_16x16x32_bf16 v[160:163], v[96:99], v[8:11], v[160:163]
    v_mfma_f32_16x16x32_bf16 v[164:167], v[100:103], v[8:11], v[164:167]
    v_mfma_f32_16x16x32_bf16 v[160:163], v[96:99], v[12:15], v[160:163]
    v_mfma_f32_16x16x32_bf16 v[164:167], v[100:103], v[12:15], v[164:167]
    v_mfma_f32_16x16x32_bf16 v[160:163], v[96:99], v[16:19], v[160:163]
    v_mfma_f32_16x16x32_bf16 v[164:167], v[100:103], v[16:19], v[164:167]
    v_mfma_f32_16x16x32_bf16 v[160:163], v[96:99], v[20:23], v[160:163]
    v_mfma_f32_16x16x32_bf16 v[164:167], v[100:103], v[20:23], v[164:167]
    v_mfma_f32_16x16x32_bf16 v[160:163], v[96:99], v[24:27], v[160:163]
    v_mfma_f32_16x16x32_bf16 v[164:167], v[100:103], v[24:27], v[164:167]
    v_mfma_f32_16x16x32_bf16 v[160:163], v[96:99], v[28:31], v[160:163]
    v_mfma_f32_16x16x32_bf16 v[164:167], v[100:103], v[28:31], v[164:167]
    s_mov_b32 s36, 0
L_e4chk:
    s_waitcnt vmcnt(15)
    v_max3_u32 v180, v32, v33, v34
    s_waitcnt vmcnt(14)
    v_max3_u32 v181, v35, v36, v37
    v_max3_u32 v180, v180, v38, v39
    s_waitcnt vmcnt(13)
    v_max3_u32 v181, v181, v40, v41
    v_max3_u32 v180, v180, v42, v43
    s_waitcnt vmcnt(12)
    v_max3_u32 v181, v181, v44, v45
    v_max3_u32 v180, v180, v46, v47
    s_waitcnt vmcnt(11)
    v_max3_u32 v181, v181, v48, v49
    v_max3_u32 v180, v180, v50, v51
    s_waitcnt vmcnt(10)
    v_max3_u32 v181, v181, v52, v53
    v_max3_u32 v180, v180, v54, v55
    s_waitcnt vmcnt(9)
    v_max3_u32 v181, v181, v56, v57
    v_max3_u32 v180, v180, v58, v59
    s_waitcnt vmcnt(8)
    v_max3_u32 v181, v181, v60, v61
    v_max3_u32 v180, v180, v62, v63
    v_max_u32 v180, v180, v181
    v_cmp_eq_u32 vcc, -1, v180
    s_cbranch_vccz L_e4ok
    v_max3_u32 v180, v32, v33, v34
    v_max_u32 v180, v180, v35
    v_cmp_eq_u32 vcc, -1, v180
    s_cbranch_vccz L_e4s0
    s_add_u32 s34, s81, 0
    buffer_load_dwordx4 v[32:35], v210, s[24:27], s34 offen sc1
L_e4s0:
    v_max3_u32 v180, v36, v37, v38
    v_max_u32 v180, v180, v39
    v_cmp_eq_u32 vcc, -1, v180
    s_cbranch_vccz L_e4s1
    s_add_u32 s34, s81, 2359296
    buffer_load_dwordx4 v[36:39], v210, s[24:27], s34 offen sc1
L_e4s1:
    v_max3_u32 v180, v40, v41, v42
    v_max_u32 v180, v180, v43
    v_cmp_eq_u32 vcc, -1, v180
    s_cbranch_vccz L_e4s2
    s_add_u32 s34, s81, 4718592
    buffer_load_dwordx4 v[40:43], v210, s[24:27], s34 offen sc1
L_e4s2:
    v_max3_u32 v180, v44, v45, v46
    v_max_u32 v180, v180, v47
    v_cmp_eq_u32 vcc, -1, v180
    s_cbranch_vccz L_e4s3
    s_add_u32 s34, s81, 7077888
    buffer_load_dwordx4 v[44:47], v210, s[24:27], s34 offen sc1
L_e4s3:
    v_max3_u32 v180, v48, v49, v50
    v_max_u32 v180, v180, v51
    v_cmp_eq_u32 vcc, -1, v180
    s_cbranch_vccz L_e4s4
    s_add_u32 s34, s81, 9437184
    buffer_load_dwordx4 v[48:51], v210, s[24:27], s34 offen sc1
L_e4s4:
    v_max3_u32 v180, v52, v53, v54
    v_max_u32 v180, v180, v55
    v_cmp_eq_u32 vcc, -1, v180
    s_cbranch_vccz L_e4s5
    s_add_u32 s34, s81, 11796480
    buffer_load_dwordx4 v[52:55], v210, s[24:27], s34 offen sc1
L_e4s5:
    v_max3_u32 v180, v56, v57, v58
    v_max_u32 v180, v180, v59
    v_cmp_eq_u32 vcc, -1, v180
    s_cbranch_vccz L_e4s6
    s_add_u32 s34, s81, 14155776
    buffer_load_dwordx4 v[56:59], v210, s[24:27], s34 offen sc1
L_e4s6:
    v_max3_u32 v180, v60, v61, v62
    v_max_u32 v180, v180, v63
    v_cmp_eq_u32 vcc, -1, v180
    s_cbranch_vccz L_e4s7
    s_add_u32 s34, s81, 16515072
    buffer_load_dwordx4 v[60:63], v210, s[24:27], s34 offen sc1
L_e4s7:
    s_waitcnt vmcnt(0)
    s_add_u32 s36, s36, 1
    s_cmp_lt_u32 s36, 0x8000
    s_cbranch_scc1 L_e4chk
L_e4ok:
    v_mfma_f32_16x16x32_bf16 v[176:179], v[104:107], v[32:35], 0
    v_mfma_f32_16x16x32_bf16 v[176:179], v[104:107], v[36:39], v[176:179]
    v_mfma_f32_16x16x32_bf16 v[176:179], v[104:107], v[40:43], v[176:179]
    v_mfma_f32_16x16x32_bf16 v[176:179], v[104:107], v[44:47], v[176:179]
    v_mfma_f32_16x16x32_bf16 v[176:179], v[104:107], v[48:51], v[176:179]
    v_mfma_f32_16x16x32_bf16 v[176:179], v[104:107], v[52:55], v[176:179]
    v_mfma_f32_16x16x32_bf16 v[176:179], v[104:107], v[56:59], v[176:179]
    v_mfma_f32_16x16x32_bf16 v[176:179], v[104:107], v[60:63], v[176:179]
    v_mul_f32 v0, 0xbfb8aa3b, v160
    v_mul_f32 v1, 0xbfb8aa3b, v161
    v_mul_f32 v2, 0xbfb8aa3b, v162
    v_mul_f32 v3, 0xbfb8aa3b, v163
    v_mul_f32 v4, 0xbfb8aa3b, v164
    v_mul_f32 v5, 0xbfb8aa3b, v165
    v_mul_f32 v6, 0xbfb8aa3b, v166
    v_mul_f32 v7, 0xbfb8aa3b, v167
    v_mul_f32 v8, 0xbfb8aa3b, v176
    v_mul_f32 v9, 0xbfb8aa3b, v177
    v_mul_f32 v10, 0xbfb8aa3b, v178
    v_mul_f32 v11, 0xbfb8aa3b, v179
    v_exp_f32 v0, v0
    v_exp_f32 v1, v1
    v_exp_f32 v2, v2
    v_exp_f32 v3, v3
    v_exp_f32 v4, v4
    v_exp_f32 v5, v5
    v_exp_f32 v6, v6
    v_exp_f32 v7, v7
    v_exp_f32 v8, v8
    v_exp_f32 v9, v9
    v_exp_f32 v10, v10
    v_exp_f32 v11, v11
    v_add_f32 v0, 1.0, v0
    v_add_f32 v1, 1.0, v1
    v_add_f32 v2, 1.0, v2
    v_add_f32 v3, 1.0, v3
    v_add_f32 v4, 1.0, v4
    v_add_f32 v5, 1.0, v5
    v_add_f32 v6, 1.0, v6
    v_add_f32 v7, 1.0, v7
    v_add_f32 v8, 1.0, v8
    v_add_f32 v9, 1.0, v9
    v_add_f32 v10, 1.0, v10
    v_add_f32 v11, 1.0, v11
    v_rcp_f32 v0, v0
    v_rcp_f32 v1, v1
    v_rcp_f32 v2, v2
    v_rcp_f32 v3, v3
    v_rcp_f32 v4, v4
    v_rcp_f32 v5, v5
    v_rcp_f32 v6, v6
    v_rcp_f32 v7, v7
    v_rcp_f32 v8, v8
    v_rcp_f32 v9, v9
    v_rcp_f32 v10, v10
    v_rcp_f32 v11, v11
    v_mul_f32 v160, v160, v0
    v_mul_f32 v161, v161, v1
    v_mul_f32 v162, v162, v2
    v_mul_f32 v163, v163, v3
    v_mul_f32 v164, v164, v4
    v_mul_f32 v165, v165, v5
    v_mul_f32 v166, v166, v6
    v_mul_f32 v167, v167, v7
    v_mul_f32 v176, v176, v8
    v_mul_f32 v177, v177, v9
    v_mul_f32 v178, v178, v10
    v_mul_f32 v179, v179, v11
    v_lshlrev_b32 v0, 16, v64
    v_and_b32 v1, 0xffff0000, v64
    v_fma_f32 v0, v160, v224, v0
    v_fma_f32 v1, v161, v225, v1
    v_cvt_pk_bf16_f32 v64, v0, v1
    v_lshlrev_b32 v2, 16, v65
    v_and_b32 v3, 0xffff0000, v65
    v_fma_f32 v2, v162, v226, v2
    v_fma_f32 v3, v163, v227, v3
    v_cvt_pk_bf16_f32 v65, v2, v3
    v_lshlrev_b32 v4, 16, v66
    v_and_b32 v5, 0xffff0000, v66
    v_fma_f32 v4, v164, v228, v4
    v_fma_f32 v5, v165, v229, v5
    v_cvt_pk_bf16_f32 v66, v4, v5
    v_lshlrev_b32 v6, 16, v67
    v_and_b32 v7, 0xffff0000, v67
    v_fma_f32 v6, v166, v230, v6
    v_fma_f32 v7, v167, v231, v7
    v_cvt_pk_bf16_f32 v67, v6, v7
    v_lshlrev_b32 v0, 16, v126
    v_and_b32 v1, 0xffff0000, v126
    v_fma_f32 v0, v176, v240, v0
    v_fma_f32 v1, v177, v241, v1
    v_cvt_pk_bf16_f32 v126, v0, v1
    v_lshlrev_b32 v2, 16, v127
    v_and_b32 v3, 0xffff0000, v127
    v_fma_f32 v2, v178, v242, v2
    v_fma_f32 v3, v179, v243, v3
    v_cvt_pk_bf16_f32 v127, v2, v3
    v_permlane16_swap_b32 v64, v66
    v_permlane16_swap_b32 v65, v67
    buffer_store_dwordx4 v[64:67], v121, s[68:71], s46 offen
    buffer_store_dwordx2 v[126:127], v122, s[68:71], s59 offen
    s_mov_b32 s36, 0
L_lchk:
    s_waitcnt vmcnt(9)
    v_max3_u32 v180, v128, v129, v130
    s_waitcnt vmcnt(8)
    v_max3_u32 v181, v131, v132, v133
    v_max3_u32 v180, v180, v134, v135
    s_waitcnt vmcnt(7)
    v_max3_u32 v181, v181, v136, v137
    v_max3_u32 v180, v180, v138, v139
    s_waitcnt vmcnt(6)
    v_max3_u32 v181, v181, v140, v141
    v_max3_u32 v180, v180, v142, v143
    s_waitcnt vmcnt(5)
    v_max3_u32 v181, v181, v144, v145
    v_max3_u32 v180, v180, v146, v147
    s_waitcnt vmcnt(4)
    v_max3_u32 v181, v181, v148, v149
    v_max3_u32 v180, v180, v150, v151
    s_waitcnt vmcnt(3)
    v_max3_u32 v181, v181, v152, v153
    v_max3_u32 v180, v180, v154, v155
    s_waitcnt vmcnt(2)
    v_max3_u32 v181, v181, v156, v157
    v_max3_u32 v180, v180, v158, v159
    v_max_u32 v180, v180, v181
    v_cmp_eq_u32 vcc, -1, v180
    s_cbranch_vccz L_lok
    v_max3_u32 v180, v128, v129, v130
    v_max_u32 v180, v180, v131
    v_cmp_eq_u32 vcc, -1, v180
    s_cbranch_vccz L_ls0
    s_add_u32 s34, s80, 0
    buffer_load_dwordx4 v[128:131], v210, s[24:27], s34 offen sc1
L_ls0:
    v_max3_u32 v180, v132, v133, v134
    v_max_u32 v180, v180, v135
    v_cmp_eq_u32 vcc, -1, v180
    s_cbranch_vccz L_ls1
    s_add_u32 s34, s80, 2359296
    buffer_load_dwordx4 v[132:135], v210, s[24:27], s34 offen sc1
L_ls1:
    v_max3_u32 v180, v136, v137, v138
    v_max_u32 v180, v180, v139
    v_cmp_eq_u32 vcc, -1, v180
    s_cbranch_vccz L_ls2
    s_add_u32 s34, s80, 4718592
    buffer_load_dwordx4 v[136:139], v210, s[24:27], s34 offen sc1
L_ls2:
    v_max3_u32 v180, v140, v141, v142
    v_max_u32 v180, v180, v143
    v_cmp_eq_u32 vcc, -1, v180
    s_cbranch_vccz L_ls3
    s_add_u32 s34, s80, 7077888
    buffer_load_dwordx4 v[140:143], v210, s[24:27], s34 offen sc1
L_ls3:
    v_max3_u32 v180, v144, v145, v146
    v_max_u32 v180, v180, v147
    v_cmp_eq_u32 vcc, -1, v180
    s_cbranch_vccz L_ls4
    s_add_u32 s34, s80, 9437184
    buffer_load_dwordx4 v[144:147], v210, s[24:27], s34 offen sc1
L_ls4:
    v_max3_u32 v180, v148, v149, v150
    v_max_u32 v180, v180, v151
    v_cmp_eq_u32 vcc, -1, v180
    s_cbranch_vccz L_ls5
    s_add_u32 s34, s80, 11796480
    buffer_load_dwordx4 v[148:151], v210, s[24:27], s34 offen sc1
L_ls5:
    v_max3_u32 v180, v152, v153, v154
    v_max_u32 v180, v180, v155
    v_cmp_eq_u32 vcc, -1, v180
    s_cbranch_vccz L_ls6
    s_add_u32 s34, s80, 14155776
    buffer_load_dwordx4 v[152:155], v210, s[24:27], s34 offen sc1
L_ls6:
    v_max3_u32 v180, v156, v157, v158
    v_max_u32 v180, v180, v159
    v_cmp_eq_u32 vcc, -1, v180
    s_cbranch_vccz L_ls7
    s_add_u32 s34, s80, 16515072
    buffer_load_dwordx4 v[156:159], v210, s[24:27], s34 offen sc1
L_ls7:
    s_waitcnt vmcnt(0)
    s_add_u32 s36, s36, 1
    s_cmp_lt_u32 s36, 0x8000
    s_cbranch_scc1 L_lchk
L_lok:
    v_mfma_f32_16x16x32_bf16 v[168:171], v[96:99], v[128:131], 0
    v_mfma_f32_16x16x32_bf16 v[172:175], v[100:103], v[128:131], 0
    v_mfma_f32_16x16x32_bf16 v[168:171], v[96:99], v[132:135], v[168:171]
    v_mfma_f32_16x16x32_bf16 v[172:175], v[100:103], v[132:135], v[172:175]
    v_mfma_f32_16x16x32_bf16 v[168:171], v[96:99], v[136:139], v[168:171]
    v_mfma_f32_16x16x32_bf16 v[172:175], v[100:103], v[136:139], v[172:175]
    v_mfma_f32_16x16x32_bf16 v[168:171], v[96:99], v[140:143], v[168:171]
    v_mfma_f32_16x16x32_bf16 v[172:175], v[100:103], v[140:143], v[172:175]
    v_mfma_f32_16x16x32_bf16 v[168:171], v[96:99], v[144:147], v[168:171]
    v_mfma_f32_16x16x32_bf16 v[172:175], v[100:103], v[144:147], v[172:175]
    v_mfma_f32_16x16x32_bf16 v[168:171], v[96:99], v[148:151], v[168:171]
    v_mfma_f32_16x16x32_bf16 v[172:175], v[100:103], v[148:151], v[172:175]
    v_mfma_f32_16x16x32_bf16 v[168:171], v[96:99], v[152:155], v[168:171]
    v_mfma_f32_16x16x32_bf16 v[172:175], v[100:103], v[152:155], v[172:175]
    v_mfma_f32_16x16x32_bf16 v[168:171], v[96:99], v[156:159], v[168:171]
    v_mfma_f32_16x16x32_bf16 v[172:175], v[100:103], v[156:159], v[172:175]
    s_nop 6
    v_mul_f32 v32, 0xbfb8aa3b, v168
    v_mul_f32 v33, 0xbfb8aa3b, v169
    v_mul_f32 v34, 0xbfb8aa3b, v170
    v_mul_f32 v35, 0xbfb8aa3b, v171
    v_mul_f32 v36, 0xbfb8aa3b, v172
    v_mul_f32 v37, 0xbfb8aa3b, v173
    v_mul_f32 v38, 0xbfb8aa3b, v174
    v_mul_f32 v39, 0xbfb8aa3b, v175
    v_exp_f32 v32, v32
    v_exp_f32 v33, v33
    v_exp_f32 v34, v34
    v_exp_f32 v35, v35
    v_exp_f32 v36, v36
    v_exp_f32 v37, v37
    v_exp_f32 v38, v38
    v_exp_f32 v39, v39
    v_add_f32 v32, 1.0, v32
    v_add_f32 v33, 1.0, v33
    v_add_f32 v34, 1.0, v34
    v_add_f32 v35, 1.0, v35
    v_add_f32 v36, 1.0, v36
    v_add_f32 v37, 1.0, v37
    v_add_f32 v38, 1.0, v38
    v_add_f32 v39, 1.0, v39
    v_rcp_f32 v32, v32
    v_rcp_f32 v33, v33
    v_rcp_f32 v34, v34
    v_rcp_f32 v35, v35
    v_rcp_f32 v36, v36
    v_rcp_f32 v37, v37
    v_rcp_f32 v38, v38
    v_rcp_f32 v39, v39
    v_mul_f32 v168, v168, v32
    v_mul_f32 v169, v169, v33
    v_mul_f32 v170, v170, v34
    v_mul_f32 v171, v171, v35
    v_mul_f32 v172, v172, v36
    v_mul_f32 v173, v173, v37
    v_mul_f32 v174, v174, v38
    v_mul_f32 v175, v175, v39
    v_lshlrev_b32 v32, 16, v68
    v_and_b32 v33, 0xffff0000, v68
    v_fma_f32 v32, v168, v232, v32
    v_fma_f32 v33, v169, v233, v33
    v_cvt_pk_bf16_f32 v68, v32, v33
    v_lshlrev_b32 v34, 16, v69
    v_and_b32 v35, 0xffff0000, v69
    v_fma_f32 v34, v170, v234, v34
    v_fma_f32 v35, v171, v235, v35
    v_cvt_pk_bf16_f32 v69, v34, v35
    v_lshlrev_b32 v36, 16, v70
    v_and_b32 v37, 0xffff0000, v70
    v_fma_f32 v36, v172, v236, v36
    v_fma_f32 v37, v173, v237, v37
    v_cvt_pk_bf16_f32 v70, v36, v37
    v_lshlrev_b32 v38, 16, v71
    v_and_b32 v39, 0xffff0000, v71
    v_fma_f32 v38, v174, v238, v38
    v_fma_f32 v39, v175, v239, v39
    v_cvt_pk_bf16_f32 v71, v38, v39
    v_permlane16_swap_b32 v68, v70
    s_nop 0
    v_permlane16_swap_b32 v69, v71
    buffer_store_dwordx4 v[68:71], v121, s[68:71], s47 offen
L_end:
    s_endpgm
L_codeend:

.section .rodata,"a"
.p2align 6
.amdhsa_kernel recurrent_scan__softmax_full_mha__glu_gated_bilinear__prompt_kernel
  .amdhsa_next_free_vgpr 512
  .amdhsa_next_free_sgpr 100
  .amdhsa_accum_offset 256
  .amdhsa_group_segment_fixed_size 0
  .amdhsa_kernarg_size 80
  .amdhsa_user_sgpr_count 2
  .amdhsa_user_sgpr_kernarg_segment_ptr 1
  .amdhsa_system_sgpr_workgroup_id_x 1
.end_amdhsa_kernel
```
